```python
import torch

def _softmax(x, axis=-1):
    return torch.softmax(x, dim=axis)

def _gelu(x):
    return torch.nn.functional.gelu(x, approximate='tanh')

def _silu(x):
    return torch.nn.functional.silu(x)

def _sigmoid(x):
    return torch.sigmoid(x)

def _layernorm(x, axis=-1, eps=1e-05):
    m = x.mean(dim=axis, keepdim=True)
    v = x.var(dim=axis, keepdim=True, unbiased=False)
    return (x - m) / torch.sqrt(v + eps)

def _scatter_add(tgt, idx, src, axis=0):
    return tgt.clone().index_add_(axis, idx, src)

def _segment_sum(src, seg, n):
    out = torch.zeros((n,) + src.shape[1:], dtype=src.dtype)
    return out.index_add_(0, seg, src)

def _pad(x, pw):
    flat = tuple((v for pair in reversed(pw) for v in pair))
    return torch.nn.functional.pad(x, flat)
kernel_name = 'concat_heads__memory_aug_recurrent_mem_tr__ssm_conv_s5__prompt'

def setup_inputs():

    _w = lambda a: (lambda t: t.to(torch.bfloat16) if t.is_floating_point() else t)(torch.as_tensor(a))

    def _A_setup():
        B, S, Dm = (1, 2048, 512)
        H, Dh = (32, 128)
        M, seg = (8, 32)
        seg = min(seg, S)
        S = S // seg * seg
        return {'x': _w((lambda *s: torch.randn(*s, dtype=torch.bfloat16) * 0.05)(B, S, Dm)), 'mem0': _w((lambda *s: torch.randn(*s, dtype=torch.bfloat16) * 0.8)(B, M, Dm)), 'Wq': _w((lambda *s: torch.randn(*s, dtype=torch.bfloat16) * 1.6)(Dm, H, Dh) * Dm ** (-0.5)), 'Wk': _w((lambda *s: torch.randn(*s, dtype=torch.bfloat16) * 1.6)(Dm, H, Dh) * Dm ** (-0.5)), 'Wv': _w((lambda *s: torch.randn(*s, dtype=torch.bfloat16) * 0.8)(Dm, H, Dh) * Dm ** (-0.5)), 'Wo': _w((lambda *s: torch.randn(*s, dtype=torch.bfloat16) * 0.8)(H, Dh, Dm) * (H * Dh) ** (-0.5)), 'seg_len': seg}
    _A_in = _A_setup()

    def _B_setup():
        B, S, D = (1, 2048, 512)
        P = D
        Lambda_re = -0.5 * (lambda _x: torch.exp(torch.as_tensor(_x)))((lambda *s: torch.randn(*s, dtype=torch.bfloat16) * 0.8)(P))
        Lambda_im = (lambda *s: torch.randn(*s, dtype=torch.bfloat16) * 0.8)(P) * 1.0
        B_re = (lambda *s: torch.randn(*s, dtype=torch.bfloat16) * 0.8)(P, D) * D ** (-0.5)
        B_im = (lambda *s: torch.randn(*s, dtype=torch.bfloat16) * 0.8)(P, D) * D ** (-0.5)
        C_re = (lambda *s: torch.randn(*s, dtype=torch.bfloat16) * 0.8)(D, P) * P ** (-0.5)
        C_im = (lambda *s: torch.randn(*s, dtype=torch.bfloat16) * 0.8)(D, P) * P ** (-0.5)
        log_dt = (lambda *s: torch.randn(*s, dtype=torch.bfloat16) * 0.8)(P) * 0.3 - 2.0
        Dskip = (lambda *s: torch.randn(*s, dtype=torch.bfloat16) * 0.8)(D)
        return {'x': _w((lambda *s: torch.randn(*s, dtype=torch.bfloat16) * 0.05)(B, S, D)), 'Lambda_re': _w(Lambda_re), 'Lambda_im': _w(Lambda_im), 'B_re': _w(B_re), 'B_im': _w(B_im), 'C_re': _w(C_re), 'C_im': _w(C_im), 'log_dt': _w(log_dt), 'Dskip': _w(Dskip)}
    _B_in = _B_setup()
    return {'A_x': _A_in['x'], 'A_mem0': _A_in['mem0'], 'A_Wq': _A_in['Wq'], 'A_Wk': _A_in['Wk'], 'A_Wv': _A_in['Wv'], 'A_Wo': _A_in['Wo'], 'A_seg_len': _A_in['seg_len'], 'B_x': _B_in['x'], 'B_Lambda_re': _B_in['Lambda_re'], 'B_Lambda_im': _B_in['Lambda_im'], 'B_B_re': _B_in['B_re'], 'B_B_im': _B_in['B_im'], 'B_C_re': _B_in['C_re'], 'B_C_im': _B_in['C_im'], 'B_log_dt': _B_in['log_dt'], 'B_Dskip': _B_in['Dskip']}

def reference(A_x, A_mem0, A_Wq, A_Wk, A_Wv, A_Wo, A_seg_len, B_x, B_Lambda_re, B_Lambda_im, B_B_re, B_B_im, B_C_re, B_C_im, B_log_dt, B_Dskip):

    def _A_ref(x, mem0, Wq, Wk, Wv, Wo, seg_len):
        B, S, Dm = x.shape
        H, Dh = (Wq.shape[1], Wq.shape[2])
        M = mem0.shape[1]
        scale = Dh ** (-0.5)
        n_seg = S // seg_len
        L = M + seg_len
        idx = torch.arange(L)
        mask = (idx[:, None] < M) | (idx[:, None] >= idx[None, :])
        mem = mem0
        outs = []
        for s in range(n_seg):
            xs = x[:, s * seg_len:(s + 1) * seg_len, :].clone()
            h = torch.concatenate([mem, xs], axis=1)
            q = torch.einsum('btd,dhe->bhte', h, Wq)
            k = torch.einsum('btd,dhe->bhte', h, Wk)
            v = torch.einsum('btd,dhe->bhte', h, Wv)
            scores = torch.einsum('bhqe,bhke->bhqk', q, k) * scale
            scores = torch.where(mask[None, None], scores, -1000000000.0)
            p = _softmax(scores, axis=-1)
            o = torch.einsum('bhqk,bhke->bhqe', p, v)
            o = torch.einsum('bhte,hed->btd', o, Wo)
            mem = o[:, :M, :].clone()
            outs.append(o[:, M:, :])
        return torch.concatenate(outs, axis=1)

    def _B_ref(x, Lambda_re, Lambda_im, B_re, B_im, C_re, C_im, log_dt, Dskip):
        Bsz, L, H = x.shape
        Lam = Lambda_re + 1j * Lambda_im
        Bmat = B_re + 1j * B_im
        Cmat = C_re + 1j * C_im
        dt = torch.exp(log_dt)
        Lam_bar = torch.exp(dt * Lam)
        B_bar = ((Lam_bar - 1.0) / Lam)[:, None] * Bmat
        Bu = torch.einsum('bld,pd->blp', x + 0j, B_bar)
        h = torch.zeros_like(Bu[:, 0, :])
        hs = []
        for t in range(L):
            h = Lam_bar[None, :] * h + Bu[:, t, :]
            hs.append(h)
        hseq = torch.stack(hs, 1)
        y = 2.0 * torch.einsum('blp,dp->bld', hseq, Cmat).real + x * Dskip[None, None, :]
        return y
    a = _A_ref(A_x, A_mem0, A_Wq, A_Wk, A_Wv, A_Wo, A_seg_len)
    b = _B_ref(B_x, B_Lambda_re, B_Lambda_im, B_B_re, B_B_im, B_C_re, B_C_im, B_log_dt, B_Dskip)
    return torch.concatenate([a, b], axis=-1)
```

```asm
; @launch grid=(256,1,1) block=(256,1,1) lds=163840
.amdgcn_target "amdgcn-amd-amdhsa--gfx950"
.text
.globl concat_heads__memory_aug_recurrent_mem_tr__ssm_conv_s5__prompt_kernel
.p2align 8
.type concat_heads__memory_aug_recurrent_mem_tr__ssm_conv_s5__prompt_kernel,@function
concat_heads__memory_aug_recurrent_mem_tr__ssm_conv_s5__prompt_kernel:
s_cmp_ge_u32 s2, 256
s_cbranch_scc1 L_end
s_load_dwordx2 s[52:53], s[0:1], 136
s_getreg_b32 s3, hwreg(HW_REG_XCC_ID)
s_and_b32 s3, s3, 7
s_waitcnt lgkmcnt(0)
s_load_dwordx2 s[8:9], s[0:1], 144
s_waitcnt lgkmcnt(0)
s_and_b32 s9, s9, 0xffff
s_mov_b32 s10, 268435456
s_mov_b32 s11, 0x20000
v_lshrrev_b32 v1, 6, v0
s_nop 0
v_readfirstlane_b32 s17, v1
v_cmp_eq_u32 vcc, 0, v0
s_nop 0
s_and_saveexec_b64 s[48:49], vcc
s_cbranch_execz L_noticket
s_lshl_b32 s38, s3, 2
v_mov_b32 v1, s38
v_mov_b32 v2, 1
global_atomic_add v3, v1, v2, s[52:53] sc0
s_waitcnt vmcnt(0)
v_mov_b32 v1, 0
ds_write_b32 v1, v3
s_waitcnt lgkmcnt(0)
L_noticket:
s_mov_b64 exec, s[48:49]
s_barrier
v_mov_b32 v1, 0
ds_read_b32 v3, v1
s_waitcnt lgkmcnt(0)
v_readfirstlane_b32 s16, v3
s_barrier
s_cmp_lg_u32 s3, 0
s_cbranch_scc1 W_start
s_cmp_ge_u32 s16, 32
s_cbranch_scc1 L_end
v_and_b32 v24, 63, v0
v_lshlrev_b32 v1, 4, v24
s_lshl_b32 s38, s17, 11
v_add_u32 v2, s38, v1
v_lshrrev_b32 v0, 4, v24
v_mul_u32_u24 v3, 576, v0
v_bfe_u32 v0, v24, 1, 1
v_lshl_add_u32 v3, v0, 7, v3
v_bfe_u32 v0, v24, 2, 2
v_lshl_add_u32 v3, v0, 4, v3
v_and_b32 v0, 1, v24
v_lshl_add_u32 v3, v0, 3, v3
s_lshr_b32 s38, s17, 1
s_lshl_b32 s38, s38, 6
s_and_b32 s39, s17, 1
s_lshl_b32 s39, s39, 2
s_add_u32 s38, s38, s39
v_add_u32 v3, s38, v3
v_and_b32 v0, 7, v24
v_mul_u32_u24 v4, 288, v0
v_lshrrev_b32 v0, 4, v24
v_lshl_add_u32 v4, v0, 4, v4
s_add_u32 s39, s38, 29184
v_add_u32 v5, s39, v4
v_bfe_u32 v0, v24, 2, 2
v_lshlrev_b32 v0, 1, v0
v_and_b32 v6, 1, v24
v_add_u32 v0, v0, v6
v_mul_u32_u24 v6, 288, v0
v_lshrrev_b32 v0, 4, v24
v_lshl_add_u32 v6, v0, 4, v6
v_bfe_u32 v0, v24, 1, 1
v_lshl_add_u32 v6, v0, 7, v6
v_lshlrev_b32 v7, 2, v24
v_lshrrev_b32 v0, 4, v24
v_mul_u32_u24 v11, 2304, v0
v_and_b32 v0, 15, v24
v_lshl_add_u32 v11, v0, 4, v11
v_lshrrev_b32 v0, 4, v24
v_lshlrev_b32 v8, 6, v0
v_bfe_u32 v0, v24, 2, 1
v_lshl_add_u32 v8, v0, 5, v8
v_and_b32 v0, 1, v24
v_lshl_add_u32 v8, v0, 4, v8
v_bfe_u32 v0, v24, 1, 1
v_lshl_add_u32 v8, v0, 3, v8
s_lshl_b32 s38, s17, 15
s_add_u32 s38, s38, 32768
v_add_u32 v9, s38, v1
v_bfe_u32 v0, v24, 1, 1
v_mov_b32 v10, 0x44444444
v_cmp_eq_u32 vcc, 1, v0
v_mov_b32 v0, 0xeeeeeeee
s_nop 0
v_cndmask_b32 v10, v10, v0, vcc
v_and_b32 v0, 7, v24
v_mov_b32 v12, 0
v_cmp_eq_u32 vcc, 0, v0
v_mov_b32 v25, 0x3f80
s_nop 0
v_cndmask_b32 v12, v12, v25, vcc
v_cmp_eq_u32 vcc, 1, v0
v_mov_b32 v25, 0x3f800000
s_nop 0
v_cndmask_b32 v12, v12, v25, vcc
v_mov_b32 v13, 0
v_cmp_eq_u32 vcc, 2, v0
v_mov_b32 v25, 0x3f80
s_nop 0
v_cndmask_b32 v13, v13, v25, vcc
v_cmp_eq_u32 vcc, 3, v0
v_mov_b32 v25, 0x3f800000
s_nop 0
v_cndmask_b32 v13, v13, v25, vcc
v_mov_b32 v14, 0
v_cmp_eq_u32 vcc, 4, v0
v_mov_b32 v25, 0x3f80
s_nop 0
v_cndmask_b32 v14, v14, v25, vcc
v_cmp_eq_u32 vcc, 5, v0
v_mov_b32 v25, 0x3f800000
s_nop 0
v_cndmask_b32 v14, v14, v25, vcc
v_mov_b32 v15, 0
v_cmp_eq_u32 vcc, 6, v0
v_mov_b32 v25, 0x3f80
s_nop 0
v_cndmask_b32 v15, v15, v25, vcc
v_cmp_eq_u32 vcc, 7, v0
v_mov_b32 v25, 0x3f800000
s_nop 0
v_cndmask_b32 v15, v15, v25, vcc
s_mov_b32 s36, 0x3e0293ee
s_mov_b32 s24, 0x3f803f80
s_mov_b32 s25, 0x3f803f80
s_mov_b32 s37, 0x80000
s_mov_b32 s50, 0x05040100
s_mov_b32 s51, 0x07060302
s_mov_b32 s18, 0
s_mov_b32 s19, 80740352
s_lshl_b32 s38, s16, 8
s_add_u32 s21, s38, 80740352
s_add_u32 s20, s38, 80748544
s_add_u32 s46, s38, 81797120
s_mul_i32 s39, s17, 73728
s_mul_i32 s38, s16, 2304
s_add_u32 s39, s39, s38
s_add_u32 s22, s39, 83886080
s_lshl_b32 s38, s16, 13
s_add_u32 s28, s38, 0
s_add_u32 s29, s38, 16777216
s_add_u32 s54, s38, 524288
s_cmp_eq_u32 s17, 2
s_cselect_b32 s39, 0x1000000, 0
s_add_u32 s54, s54, s39
s_lshl_b32 s38, s16, 11
s_add_u32 s30, s38, 67305472
s_lshl_b32 s38, s16, 11
s_add_u32 s31, s38, 75825152
s_add_u32 s55, s38, 80019456
s_load_dwordx2 s[12:13], s[0:1], 24
s_load_dwordx2 s[60:61], s[0:1], 16
s_load_dwordx2 s[64:65], s[0:1], 32
s_load_dwordx2 s[68:69], s[0:1], 40
s_waitcnt lgkmcnt(0)
s_and_b32 s13, s13, 0xffff
s_mov_b32 s14, 4194304
s_mov_b32 s15, 0x20000
s_and_b32 s61, s61, 0xffff
s_mov_b32 s62, 4194304
s_mov_b32 s63, 0x20000
s_and_b32 s65, s65, 0xffff
s_mov_b32 s66, 4194304
s_mov_b32 s67, 0x20000
s_and_b32 s69, s69, 0xffff
s_mov_b32 s70, 4194304
s_mov_b32 s71, 0x20000
v_lshrrev_b32 v21, 4, v1
v_lshrrev_b32 v0, 3, v21
v_lshlrev_b32 v16, 13, v0
v_and_b32 v0, 7, v21
v_lshl_add_u32 v16, v0, 4, v16
s_lshr_b32 s42, s17, 1
s_and_b32 s43, s17, 1
s_xor_b32 s38, s42, 0
s_lshl_b32 s38, s38, 21
s_lshl_b32 s39, s43, 20
s_add_u32 s38, s38, s39
s_lshl_b32 s39, s16, 8
s_add_u32 s38, s38, s39
s_lshl_b32 s39, s42, 7
s_add_u32 s72, s38, s39
s_lshl_b32 s38, s42, 15
s_lshl_b32 s39, s43, 14
s_add_u32 s38, s38, s39
s_add_u32 s74, s38, 32768
s_xor_b32 s38, s42, 1
s_lshl_b32 s38, s38, 21
s_lshl_b32 s39, s43, 20
s_add_u32 s38, s38, s39
s_lshl_b32 s39, s16, 8
s_add_u32 s38, s38, s39
s_lshl_b32 s39, s42, 7
s_add_u32 s73, s38, s39
s_lshl_b32 s38, s42, 15
s_lshl_b32 s39, s43, 14
s_add_u32 s38, s38, s39
s_add_u32 s75, s38, 98304
v_bfe_u32 v0, v21, 4, 1
v_lshlrev_b32 v0, 3, v0
v_lshrrev_b32 v17, 5, v21
v_add_u32 v0, v0, v17
v_lshlrev_b32 v0, 7, v0
v_and_b32 v17, 15, v21
v_lshl_add_u32 v0, v17, 3, v0
s_lshl_b32 s38, s42, 15
s_lshl_b32 s39, s43, 2
s_add_u32 s38, s38, s39
s_add_u32 s38, s38, 32768
v_add_u32 v0, s38, v0
s_xor_b32 s38, s43, 0
s_lshl_b32 s38, s38, 14
s_add_u32 s38, s38, 0
v_add_u32 v17, s38, v0
s_xor_b32 s38, s43, 1
s_lshl_b32 s38, s38, 14
s_add_u32 s38, s38, 0
v_add_u32 v18, s38, v0
s_xor_b32 s38, s43, 0
s_lshl_b32 s38, s38, 14
s_add_u32 s38, s38, 65536
v_add_u32 v19, s38, v0
s_xor_b32 s38, s43, 1
s_lshl_b32 s38, s38, 14
s_add_u32 s38, s38, 65536
v_add_u32 v20, s38, v0
v_lshrrev_b32 v0, 4, v21
v_lshlrev_b32 v53, 10, v0
v_and_b32 v0, 15, v21
v_lshl_add_u32 v53, v0, 4, v53
s_lshl_b32 s39, s16, 17
s_lshl_b32 s38, s17, 8
s_add_u32 s76, s39, s38
s_lshl_b32 s38, s17, 15
s_add_u32 s77, s38, 32768
s_cmp_lg_u32 s17, 0
s_cbranch_scc1 C_noinit
s_cmp_lg_u32 s16, 0
s_cbranch_scc1 C_nononce
s_memrealtime s[48:49]
s_waitcnt lgkmcnt(0)
s_or_b32 s38, s48, 1
v_mov_b32 v0, 64
v_mov_b32 v24, s38
global_store_dword v0, v24, s[52:53] sc1
C_nononce:
s_lshr_b32 s38, s16, 3
s_mul_i32 s38, s38, 73728
s_and_b32 s39, s16, 7
s_lshl_b32 s39, s39, 8
s_add_u32 s38, s38, s39
s_add_u32 s84, s38, 83886080
s_add_u32 s85, s38, 83895296
s_add_u32 s86, s38, 83904512
s_add_u32 s87, s38, 83913728
s_add_u32 s88, s38, 83922944
s_add_u32 s89, s38, 83932160
s_add_u32 s90, s38, 83941376
s_add_u32 s91, s38, 83950592
v_mov_b32 v36, -1
v_mov_b32 v37, -1
v_mov_b32 v38, -1
v_mov_b32 v39, -1
s_add_u32 s38, s84, 0
buffer_store_dwordx4 v[36:39], v11, s[8:11], s38 offen
s_add_u32 s38, s85, 0
buffer_store_dwordx4 v[36:39], v11, s[8:11], s38 offen
s_add_u32 s38, s86, 0
buffer_store_dwordx4 v[36:39], v11, s[8:11], s38 offen
s_add_u32 s38, s87, 0
buffer_store_dwordx4 v[36:39], v11, s[8:11], s38 offen
s_add_u32 s38, s88, 0
buffer_store_dwordx4 v[36:39], v11, s[8:11], s38 offen
s_add_u32 s38, s89, 0
buffer_store_dwordx4 v[36:39], v11, s[8:11], s38 offen
s_add_u32 s38, s90, 0
buffer_store_dwordx4 v[36:39], v11, s[8:11], s38 offen
s_add_u32 s38, s91, 0
buffer_store_dwordx4 v[36:39], v11, s[8:11], s38 offen
s_add_u32 s38, s84, 524288
buffer_store_dwordx4 v[36:39], v11, s[8:11], s38 offen
s_add_u32 s38, s85, 524288
buffer_store_dwordx4 v[36:39], v11, s[8:11], s38 offen
s_add_u32 s38, s86, 524288
buffer_store_dwordx4 v[36:39], v11, s[8:11], s38 offen
s_add_u32 s38, s87, 524288
buffer_store_dwordx4 v[36:39], v11, s[8:11], s38 offen
s_add_u32 s38, s88, 524288
buffer_store_dwordx4 v[36:39], v11, s[8:11], s38 offen
s_add_u32 s38, s89, 524288
buffer_store_dwordx4 v[36:39], v11, s[8:11], s38 offen
s_add_u32 s38, s90, 524288
buffer_store_dwordx4 v[36:39], v11, s[8:11], s38 offen
s_add_u32 s38, s91, 524288
buffer_store_dwordx4 v[36:39], v11, s[8:11], s38 offen
s_add_u32 s38, s84, 1048576
buffer_store_dwordx4 v[36:39], v11, s[8:11], s38 offen
s_add_u32 s38, s85, 1048576
buffer_store_dwordx4 v[36:39], v11, s[8:11], s38 offen
s_add_u32 s38, s86, 1048576
buffer_store_dwordx4 v[36:39], v11, s[8:11], s38 offen
s_add_u32 s38, s87, 1048576
buffer_store_dwordx4 v[36:39], v11, s[8:11], s38 offen
s_add_u32 s38, s88, 1048576
buffer_store_dwordx4 v[36:39], v11, s[8:11], s38 offen
s_add_u32 s38, s89, 1048576
buffer_store_dwordx4 v[36:39], v11, s[8:11], s38 offen
s_add_u32 s38, s90, 1048576
buffer_store_dwordx4 v[36:39], v11, s[8:11], s38 offen
s_add_u32 s38, s91, 1048576
buffer_store_dwordx4 v[36:39], v11, s[8:11], s38 offen
s_add_u32 s38, s84, 1572864
buffer_store_dwordx4 v[36:39], v11, s[8:11], s38 offen
s_add_u32 s38, s85, 1572864
buffer_store_dwordx4 v[36:39], v11, s[8:11], s38 offen
s_add_u32 s38, s86, 1572864
buffer_store_dwordx4 v[36:39], v11, s[8:11], s38 offen
s_add_u32 s38, s87, 1572864
buffer_store_dwordx4 v[36:39], v11, s[8:11], s38 offen
s_add_u32 s38, s88, 1572864
buffer_store_dwordx4 v[36:39], v11, s[8:11], s38 offen
s_add_u32 s38, s89, 1572864
buffer_store_dwordx4 v[36:39], v11, s[8:11], s38 offen
s_add_u32 s38, s90, 1572864
buffer_store_dwordx4 v[36:39], v11, s[8:11], s38 offen
s_add_u32 s38, s91, 1572864
buffer_store_dwordx4 v[36:39], v11, s[8:11], s38 offen
buffer_store_dwordx2 v[36:37], v8, s[8:11], s21 offen
buffer_store_dwordx2 v[36:37], v8, s[8:11], s20 offen
s_waitcnt vmcnt(0)
v_mov_b32 v0, 32
v_mov_b32 v54, 1
s_mov_b64 exec, 1
global_atomic_add v0, v54, s[52:53]
s_mov_b64 exec, -1
C_noinit:
s_add_u32 m0, s74, 0
s_add_u32 s38, s72, 0
buffer_load_dwordx4 v16, s[60:63], s38 offen nt lds
s_add_u32 m0, s74, 1024
s_add_u32 s38, s72, 65536
buffer_load_dwordx4 v16, s[60:63], s38 offen nt lds
s_add_u32 m0, s74, 2048
s_add_u32 s38, s72, 131072
buffer_load_dwordx4 v16, s[60:63], s38 offen nt lds
s_add_u32 m0, s74, 3072
s_add_u32 s38, s72, 196608
buffer_load_dwordx4 v16, s[60:63], s38 offen nt lds
s_add_u32 m0, s74, 4096
s_add_u32 s38, s72, 262144
buffer_load_dwordx4 v16, s[60:63], s38 offen nt lds
s_add_u32 m0, s74, 5120
s_add_u32 s38, s72, 327680
buffer_load_dwordx4 v16, s[60:63], s38 offen nt lds
s_add_u32 m0, s74, 6144
s_add_u32 s38, s72, 393216
buffer_load_dwordx4 v16, s[60:63], s38 offen nt lds
s_add_u32 m0, s74, 7168
s_add_u32 s38, s72, 458752
buffer_load_dwordx4 v16, s[60:63], s38 offen nt lds
s_add_u32 m0, s74, 8192
s_add_u32 s38, s72, 524288
buffer_load_dwordx4 v16, s[60:63], s38 offen nt lds
s_add_u32 m0, s74, 9216
s_add_u32 s38, s72, 589824
buffer_load_dwordx4 v16, s[60:63], s38 offen nt lds
s_add_u32 m0, s74, 10240
s_add_u32 s38, s72, 655360
buffer_load_dwordx4 v16, s[60:63], s38 offen nt lds
s_add_u32 m0, s74, 11264
s_add_u32 s38, s72, 720896
buffer_load_dwordx4 v16, s[60:63], s38 offen nt lds
s_add_u32 m0, s74, 12288
s_add_u32 s38, s72, 786432
buffer_load_dwordx4 v16, s[60:63], s38 offen nt lds
s_add_u32 m0, s74, 13312
s_add_u32 s38, s72, 851968
buffer_load_dwordx4 v16, s[60:63], s38 offen nt lds
s_add_u32 m0, s74, 14336
s_add_u32 s38, s72, 917504
buffer_load_dwordx4 v16, s[60:63], s38 offen nt lds
s_add_u32 m0, s74, 15360
s_add_u32 s38, s72, 983040
buffer_load_dwordx4 v16, s[60:63], s38 offen nt lds
s_add_u32 m0, s75, 0
s_add_u32 s38, s73, 0
buffer_load_dwordx4 v16, s[60:63], s38 offen nt lds
s_add_u32 m0, s75, 1024
s_add_u32 s38, s73, 65536
buffer_load_dwordx4 v16, s[60:63], s38 offen nt lds
s_add_u32 m0, s75, 2048
s_add_u32 s38, s73, 131072
buffer_load_dwordx4 v16, s[60:63], s38 offen nt lds
s_add_u32 m0, s75, 3072
s_add_u32 s38, s73, 196608
buffer_load_dwordx4 v16, s[60:63], s38 offen nt lds
s_add_u32 m0, s75, 4096
s_add_u32 s38, s73, 262144
buffer_load_dwordx4 v16, s[60:63], s38 offen nt lds
s_add_u32 m0, s75, 5120
s_add_u32 s38, s73, 327680
buffer_load_dwordx4 v16, s[60:63], s38 offen nt lds
s_add_u32 m0, s75, 6144
s_add_u32 s38, s73, 393216
buffer_load_dwordx4 v16, s[60:63], s38 offen nt lds
s_add_u32 m0, s75, 7168
s_add_u32 s38, s73, 458752
buffer_load_dwordx4 v16, s[60:63], s38 offen nt lds
s_add_u32 m0, s75, 8192
s_add_u32 s38, s73, 524288
buffer_load_dwordx4 v16, s[60:63], s38 offen nt lds
s_add_u32 m0, s75, 9216
s_add_u32 s38, s73, 589824
buffer_load_dwordx4 v16, s[60:63], s38 offen nt lds
s_add_u32 m0, s75, 10240
s_add_u32 s38, s73, 655360
buffer_load_dwordx4 v16, s[60:63], s38 offen nt lds
s_add_u32 m0, s75, 11264
s_add_u32 s38, s73, 720896
buffer_load_dwordx4 v16, s[60:63], s38 offen nt lds
s_add_u32 m0, s75, 12288
s_add_u32 s38, s73, 786432
buffer_load_dwordx4 v16, s[60:63], s38 offen nt lds
s_add_u32 m0, s75, 13312
s_add_u32 s38, s73, 851968
buffer_load_dwordx4 v16, s[60:63], s38 offen nt lds
s_add_u32 m0, s75, 14336
s_add_u32 s38, s73, 917504
buffer_load_dwordx4 v16, s[60:63], s38 offen nt lds
s_add_u32 m0, s75, 15360
s_add_u32 s38, s73, 983040
buffer_load_dwordx4 v16, s[60:63], s38 offen nt lds
    s_getpc_b64 s[80:81]
C_vicw_pc:
    s_cmp_eq_u32 s17, 0
    s_cselect_b32 s82, C0_step-C_vicw_pc, s82
    s_cmp_eq_u32 s17, 1
    s_cselect_b32 s82, C1_step-C_vicw_pc, s82
    s_cmp_eq_u32 s17, 2
    s_cselect_b32 s82, C2_step-C_vicw_pc, s82
    s_cmp_eq_u32 s17, 3
    s_cselect_b32 s82, C3_step-C_vicw_pc, s82
    s_add_u32 s80, s80, s82
    s_addc_u32 s81, s81, 0
v_lshlrev_b32 v54, 2, v1
global_load_dword v55, v54, s[80:81]
s_waitcnt vmcnt(16)
s_barrier
ds_read_b32 v24, v17 offset:0
ds_read_b32 v25, v17 offset:4096
ds_read_b32 v26, v17 offset:2048
ds_read_b32 v27, v17 offset:6144
ds_read_b32 v28, v17 offset:8192
ds_read_b32 v29, v17 offset:12288
ds_read_b32 v30, v17 offset:10240
ds_read_b32 v31, v17 offset:14336
ds_read_b32 v32, v17 offset:256
ds_read_b32 v33, v17 offset:4352
s_waitcnt lgkmcnt(8)
v_perm_b32 v22, v25, v24, s50
v_accvgpr_write_b32 a0, v22
v_perm_b32 v23, v25, v24, s51
v_accvgpr_write_b32 a8, v23
ds_read_b32 v34, v17 offset:2304
ds_read_b32 v35, v17 offset:6400
s_waitcnt lgkmcnt(8)
v_perm_b32 v22, v27, v26, s50
v_accvgpr_write_b32 a1, v22
v_perm_b32 v23, v27, v26, s51
v_accvgpr_write_b32 a9, v23
ds_read_b32 v24, v17 offset:8448
ds_read_b32 v25, v17 offset:12544
s_waitcnt lgkmcnt(8)
v_perm_b32 v22, v29, v28, s50
v_accvgpr_write_b32 a2, v22
v_perm_b32 v23, v29, v28, s51
v_accvgpr_write_b32 a10, v23
ds_read_b32 v26, v17 offset:10496
ds_read_b32 v27, v17 offset:14592
s_waitcnt lgkmcnt(8)
v_perm_b32 v22, v31, v30, s50
v_accvgpr_write_b32 a3, v22
v_perm_b32 v23, v31, v30, s51
v_accvgpr_write_b32 a11, v23
ds_read_b32 v28, v17 offset:512
ds_read_b32 v29, v17 offset:4608
s_waitcnt lgkmcnt(8)
v_perm_b32 v22, v33, v32, s50
v_accvgpr_write_b32 a4, v22
v_perm_b32 v23, v33, v32, s51
v_accvgpr_write_b32 a12, v23
ds_read_b32 v30, v17 offset:2560
ds_read_b32 v31, v17 offset:6656
s_waitcnt lgkmcnt(8)
v_perm_b32 v22, v35, v34, s50
v_accvgpr_write_b32 a5, v22
v_perm_b32 v23, v35, v34, s51
v_accvgpr_write_b32 a13, v23
ds_read_b32 v32, v17 offset:8704
ds_read_b32 v33, v17 offset:12800
s_waitcnt lgkmcnt(8)
v_perm_b32 v22, v25, v24, s50
v_accvgpr_write_b32 a6, v22
v_perm_b32 v23, v25, v24, s51
v_accvgpr_write_b32 a14, v23
ds_read_b32 v34, v17 offset:10752
ds_read_b32 v35, v17 offset:14848
s_waitcnt lgkmcnt(8)
v_perm_b32 v22, v27, v26, s50
v_accvgpr_write_b32 a7, v22
v_perm_b32 v23, v27, v26, s51
v_accvgpr_write_b32 a15, v23
ds_read_b32 v24, v17 offset:768
ds_read_b32 v25, v17 offset:4864
s_waitcnt lgkmcnt(8)
v_perm_b32 v22, v29, v28, s50
v_accvgpr_write_b32 a16, v22
v_perm_b32 v23, v29, v28, s51
v_accvgpr_write_b32 a24, v23
ds_read_b32 v26, v17 offset:2816
ds_read_b32 v27, v17 offset:6912
s_waitcnt lgkmcnt(8)
v_perm_b32 v22, v31, v30, s50
v_accvgpr_write_b32 a17, v22
v_perm_b32 v23, v31, v30, s51
v_accvgpr_write_b32 a25, v23
ds_read_b32 v28, v17 offset:8960
ds_read_b32 v29, v17 offset:13056
s_waitcnt lgkmcnt(8)
v_perm_b32 v22, v33, v32, s50
v_accvgpr_write_b32 a18, v22
v_perm_b32 v23, v33, v32, s51
v_accvgpr_write_b32 a26, v23
ds_read_b32 v30, v17 offset:11008
ds_read_b32 v31, v17 offset:15104
s_waitcnt lgkmcnt(8)
v_perm_b32 v22, v35, v34, s50
v_accvgpr_write_b32 a19, v22
v_perm_b32 v23, v35, v34, s51
v_accvgpr_write_b32 a27, v23
ds_read_b32 v32, v18 offset:0
ds_read_b32 v33, v18 offset:4096
s_waitcnt lgkmcnt(8)
v_perm_b32 v22, v25, v24, s50
v_accvgpr_write_b32 a20, v22
v_perm_b32 v23, v25, v24, s51
v_accvgpr_write_b32 a28, v23
ds_read_b32 v34, v18 offset:2048
ds_read_b32 v35, v18 offset:6144
s_waitcnt lgkmcnt(8)
v_perm_b32 v22, v27, v26, s50
v_accvgpr_write_b32 a21, v22
v_perm_b32 v23, v27, v26, s51
v_accvgpr_write_b32 a29, v23
ds_read_b32 v24, v18 offset:8192
ds_read_b32 v25, v18 offset:12288
s_waitcnt lgkmcnt(8)
v_perm_b32 v22, v29, v28, s50
v_accvgpr_write_b32 a22, v22
v_perm_b32 v23, v29, v28, s51
v_accvgpr_write_b32 a30, v23
ds_read_b32 v26, v18 offset:10240
ds_read_b32 v27, v18 offset:14336
s_waitcnt lgkmcnt(8)
v_perm_b32 v22, v31, v30, s50
v_accvgpr_write_b32 a23, v22
v_perm_b32 v23, v31, v30, s51
v_accvgpr_write_b32 a31, v23
ds_read_b32 v28, v18 offset:256
ds_read_b32 v29, v18 offset:4352
s_waitcnt lgkmcnt(8)
v_perm_b32 v22, v33, v32, s50
v_accvgpr_write_b32 a32, v22
v_perm_b32 v23, v33, v32, s51
v_accvgpr_write_b32 a40, v23
ds_read_b32 v30, v18 offset:2304
ds_read_b32 v31, v18 offset:6400
s_waitcnt lgkmcnt(8)
v_perm_b32 v22, v35, v34, s50
v_accvgpr_write_b32 a33, v22
v_perm_b32 v23, v35, v34, s51
v_accvgpr_write_b32 a41, v23
ds_read_b32 v32, v18 offset:8448
ds_read_b32 v33, v18 offset:12544
s_waitcnt lgkmcnt(8)
v_perm_b32 v22, v25, v24, s50
v_accvgpr_write_b32 a34, v22
v_perm_b32 v23, v25, v24, s51
v_accvgpr_write_b32 a42, v23
ds_read_b32 v34, v18 offset:10496
ds_read_b32 v35, v18 offset:14592
s_waitcnt lgkmcnt(8)
v_perm_b32 v22, v27, v26, s50
v_accvgpr_write_b32 a35, v22
v_perm_b32 v23, v27, v26, s51
v_accvgpr_write_b32 a43, v23
ds_read_b32 v24, v18 offset:512
ds_read_b32 v25, v18 offset:4608
s_waitcnt lgkmcnt(8)
v_perm_b32 v22, v29, v28, s50
v_accvgpr_write_b32 a36, v22
v_perm_b32 v23, v29, v28, s51
v_accvgpr_write_b32 a44, v23
ds_read_b32 v26, v18 offset:2560
ds_read_b32 v27, v18 offset:6656
s_waitcnt lgkmcnt(8)
v_perm_b32 v22, v31, v30, s50
v_accvgpr_write_b32 a37, v22
v_perm_b32 v23, v31, v30, s51
v_accvgpr_write_b32 a45, v23
ds_read_b32 v28, v18 offset:8704
ds_read_b32 v29, v18 offset:12800
s_waitcnt lgkmcnt(8)
v_perm_b32 v22, v33, v32, s50
v_accvgpr_write_b32 a38, v22
v_perm_b32 v23, v33, v32, s51
v_accvgpr_write_b32 a46, v23
ds_read_b32 v30, v18 offset:10752
ds_read_b32 v31, v18 offset:14848
s_waitcnt lgkmcnt(8)
v_perm_b32 v22, v35, v34, s50
v_accvgpr_write_b32 a39, v22
v_perm_b32 v23, v35, v34, s51
v_accvgpr_write_b32 a47, v23
ds_read_b32 v32, v18 offset:768
ds_read_b32 v33, v18 offset:4864
s_waitcnt lgkmcnt(8)
v_perm_b32 v22, v25, v24, s50
v_accvgpr_write_b32 a48, v22
v_perm_b32 v23, v25, v24, s51
v_accvgpr_write_b32 a56, v23
ds_read_b32 v34, v18 offset:2816
ds_read_b32 v35, v18 offset:6912
s_waitcnt lgkmcnt(8)
v_perm_b32 v22, v27, v26, s50
v_accvgpr_write_b32 a49, v22
v_perm_b32 v23, v27, v26, s51
v_accvgpr_write_b32 a57, v23
ds_read_b32 v24, v18 offset:8960
ds_read_b32 v25, v18 offset:13056
s_waitcnt lgkmcnt(8)
v_perm_b32 v22, v29, v28, s50
v_accvgpr_write_b32 a50, v22
v_perm_b32 v23, v29, v28, s51
v_accvgpr_write_b32 a58, v23
ds_read_b32 v26, v18 offset:11008
ds_read_b32 v27, v18 offset:15104
s_waitcnt lgkmcnt(8)
v_perm_b32 v22, v31, v30, s50
v_accvgpr_write_b32 a51, v22
v_perm_b32 v23, v31, v30, s51
v_accvgpr_write_b32 a59, v23
s_waitcnt lgkmcnt(6)
v_perm_b32 v22, v33, v32, s50
v_accvgpr_write_b32 a52, v22
v_perm_b32 v23, v33, v32, s51
v_accvgpr_write_b32 a60, v23
s_waitcnt lgkmcnt(4)
v_perm_b32 v22, v35, v34, s50
v_accvgpr_write_b32 a53, v22
v_perm_b32 v23, v35, v34, s51
v_accvgpr_write_b32 a61, v23
s_waitcnt lgkmcnt(2)
v_perm_b32 v22, v25, v24, s50
v_accvgpr_write_b32 a54, v22
v_perm_b32 v23, v25, v24, s51
v_accvgpr_write_b32 a62, v23
s_waitcnt lgkmcnt(0)
v_perm_b32 v22, v27, v26, s50
v_accvgpr_write_b32 a55, v22
v_perm_b32 v23, v27, v26, s51
v_accvgpr_write_b32 a63, v23
s_waitcnt lgkmcnt(0)
s_barrier
s_add_u32 m0, s74, 0
s_add_u32 s38, s72, 0
buffer_load_dwordx4 v16, s[64:67], s38 offen nt lds
s_add_u32 m0, s74, 1024
s_add_u32 s38, s72, 65536
buffer_load_dwordx4 v16, s[64:67], s38 offen nt lds
s_add_u32 m0, s74, 2048
s_add_u32 s38, s72, 131072
buffer_load_dwordx4 v16, s[64:67], s38 offen nt lds
s_add_u32 m0, s74, 3072
s_add_u32 s38, s72, 196608
buffer_load_dwordx4 v16, s[64:67], s38 offen nt lds
s_add_u32 m0, s74, 4096
s_add_u32 s38, s72, 262144
buffer_load_dwordx4 v16, s[64:67], s38 offen nt lds
s_add_u32 m0, s74, 5120
s_add_u32 s38, s72, 327680
buffer_load_dwordx4 v16, s[64:67], s38 offen nt lds
s_add_u32 m0, s74, 6144
s_add_u32 s38, s72, 393216
buffer_load_dwordx4 v16, s[64:67], s38 offen nt lds
s_add_u32 m0, s74, 7168
s_add_u32 s38, s72, 458752
buffer_load_dwordx4 v16, s[64:67], s38 offen nt lds
s_add_u32 m0, s74, 8192
s_add_u32 s38, s72, 524288
buffer_load_dwordx4 v16, s[64:67], s38 offen nt lds
s_add_u32 m0, s74, 9216
s_add_u32 s38, s72, 589824
buffer_load_dwordx4 v16, s[64:67], s38 offen nt lds
s_add_u32 m0, s74, 10240
s_add_u32 s38, s72, 655360
buffer_load_dwordx4 v16, s[64:67], s38 offen nt lds
s_add_u32 m0, s74, 11264
s_add_u32 s38, s72, 720896
buffer_load_dwordx4 v16, s[64:67], s38 offen nt lds
s_add_u32 m0, s74, 12288
s_add_u32 s38, s72, 786432
buffer_load_dwordx4 v16, s[64:67], s38 offen nt lds
s_add_u32 m0, s74, 13312
s_add_u32 s38, s72, 851968
buffer_load_dwordx4 v16, s[64:67], s38 offen nt lds
s_add_u32 m0, s74, 14336
s_add_u32 s38, s72, 917504
buffer_load_dwordx4 v16, s[64:67], s38 offen nt lds
s_add_u32 m0, s74, 15360
s_add_u32 s38, s72, 983040
buffer_load_dwordx4 v16, s[64:67], s38 offen nt lds
s_waitcnt vmcnt(16)
s_barrier
ds_read_b32 v24, v19 offset:0
ds_read_b32 v25, v19 offset:4096
ds_read_b32 v26, v19 offset:2048
ds_read_b32 v27, v19 offset:6144
ds_read_b32 v28, v19 offset:8192
ds_read_b32 v29, v19 offset:12288
ds_read_b32 v30, v19 offset:10240
ds_read_b32 v31, v19 offset:14336
ds_read_b32 v32, v19 offset:256
ds_read_b32 v33, v19 offset:4352
s_waitcnt lgkmcnt(8)
v_perm_b32 v22, v25, v24, s50
v_accvgpr_write_b32 a64, v22
v_perm_b32 v23, v25, v24, s51
v_accvgpr_write_b32 a72, v23
ds_read_b32 v34, v19 offset:2304
ds_read_b32 v35, v19 offset:6400
s_waitcnt lgkmcnt(8)
v_perm_b32 v22, v27, v26, s50
v_accvgpr_write_b32 a65, v22
v_perm_b32 v23, v27, v26, s51
v_accvgpr_write_b32 a73, v23
ds_read_b32 v24, v19 offset:8448
ds_read_b32 v25, v19 offset:12544
s_waitcnt lgkmcnt(8)
v_perm_b32 v22, v29, v28, s50
v_accvgpr_write_b32 a66, v22
v_perm_b32 v23, v29, v28, s51
v_accvgpr_write_b32 a74, v23
ds_read_b32 v26, v19 offset:10496
ds_read_b32 v27, v19 offset:14592
s_waitcnt lgkmcnt(8)
v_perm_b32 v22, v31, v30, s50
v_accvgpr_write_b32 a67, v22
v_perm_b32 v23, v31, v30, s51
v_accvgpr_write_b32 a75, v23
ds_read_b32 v28, v19 offset:512
ds_read_b32 v29, v19 offset:4608
s_waitcnt lgkmcnt(8)
v_perm_b32 v22, v33, v32, s50
v_accvgpr_write_b32 a68, v22
v_perm_b32 v23, v33, v32, s51
v_accvgpr_write_b32 a76, v23
ds_read_b32 v30, v19 offset:2560
ds_read_b32 v31, v19 offset:6656
s_waitcnt lgkmcnt(8)
v_perm_b32 v22, v35, v34, s50
v_accvgpr_write_b32 a69, v22
v_perm_b32 v23, v35, v34, s51
v_accvgpr_write_b32 a77, v23
ds_read_b32 v32, v19 offset:8704
ds_read_b32 v33, v19 offset:12800
s_waitcnt lgkmcnt(8)
v_perm_b32 v22, v25, v24, s50
v_accvgpr_write_b32 a70, v22
v_perm_b32 v23, v25, v24, s51
v_accvgpr_write_b32 a78, v23
ds_read_b32 v34, v19 offset:10752
ds_read_b32 v35, v19 offset:14848
s_waitcnt lgkmcnt(8)
v_perm_b32 v22, v27, v26, s50
v_accvgpr_write_b32 a71, v22
v_perm_b32 v23, v27, v26, s51
v_accvgpr_write_b32 a79, v23
ds_read_b32 v24, v19 offset:768
ds_read_b32 v25, v19 offset:4864
s_waitcnt lgkmcnt(8)
v_perm_b32 v22, v29, v28, s50
v_accvgpr_write_b32 a80, v22
v_perm_b32 v23, v29, v28, s51
v_accvgpr_write_b32 a88, v23
ds_read_b32 v26, v19 offset:2816
ds_read_b32 v27, v19 offset:6912
s_waitcnt lgkmcnt(8)
v_perm_b32 v22, v31, v30, s50
v_accvgpr_write_b32 a81, v22
v_perm_b32 v23, v31, v30, s51
v_accvgpr_write_b32 a89, v23
ds_read_b32 v28, v19 offset:8960
ds_read_b32 v29, v19 offset:13056
s_waitcnt lgkmcnt(8)
v_perm_b32 v22, v33, v32, s50
v_accvgpr_write_b32 a82, v22
v_perm_b32 v23, v33, v32, s51
v_accvgpr_write_b32 a90, v23
ds_read_b32 v30, v19 offset:11008
ds_read_b32 v31, v19 offset:15104
s_waitcnt lgkmcnt(8)
v_perm_b32 v22, v35, v34, s50
v_accvgpr_write_b32 a83, v22
v_perm_b32 v23, v35, v34, s51
v_accvgpr_write_b32 a91, v23
ds_read_b32 v32, v20 offset:0
ds_read_b32 v33, v20 offset:4096
s_waitcnt lgkmcnt(8)
v_perm_b32 v22, v25, v24, s50
v_accvgpr_write_b32 a84, v22
v_perm_b32 v23, v25, v24, s51
v_accvgpr_write_b32 a92, v23
ds_read_b32 v34, v20 offset:2048
ds_read_b32 v35, v20 offset:6144
s_waitcnt lgkmcnt(8)
v_perm_b32 v22, v27, v26, s50
v_accvgpr_write_b32 a85, v22
v_perm_b32 v23, v27, v26, s51
v_accvgpr_write_b32 a93, v23
ds_read_b32 v24, v20 offset:8192
ds_read_b32 v25, v20 offset:12288
s_waitcnt lgkmcnt(8)
v_perm_b32 v22, v29, v28, s50
v_accvgpr_write_b32 a86, v22
v_perm_b32 v23, v29, v28, s51
v_accvgpr_write_b32 a94, v23
ds_read_b32 v26, v20 offset:10240
ds_read_b32 v27, v20 offset:14336
s_waitcnt lgkmcnt(8)
v_perm_b32 v22, v31, v30, s50
v_accvgpr_write_b32 a87, v22
v_perm_b32 v23, v31, v30, s51
v_accvgpr_write_b32 a95, v23
ds_read_b32 v28, v20 offset:256
ds_read_b32 v29, v20 offset:4352
s_waitcnt lgkmcnt(8)
v_perm_b32 v22, v33, v32, s50
v_accvgpr_write_b32 a96, v22
v_perm_b32 v23, v33, v32, s51
v_accvgpr_write_b32 a104, v23
ds_read_b32 v30, v20 offset:2304
ds_read_b32 v31, v20 offset:6400
s_waitcnt lgkmcnt(8)
v_perm_b32 v22, v35, v34, s50
v_accvgpr_write_b32 a97, v22
v_perm_b32 v23, v35, v34, s51
v_accvgpr_write_b32 a105, v23
ds_read_b32 v32, v20 offset:8448
ds_read_b32 v33, v20 offset:12544
s_waitcnt lgkmcnt(8)
v_perm_b32 v22, v25, v24, s50
v_accvgpr_write_b32 a98, v22
v_perm_b32 v23, v25, v24, s51
v_accvgpr_write_b32 a106, v23
ds_read_b32 v34, v20 offset:10496
ds_read_b32 v35, v20 offset:14592
s_waitcnt lgkmcnt(8)
v_perm_b32 v22, v27, v26, s50
v_accvgpr_write_b32 a99, v22
v_perm_b32 v23, v27, v26, s51
v_accvgpr_write_b32 a107, v23
ds_read_b32 v24, v20 offset:512
ds_read_b32 v25, v20 offset:4608
s_waitcnt lgkmcnt(8)
v_perm_b32 v22, v29, v28, s50
v_accvgpr_write_b32 a100, v22
v_perm_b32 v23, v29, v28, s51
v_accvgpr_write_b32 a108, v23
ds_read_b32 v26, v20 offset:2560
ds_read_b32 v27, v20 offset:6656
s_waitcnt lgkmcnt(8)
v_perm_b32 v22, v31, v30, s50
v_accvgpr_write_b32 a101, v22
v_perm_b32 v23, v31, v30, s51
v_accvgpr_write_b32 a109, v23
ds_read_b32 v28, v20 offset:8704
ds_read_b32 v29, v20 offset:12800
s_waitcnt lgkmcnt(8)
v_perm_b32 v22, v33, v32, s50
v_accvgpr_write_b32 a102, v22
v_perm_b32 v23, v33, v32, s51
v_accvgpr_write_b32 a110, v23
ds_read_b32 v30, v20 offset:10752
ds_read_b32 v31, v20 offset:14848
s_waitcnt lgkmcnt(8)
v_perm_b32 v22, v35, v34, s50
v_accvgpr_write_b32 a103, v22
v_perm_b32 v23, v35, v34, s51
v_accvgpr_write_b32 a111, v23
ds_read_b32 v32, v20 offset:768
ds_read_b32 v33, v20 offset:4864
s_waitcnt lgkmcnt(8)
v_perm_b32 v22, v25, v24, s50
v_accvgpr_write_b32 a112, v22
v_perm_b32 v23, v25, v24, s51
v_accvgpr_write_b32 a120, v23
ds_read_b32 v34, v20 offset:2816
ds_read_b32 v35, v20 offset:6912
s_waitcnt lgkmcnt(8)
v_perm_b32 v22, v27, v26, s50
v_accvgpr_write_b32 a113, v22
v_perm_b32 v23, v27, v26, s51
v_accvgpr_write_b32 a121, v23
ds_read_b32 v24, v20 offset:8960
ds_read_b32 v25, v20 offset:13056
s_waitcnt lgkmcnt(8)
v_perm_b32 v22, v29, v28, s50
v_accvgpr_write_b32 a114, v22
v_perm_b32 v23, v29, v28, s51
v_accvgpr_write_b32 a122, v23
ds_read_b32 v26, v20 offset:11008
ds_read_b32 v27, v20 offset:15104
s_waitcnt lgkmcnt(8)
v_perm_b32 v22, v31, v30, s50
v_accvgpr_write_b32 a115, v22
v_perm_b32 v23, v31, v30, s51
v_accvgpr_write_b32 a123, v23
s_waitcnt lgkmcnt(6)
v_perm_b32 v22, v33, v32, s50
v_accvgpr_write_b32 a116, v22
v_perm_b32 v23, v33, v32, s51
v_accvgpr_write_b32 a124, v23
s_waitcnt lgkmcnt(4)
v_perm_b32 v22, v35, v34, s50
v_accvgpr_write_b32 a117, v22
v_perm_b32 v23, v35, v34, s51
v_accvgpr_write_b32 a125, v23
s_waitcnt lgkmcnt(2)
v_perm_b32 v22, v25, v24, s50
v_accvgpr_write_b32 a118, v22
v_perm_b32 v23, v25, v24, s51
v_accvgpr_write_b32 a126, v23
s_waitcnt lgkmcnt(0)
v_perm_b32 v22, v27, v26, s50
v_accvgpr_write_b32 a119, v22
v_perm_b32 v23, v27, v26, s51
v_accvgpr_write_b32 a127, v23
s_waitcnt lgkmcnt(0)
s_barrier
s_add_u32 m0, s75, 0
s_add_u32 s38, s73, 0
buffer_load_dwordx4 v16, s[64:67], s38 offen nt lds
s_add_u32 m0, s75, 1024
s_add_u32 s38, s73, 65536
buffer_load_dwordx4 v16, s[64:67], s38 offen nt lds
s_add_u32 m0, s75, 2048
s_add_u32 s38, s73, 131072
buffer_load_dwordx4 v16, s[64:67], s38 offen nt lds
s_add_u32 m0, s75, 3072
s_add_u32 s38, s73, 196608
buffer_load_dwordx4 v16, s[64:67], s38 offen nt lds
s_add_u32 m0, s75, 4096
s_add_u32 s38, s73, 262144
buffer_load_dwordx4 v16, s[64:67], s38 offen nt lds
s_add_u32 m0, s75, 5120
s_add_u32 s38, s73, 327680
buffer_load_dwordx4 v16, s[64:67], s38 offen nt lds
s_add_u32 m0, s75, 6144
s_add_u32 s38, s73, 393216
buffer_load_dwordx4 v16, s[64:67], s38 offen nt lds
s_add_u32 m0, s75, 7168
s_add_u32 s38, s73, 458752
buffer_load_dwordx4 v16, s[64:67], s38 offen nt lds
s_add_u32 m0, s75, 8192
s_add_u32 s38, s73, 524288
buffer_load_dwordx4 v16, s[64:67], s38 offen nt lds
s_add_u32 m0, s75, 9216
s_add_u32 s38, s73, 589824
buffer_load_dwordx4 v16, s[64:67], s38 offen nt lds
s_add_u32 m0, s75, 10240
s_add_u32 s38, s73, 655360
buffer_load_dwordx4 v16, s[64:67], s38 offen nt lds
s_add_u32 m0, s75, 11264
s_add_u32 s38, s73, 720896
buffer_load_dwordx4 v16, s[64:67], s38 offen nt lds
s_add_u32 m0, s75, 12288
s_add_u32 s38, s73, 786432
buffer_load_dwordx4 v16, s[64:67], s38 offen nt lds
s_add_u32 m0, s75, 13312
s_add_u32 s38, s73, 851968
buffer_load_dwordx4 v16, s[64:67], s38 offen nt lds
s_add_u32 m0, s75, 14336
s_add_u32 s38, s73, 917504
buffer_load_dwordx4 v16, s[64:67], s38 offen nt lds
s_add_u32 m0, s75, 15360
s_add_u32 s38, s73, 983040
buffer_load_dwordx4 v16, s[64:67], s38 offen nt lds
s_waitcnt vmcnt(16)
s_barrier
ds_read_b32 v24, v17 offset:0
ds_read_b32 v25, v17 offset:4096
ds_read_b32 v26, v17 offset:2048
ds_read_b32 v27, v17 offset:6144
ds_read_b32 v28, v17 offset:8192
ds_read_b32 v29, v17 offset:12288
ds_read_b32 v30, v17 offset:10240
ds_read_b32 v31, v17 offset:14336
ds_read_b32 v32, v17 offset:256
ds_read_b32 v33, v17 offset:4352
s_waitcnt lgkmcnt(8)
v_perm_b32 v22, v25, v24, s50
v_accvgpr_write_b32 a128, v22
v_perm_b32 v23, v25, v24, s51
v_accvgpr_write_b32 a136, v23
ds_read_b32 v34, v17 offset:2304
ds_read_b32 v35, v17 offset:6400
s_waitcnt lgkmcnt(8)
v_perm_b32 v22, v27, v26, s50
v_accvgpr_write_b32 a129, v22
v_perm_b32 v23, v27, v26, s51
v_accvgpr_write_b32 a137, v23
ds_read_b32 v24, v17 offset:8448
ds_read_b32 v25, v17 offset:12544
s_waitcnt lgkmcnt(8)
v_perm_b32 v22, v29, v28, s50
v_accvgpr_write_b32 a130, v22
v_perm_b32 v23, v29, v28, s51
v_accvgpr_write_b32 a138, v23
ds_read_b32 v26, v17 offset:10496
ds_read_b32 v27, v17 offset:14592
s_waitcnt lgkmcnt(8)
v_perm_b32 v22, v31, v30, s50
v_accvgpr_write_b32 a131, v22
v_perm_b32 v23, v31, v30, s51
v_accvgpr_write_b32 a139, v23
ds_read_b32 v28, v17 offset:512
ds_read_b32 v29, v17 offset:4608
s_waitcnt lgkmcnt(8)
v_perm_b32 v22, v33, v32, s50
v_accvgpr_write_b32 a132, v22
v_perm_b32 v23, v33, v32, s51
v_accvgpr_write_b32 a140, v23
ds_read_b32 v30, v17 offset:2560
ds_read_b32 v31, v17 offset:6656
s_waitcnt lgkmcnt(8)
v_perm_b32 v22, v35, v34, s50
v_accvgpr_write_b32 a133, v22
v_perm_b32 v23, v35, v34, s51
v_accvgpr_write_b32 a141, v23
ds_read_b32 v32, v17 offset:8704
ds_read_b32 v33, v17 offset:12800
s_waitcnt lgkmcnt(8)
v_perm_b32 v22, v25, v24, s50
v_accvgpr_write_b32 a134, v22
v_perm_b32 v23, v25, v24, s51
v_accvgpr_write_b32 a142, v23
ds_read_b32 v34, v17 offset:10752
ds_read_b32 v35, v17 offset:14848
s_waitcnt lgkmcnt(8)
v_perm_b32 v22, v27, v26, s50
v_accvgpr_write_b32 a135, v22
v_perm_b32 v23, v27, v26, s51
v_accvgpr_write_b32 a143, v23
ds_read_b32 v24, v17 offset:768
ds_read_b32 v25, v17 offset:4864
s_waitcnt lgkmcnt(8)
v_perm_b32 v22, v29, v28, s50
v_accvgpr_write_b32 a144, v22
v_perm_b32 v23, v29, v28, s51
v_accvgpr_write_b32 a152, v23
ds_read_b32 v26, v17 offset:2816
ds_read_b32 v27, v17 offset:6912
s_waitcnt lgkmcnt(8)
v_perm_b32 v22, v31, v30, s50
v_accvgpr_write_b32 a145, v22
v_perm_b32 v23, v31, v30, s51
v_accvgpr_write_b32 a153, v23
ds_read_b32 v28, v17 offset:8960
ds_read_b32 v29, v17 offset:13056
s_waitcnt lgkmcnt(8)
v_perm_b32 v22, v33, v32, s50
v_accvgpr_write_b32 a146, v22
v_perm_b32 v23, v33, v32, s51
v_accvgpr_write_b32 a154, v23
ds_read_b32 v30, v17 offset:11008
ds_read_b32 v31, v17 offset:15104
s_waitcnt lgkmcnt(8)
v_perm_b32 v22, v35, v34, s50
v_accvgpr_write_b32 a147, v22
v_perm_b32 v23, v35, v34, s51
v_accvgpr_write_b32 a155, v23
ds_read_b32 v32, v18 offset:0
ds_read_b32 v33, v18 offset:4096
s_waitcnt lgkmcnt(8)
v_perm_b32 v22, v25, v24, s50
v_accvgpr_write_b32 a148, v22
v_perm_b32 v23, v25, v24, s51
v_accvgpr_write_b32 a156, v23
ds_read_b32 v34, v18 offset:2048
ds_read_b32 v35, v18 offset:6144
s_waitcnt lgkmcnt(8)
v_perm_b32 v22, v27, v26, s50
v_accvgpr_write_b32 a149, v22
v_perm_b32 v23, v27, v26, s51
v_accvgpr_write_b32 a157, v23
ds_read_b32 v24, v18 offset:8192
ds_read_b32 v25, v18 offset:12288
s_waitcnt lgkmcnt(8)
v_perm_b32 v22, v29, v28, s50
v_accvgpr_write_b32 a150, v22
v_perm_b32 v23, v29, v28, s51
v_accvgpr_write_b32 a158, v23
ds_read_b32 v26, v18 offset:10240
ds_read_b32 v27, v18 offset:14336
s_waitcnt lgkmcnt(8)
v_perm_b32 v22, v31, v30, s50
v_accvgpr_write_b32 a151, v22
v_perm_b32 v23, v31, v30, s51
v_accvgpr_write_b32 a159, v23
ds_read_b32 v28, v18 offset:256
ds_read_b32 v29, v18 offset:4352
s_waitcnt lgkmcnt(8)
v_perm_b32 v22, v33, v32, s50
v_accvgpr_write_b32 a160, v22
v_perm_b32 v23, v33, v32, s51
v_accvgpr_write_b32 a168, v23
ds_read_b32 v30, v18 offset:2304
ds_read_b32 v31, v18 offset:6400
s_waitcnt lgkmcnt(8)
v_perm_b32 v22, v35, v34, s50
v_accvgpr_write_b32 a161, v22
v_perm_b32 v23, v35, v34, s51
v_accvgpr_write_b32 a169, v23
ds_read_b32 v32, v18 offset:8448
ds_read_b32 v33, v18 offset:12544
s_waitcnt lgkmcnt(8)
v_perm_b32 v22, v25, v24, s50
v_accvgpr_write_b32 a162, v22
v_perm_b32 v23, v25, v24, s51
v_accvgpr_write_b32 a170, v23
ds_read_b32 v34, v18 offset:10496
ds_read_b32 v35, v18 offset:14592
s_waitcnt lgkmcnt(8)
v_perm_b32 v22, v27, v26, s50
v_accvgpr_write_b32 a163, v22
v_perm_b32 v23, v27, v26, s51
v_accvgpr_write_b32 a171, v23
ds_read_b32 v24, v18 offset:512
ds_read_b32 v25, v18 offset:4608
s_waitcnt lgkmcnt(8)
v_perm_b32 v22, v29, v28, s50
v_accvgpr_write_b32 a164, v22
v_perm_b32 v23, v29, v28, s51
v_accvgpr_write_b32 a172, v23
ds_read_b32 v26, v18 offset:2560
ds_read_b32 v27, v18 offset:6656
s_waitcnt lgkmcnt(8)
v_perm_b32 v22, v31, v30, s50
v_accvgpr_write_b32 a165, v22
v_perm_b32 v23, v31, v30, s51
v_accvgpr_write_b32 a173, v23
ds_read_b32 v28, v18 offset:8704
ds_read_b32 v29, v18 offset:12800
s_waitcnt lgkmcnt(8)
v_perm_b32 v22, v33, v32, s50
v_accvgpr_write_b32 a166, v22
v_perm_b32 v23, v33, v32, s51
v_accvgpr_write_b32 a174, v23
ds_read_b32 v30, v18 offset:10752
ds_read_b32 v31, v18 offset:14848
s_waitcnt lgkmcnt(8)
v_perm_b32 v22, v35, v34, s50
v_accvgpr_write_b32 a167, v22
v_perm_b32 v23, v35, v34, s51
v_accvgpr_write_b32 a175, v23
ds_read_b32 v32, v18 offset:768
ds_read_b32 v33, v18 offset:4864
s_waitcnt lgkmcnt(8)
v_perm_b32 v22, v25, v24, s50
v_accvgpr_write_b32 a176, v22
v_perm_b32 v23, v25, v24, s51
v_accvgpr_write_b32 a184, v23
ds_read_b32 v34, v18 offset:2816
ds_read_b32 v35, v18 offset:6912
s_waitcnt lgkmcnt(8)
v_perm_b32 v22, v27, v26, s50
v_accvgpr_write_b32 a177, v22
v_perm_b32 v23, v27, v26, s51
v_accvgpr_write_b32 a185, v23
ds_read_b32 v24, v18 offset:8960
ds_read_b32 v25, v18 offset:13056
s_waitcnt lgkmcnt(8)
v_perm_b32 v22, v29, v28, s50
v_accvgpr_write_b32 a178, v22
v_perm_b32 v23, v29, v28, s51
v_accvgpr_write_b32 a186, v23
ds_read_b32 v26, v18 offset:11008
ds_read_b32 v27, v18 offset:15104
s_waitcnt lgkmcnt(8)
v_perm_b32 v22, v31, v30, s50
v_accvgpr_write_b32 a179, v22
v_perm_b32 v23, v31, v30, s51
v_accvgpr_write_b32 a187, v23
s_waitcnt lgkmcnt(6)
v_perm_b32 v22, v33, v32, s50
v_accvgpr_write_b32 a180, v22
v_perm_b32 v23, v33, v32, s51
v_accvgpr_write_b32 a188, v23
s_waitcnt lgkmcnt(4)
v_perm_b32 v22, v35, v34, s50
v_accvgpr_write_b32 a181, v22
v_perm_b32 v23, v35, v34, s51
v_accvgpr_write_b32 a189, v23
s_waitcnt lgkmcnt(2)
v_perm_b32 v22, v25, v24, s50
v_accvgpr_write_b32 a182, v22
v_perm_b32 v23, v25, v24, s51
v_accvgpr_write_b32 a190, v23
s_waitcnt lgkmcnt(0)
v_perm_b32 v22, v27, v26, s50
v_accvgpr_write_b32 a183, v22
v_perm_b32 v23, v27, v26, s51
v_accvgpr_write_b32 a191, v23
s_waitcnt lgkmcnt(0)
s_barrier
s_add_u32 m0, s74, 0
s_add_u32 s38, s72, 0
buffer_load_dwordx4 v16, s[12:15], s38 offen nt lds
s_add_u32 m0, s74, 1024
s_add_u32 s38, s72, 65536
buffer_load_dwordx4 v16, s[12:15], s38 offen nt lds
s_add_u32 m0, s74, 2048
s_add_u32 s38, s72, 131072
buffer_load_dwordx4 v16, s[12:15], s38 offen nt lds
s_add_u32 m0, s74, 3072
s_add_u32 s38, s72, 196608
buffer_load_dwordx4 v16, s[12:15], s38 offen nt lds
s_add_u32 m0, s74, 4096
s_add_u32 s38, s72, 262144
buffer_load_dwordx4 v16, s[12:15], s38 offen nt lds
s_add_u32 m0, s74, 5120
s_add_u32 s38, s72, 327680
buffer_load_dwordx4 v16, s[12:15], s38 offen nt lds
s_add_u32 m0, s74, 6144
s_add_u32 s38, s72, 393216
buffer_load_dwordx4 v16, s[12:15], s38 offen nt lds
s_add_u32 m0, s74, 7168
s_add_u32 s38, s72, 458752
buffer_load_dwordx4 v16, s[12:15], s38 offen nt lds
s_add_u32 m0, s74, 8192
s_add_u32 s38, s72, 524288
buffer_load_dwordx4 v16, s[12:15], s38 offen nt lds
s_add_u32 m0, s74, 9216
s_add_u32 s38, s72, 589824
buffer_load_dwordx4 v16, s[12:15], s38 offen nt lds
s_add_u32 m0, s74, 10240
s_add_u32 s38, s72, 655360
buffer_load_dwordx4 v16, s[12:15], s38 offen nt lds
s_add_u32 m0, s74, 11264
s_add_u32 s38, s72, 720896
buffer_load_dwordx4 v16, s[12:15], s38 offen nt lds
s_add_u32 m0, s74, 12288
s_add_u32 s38, s72, 786432
buffer_load_dwordx4 v16, s[12:15], s38 offen nt lds
s_add_u32 m0, s74, 13312
s_add_u32 s38, s72, 851968
buffer_load_dwordx4 v16, s[12:15], s38 offen nt lds
s_add_u32 m0, s74, 14336
s_add_u32 s38, s72, 917504
buffer_load_dwordx4 v16, s[12:15], s38 offen nt lds
s_add_u32 m0, s74, 15360
s_add_u32 s38, s72, 983040
buffer_load_dwordx4 v16, s[12:15], s38 offen nt lds
s_waitcnt vmcnt(16)
s_barrier
ds_read_b32 v24, v19 offset:0
ds_read_b32 v25, v19 offset:4096
ds_read_b32 v26, v19 offset:2048
ds_read_b32 v27, v19 offset:6144
ds_read_b32 v28, v19 offset:8192
ds_read_b32 v29, v19 offset:12288
ds_read_b32 v30, v19 offset:10240
ds_read_b32 v31, v19 offset:14336
ds_read_b32 v32, v19 offset:256
ds_read_b32 v33, v19 offset:4352
s_waitcnt lgkmcnt(8)
v_perm_b32 v22, v25, v24, s50
v_accvgpr_write_b32 a192, v22
v_perm_b32 v23, v25, v24, s51
v_accvgpr_write_b32 a200, v23
ds_read_b32 v34, v19 offset:2304
ds_read_b32 v35, v19 offset:6400
s_waitcnt lgkmcnt(8)
v_perm_b32 v22, v27, v26, s50
v_accvgpr_write_b32 a193, v22
v_perm_b32 v23, v27, v26, s51
v_accvgpr_write_b32 a201, v23
ds_read_b32 v24, v19 offset:8448
ds_read_b32 v25, v19 offset:12544
s_waitcnt lgkmcnt(8)
v_perm_b32 v22, v29, v28, s50
v_accvgpr_write_b32 a194, v22
v_perm_b32 v23, v29, v28, s51
v_accvgpr_write_b32 a202, v23
ds_read_b32 v26, v19 offset:10496
ds_read_b32 v27, v19 offset:14592
s_waitcnt lgkmcnt(8)
v_perm_b32 v22, v31, v30, s50
v_accvgpr_write_b32 a195, v22
v_perm_b32 v23, v31, v30, s51
v_accvgpr_write_b32 a203, v23
ds_read_b32 v28, v19 offset:512
ds_read_b32 v29, v19 offset:4608
s_waitcnt lgkmcnt(8)
v_perm_b32 v22, v33, v32, s50
v_accvgpr_write_b32 a196, v22
v_perm_b32 v23, v33, v32, s51
v_accvgpr_write_b32 a204, v23
ds_read_b32 v30, v19 offset:2560
ds_read_b32 v31, v19 offset:6656
s_waitcnt lgkmcnt(8)
v_perm_b32 v22, v35, v34, s50
v_accvgpr_write_b32 a197, v22
v_perm_b32 v23, v35, v34, s51
v_accvgpr_write_b32 a205, v23
ds_read_b32 v32, v19 offset:8704
ds_read_b32 v33, v19 offset:12800
s_waitcnt lgkmcnt(8)
v_perm_b32 v22, v25, v24, s50
v_accvgpr_write_b32 a198, v22
v_perm_b32 v23, v25, v24, s51
v_accvgpr_write_b32 a206, v23
ds_read_b32 v34, v19 offset:10752
ds_read_b32 v35, v19 offset:14848
s_waitcnt lgkmcnt(8)
v_perm_b32 v22, v27, v26, s50
v_accvgpr_write_b32 a199, v22
v_perm_b32 v23, v27, v26, s51
v_accvgpr_write_b32 a207, v23
ds_read_b32 v24, v19 offset:768
ds_read_b32 v25, v19 offset:4864
s_waitcnt lgkmcnt(8)
v_perm_b32 v22, v29, v28, s50
v_accvgpr_write_b32 a208, v22
v_perm_b32 v23, v29, v28, s51
v_accvgpr_write_b32 a216, v23
ds_read_b32 v26, v19 offset:2816
ds_read_b32 v27, v19 offset:6912
s_waitcnt lgkmcnt(8)
v_perm_b32 v22, v31, v30, s50
v_accvgpr_write_b32 a209, v22
v_perm_b32 v23, v31, v30, s51
v_accvgpr_write_b32 a217, v23
ds_read_b32 v28, v19 offset:8960
ds_read_b32 v29, v19 offset:13056
s_waitcnt lgkmcnt(8)
v_perm_b32 v22, v33, v32, s50
v_accvgpr_write_b32 a210, v22
v_perm_b32 v23, v33, v32, s51
v_accvgpr_write_b32 a218, v23
ds_read_b32 v30, v19 offset:11008
ds_read_b32 v31, v19 offset:15104
s_waitcnt lgkmcnt(8)
v_perm_b32 v22, v35, v34, s50
v_accvgpr_write_b32 a211, v22
v_perm_b32 v23, v35, v34, s51
v_accvgpr_write_b32 a219, v23
ds_read_b32 v32, v20 offset:0
ds_read_b32 v33, v20 offset:4096
s_waitcnt lgkmcnt(8)
v_perm_b32 v22, v25, v24, s50
v_accvgpr_write_b32 a212, v22
v_perm_b32 v23, v25, v24, s51
v_accvgpr_write_b32 a220, v23
ds_read_b32 v34, v20 offset:2048
ds_read_b32 v35, v20 offset:6144
s_waitcnt lgkmcnt(8)
v_perm_b32 v22, v27, v26, s50
v_accvgpr_write_b32 a213, v22
v_perm_b32 v23, v27, v26, s51
v_accvgpr_write_b32 a221, v23
ds_read_b32 v24, v20 offset:8192
ds_read_b32 v25, v20 offset:12288
s_waitcnt lgkmcnt(8)
v_perm_b32 v22, v29, v28, s50
v_accvgpr_write_b32 a214, v22
v_perm_b32 v23, v29, v28, s51
v_accvgpr_write_b32 a222, v23
ds_read_b32 v26, v20 offset:10240
ds_read_b32 v27, v20 offset:14336
s_waitcnt lgkmcnt(8)
v_perm_b32 v22, v31, v30, s50
v_accvgpr_write_b32 a215, v22
v_perm_b32 v23, v31, v30, s51
v_accvgpr_write_b32 a223, v23
ds_read_b32 v28, v20 offset:256
ds_read_b32 v29, v20 offset:4352
s_waitcnt lgkmcnt(8)
v_perm_b32 v22, v33, v32, s50
v_accvgpr_write_b32 a224, v22
v_perm_b32 v23, v33, v32, s51
v_accvgpr_write_b32 a232, v23
ds_read_b32 v30, v20 offset:2304
ds_read_b32 v31, v20 offset:6400
s_waitcnt lgkmcnt(8)
v_perm_b32 v22, v35, v34, s50
v_accvgpr_write_b32 a225, v22
v_perm_b32 v23, v35, v34, s51
v_accvgpr_write_b32 a233, v23
ds_read_b32 v32, v20 offset:8448
ds_read_b32 v33, v20 offset:12544
s_waitcnt lgkmcnt(8)
v_perm_b32 v22, v25, v24, s50
v_accvgpr_write_b32 a226, v22
v_perm_b32 v23, v25, v24, s51
v_accvgpr_write_b32 a234, v23
ds_read_b32 v34, v20 offset:10496
ds_read_b32 v35, v20 offset:14592
s_waitcnt lgkmcnt(8)
v_perm_b32 v22, v27, v26, s50
v_accvgpr_write_b32 a227, v22
v_perm_b32 v23, v27, v26, s51
v_accvgpr_write_b32 a235, v23
ds_read_b32 v24, v20 offset:512
ds_read_b32 v25, v20 offset:4608
s_waitcnt lgkmcnt(8)
v_perm_b32 v22, v29, v28, s50
v_accvgpr_write_b32 a228, v22
v_perm_b32 v23, v29, v28, s51
v_accvgpr_write_b32 a236, v23
ds_read_b32 v26, v20 offset:2560
ds_read_b32 v27, v20 offset:6656
s_waitcnt lgkmcnt(8)
v_perm_b32 v22, v31, v30, s50
v_accvgpr_write_b32 a229, v22
v_perm_b32 v23, v31, v30, s51
v_accvgpr_write_b32 a237, v23
ds_read_b32 v28, v20 offset:8704
ds_read_b32 v29, v20 offset:12800
s_waitcnt lgkmcnt(8)
v_perm_b32 v22, v33, v32, s50
v_accvgpr_write_b32 a230, v22
v_perm_b32 v23, v33, v32, s51
v_accvgpr_write_b32 a238, v23
ds_read_b32 v30, v20 offset:10752
ds_read_b32 v31, v20 offset:14848
s_waitcnt lgkmcnt(8)
v_perm_b32 v22, v35, v34, s50
v_accvgpr_write_b32 a231, v22
v_perm_b32 v23, v35, v34, s51
v_accvgpr_write_b32 a239, v23
ds_read_b32 v32, v20 offset:768
ds_read_b32 v33, v20 offset:4864
s_waitcnt lgkmcnt(8)
v_perm_b32 v22, v25, v24, s50
v_accvgpr_write_b32 a240, v22
v_perm_b32 v23, v25, v24, s51
v_accvgpr_write_b32 a248, v23
ds_read_b32 v34, v20 offset:2816
ds_read_b32 v35, v20 offset:6912
s_waitcnt lgkmcnt(8)
v_perm_b32 v22, v27, v26, s50
v_accvgpr_write_b32 a241, v22
v_perm_b32 v23, v27, v26, s51
v_accvgpr_write_b32 a249, v23
ds_read_b32 v24, v20 offset:8960
ds_read_b32 v25, v20 offset:13056
s_waitcnt lgkmcnt(8)
v_perm_b32 v22, v29, v28, s50
v_accvgpr_write_b32 a242, v22
v_perm_b32 v23, v29, v28, s51
v_accvgpr_write_b32 a250, v23
ds_read_b32 v26, v20 offset:11008
ds_read_b32 v27, v20 offset:15104
s_waitcnt lgkmcnt(8)
v_perm_b32 v22, v31, v30, s50
v_accvgpr_write_b32 a243, v22
v_perm_b32 v23, v31, v30, s51
v_accvgpr_write_b32 a251, v23
s_waitcnt lgkmcnt(6)
v_perm_b32 v22, v33, v32, s50
v_accvgpr_write_b32 a244, v22
v_perm_b32 v23, v33, v32, s51
v_accvgpr_write_b32 a252, v23
s_waitcnt lgkmcnt(4)
v_perm_b32 v22, v35, v34, s50
v_accvgpr_write_b32 a245, v22
v_perm_b32 v23, v35, v34, s51
v_accvgpr_write_b32 a253, v23
s_waitcnt lgkmcnt(2)
v_perm_b32 v22, v25, v24, s50
v_accvgpr_write_b32 a246, v22
v_perm_b32 v23, v25, v24, s51
v_accvgpr_write_b32 a254, v23
s_waitcnt lgkmcnt(0)
v_perm_b32 v22, v27, v26, s50
v_accvgpr_write_b32 a247, v22
v_perm_b32 v23, v27, v26, s51
v_accvgpr_write_b32 a255, v23
s_waitcnt lgkmcnt(0)
s_barrier
s_add_u32 m0, s75, 0
s_add_u32 s38, s73, 0
buffer_load_dwordx4 v16, s[12:15], s38 offen nt lds
s_add_u32 m0, s75, 1024
s_add_u32 s38, s73, 65536
buffer_load_dwordx4 v16, s[12:15], s38 offen nt lds
s_add_u32 m0, s75, 2048
s_add_u32 s38, s73, 131072
buffer_load_dwordx4 v16, s[12:15], s38 offen nt lds
s_add_u32 m0, s75, 3072
s_add_u32 s38, s73, 196608
buffer_load_dwordx4 v16, s[12:15], s38 offen nt lds
s_add_u32 m0, s75, 4096
s_add_u32 s38, s73, 262144
buffer_load_dwordx4 v16, s[12:15], s38 offen nt lds
s_add_u32 m0, s75, 5120
s_add_u32 s38, s73, 327680
buffer_load_dwordx4 v16, s[12:15], s38 offen nt lds
s_add_u32 m0, s75, 6144
s_add_u32 s38, s73, 393216
buffer_load_dwordx4 v16, s[12:15], s38 offen nt lds
s_add_u32 m0, s75, 7168
s_add_u32 s38, s73, 458752
buffer_load_dwordx4 v16, s[12:15], s38 offen nt lds
s_add_u32 m0, s75, 8192
s_add_u32 s38, s73, 524288
buffer_load_dwordx4 v16, s[12:15], s38 offen nt lds
s_add_u32 m0, s75, 9216
s_add_u32 s38, s73, 589824
buffer_load_dwordx4 v16, s[12:15], s38 offen nt lds
s_add_u32 m0, s75, 10240
s_add_u32 s38, s73, 655360
buffer_load_dwordx4 v16, s[12:15], s38 offen nt lds
s_add_u32 m0, s75, 11264
s_add_u32 s38, s73, 720896
buffer_load_dwordx4 v16, s[12:15], s38 offen nt lds
s_add_u32 m0, s75, 12288
s_add_u32 s38, s73, 786432
buffer_load_dwordx4 v16, s[12:15], s38 offen nt lds
s_add_u32 m0, s75, 13312
s_add_u32 s38, s73, 851968
buffer_load_dwordx4 v16, s[12:15], s38 offen nt lds
s_add_u32 m0, s75, 14336
s_add_u32 s38, s73, 917504
buffer_load_dwordx4 v16, s[12:15], s38 offen nt lds
s_add_u32 m0, s75, 15360
s_add_u32 s38, s73, 983040
buffer_load_dwordx4 v16, s[12:15], s38 offen nt lds
s_waitcnt vmcnt(16)
s_barrier
ds_read_b32 v24, v17 offset:0
ds_read_b32 v25, v17 offset:4096
ds_read_b32 v26, v17 offset:2048
ds_read_b32 v27, v17 offset:6144
ds_read_b32 v28, v17 offset:8192
ds_read_b32 v29, v17 offset:12288
ds_read_b32 v30, v17 offset:10240
ds_read_b32 v31, v17 offset:14336
ds_read_b32 v32, v17 offset:256
ds_read_b32 v33, v17 offset:4352
s_waitcnt lgkmcnt(8)
v_perm_b32 v64, v25, v24, s50
v_perm_b32 v72, v25, v24, s51
ds_read_b32 v34, v17 offset:2304
ds_read_b32 v35, v17 offset:6400
s_waitcnt lgkmcnt(8)
v_perm_b32 v65, v27, v26, s50
v_perm_b32 v73, v27, v26, s51
ds_read_b32 v24, v17 offset:8448
ds_read_b32 v25, v17 offset:12544
s_waitcnt lgkmcnt(8)
v_perm_b32 v66, v29, v28, s50
v_perm_b32 v74, v29, v28, s51
ds_read_b32 v26, v17 offset:10496
ds_read_b32 v27, v17 offset:14592
s_waitcnt lgkmcnt(8)
v_perm_b32 v67, v31, v30, s50
v_perm_b32 v75, v31, v30, s51
ds_read_b32 v28, v17 offset:512
ds_read_b32 v29, v17 offset:4608
s_waitcnt lgkmcnt(8)
v_perm_b32 v68, v33, v32, s50
v_perm_b32 v76, v33, v32, s51
ds_read_b32 v30, v17 offset:2560
ds_read_b32 v31, v17 offset:6656
s_waitcnt lgkmcnt(8)
v_perm_b32 v69, v35, v34, s50
v_perm_b32 v77, v35, v34, s51
ds_read_b32 v32, v17 offset:8704
ds_read_b32 v33, v17 offset:12800
s_waitcnt lgkmcnt(8)
v_perm_b32 v70, v25, v24, s50
v_perm_b32 v78, v25, v24, s51
ds_read_b32 v34, v17 offset:10752
ds_read_b32 v35, v17 offset:14848
s_waitcnt lgkmcnt(8)
v_perm_b32 v71, v27, v26, s50
v_perm_b32 v79, v27, v26, s51
ds_read_b32 v24, v17 offset:768
ds_read_b32 v25, v17 offset:4864
s_waitcnt lgkmcnt(8)
v_perm_b32 v80, v29, v28, s50
v_perm_b32 v88, v29, v28, s51
ds_read_b32 v26, v17 offset:2816
ds_read_b32 v27, v17 offset:6912
s_waitcnt lgkmcnt(8)
v_perm_b32 v81, v31, v30, s50
v_perm_b32 v89, v31, v30, s51
ds_read_b32 v28, v17 offset:8960
ds_read_b32 v29, v17 offset:13056
s_waitcnt lgkmcnt(8)
v_perm_b32 v82, v33, v32, s50
v_perm_b32 v90, v33, v32, s51
ds_read_b32 v30, v17 offset:11008
ds_read_b32 v31, v17 offset:15104
s_waitcnt lgkmcnt(8)
v_perm_b32 v83, v35, v34, s50
v_perm_b32 v91, v35, v34, s51
ds_read_b32 v32, v18 offset:0
ds_read_b32 v33, v18 offset:4096
s_waitcnt lgkmcnt(8)
v_perm_b32 v84, v25, v24, s50
v_perm_b32 v92, v25, v24, s51
ds_read_b32 v34, v18 offset:2048
ds_read_b32 v35, v18 offset:6144
s_waitcnt lgkmcnt(8)
v_perm_b32 v85, v27, v26, s50
v_perm_b32 v93, v27, v26, s51
ds_read_b32 v24, v18 offset:8192
ds_read_b32 v25, v18 offset:12288
s_waitcnt lgkmcnt(8)
v_perm_b32 v86, v29, v28, s50
v_perm_b32 v94, v29, v28, s51
ds_read_b32 v26, v18 offset:10240
ds_read_b32 v27, v18 offset:14336
s_waitcnt lgkmcnt(8)
v_perm_b32 v87, v31, v30, s50
v_perm_b32 v95, v31, v30, s51
ds_read_b32 v28, v18 offset:256
ds_read_b32 v29, v18 offset:4352
s_waitcnt lgkmcnt(8)
v_perm_b32 v96, v33, v32, s50
v_perm_b32 v104, v33, v32, s51
ds_read_b32 v30, v18 offset:2304
ds_read_b32 v31, v18 offset:6400
s_waitcnt lgkmcnt(8)
v_perm_b32 v97, v35, v34, s50
v_perm_b32 v105, v35, v34, s51
ds_read_b32 v32, v18 offset:8448
ds_read_b32 v33, v18 offset:12544
s_waitcnt lgkmcnt(8)
v_perm_b32 v98, v25, v24, s50
v_perm_b32 v106, v25, v24, s51
ds_read_b32 v34, v18 offset:10496
ds_read_b32 v35, v18 offset:14592
s_waitcnt lgkmcnt(8)
v_perm_b32 v99, v27, v26, s50
v_perm_b32 v107, v27, v26, s51
ds_read_b32 v24, v18 offset:512
ds_read_b32 v25, v18 offset:4608
s_waitcnt lgkmcnt(8)
v_perm_b32 v100, v29, v28, s50
v_perm_b32 v108, v29, v28, s51
ds_read_b32 v26, v18 offset:2560
ds_read_b32 v27, v18 offset:6656
s_waitcnt lgkmcnt(8)
v_perm_b32 v101, v31, v30, s50
v_perm_b32 v109, v31, v30, s51
ds_read_b32 v28, v18 offset:8704
ds_read_b32 v29, v18 offset:12800
s_waitcnt lgkmcnt(8)
v_perm_b32 v102, v33, v32, s50
v_perm_b32 v110, v33, v32, s51
ds_read_b32 v30, v18 offset:10752
ds_read_b32 v31, v18 offset:14848
s_waitcnt lgkmcnt(8)
v_perm_b32 v103, v35, v34, s50
v_perm_b32 v111, v35, v34, s51
ds_read_b32 v32, v18 offset:768
ds_read_b32 v33, v18 offset:4864
s_waitcnt lgkmcnt(8)
v_perm_b32 v112, v25, v24, s50
v_perm_b32 v120, v25, v24, s51
ds_read_b32 v34, v18 offset:2816
ds_read_b32 v35, v18 offset:6912
s_waitcnt lgkmcnt(8)
v_perm_b32 v113, v27, v26, s50
v_perm_b32 v121, v27, v26, s51
ds_read_b32 v24, v18 offset:8960
ds_read_b32 v25, v18 offset:13056
s_waitcnt lgkmcnt(8)
v_perm_b32 v114, v29, v28, s50
v_perm_b32 v122, v29, v28, s51
ds_read_b32 v26, v18 offset:11008
ds_read_b32 v27, v18 offset:15104
s_waitcnt lgkmcnt(8)
v_perm_b32 v115, v31, v30, s50
v_perm_b32 v123, v31, v30, s51
s_waitcnt lgkmcnt(6)
v_perm_b32 v116, v33, v32, s50
v_perm_b32 v124, v33, v32, s51
s_waitcnt lgkmcnt(4)
v_perm_b32 v117, v35, v34, s50
v_perm_b32 v125, v35, v34, s51
s_waitcnt lgkmcnt(2)
v_perm_b32 v118, v25, v24, s50
v_perm_b32 v126, v25, v24, s51
s_waitcnt lgkmcnt(0)
v_perm_b32 v119, v27, v26, s50
v_perm_b32 v127, v27, v26, s51
s_waitcnt lgkmcnt(0)
s_barrier
s_cmp_ge_u32 s17, 2
s_cbranch_scc1 C_wo1
s_add_u32 m0, s77, 0
s_add_u32 s38, s76, 0
buffer_load_dwordx4 v53, s[68:71], s38 offen nt lds
s_add_u32 m0, s77, 1024
s_add_u32 s38, s76, 4096
buffer_load_dwordx4 v53, s[68:71], s38 offen nt lds
s_add_u32 m0, s77, 2048
s_add_u32 s38, s76, 8192
buffer_load_dwordx4 v53, s[68:71], s38 offen nt lds
s_add_u32 m0, s77, 3072
s_add_u32 s38, s76, 12288
buffer_load_dwordx4 v53, s[68:71], s38 offen nt lds
s_add_u32 m0, s77, 4096
s_add_u32 s38, s76, 16384
buffer_load_dwordx4 v53, s[68:71], s38 offen nt lds
s_add_u32 m0, s77, 5120
s_add_u32 s38, s76, 20480
buffer_load_dwordx4 v53, s[68:71], s38 offen nt lds
s_add_u32 m0, s77, 6144
s_add_u32 s38, s76, 24576
buffer_load_dwordx4 v53, s[68:71], s38 offen nt lds
s_add_u32 m0, s77, 7168
s_add_u32 s38, s76, 28672
buffer_load_dwordx4 v53, s[68:71], s38 offen nt lds
s_add_u32 m0, s77, 8192
s_add_u32 s38, s76, 32768
buffer_load_dwordx4 v53, s[68:71], s38 offen nt lds
s_add_u32 m0, s77, 9216
s_add_u32 s38, s76, 36864
buffer_load_dwordx4 v53, s[68:71], s38 offen nt lds
s_add_u32 m0, s77, 10240
s_add_u32 s38, s76, 40960
buffer_load_dwordx4 v53, s[68:71], s38 offen nt lds
s_add_u32 m0, s77, 11264
s_add_u32 s38, s76, 45056
buffer_load_dwordx4 v53, s[68:71], s38 offen nt lds
s_add_u32 m0, s77, 12288
s_add_u32 s38, s76, 49152
buffer_load_dwordx4 v53, s[68:71], s38 offen nt lds
s_add_u32 m0, s77, 13312
s_add_u32 s38, s76, 53248
buffer_load_dwordx4 v53, s[68:71], s38 offen nt lds
s_add_u32 m0, s77, 14336
s_add_u32 s38, s76, 57344
buffer_load_dwordx4 v53, s[68:71], s38 offen nt lds
s_add_u32 m0, s77, 15360
s_add_u32 s38, s76, 61440
buffer_load_dwordx4 v53, s[68:71], s38 offen nt lds
s_add_u32 m0, s77, 16384
s_add_u32 s38, s76, 65536
buffer_load_dwordx4 v53, s[68:71], s38 offen nt lds
s_add_u32 m0, s77, 17408
s_add_u32 s38, s76, 69632
buffer_load_dwordx4 v53, s[68:71], s38 offen nt lds
s_add_u32 m0, s77, 18432
s_add_u32 s38, s76, 73728
buffer_load_dwordx4 v53, s[68:71], s38 offen nt lds
s_add_u32 m0, s77, 19456
s_add_u32 s38, s76, 77824
buffer_load_dwordx4 v53, s[68:71], s38 offen nt lds
s_add_u32 m0, s77, 20480
s_add_u32 s38, s76, 81920
buffer_load_dwordx4 v53, s[68:71], s38 offen nt lds
s_add_u32 m0, s77, 21504
s_add_u32 s38, s76, 86016
buffer_load_dwordx4 v53, s[68:71], s38 offen nt lds
s_add_u32 m0, s77, 22528
s_add_u32 s38, s76, 90112
buffer_load_dwordx4 v53, s[68:71], s38 offen nt lds
s_add_u32 m0, s77, 23552
s_add_u32 s38, s76, 94208
buffer_load_dwordx4 v53, s[68:71], s38 offen nt lds
s_add_u32 m0, s77, 24576
s_add_u32 s38, s76, 98304
buffer_load_dwordx4 v53, s[68:71], s38 offen nt lds
s_add_u32 m0, s77, 25600
s_add_u32 s38, s76, 102400
buffer_load_dwordx4 v53, s[68:71], s38 offen nt lds
s_add_u32 m0, s77, 26624
s_add_u32 s38, s76, 106496
buffer_load_dwordx4 v53, s[68:71], s38 offen nt lds
s_add_u32 m0, s77, 27648
s_add_u32 s38, s76, 110592
buffer_load_dwordx4 v53, s[68:71], s38 offen nt lds
s_add_u32 m0, s77, 28672
s_add_u32 s38, s76, 114688
buffer_load_dwordx4 v53, s[68:71], s38 offen nt lds
s_add_u32 m0, s77, 29696
s_add_u32 s38, s76, 118784
buffer_load_dwordx4 v53, s[68:71], s38 offen nt lds
s_add_u32 m0, s77, 30720
s_add_u32 s38, s76, 122880
buffer_load_dwordx4 v53, s[68:71], s38 offen nt lds
s_add_u32 m0, s77, 31744
s_add_u32 s38, s76, 126976
buffer_load_dwordx4 v53, s[68:71], s38 offen nt lds
C_wo1:
s_waitcnt vmcnt(32)
s_cmp_lt_u32 s17, 2
s_cbranch_scc1 C_w5
s_waitcnt vmcnt(0)
C_w5:
s_barrier
ds_read_b32 v24, v19 offset:0
ds_read_b32 v25, v19 offset:4096
ds_read_b32 v26, v19 offset:2048
ds_read_b32 v27, v19 offset:6144
ds_read_b32 v28, v19 offset:8192
ds_read_b32 v29, v19 offset:12288
ds_read_b32 v30, v19 offset:10240
ds_read_b32 v31, v19 offset:14336
ds_read_b32 v32, v19 offset:256
ds_read_b32 v33, v19 offset:4352
s_waitcnt lgkmcnt(8)
v_perm_b32 v128, v25, v24, s50
v_perm_b32 v136, v25, v24, s51
ds_read_b32 v34, v19 offset:2304
ds_read_b32 v35, v19 offset:6400
s_waitcnt lgkmcnt(8)
v_perm_b32 v129, v27, v26, s50
v_perm_b32 v137, v27, v26, s51
ds_read_b32 v24, v19 offset:8448
ds_read_b32 v25, v19 offset:12544
s_waitcnt lgkmcnt(8)
v_perm_b32 v130, v29, v28, s50
v_perm_b32 v138, v29, v28, s51
ds_read_b32 v26, v19 offset:10496
ds_read_b32 v27, v19 offset:14592
s_waitcnt lgkmcnt(8)
v_perm_b32 v131, v31, v30, s50
v_perm_b32 v139, v31, v30, s51
ds_read_b32 v28, v19 offset:512
ds_read_b32 v29, v19 offset:4608
s_waitcnt lgkmcnt(8)
v_perm_b32 v132, v33, v32, s50
v_perm_b32 v140, v33, v32, s51
ds_read_b32 v30, v19 offset:2560
ds_read_b32 v31, v19 offset:6656
s_waitcnt lgkmcnt(8)
v_perm_b32 v133, v35, v34, s50
v_perm_b32 v141, v35, v34, s51
ds_read_b32 v32, v19 offset:8704
ds_read_b32 v33, v19 offset:12800
s_waitcnt lgkmcnt(8)
v_perm_b32 v134, v25, v24, s50
v_perm_b32 v142, v25, v24, s51
ds_read_b32 v34, v19 offset:10752
ds_read_b32 v35, v19 offset:14848
s_waitcnt lgkmcnt(8)
v_perm_b32 v135, v27, v26, s50
v_perm_b32 v143, v27, v26, s51
ds_read_b32 v24, v19 offset:768
ds_read_b32 v25, v19 offset:4864
s_waitcnt lgkmcnt(8)
v_perm_b32 v144, v29, v28, s50
v_perm_b32 v152, v29, v28, s51
ds_read_b32 v26, v19 offset:2816
ds_read_b32 v27, v19 offset:6912
s_waitcnt lgkmcnt(8)
v_perm_b32 v145, v31, v30, s50
v_perm_b32 v153, v31, v30, s51
ds_read_b32 v28, v19 offset:8960
ds_read_b32 v29, v19 offset:13056
s_waitcnt lgkmcnt(8)
v_perm_b32 v146, v33, v32, s50
v_perm_b32 v154, v33, v32, s51
ds_read_b32 v30, v19 offset:11008
ds_read_b32 v31, v19 offset:15104
s_waitcnt lgkmcnt(8)
v_perm_b32 v147, v35, v34, s50
v_perm_b32 v155, v35, v34, s51
ds_read_b32 v32, v20 offset:0
ds_read_b32 v33, v20 offset:4096
s_waitcnt lgkmcnt(8)
v_perm_b32 v148, v25, v24, s50
v_perm_b32 v156, v25, v24, s51
ds_read_b32 v34, v20 offset:2048
ds_read_b32 v35, v20 offset:6144
s_waitcnt lgkmcnt(8)
v_perm_b32 v149, v27, v26, s50
v_perm_b32 v157, v27, v26, s51
ds_read_b32 v24, v20 offset:8192
ds_read_b32 v25, v20 offset:12288
s_waitcnt lgkmcnt(8)
v_perm_b32 v150, v29, v28, s50
v_perm_b32 v158, v29, v28, s51
ds_read_b32 v26, v20 offset:10240
ds_read_b32 v27, v20 offset:14336
s_waitcnt lgkmcnt(8)
v_perm_b32 v151, v31, v30, s50
v_perm_b32 v159, v31, v30, s51
ds_read_b32 v28, v20 offset:256
ds_read_b32 v29, v20 offset:4352
s_waitcnt lgkmcnt(8)
v_perm_b32 v160, v33, v32, s50
v_perm_b32 v168, v33, v32, s51
ds_read_b32 v30, v20 offset:2304
ds_read_b32 v31, v20 offset:6400
s_waitcnt lgkmcnt(8)
v_perm_b32 v161, v35, v34, s50
v_perm_b32 v169, v35, v34, s51
ds_read_b32 v32, v20 offset:8448
ds_read_b32 v33, v20 offset:12544
s_waitcnt lgkmcnt(8)
v_perm_b32 v162, v25, v24, s50
v_perm_b32 v170, v25, v24, s51
ds_read_b32 v34, v20 offset:10496
ds_read_b32 v35, v20 offset:14592
s_waitcnt lgkmcnt(8)
v_perm_b32 v163, v27, v26, s50
v_perm_b32 v171, v27, v26, s51
ds_read_b32 v24, v20 offset:512
ds_read_b32 v25, v20 offset:4608
s_waitcnt lgkmcnt(8)
v_perm_b32 v164, v29, v28, s50
v_perm_b32 v172, v29, v28, s51
ds_read_b32 v26, v20 offset:2560
ds_read_b32 v27, v20 offset:6656
s_waitcnt lgkmcnt(8)
v_perm_b32 v165, v31, v30, s50
v_perm_b32 v173, v31, v30, s51
ds_read_b32 v28, v20 offset:8704
ds_read_b32 v29, v20 offset:12800
s_waitcnt lgkmcnt(8)
v_perm_b32 v166, v33, v32, s50
v_perm_b32 v174, v33, v32, s51
ds_read_b32 v30, v20 offset:10752
ds_read_b32 v31, v20 offset:14848
s_waitcnt lgkmcnt(8)
v_perm_b32 v167, v35, v34, s50
v_perm_b32 v175, v35, v34, s51
ds_read_b32 v32, v20 offset:768
ds_read_b32 v33, v20 offset:4864
s_waitcnt lgkmcnt(8)
v_perm_b32 v176, v25, v24, s50
v_perm_b32 v184, v25, v24, s51
ds_read_b32 v34, v20 offset:2816
ds_read_b32 v35, v20 offset:6912
s_waitcnt lgkmcnt(8)
v_perm_b32 v177, v27, v26, s50
v_perm_b32 v185, v27, v26, s51
ds_read_b32 v24, v20 offset:8960
ds_read_b32 v25, v20 offset:13056
s_waitcnt lgkmcnt(8)
v_perm_b32 v178, v29, v28, s50
v_perm_b32 v186, v29, v28, s51
ds_read_b32 v26, v20 offset:11008
ds_read_b32 v27, v20 offset:15104
s_waitcnt lgkmcnt(8)
v_perm_b32 v179, v31, v30, s50
v_perm_b32 v187, v31, v30, s51
s_waitcnt lgkmcnt(6)
v_perm_b32 v180, v33, v32, s50
v_perm_b32 v188, v33, v32, s51
s_waitcnt lgkmcnt(4)
v_perm_b32 v181, v35, v34, s50
v_perm_b32 v189, v35, v34, s51
s_waitcnt lgkmcnt(2)
v_perm_b32 v182, v25, v24, s50
v_perm_b32 v190, v25, v24, s51
s_waitcnt lgkmcnt(0)
v_perm_b32 v183, v27, v26, s50
v_perm_b32 v191, v27, v26, s51
s_waitcnt lgkmcnt(0)
s_barrier
s_cmp_lt_u32 s17, 2
s_cbranch_scc1 C_wo2
s_add_u32 m0, s77, 0
s_add_u32 s38, s76, 0
buffer_load_dwordx4 v53, s[68:71], s38 offen nt lds
s_add_u32 m0, s77, 1024
s_add_u32 s38, s76, 4096
buffer_load_dwordx4 v53, s[68:71], s38 offen nt lds
s_add_u32 m0, s77, 2048
s_add_u32 s38, s76, 8192
buffer_load_dwordx4 v53, s[68:71], s38 offen nt lds
s_add_u32 m0, s77, 3072
s_add_u32 s38, s76, 12288
buffer_load_dwordx4 v53, s[68:71], s38 offen nt lds
s_add_u32 m0, s77, 4096
s_add_u32 s38, s76, 16384
buffer_load_dwordx4 v53, s[68:71], s38 offen nt lds
s_add_u32 m0, s77, 5120
s_add_u32 s38, s76, 20480
buffer_load_dwordx4 v53, s[68:71], s38 offen nt lds
s_add_u32 m0, s77, 6144
s_add_u32 s38, s76, 24576
buffer_load_dwordx4 v53, s[68:71], s38 offen nt lds
s_add_u32 m0, s77, 7168
s_add_u32 s38, s76, 28672
buffer_load_dwordx4 v53, s[68:71], s38 offen nt lds
s_add_u32 m0, s77, 8192
s_add_u32 s38, s76, 32768
buffer_load_dwordx4 v53, s[68:71], s38 offen nt lds
s_add_u32 m0, s77, 9216
s_add_u32 s38, s76, 36864
buffer_load_dwordx4 v53, s[68:71], s38 offen nt lds
s_add_u32 m0, s77, 10240
s_add_u32 s38, s76, 40960
buffer_load_dwordx4 v53, s[68:71], s38 offen nt lds
s_add_u32 m0, s77, 11264
s_add_u32 s38, s76, 45056
buffer_load_dwordx4 v53, s[68:71], s38 offen nt lds
s_add_u32 m0, s77, 12288
s_add_u32 s38, s76, 49152
buffer_load_dwordx4 v53, s[68:71], s38 offen nt lds
s_add_u32 m0, s77, 13312
s_add_u32 s38, s76, 53248
buffer_load_dwordx4 v53, s[68:71], s38 offen nt lds
s_add_u32 m0, s77, 14336
s_add_u32 s38, s76, 57344
buffer_load_dwordx4 v53, s[68:71], s38 offen nt lds
s_add_u32 m0, s77, 15360
s_add_u32 s38, s76, 61440
buffer_load_dwordx4 v53, s[68:71], s38 offen nt lds
s_add_u32 m0, s77, 16384
s_add_u32 s38, s76, 65536
buffer_load_dwordx4 v53, s[68:71], s38 offen nt lds
s_add_u32 m0, s77, 17408
s_add_u32 s38, s76, 69632
buffer_load_dwordx4 v53, s[68:71], s38 offen nt lds
s_add_u32 m0, s77, 18432
s_add_u32 s38, s76, 73728
buffer_load_dwordx4 v53, s[68:71], s38 offen nt lds
s_add_u32 m0, s77, 19456
s_add_u32 s38, s76, 77824
buffer_load_dwordx4 v53, s[68:71], s38 offen nt lds
s_add_u32 m0, s77, 20480
s_add_u32 s38, s76, 81920
buffer_load_dwordx4 v53, s[68:71], s38 offen nt lds
s_add_u32 m0, s77, 21504
s_add_u32 s38, s76, 86016
buffer_load_dwordx4 v53, s[68:71], s38 offen nt lds
s_add_u32 m0, s77, 22528
s_add_u32 s38, s76, 90112
buffer_load_dwordx4 v53, s[68:71], s38 offen nt lds
s_add_u32 m0, s77, 23552
s_add_u32 s38, s76, 94208
buffer_load_dwordx4 v53, s[68:71], s38 offen nt lds
s_add_u32 m0, s77, 24576
s_add_u32 s38, s76, 98304
buffer_load_dwordx4 v53, s[68:71], s38 offen nt lds
s_add_u32 m0, s77, 25600
s_add_u32 s38, s76, 102400
buffer_load_dwordx4 v53, s[68:71], s38 offen nt lds
s_add_u32 m0, s77, 26624
s_add_u32 s38, s76, 106496
buffer_load_dwordx4 v53, s[68:71], s38 offen nt lds
s_add_u32 m0, s77, 27648
s_add_u32 s38, s76, 110592
buffer_load_dwordx4 v53, s[68:71], s38 offen nt lds
s_add_u32 m0, s77, 28672
s_add_u32 s38, s76, 114688
buffer_load_dwordx4 v53, s[68:71], s38 offen nt lds
s_add_u32 m0, s77, 29696
s_add_u32 s38, s76, 118784
buffer_load_dwordx4 v53, s[68:71], s38 offen nt lds
s_add_u32 m0, s77, 30720
s_add_u32 s38, s76, 122880
buffer_load_dwordx4 v53, s[68:71], s38 offen nt lds
s_add_u32 m0, s77, 31744
s_add_u32 s38, s76, 126976
buffer_load_dwordx4 v53, s[68:71], s38 offen nt lds
C_wo2:
v_mov_b32 v52, 64
global_load_dword v54, v52, s[52:53] sc1
v_lshrrev_b32 v51, 2, v1
v_and_b32 v51, 60, v51
s_lshl_b32 s39, s16, 6
s_add_u32 s39, s39, 82837504
buffer_load_dword v55, v51, s[8:11], s39 offen sc1
s_cmp_lg_u32 s17, 0
s_cbranch_scc1 C_mid0
v_mov_b32 v52, 32
global_load_dword v50, v52, s[52:53] sc1
s_load_dwordx2 s[12:13], s[0:1], 8
s_waitcnt lgkmcnt(0)
s_and_b32 s13, s13, 0xffff
s_mov_b32 s14, 8192
s_mov_b32 s15, 0x20000
v_lshrrev_b32 v42, 4, v1
v_lshrrev_b32 v49, 4, v42
v_lshlrev_b32 v49, 1, v49
v_and_b32 v43, 1, v42
v_add_u32 v49, v49, v43
v_lshlrev_b32 v49, 10, v49
v_bfe_u32 v43, v42, 1, 2
v_lshl_add_u32 v49, v43, 4, v49
s_lshr_b32 s38, s16, 3
s_lshl_b32 s38, s38, 8
s_and_b32 s39, s16, 7
s_lshl_b32 s39, s39, 1
s_add_u32 s38, s38, s39
buffer_load_ushort v44, v49, s[12:15], s38 offen offset:0
buffer_load_ushort v45, v49, s[12:15], s38 offen offset:64
buffer_load_ushort v46, v49, s[12:15], s38 offen offset:128
buffer_load_ushort v47, v49, s[12:15], s38 offen offset:192
C_mid0:
v_lshrrev_b32 v21, 4, v1
v_lshrrev_b32 v0, 5, v21
v_lshlrev_b32 v0, 4, v0
v_bfe_u32 v17, v21, 4, 1
v_lshl_add_u32 v0, v17, 2, v0
v_lshlrev_b32 v0, 8, v0
v_and_b32 v17, 15, v21
v_lshl_add_u32 v0, v17, 4, v0
v_add_u32 v17, s77, v0
s_waitcnt vmcnt(0)
v_readfirstlane_b32 s69, v54
s_nop 0
s_cmp_lg_u32 s69, 0
s_cbranch_scc1 C_nonce_have
v_mov_b32 v52, 64
s_mov_b32 s41, 0x40000
C_nonce:
global_load_dword v54, v52, s[52:53] sc1
s_waitcnt vmcnt(0)
v_readfirstlane_b32 s69, v54
s_nop 0
s_cmp_lg_u32 s69, 0
s_cbranch_scc1 C_nonce_ok
s_sub_u32 s41, s41, 1
s_cbranch_scc1 C_nonce_ok
s_sleep 4
s_branch C_nonce
C_nonce_ok:
C_nonce_have:
s_lshl_b32 s47, s16, 2
s_add_u32 s47, s47, 82845440
v_cmp_ne_u32 vcc, s69, v55
s_nop 1
s_or_b32 s39, vcc_lo, 0x10000
s_ff1_i32_b32 s68, s39
s_mov_b32 s38, 0
s_cmp_lg_u32 s68, 0
s_cbranch_scc1 C_kv0_have
C_kv0:
v_lshrrev_b32 v52, 2, v1
v_and_b32 v52, 60, v52
s_lshl_b32 s39, s16, 6
s_add_u32 s39, s39, 82837504
buffer_load_dword v55, v52, s[8:11], s39 offen sc1
s_waitcnt vmcnt(0)
v_cmp_ne_u32 vcc, s69, v55
s_nop 1
s_or_b32 s39, vcc_lo, 0x10000
s_ff1_i32_b32 s68, s39
s_cmp_lt_u32 s38, s68
s_cbranch_scc1 C_kv0_ok
s_cmp_eq_u32 s37, 0
s_cbranch_scc1 C_kv0_ok
s_sub_u32 s37, s37, 1
s_sleep 8
s_branch C_kv0
C_kv0_ok:
C_kv0_have:
s_cmp_lg_u32 s17, 2
s_cbranch_scc1 C_nosnap
v_mov_b32 v8, v55
C_nosnap:
s_cmp_lg_u32 s17, 1
s_cbranch_scc1 C_nokx0
s_mov_b32 m0, 8192
s_nop 0
buffer_load_dwordx4 v1, s[8:11], s28 offen lds
buffer_load_dwordx4 v1, s[8:11], s28 offen offset:1024 lds
buffer_load_dwordx4 v1, s[8:11], s28 offen offset:2048 lds
buffer_load_dwordx4 v1, s[8:11], s28 offen offset:3072 lds
s_mov_b32 m0, 12288
s_add_u32 s38, s28, 4096
buffer_load_dwordx4 v1, s[8:11], s38 offen lds
buffer_load_dwordx4 v1, s[8:11], s38 offen offset:1024 lds
buffer_load_dwordx4 v1, s[8:11], s38 offen offset:2048 lds
buffer_load_dwordx4 v1, s[8:11], s38 offen offset:3072 lds
C_nokx0:
s_cmp_lg_u32 s17, 2
s_cbranch_scc1 C_novx0
s_mov_b32 m0, 16384
s_nop 0
buffer_load_dwordx4 v1, s[8:11], s29 offen lds
buffer_load_dwordx4 v1, s[8:11], s29 offen offset:1024 lds
buffer_load_dwordx4 v1, s[8:11], s29 offen offset:2048 lds
buffer_load_dwordx4 v1, s[8:11], s29 offen offset:3072 lds
s_mov_b32 m0, 20480
s_add_u32 s38, s29, 4096
buffer_load_dwordx4 v1, s[8:11], s38 offen lds
buffer_load_dwordx4 v1, s[8:11], s38 offen offset:1024 lds
buffer_load_dwordx4 v1, s[8:11], s38 offen offset:2048 lds
buffer_load_dwordx4 v1, s[8:11], s38 offen offset:3072 lds
C_novx0:
s_add_u32 s28, s28, 262144
s_add_u32 s29, s29, 262144
s_cmp_lg_u32 s17, 0
s_cbranch_scc1 C_nomem0
v_cmp_gt_u32 vcc, 32, v50
s_nop 0
s_cbranch_vccz C_initok
C_initwait:
v_mov_b32 v52, 32
global_load_dword v50, v52, s[52:53] sc1
s_waitcnt vmcnt(0)
v_cmp_gt_u32 vcc, 32, v50
s_nop 0
s_cbranch_vccz C_initok
s_cmp_eq_u32 s37, 0
s_cbranch_scc1 C_initok
s_sub_u32 s37, s37, 1
s_branch C_initwait
C_initok:
v_lshl_or_b32 v44, v45, 16, v44
v_lshl_or_b32 v45, v47, 16, v46
buffer_store_dwordx2 v[44:45], v8, s[8:11], s21 offen
C_nomem0:
v_lshrrev_b32 v21, 4, v1
ds_read_b128 v[56:59], v17 offset:0
ds_read_b128 v[60:63], v17 offset:256
s_waitcnt lgkmcnt(0)
v_perm_b32 v24, v60, v56, s50
v_perm_b32 v32, v60, v56, s51
v_perm_b32 v40, v61, v57, s50
v_perm_b32 v48, v61, v57, s51
v_perm_b32 v192, v62, v58, s50
v_perm_b32 v200, v62, v58, s51
v_perm_b32 v208, v63, v59, s50
v_perm_b32 v216, v63, v59, s51
ds_read_b128 v[56:59], v17 offset:2048
ds_read_b128 v[60:63], v17 offset:2304
s_waitcnt lgkmcnt(0)
v_perm_b32 v25, v60, v56, s50
v_perm_b32 v33, v60, v56, s51
v_perm_b32 v41, v61, v57, s50
v_perm_b32 v49, v61, v57, s51
v_perm_b32 v193, v62, v58, s50
v_perm_b32 v201, v62, v58, s51
v_perm_b32 v209, v63, v59, s50
v_perm_b32 v217, v63, v59, s51
ds_read_b128 v[56:59], v17 offset:512
ds_read_b128 v[60:63], v17 offset:768
s_waitcnt lgkmcnt(0)
v_perm_b32 v26, v60, v56, s50
v_perm_b32 v34, v60, v56, s51
v_perm_b32 v42, v61, v57, s50
v_perm_b32 v50, v61, v57, s51
v_perm_b32 v194, v62, v58, s50
v_perm_b32 v202, v62, v58, s51
v_perm_b32 v210, v63, v59, s50
v_perm_b32 v218, v63, v59, s51
ds_read_b128 v[56:59], v17 offset:2560
ds_read_b128 v[60:63], v17 offset:2816
s_waitcnt lgkmcnt(0)
v_perm_b32 v27, v60, v56, s50
v_perm_b32 v35, v60, v56, s51
v_perm_b32 v43, v61, v57, s50
v_perm_b32 v51, v61, v57, s51
v_perm_b32 v195, v62, v58, s50
v_perm_b32 v203, v62, v58, s51
v_perm_b32 v211, v63, v59, s50
v_perm_b32 v219, v63, v59, s51
ds_read_b128 v[56:59], v17 offset:8192
ds_read_b128 v[60:63], v17 offset:8448
s_waitcnt lgkmcnt(0)
v_perm_b32 v28, v60, v56, s50
v_perm_b32 v36, v60, v56, s51
v_perm_b32 v44, v61, v57, s50
v_perm_b32 v52, v61, v57, s51
v_perm_b32 v196, v62, v58, s50
v_perm_b32 v204, v62, v58, s51
v_perm_b32 v212, v63, v59, s50
v_perm_b32 v220, v63, v59, s51
ds_read_b128 v[56:59], v17 offset:10240
ds_read_b128 v[60:63], v17 offset:10496
s_waitcnt lgkmcnt(0)
v_perm_b32 v29, v60, v56, s50
v_perm_b32 v37, v60, v56, s51
v_perm_b32 v45, v61, v57, s50
v_perm_b32 v53, v61, v57, s51
v_perm_b32 v197, v62, v58, s50
v_perm_b32 v205, v62, v58, s51
v_perm_b32 v213, v63, v59, s50
v_perm_b32 v221, v63, v59, s51
ds_read_b128 v[56:59], v17 offset:8704
ds_read_b128 v[60:63], v17 offset:8960
s_waitcnt lgkmcnt(0)
v_perm_b32 v30, v60, v56, s50
v_perm_b32 v38, v60, v56, s51
v_perm_b32 v46, v61, v57, s50
v_perm_b32 v54, v61, v57, s51
v_perm_b32 v198, v62, v58, s50
v_perm_b32 v206, v62, v58, s51
v_perm_b32 v214, v63, v59, s50
v_perm_b32 v222, v63, v59, s51
ds_read_b128 v[56:59], v17 offset:10752
ds_read_b128 v[60:63], v17 offset:11008
s_waitcnt lgkmcnt(0)
v_perm_b32 v31, v60, v56, s50
v_perm_b32 v39, v60, v56, s51
v_perm_b32 v47, v61, v57, s50
v_perm_b32 v55, v61, v57, s51
v_perm_b32 v199, v62, v58, s50
v_perm_b32 v207, v62, v58, s51
v_perm_b32 v215, v63, v59, s50
v_perm_b32 v223, v63, v59, s51
s_waitcnt lgkmcnt(0)
ds_write_b128 v9, v[64:67] offset:0
ds_write_b128 v9, v[68:71] offset:1024
ds_write_b128 v9, v[72:75] offset:2048
ds_write_b128 v9, v[76:79] offset:3072
ds_write_b128 v9, v[80:83] offset:4096
ds_write_b128 v9, v[84:87] offset:5120
ds_write_b128 v9, v[88:91] offset:6144
ds_write_b128 v9, v[92:95] offset:7168
ds_write_b128 v9, v[96:99] offset:8192
ds_write_b128 v9, v[100:103] offset:9216
ds_write_b128 v9, v[104:107] offset:10240
ds_write_b128 v9, v[108:111] offset:11264
ds_write_b128 v9, v[112:115] offset:12288
ds_write_b128 v9, v[116:119] offset:13312
ds_write_b128 v9, v[120:123] offset:14336
ds_write_b128 v9, v[124:127] offset:15360
s_waitcnt lgkmcnt(0)
ds_read_b128 v[56:59], v17 offset:16384
ds_read_b128 v[60:63], v17 offset:16640
s_waitcnt lgkmcnt(0)
v_perm_b32 v64, v60, v56, s50
v_perm_b32 v72, v60, v56, s51
v_perm_b32 v80, v61, v57, s50
v_perm_b32 v88, v61, v57, s51
v_perm_b32 v224, v62, v58, s50
v_perm_b32 v232, v62, v58, s51
v_perm_b32 v240, v63, v59, s50
v_perm_b32 v248, v63, v59, s51
ds_read_b128 v[56:59], v17 offset:18432
ds_read_b128 v[60:63], v17 offset:18688
s_waitcnt lgkmcnt(0)
v_perm_b32 v65, v60, v56, s50
v_perm_b32 v73, v60, v56, s51
v_perm_b32 v81, v61, v57, s50
v_perm_b32 v89, v61, v57, s51
v_perm_b32 v225, v62, v58, s50
v_perm_b32 v233, v62, v58, s51
v_perm_b32 v241, v63, v59, s50
v_perm_b32 v249, v63, v59, s51
ds_read_b128 v[56:59], v17 offset:16896
ds_read_b128 v[60:63], v17 offset:17152
s_waitcnt lgkmcnt(0)
v_perm_b32 v66, v60, v56, s50
v_perm_b32 v74, v60, v56, s51
v_perm_b32 v82, v61, v57, s50
v_perm_b32 v90, v61, v57, s51
v_perm_b32 v226, v62, v58, s50
v_perm_b32 v234, v62, v58, s51
v_perm_b32 v242, v63, v59, s50
v_perm_b32 v250, v63, v59, s51
ds_read_b128 v[56:59], v17 offset:18944
ds_read_b128 v[60:63], v17 offset:19200
s_waitcnt lgkmcnt(0)
v_perm_b32 v67, v60, v56, s50
v_perm_b32 v75, v60, v56, s51
v_perm_b32 v83, v61, v57, s50
v_perm_b32 v91, v61, v57, s51
v_perm_b32 v227, v62, v58, s50
v_perm_b32 v235, v62, v58, s51
v_perm_b32 v243, v63, v59, s50
v_perm_b32 v251, v63, v59, s51
ds_read_b128 v[56:59], v17 offset:24576
ds_read_b128 v[60:63], v17 offset:24832
s_waitcnt lgkmcnt(0)
v_perm_b32 v68, v60, v56, s50
v_perm_b32 v76, v60, v56, s51
v_perm_b32 v84, v61, v57, s50
v_perm_b32 v92, v61, v57, s51
v_perm_b32 v228, v62, v58, s50
v_perm_b32 v236, v62, v58, s51
v_perm_b32 v244, v63, v59, s50
v_perm_b32 v252, v63, v59, s51
ds_read_b128 v[56:59], v17 offset:26624
ds_read_b128 v[60:63], v17 offset:26880
s_waitcnt lgkmcnt(0)
v_perm_b32 v69, v60, v56, s50
v_perm_b32 v77, v60, v56, s51
v_perm_b32 v85, v61, v57, s50
v_perm_b32 v93, v61, v57, s51
v_perm_b32 v229, v62, v58, s50
v_perm_b32 v237, v62, v58, s51
v_perm_b32 v245, v63, v59, s50
v_perm_b32 v253, v63, v59, s51
ds_read_b128 v[56:59], v17 offset:25088
ds_read_b128 v[60:63], v17 offset:25344
s_waitcnt lgkmcnt(0)
v_perm_b32 v70, v60, v56, s50
v_perm_b32 v78, v60, v56, s51
v_perm_b32 v86, v61, v57, s50
v_perm_b32 v94, v61, v57, s51
v_perm_b32 v230, v62, v58, s50
v_perm_b32 v238, v62, v58, s51
v_perm_b32 v246, v63, v59, s50
v_perm_b32 v254, v63, v59, s51
ds_read_b128 v[56:59], v17 offset:27136
ds_read_b128 v[60:63], v17 offset:27392
s_waitcnt lgkmcnt(0)
v_perm_b32 v71, v60, v56, s50
v_perm_b32 v79, v60, v56, s51
v_perm_b32 v87, v61, v57, s50
v_perm_b32 v95, v61, v57, s51
v_perm_b32 v231, v62, v58, s50
v_perm_b32 v239, v62, v58, s51
v_perm_b32 v247, v63, v59, s50
v_perm_b32 v255, v63, v59, s51
s_waitcnt lgkmcnt(0)
ds_write_b128 v9, v[24:27] offset:16384
ds_write_b128 v9, v[28:31] offset:17408
ds_write_b128 v9, v[64:67] offset:24576
ds_write_b128 v9, v[68:71] offset:25600
ds_write_b128 v9, v[32:35] offset:18432
ds_write_b128 v9, v[36:39] offset:19456
ds_write_b128 v9, v[72:75] offset:26624
ds_write_b128 v9, v[76:79] offset:27648
ds_write_b128 v9, v[40:43] offset:20480
ds_write_b128 v9, v[44:47] offset:21504
ds_write_b128 v9, v[80:83] offset:28672
ds_write_b128 v9, v[84:87] offset:29696
ds_write_b128 v9, v[48:51] offset:22528
ds_write_b128 v9, v[52:55] offset:23552
ds_write_b128 v9, v[88:91] offset:30720
ds_write_b128 v9, v[92:95] offset:31744
s_waitcnt vmcnt(0) lgkmcnt(0)
s_lshr_b32 s38, s16, 3
s_mul_i32 s38, s38, 73728
s_and_b32 s39, s16, 7
s_lshl_b32 s39, s39, 8
s_add_u32 s38, s38, s39
s_add_u32 s60, s38, 83886080
s_add_u32 s61, s38, 83895296
s_add_u32 s62, s38, 83904512
s_add_u32 s63, s38, 83913728
s_add_u32 s64, s38, 83922944
s_add_u32 s65, s38, 83932160
s_add_u32 s66, s38, 83941376
s_add_u32 s67, s38, 83950592
s_mul_i32 s38, s17, 27648
s_add_u32 s57, s60, s38
s_add_u32 s57, s57, 1545216
s_add_u32 s58, s57, 9216
s_add_u32 s59, s57, 18432
s_waitcnt vmcnt(0) lgkmcnt(0)
s_barrier
s_cmp_eq_u32 s17, 1
s_cbranch_scc1 C_enter1
s_cmp_eq_u32 s17, 2
s_cbranch_scc1 C_enter2
s_cmp_eq_u32 s17, 3
s_cbranch_scc1 C_enter3
C_enter0:
ds_read_b128 v[96:99], v9 offset:8192
ds_read_b128 v[100:103], v9 offset:9216
ds_read_b128 v[104:107], v9 offset:10240
ds_read_b128 v[108:111], v9 offset:11264
ds_read_b128 v[112:115], v9 offset:12288
ds_read_b128 v[116:119], v9 offset:13312
ds_read_b128 v[120:123], v9 offset:14336
ds_read_b128 v[124:127], v9 offset:15360
ds_read_b128 v[64:67], v9 offset:0
ds_read_b128 v[68:71], v9 offset:1024
ds_read_b128 v[72:75], v9 offset:2048
ds_read_b128 v[76:79], v9 offset:3072
ds_read_b128 v[80:83], v9 offset:4096
ds_read_b128 v[84:87], v9 offset:5120
ds_read_b128 v[88:91], v9 offset:6144
ds_read_b128 v[92:95], v9 offset:7168
v_mov_b64 v[40:41], 0
v_mov_b64 v[42:43], 0
v_mov_b64 v[44:45], 0
v_mov_b64 v[46:47], 0
v_mov_b64 v[48:49], 0
v_mov_b64 v[50:51], 0
v_mov_b64 v[52:53], 0
v_mov_b64 v[54:55], 0
v_mov_b64 v[56:57], 0
v_mov_b64 v[58:59], 0
v_mov_b64 v[60:61], 0
v_mov_b64 v[62:63], 0
s_add_u32 s57, s60, 1572864
s_add_u32 s58, s61, 1572864
s_add_u32 s59, s62, 1572864
C0_step:
buffer_load_dwordx4 v[16:19], v2, s[8:11], s19 offen sc1
buffer_load_dwordx4 v[20:23], v2, s[8:11], s19 offen offset:1024 sc1
s_nop 15
s_nop 15
buffer_load_dwordx4 v[24:27], v2, s[8:11], s19 offen sc1
buffer_load_dwordx4 v[28:31], v2, s[8:11], s19 offen offset:1024 sc1
C0_ag:
s_waitcnt vmcnt(2)
v_max3_u32 v0, v16, v18, v20
v_max_u32 v0, v0, v22
v_cmp_eq_u32 vcc, -1, v0
s_nop 0
s_cbranch_vccz C0_agA
buffer_load_dwordx4 v[16:19], v2, s[8:11], s19 offen sc1
buffer_load_dwordx4 v[20:23], v2, s[8:11], s19 offen offset:1024 sc1
s_waitcnt vmcnt(2)
v_max3_u32 v0, v24, v26, v28
v_max_u32 v0, v0, v30
v_cmp_eq_u32 vcc, -1, v0
s_nop 0
s_cbranch_vccz C0_agB
buffer_load_dwordx4 v[24:27], v2, s[8:11], s19 offen sc1
buffer_load_dwordx4 v[28:31], v2, s[8:11], s19 offen offset:1024 sc1
s_cmp_eq_u32 s37, 0
s_cbranch_scc1 C0_agA
s_sub_u32 s37, s37, 1
s_branch C0_ag
C0_agB:
ds_write_b128 v2, v[24:27] offset:0
ds_write_b128 v2, v[28:31] offset:1024
v_smfmac_f32_16x16x64_bf16 v[40:43], v[24:27], a[0:7], v10
v_smfmac_f32_16x16x64_bf16 v[44:47], v[24:27], a[8:15], v10
v_smfmac_f32_16x16x64_bf16 v[40:43], v[28:31], a[16:23], v10
v_smfmac_f32_16x16x64_bf16 v[44:47], v[28:31], a[24:31], v10
s_waitcnt lgkmcnt(8)
v_smfmac_f32_16x16x64_bf16 v[48:51], v[24:27], v[64:71], v10
v_xor_b32 v0, 2048, v2
s_waitcnt lgkmcnt(6)
v_smfmac_f32_16x16x64_bf16 v[52:55], v[24:27], v[72:79], v10
s_waitcnt lgkmcnt(0)
s_barrier
v_smfmac_f32_16x16x64_bf16 v[48:51], v[28:31], v[80:87], v10
ds_read_b128 v[64:67], v0 offset:0
v_smfmac_f32_16x16x64_bf16 v[52:55], v[28:31], v[88:95], v10
ds_read_b128 v[68:71], v0 offset:1024
v_xor_b32 v0, 4096, v2
v_smfmac_f32_16x16x64_bf16 v[56:59], v[24:27], a[128:135], v10
ds_read_b128 v[72:75], v0 offset:0
v_smfmac_f32_16x16x64_bf16 v[60:63], v[24:27], a[136:143], v10
ds_read_b128 v[76:79], v0 offset:1024
v_xor_b32 v0, 6144, v2
v_smfmac_f32_16x16x64_bf16 v[56:59], v[28:31], a[144:151], v10
ds_read_b128 v[80:83], v0 offset:0
v_smfmac_f32_16x16x64_bf16 v[60:63], v[28:31], a[152:159], v10
ds_read_b128 v[84:87], v0 offset:1024
s_branch C0_agJ
C0_agA:
ds_write_b128 v2, v[16:19] offset:0
ds_write_b128 v2, v[20:23] offset:1024
v_smfmac_f32_16x16x64_bf16 v[40:43], v[16:19], a[0:7], v10
v_smfmac_f32_16x16x64_bf16 v[44:47], v[16:19], a[8:15], v10
v_smfmac_f32_16x16x64_bf16 v[40:43], v[20:23], a[16:23], v10
v_smfmac_f32_16x16x64_bf16 v[44:47], v[20:23], a[24:31], v10
s_waitcnt lgkmcnt(6)
v_smfmac_f32_16x16x64_bf16 v[48:51], v[16:19], v[64:71], v10
v_xor_b32 v0, 2048, v2
s_waitcnt lgkmcnt(4)
v_smfmac_f32_16x16x64_bf16 v[52:55], v[16:19], v[72:79], v10
s_waitcnt lgkmcnt(0)
s_barrier
v_smfmac_f32_16x16x64_bf16 v[48:51], v[20:23], v[80:87], v10
ds_read_b128 v[64:67], v0 offset:0
v_smfmac_f32_16x16x64_bf16 v[52:55], v[20:23], v[88:95], v10
ds_read_b128 v[68:71], v0 offset:1024
v_xor_b32 v0, 4096, v2
v_smfmac_f32_16x16x64_bf16 v[56:59], v[16:19], a[128:135], v10
ds_read_b128 v[72:75], v0 offset:0
v_smfmac_f32_16x16x64_bf16 v[60:63], v[16:19], a[136:143], v10
ds_read_b128 v[76:79], v0 offset:1024
v_xor_b32 v0, 6144, v2
v_smfmac_f32_16x16x64_bf16 v[56:59], v[20:23], a[144:151], v10
ds_read_b128 v[80:83], v0 offset:0
v_smfmac_f32_16x16x64_bf16 v[60:63], v[20:23], a[152:159], v10
ds_read_b128 v[84:87], v0 offset:1024
C0_agJ:
s_waitcnt lgkmcnt(5)
v_smfmac_f32_16x16x64_bf16 v[40:43], v[64:67], a[32:39], v10
ds_read_b128 v[88:91], v9 offset:18432
v_smfmac_f32_16x16x64_bf16 v[44:47], v[64:67], a[40:47], v10
ds_read_b128 v[92:95], v9 offset:19456
s_waitcnt lgkmcnt(6)
v_smfmac_f32_16x16x64_bf16 v[40:43], v[68:71], a[48:55], v10
v_smfmac_f32_16x16x64_bf16 v[44:47], v[68:71], a[56:63], v10
s_waitcnt lgkmcnt(5)
v_smfmac_f32_16x16x64_bf16 v[40:43], v[72:75], a[64:71], v10
v_mov_b32 v36, -1
v_smfmac_f32_16x16x64_bf16 v[44:47], v[72:75], a[72:79], v10
v_mov_b32 v37, -1
s_waitcnt lgkmcnt(4)
v_smfmac_f32_16x16x64_bf16 v[40:43], v[76:79], a[80:87], v10
v_mov_b32 v38, -1
v_smfmac_f32_16x16x64_bf16 v[44:47], v[76:79], a[88:95], v10
v_mov_b32 v39, -1
s_waitcnt lgkmcnt(3)
v_smfmac_f32_16x16x64_bf16 v[40:43], v[80:83], a[96:103], v10
s_waitcnt vmcnt(0)
ds_read_b128 v[16:19], v2 offset:16384
v_smfmac_f32_16x16x64_bf16 v[44:47], v[80:83], a[104:111], v10
ds_read_b128 v[20:23], v2 offset:17408
buffer_store_dwordx2 v[36:37], v8, s[8:11], s20 offen
s_waitcnt lgkmcnt(4)
v_smfmac_f32_16x16x64_bf16 v[40:43], v[84:87], a[112:119], v10
v_smfmac_f32_16x16x64_bf16 v[44:47], v[84:87], a[120:127], v10
buffer_store_dwordx4 v[36:39], v11, s[8:11], s57 offen
v_smfmac_f32_16x16x64_bf16 v[48:51], v[64:67], v[96:103], v10
v_smfmac_f32_16x16x64_bf16 v[52:55], v[64:67], v[104:111], v10
v_add_f32 v40, v40, v42
v_smfmac_f32_16x16x64_bf16 v[48:51], v[68:71], v[112:119], v10
v_add_f32 v41, v41, v43
v_smfmac_f32_16x16x64_bf16 v[52:55], v[68:71], v[120:127], v10
ds_read_b128 v[96:99], v1 offset:8192
buffer_store_dwordx4 v[36:39], v11, s[8:11], s58 offen
v_add_f32 v44, v44, v46
v_smfmac_f32_16x16x64_bf16 v[48:51], v[72:75], v[128:135], v10
ds_read_b128 v[100:103], v1 offset:9216
v_add_f32 v45, v45, v47
v_smfmac_f32_16x16x64_bf16 v[52:55], v[72:75], v[136:143], v10
ds_read_b128 v[104:107], v1 offset:10240
v_cvt_pk_bf16_f32 v40, v40, v44
v_smfmac_f32_16x16x64_bf16 v[48:51], v[76:79], v[144:151], v10
ds_read_b128 v[108:111], v1 offset:11264
v_cvt_pk_bf16_f32 v41, v41, v45
v_smfmac_f32_16x16x64_bf16 v[52:55], v[76:79], v[152:159], v10
ds_write_b32 v3, v40 offset:24576
ds_write_b32 v3, v41 offset:24864
buffer_store_dwordx4 v[36:39], v11, s[8:11], s59 offen
v_smfmac_f32_16x16x64_bf16 v[48:51], v[80:83], v[160:167], v10
ds_read_b128 v[112:115], v1 offset:12288
v_smfmac_f32_16x16x64_bf16 v[52:55], v[80:83], v[168:175], v10
ds_read_b128 v[116:119], v1 offset:13312
v_smfmac_f32_16x16x64_bf16 v[48:51], v[84:87], v[176:183], v10
ds_read_b128 v[120:123], v1 offset:14336
v_smfmac_f32_16x16x64_bf16 v[52:55], v[84:87], v[184:191], v10
ds_read_b128 v[124:127], v1 offset:15360
v_smfmac_f32_16x16x64_bf16 v[56:59], v[64:67], a[160:167], v10
v_smfmac_f32_16x16x64_bf16 v[60:63], v[64:67], a[168:175], v10
v_add_f32 v48, v48, v50
v_smfmac_f32_16x16x64_bf16 v[56:59], v[68:71], a[176:183], v10
v_add_f32 v49, v49, v51
v_smfmac_f32_16x16x64_bf16 v[60:63], v[68:71], a[184:191], v10
v_add_f32 v52, v52, v54
v_smfmac_f32_16x16x64_bf16 v[56:59], v[72:75], a[192:199], v10
v_add_f32 v53, v53, v55
v_smfmac_f32_16x16x64_bf16 v[60:63], v[72:75], a[200:207], v10
v_cvt_pk_bf16_f32 v48, v48, v52
v_smfmac_f32_16x16x64_bf16 v[56:59], v[76:79], a[208:215], v10
v_cvt_pk_bf16_f32 v49, v49, v53
v_smfmac_f32_16x16x64_bf16 v[60:63], v[76:79], a[216:223], v10
ds_write_b32 v3, v48 offset:26880
ds_write_b32 v3, v49 offset:27168
v_smfmac_f32_16x16x64_bf16 v[56:59], v[80:83], a[224:231], v10
v_smfmac_f32_16x16x64_bf16 v[60:63], v[80:83], a[232:239], v10
s_waitcnt lgkmcnt(0)
s_barrier
v_smfmac_f32_16x16x64_bf16 v[56:59], v[84:87], a[240:247], v10
ds_read_b128 v[24:27], v4 offset:24576
ds_read_b128 v[28:31], v4 offset:24704
v_smfmac_f32_16x16x64_bf16 v[60:63], v[84:87], a[248:255], v10
ds_read_b128 v[32:35], v4 offset:24640
ds_read_b128 v[36:39], v4 offset:24768
s_cmp_eq_u32 s18, 63
s_cbranch_scc1 C0_last
ds_read_b128 v[64:67], v6 offset:26880
s_waitcnt lgkmcnt(4)
v_mfma_f32_16x16x32_bf16 v[40:43], v[96:99], v[24:27], 0
ds_read_b128 v[68:71], v6 offset:27008
s_waitcnt lgkmcnt(4)
v_mfma_f32_16x16x32_bf16 v[40:43], v[100:103], v[28:31], v[40:43]
ds_read_b128 v[72:75], v6 offset:26944
s_waitcnt lgkmcnt(4)
v_mfma_f32_16x16x32_bf16 v[40:43], v[104:107], v[32:35], v[40:43]
ds_read_b128 v[76:79], v6 offset:27072
s_waitcnt lgkmcnt(4)
v_mfma_f32_16x16x32_bf16 v[40:43], v[108:111], v[36:39], v[40:43]
ds_read_b128 v[80:83], v9 offset:30720
v_mfma_f32_16x16x32_bf16 v[44:47], v[112:115], v[24:27], 0
ds_read_b128 v[84:87], v9 offset:31744
v_mfma_f32_16x16x32_bf16 v[44:47], v[116:119], v[28:31], v[44:47]
v_mfma_f32_16x16x32_bf16 v[44:47], v[120:123], v[32:35], v[44:47]
v_mfma_f32_16x16x32_bf16 v[44:47], v[124:127], v[36:39], v[44:47]
ds_read_b128 v[96:99], v9 offset:26624
s_waitcnt lgkmcnt(6)
v_mfma_f32_16x16x32_bf16 v[48:51], v[64:67], v[24:27], 0
ds_read_b128 v[100:103], v9 offset:27648
v_max3_f32 v52, v40, v41, v42
s_waitcnt lgkmcnt(6)
v_mfma_f32_16x16x32_bf16 v[48:51], v[68:71], v[28:31], v[48:51]
ds_read_b128 v[104:107], v9 offset:20480
v_max3_f32 v53, v43, v44, v45
s_waitcnt lgkmcnt(6)
v_mfma_f32_16x16x32_bf16 v[48:51], v[72:75], v[32:35], v[48:51]
ds_read_b128 v[108:111], v9 offset:21504
v_max3_f32 v52, v52, v46, v47
s_waitcnt lgkmcnt(6)
v_mfma_f32_16x16x32_bf16 v[48:51], v[76:79], v[36:39], v[48:51]
ds_read_b128 v[112:115], v9 offset:16384
v_max_f32 v52, v52, v53
ds_read_b128 v[116:119], v9 offset:17408
ds_read_b128 v[120:123], v9 offset:24576
v_mov_b32 v28, s24
v_mov_b32 v29, s24
v_mov_b32 v30, s24
s_nop 0
v_max3_f32 v52, v52, v48, v49
v_mov_b32 v53, v52
v_mov_b32 v31, s24
v_mov_b32 v50, 0
v_permlane32_swap_b32 v52, v53
v_max_f32 v52, v52, v53
v_mov_b32 v53, v52
ds_read_b128 v[124:127], v9 offset:25600
s_nop 0
v_permlane16_swap_b32 v52, v53
v_max_f32 v52, v52, v53
v_mul_f32 v52, s36, v52
ds_read_b128 v[64:67], v9 offset:28672
ds_read_b128 v[68:71], v9 offset:29696
ds_read_b128 v[72:75], v9 offset:22528
ds_read_b128 v[76:79], v9 offset:23552
v_fma_f32 v40, v40, s36, -v52
v_fma_f32 v41, v41, s36, -v52
v_fma_f32 v42, v42, s36, -v52
v_fma_f32 v43, v43, s36, -v52
v_fma_f32 v44, v44, s36, -v52
v_fma_f32 v45, v45, s36, -v52
v_fma_f32 v46, v46, s36, -v52
v_fma_f32 v47, v47, s36, -v52
v_fma_f32 v48, v48, s36, -v52
v_fma_f32 v49, v49, s36, -v52
v_exp_f32 v40, v40
v_exp_f32 v41, v41
v_exp_f32 v42, v42
v_exp_f32 v43, v43
v_exp_f32 v44, v44
v_exp_f32 v45, v45
v_exp_f32 v46, v46
v_exp_f32 v47, v47
v_exp_f32 v48, v48
v_exp_f32 v49, v49
v_cvt_pk_bf16_f32 v52, v40, v41
v_cvt_pk_bf16_f32 v53, v42, v43
v_cvt_pk_bf16_f32 v54, v44, v45
v_cvt_pk_bf16_f32 v55, v46, v47
s_nop 1
v_mfma_f32_16x16x32_bf16 v[40:43], v[16:19], v[52:55], 0
v_cvt_pk_bf16_f32 v51, v48, v49
v_cvt_pk_bf16_f32 v48, v48, v49
v_mfma_f32_16x16x32_bf16 v[44:47], v[20:23], v[52:55], 0
v_add_f32 v56, v56, v58
v_add_f32 v57, v57, v59
v_mfma_f32_16x16x32_bf16 v[24:27], v[28:31], v[52:55], 0
v_add_f32 v60, v60, v62
v_add_f32 v61, v61, v63
v_mov_b32 v49, 0
v_cvt_pk_bf16_f32 v36, v56, v57
v_cvt_pk_bf16_f32 v37, v60, v61
s_nop 0
v_mfma_f32_16x16x16_bf16 v[24:27], v[28:29], v[48:49], v[24:27]
v_mfma_f32_16x16x16_bf16 v[40:43], v[36:37], v[48:49], v[40:43]
v_mfma_f32_16x16x16_bf16 v[44:47], v[36:37], v[50:51], v[44:47]
v_lshrrev_b32 v0, 1, v1
v_mov_b32 v52, 0
v_mov_b32 v53, 0
v_mov_b32 v54, 0
v_mov_b32 v55, 0
v_rcp_f32 v24, v24
s_nop 0
v_pk_mul_f32 v[40:41], v[40:41], v[24:25] op_sel_hi:[1,0]
v_pk_mul_f32 v[42:43], v[42:43], v[24:25] op_sel_hi:[1,0]
v_pk_mul_f32 v[44:45], v[44:45], v[24:25] op_sel_hi:[1,0]
v_pk_mul_f32 v[46:47], v[46:47], v[24:25] op_sel_hi:[1,0]
v_cvt_pk_bf16_f32 v40, v40, v44
v_cvt_pk_bf16_f32 v41, v41, v45
v_cvt_pk_bf16_f32 v42, v42, v46
v_cvt_pk_bf16_f32 v43, v43, v47
ds_write2_b32 v5, v40, v41 offset0:0 offset1:2
ds_write2_b32 v5, v42, v43 offset0:32 offset1:34
v_mov_b64 v[56:57], 0
v_mov_b64 v[58:59], 0
v_mov_b64 v[60:61], 0
v_mov_b64 v[62:63], 0
v_mov_b64 v[24:25], 0
v_mov_b64 v[26:27], 0
v_mov_b64 v[28:29], 0
v_mov_b64 v[30:31], 0
s_waitcnt lgkmcnt(0)
s_barrier
ds_read_b128 v[16:19], v6 offset:29184
ds_read_b128 v[20:23], v6 offset:29248
ds_write_b64 v0, v[36:37] offset:24576
v_mov_b64 v[40:41], 0
v_mov_b64 v[42:43], 0
v_mov_b64 v[44:45], 0
v_mov_b64 v[46:47], 0
v_mov_b64 v[48:49], 0
v_mov_b64 v[50:51], 0
s_waitcnt lgkmcnt(2)
v_smfmac_f32_16x16x64_bf16 v[56:59], v[16:19], v[192:199], v10
s_waitcnt lgkmcnt(1)
v_smfmac_f32_16x16x64_bf16 v[56:59], v[20:23], v[224:231], v10
v_smfmac_f32_16x16x64_bf16 v[60:63], v[16:19], v[200:207], v10
v_smfmac_f32_16x16x64_bf16 v[60:63], v[20:23], v[232:239], v10
v_add_f32 v56, v56, v58
v_add_f32 v57, v57, v59
v_smfmac_f32_16x16x64_bf16 v[24:27], v[16:19], v[208:215], v10
v_cvt_pk_bf16_f32 v56, v56, v57
v_smfmac_f32_16x16x64_bf16 v[24:27], v[20:23], v[240:247], v10
v_add_f32 v60, v60, v62
v_add_f32 v61, v61, v63
v_smfmac_f32_16x16x64_bf16 v[28:31], v[16:19], v[216:223], v10
buffer_store_dword v56, v7, s[8:11], s22 offen offset:1024
v_cvt_pk_bf16_f32 v60, v60, v61
v_smfmac_f32_16x16x64_bf16 v[28:31], v[20:23], v[248:255], v10
v_add_f32 v24, v24, v26
v_add_f32 v25, v25, v27
v_smfmac_f32_16x16x64_bf16 v[40:43], v[16:19], v[112:119], v10
buffer_store_dword v60, v7, s[8:11], s22 offen offset:1280
v_cvt_pk_bf16_f32 v24, v24, v25
v_smfmac_f32_16x16x64_bf16 v[40:43], v[20:23], v[120:127], v10
v_add_f32 v28, v28, v30
v_add_f32 v29, v29, v31
v_smfmac_f32_16x16x64_bf16 v[44:47], v[16:19], v[88:95], v10
buffer_store_dword v24, v7, s[8:11], s22 offen offset:1536
v_cvt_pk_bf16_f32 v28, v28, v29
v_smfmac_f32_16x16x64_bf16 v[44:47], v[20:23], v[96:103], v10
v_add_f32 v40, v40, v42
v_add_f32 v41, v41, v43
v_smfmac_f32_16x16x64_bf16 v[48:51], v[16:19], v[104:111], v10
buffer_store_dword v28, v7, s[8:11], s22 offen offset:1792
v_cvt_pk_bf16_f32 v40, v40, v41
v_smfmac_f32_16x16x64_bf16 v[48:51], v[20:23], v[64:71], v10
v_add_f32 v44, v44, v46
v_add_f32 v45, v45, v47
v_smfmac_f32_16x16x64_bf16 v[52:55], v[16:19], v[72:79], v10
buffer_store_dword v40, v7, s[8:11], s22 offen offset:0
v_cvt_pk_bf16_f32 v44, v44, v45
v_smfmac_f32_16x16x64_bf16 v[52:55], v[20:23], v[80:87], v10
v_add_f32 v48, v48, v50
v_add_f32 v49, v49, v51
buffer_store_dword v44, v7, s[8:11], s22 offen offset:256
v_cvt_pk_bf16_f32 v48, v48, v49
s_nop 3
v_add_f32 v52, v52, v54
v_add_f32 v53, v53, v55
buffer_store_dword v48, v7, s[8:11], s22 offen offset:512
v_cvt_pk_bf16_f32 v52, v52, v53
buffer_store_dword v52, v7, s[8:11], s22 offen offset:768
ds_read_b128 v[96:99], v9 offset:8192
ds_read_b128 v[100:103], v9 offset:9216
ds_read_b128 v[104:107], v9 offset:10240
ds_read_b128 v[108:111], v9 offset:11264
ds_read_b128 v[112:115], v9 offset:12288
ds_read_b128 v[116:119], v9 offset:13312
ds_read_b128 v[120:123], v9 offset:14336
ds_read_b128 v[124:127], v9 offset:15360
s_waitcnt vmcnt(8)
s_nop 15
s_nop 15
buffer_load_dwordx4 v[40:43], v11, s[8:11], s60 offen sc1
buffer_load_dwordx4 v[44:47], v11, s[8:11], s61 offen sc1
buffer_load_dwordx4 v[48:51], v11, s[8:11], s62 offen sc1
buffer_load_dwordx4 v[52:55], v11, s[8:11], s63 offen sc1
buffer_load_dwordx4 v[56:59], v11, s[8:11], s64 offen sc1
buffer_load_dwordx4 v[60:63], v11, s[8:11], s65 offen sc1
buffer_load_dwordx4 v[24:27], v11, s[8:11], s66 offen sc1
buffer_load_dwordx4 v[28:31], v11, s[8:11], s67 offen sc1
buffer_load_dwordx4 v[64:67], v11, s[8:11], s60 offen sc1
buffer_load_dwordx4 v[68:71], v11, s[8:11], s61 offen sc1
buffer_load_dwordx4 v[72:75], v11, s[8:11], s62 offen sc1
buffer_load_dwordx4 v[76:79], v11, s[8:11], s63 offen sc1
buffer_load_dwordx4 v[80:83], v11, s[8:11], s64 offen sc1
buffer_load_dwordx4 v[84:87], v11, s[8:11], s65 offen sc1
buffer_load_dwordx4 v[88:91], v11, s[8:11], s66 offen sc1
buffer_load_dwordx4 v[92:95], v11, s[8:11], s67 offen sc1
C_rs:
s_waitcnt vmcnt(15)
v_mfma_f32_16x16x32_bf16 v[32:35], v[40:43], v[12:15], 0
v_mov_b32 v0, v40
s_waitcnt vmcnt(14)
v_mfma_f32_16x16x32_bf16 v[32:35], v[44:47], v[12:15], v[32:35]
v_max_u32 v0, v0, v44
s_waitcnt vmcnt(13)
v_mfma_f32_16x16x32_bf16 v[32:35], v[48:51], v[12:15], v[32:35]
v_max_u32 v0, v0, v48
s_waitcnt vmcnt(12)
v_mfma_f32_16x16x32_bf16 v[32:35], v[52:55], v[12:15], v[32:35]
v_max_u32 v0, v0, v52
s_waitcnt vmcnt(11)
v_mfma_f32_16x16x32_bf16 v[32:35], v[56:59], v[12:15], v[32:35]
v_max_u32 v0, v0, v56
s_waitcnt vmcnt(10)
v_mfma_f32_16x16x32_bf16 v[32:35], v[60:63], v[12:15], v[32:35]
v_max_u32 v0, v0, v60
s_waitcnt vmcnt(9)
v_mfma_f32_16x16x32_bf16 v[32:35], v[24:27], v[12:15], v[32:35]
v_max_u32 v0, v0, v24
s_waitcnt vmcnt(8)
v_mfma_f32_16x16x32_bf16 v[32:35], v[28:31], v[12:15], v[32:35]
v_max_u32 v0, v0, v28
v_cmp_eq_u32 vcc, -1, v0
s_nop 0
s_cbranch_vccz C_rsA
buffer_load_dwordx4 v[40:43], v11, s[8:11], s60 offen sc1
buffer_load_dwordx4 v[44:47], v11, s[8:11], s61 offen sc1
buffer_load_dwordx4 v[48:51], v11, s[8:11], s62 offen sc1
buffer_load_dwordx4 v[52:55], v11, s[8:11], s63 offen sc1
buffer_load_dwordx4 v[56:59], v11, s[8:11], s64 offen sc1
buffer_load_dwordx4 v[60:63], v11, s[8:11], s65 offen sc1
buffer_load_dwordx4 v[24:27], v11, s[8:11], s66 offen sc1
buffer_load_dwordx4 v[28:31], v11, s[8:11], s67 offen sc1
s_waitcnt vmcnt(15)
v_mfma_f32_16x16x32_bf16 v[36:39], v[64:67], v[12:15], 0
v_mov_b32 v0, v64
s_waitcnt vmcnt(14)
v_mfma_f32_16x16x32_bf16 v[36:39], v[68:71], v[12:15], v[36:39]
v_max_u32 v0, v0, v68
s_waitcnt vmcnt(13)
v_mfma_f32_16x16x32_bf16 v[36:39], v[72:75], v[12:15], v[36:39]
v_max_u32 v0, v0, v72
s_waitcnt vmcnt(12)
v_mfma_f32_16x16x32_bf16 v[36:39], v[76:79], v[12:15], v[36:39]
v_max_u32 v0, v0, v76
s_waitcnt vmcnt(11)
v_mfma_f32_16x16x32_bf16 v[36:39], v[80:83], v[12:15], v[36:39]
v_max_u32 v0, v0, v80
s_waitcnt vmcnt(10)
v_mfma_f32_16x16x32_bf16 v[36:39], v[84:87], v[12:15], v[36:39]
v_max_u32 v0, v0, v84
s_waitcnt vmcnt(9)
v_mfma_f32_16x16x32_bf16 v[36:39], v[88:91], v[12:15], v[36:39]
v_max_u32 v0, v0, v88
s_waitcnt vmcnt(8)
v_mfma_f32_16x16x32_bf16 v[36:39], v[92:95], v[12:15], v[36:39]
v_max_u32 v0, v0, v92
v_cmp_eq_u32 vcc, -1, v0
s_nop 0
s_cbranch_vccz C_rsB
buffer_load_dwordx4 v[64:67], v11, s[8:11], s60 offen sc1
buffer_load_dwordx4 v[68:71], v11, s[8:11], s61 offen sc1
buffer_load_dwordx4 v[72:75], v11, s[8:11], s62 offen sc1
buffer_load_dwordx4 v[76:79], v11, s[8:11], s63 offen sc1
buffer_load_dwordx4 v[80:83], v11, s[8:11], s64 offen sc1
buffer_load_dwordx4 v[84:87], v11, s[8:11], s65 offen sc1
buffer_load_dwordx4 v[88:91], v11, s[8:11], s66 offen sc1
buffer_load_dwordx4 v[92:95], v11, s[8:11], s67 offen sc1
s_cmp_eq_u32 s37, 0
s_cbranch_scc1 C_rsA
s_sub_u32 s37, s37, 1
s_branch C_rs
C_rsB:
s_nop 3
v_cvt_pk_bf16_f32 v32, v36, v37
v_cvt_pk_bf16_f32 v33, v38, v39
s_branch C_rsJ
C_rsA:
s_nop 3
v_cvt_pk_bf16_f32 v32, v32, v33
v_cvt_pk_bf16_f32 v33, v34, v35
C_rsJ:
buffer_store_dwordx2 v[32:33], v8, s[8:11], s20 offen
s_waitcnt lgkmcnt(8)
s_barrier
s_xor_b32 s19, s19, 0x2000
s_waitcnt vmcnt(1)
ds_read_b128 v[64:67], v9 offset:0
ds_read_b128 v[68:71], v9 offset:1024
ds_read_b128 v[72:75], v9 offset:2048
ds_read_b128 v[76:79], v9 offset:3072
ds_read_b128 v[80:83], v9 offset:4096
ds_read_b128 v[84:87], v9 offset:5120
ds_read_b128 v[88:91], v9 offset:6144
ds_read_b128 v[92:95], v9 offset:7168
v_mov_b64 v[40:41], 0
v_mov_b64 v[42:43], 0
v_mov_b64 v[44:45], 0
v_mov_b64 v[46:47], 0
v_mov_b64 v[48:49], 0
v_mov_b64 v[50:51], 0
v_mov_b64 v[52:53], 0
v_mov_b64 v[54:55], 0
v_mov_b64 v[56:57], 0
v_mov_b64 v[58:59], 0
v_mov_b64 v[60:61], 0
v_mov_b64 v[62:63], 0
s_add_u32 s22, s22, 524288
s_bitset0_b32 s22, 21
s_add_u32 s60, s60, 524288
s_bitset0_b32 s60, 21
s_add_u32 s61, s61, 524288
s_bitset0_b32 s61, 21
s_add_u32 s62, s62, 524288
s_bitset0_b32 s62, 21
s_add_u32 s63, s63, 524288
s_bitset0_b32 s63, 21
s_add_u32 s64, s64, 524288
s_bitset0_b32 s64, 21
s_add_u32 s65, s65, 524288
s_bitset0_b32 s65, 21
s_add_u32 s66, s66, 524288
s_bitset0_b32 s66, 21
s_add_u32 s67, s67, 524288
s_bitset0_b32 s67, 21
s_add_u32 s57, s57, 524288
s_bitset0_b32 s57, 21
s_add_u32 s58, s58, 524288
s_bitset0_b32 s58, 21
s_add_u32 s59, s59, 524288
s_bitset0_b32 s59, 21
s_xor_b32 s20, s20, 0x2000
s_add_u32 s18, s18, 1
s_cmp_lt_u32 s18, 64
s_cbranch_scc1 C0_step
C0_last:
s_waitcnt lgkmcnt(0)
s_nop 7
v_add_f32 v56, v56, v58
v_add_f32 v57, v57, v59
v_add_f32 v60, v60, v62
v_add_f32 v61, v61, v63
v_cvt_pk_bf16_f32 v56, v56, v57
v_cvt_pk_bf16_f32 v57, v60, v61
v_lshrrev_b32 v0, 1, v1
s_add_u32 s38, s55, 0
buffer_store_dwordx2 v[56:57], v0, s[8:11], s38 offen sc1
s_waitcnt vmcnt(0)
s_barrier
s_branch C_exit
C_enter1:
ds_read_b128 v[96:99], v9 offset:8192
ds_read_b128 v[100:103], v9 offset:9216
ds_read_b128 v[104:107], v9 offset:10240
ds_read_b128 v[108:111], v9 offset:11264
ds_read_b128 v[112:115], v9 offset:12288
ds_read_b128 v[116:119], v9 offset:13312
ds_read_b128 v[120:123], v9 offset:14336
ds_read_b128 v[124:127], v9 offset:15360
ds_read_b128 v[64:67], v9 offset:0
ds_read_b128 v[68:71], v9 offset:1024
ds_read_b128 v[72:75], v9 offset:2048
ds_read_b128 v[76:79], v9 offset:3072
ds_read_b128 v[80:83], v9 offset:4096
ds_read_b128 v[84:87], v9 offset:5120
ds_read_b128 v[88:91], v9 offset:6144
ds_read_b128 v[92:95], v9 offset:7168
v_mov_b64 v[40:41], 0
v_mov_b64 v[42:43], 0
v_mov_b64 v[44:45], 0
v_mov_b64 v[46:47], 0
v_mov_b64 v[48:49], 0
v_mov_b64 v[50:51], 0
v_mov_b64 v[52:53], 0
v_mov_b64 v[54:55], 0
v_mov_b64 v[56:57], 0
v_mov_b64 v[58:59], 0
v_mov_b64 v[60:61], 0
v_mov_b64 v[62:63], 0
s_add_u32 s57, s63, 1572864
v_mov_b32 v12, -1
v_mov_b32 v13, -1
v_mov_b32 v14, -1
v_mov_b32 v15, -1
C1_step:
ds_read_b128 v[32:35], v1 offset:24576
ds_read_b128 v[36:39], v1 offset:25600
s_nop 15
buffer_load_dwordx4 v[16:19], v2, s[8:11], s19 offen sc1
buffer_load_dwordx4 v[20:23], v2, s[8:11], s19 offen offset:1024 sc1
s_nop 15
s_nop 15
buffer_load_dwordx4 v[24:27], v2, s[8:11], s19 offen sc1
buffer_load_dwordx4 v[28:31], v2, s[8:11], s19 offen offset:1024 sc1
C1_ag:
s_waitcnt vmcnt(2)
v_max3_u32 v0, v16, v18, v20
v_max_u32 v0, v0, v22
v_cmp_eq_u32 vcc, -1, v0
s_nop 0
s_cbranch_vccz C1_agA
buffer_load_dwordx4 v[16:19], v2, s[8:11], s19 offen sc1
buffer_load_dwordx4 v[20:23], v2, s[8:11], s19 offen offset:1024 sc1
s_waitcnt vmcnt(2)
v_max3_u32 v0, v24, v26, v28
v_max_u32 v0, v0, v30
v_cmp_eq_u32 vcc, -1, v0
s_nop 0
s_cbranch_vccz C1_agB
buffer_load_dwordx4 v[24:27], v2, s[8:11], s19 offen sc1
buffer_load_dwordx4 v[28:31], v2, s[8:11], s19 offen offset:1024 sc1
s_cmp_eq_u32 s37, 0
s_cbranch_scc1 C1_agA
s_sub_u32 s37, s37, 1
s_branch C1_ag
C1_agB:
ds_write_b128 v2, v[24:27] offset:0
ds_write_b128 v2, v[28:31] offset:1024
v_smfmac_f32_16x16x64_bf16 v[40:43], v[24:27], a[0:7], v10
v_smfmac_f32_16x16x64_bf16 v[44:47], v[24:27], a[8:15], v10
v_smfmac_f32_16x16x64_bf16 v[40:43], v[28:31], a[16:23], v10
v_smfmac_f32_16x16x64_bf16 v[44:47], v[28:31], a[24:31], v10
s_waitcnt lgkmcnt(10)
v_smfmac_f32_16x16x64_bf16 v[48:51], v[24:27], v[64:71], v10
v_xor_b32 v0, 2048, v2
s_waitcnt lgkmcnt(8)
v_smfmac_f32_16x16x64_bf16 v[52:55], v[24:27], v[72:79], v10
s_waitcnt lgkmcnt(0)
s_barrier
v_smfmac_f32_16x16x64_bf16 v[48:51], v[28:31], v[80:87], v10
ds_read_b128 v[64:67], v0 offset:0
v_smfmac_f32_16x16x64_bf16 v[52:55], v[28:31], v[88:95], v10
ds_read_b128 v[68:71], v0 offset:1024
v_xor_b32 v0, 4096, v2
v_smfmac_f32_16x16x64_bf16 v[56:59], v[24:27], a[128:135], v10
ds_read_b128 v[72:75], v0 offset:0
v_smfmac_f32_16x16x64_bf16 v[60:63], v[24:27], a[136:143], v10
ds_read_b128 v[76:79], v0 offset:1024
v_xor_b32 v0, 6144, v2
v_smfmac_f32_16x16x64_bf16 v[56:59], v[28:31], a[144:151], v10
ds_read_b128 v[80:83], v0 offset:0
v_smfmac_f32_16x16x64_bf16 v[60:63], v[28:31], a[152:159], v10
ds_read_b128 v[84:87], v0 offset:1024
s_branch C1_agJ
C1_agA:
ds_write_b128 v2, v[16:19] offset:0
ds_write_b128 v2, v[20:23] offset:1024
v_smfmac_f32_16x16x64_bf16 v[40:43], v[16:19], a[0:7], v10
v_smfmac_f32_16x16x64_bf16 v[44:47], v[16:19], a[8:15], v10
v_smfmac_f32_16x16x64_bf16 v[40:43], v[20:23], a[16:23], v10
v_smfmac_f32_16x16x64_bf16 v[44:47], v[20:23], a[24:31], v10
s_waitcnt lgkmcnt(6)
v_smfmac_f32_16x16x64_bf16 v[48:51], v[16:19], v[64:71], v10
v_xor_b32 v0, 2048, v2
s_waitcnt lgkmcnt(4)
v_smfmac_f32_16x16x64_bf16 v[52:55], v[16:19], v[72:79], v10
s_waitcnt lgkmcnt(0)
s_barrier
v_smfmac_f32_16x16x64_bf16 v[48:51], v[20:23], v[80:87], v10
ds_read_b128 v[64:67], v0 offset:0
v_smfmac_f32_16x16x64_bf16 v[52:55], v[20:23], v[88:95], v10
ds_read_b128 v[68:71], v0 offset:1024
v_xor_b32 v0, 4096, v2
v_smfmac_f32_16x16x64_bf16 v[56:59], v[16:19], a[128:135], v10
ds_read_b128 v[72:75], v0 offset:0
v_smfmac_f32_16x16x64_bf16 v[60:63], v[16:19], a[136:143], v10
ds_read_b128 v[76:79], v0 offset:1024
v_xor_b32 v0, 6144, v2
v_smfmac_f32_16x16x64_bf16 v[56:59], v[20:23], a[144:151], v10
ds_read_b128 v[80:83], v0 offset:0
v_smfmac_f32_16x16x64_bf16 v[60:63], v[20:23], a[152:159], v10
ds_read_b128 v[84:87], v0 offset:1024
C1_agJ:
s_waitcnt lgkmcnt(5)
v_smfmac_f32_16x16x64_bf16 v[40:43], v[64:67], a[32:39], v10
ds_read_b128 v[88:91], v9 offset:18432
buffer_store_dwordx4 v[32:35], v1, s[8:11], s31 offen offset:0 sc1
v_smfmac_f32_16x16x64_bf16 v[44:47], v[64:67], a[40:47], v10
ds_read_b128 v[92:95], v9 offset:19456
s_waitcnt lgkmcnt(6)
v_smfmac_f32_16x16x64_bf16 v[40:43], v[68:71], a[48:55], v10
v_smfmac_f32_16x16x64_bf16 v[44:47], v[68:71], a[56:63], v10
buffer_store_dwordx4 v[36:39], v1, s[8:11], s31 offen offset:1024 sc1
s_waitcnt lgkmcnt(5)
v_smfmac_f32_16x16x64_bf16 v[40:43], v[72:75], a[64:71], v10
v_smfmac_f32_16x16x64_bf16 v[44:47], v[72:75], a[72:79], v10
s_waitcnt lgkmcnt(4)
v_smfmac_f32_16x16x64_bf16 v[40:43], v[76:79], a[80:87], v10
v_smfmac_f32_16x16x64_bf16 v[44:47], v[76:79], a[88:95], v10
s_waitcnt lgkmcnt(3)
v_smfmac_f32_16x16x64_bf16 v[40:43], v[80:83], a[96:103], v10
s_waitcnt vmcnt(2)
ds_read_b128 v[16:19], v2 offset:16384
v_smfmac_f32_16x16x64_bf16 v[44:47], v[80:83], a[104:111], v10
ds_read_b128 v[20:23], v2 offset:17408
s_waitcnt lgkmcnt(4)
v_smfmac_f32_16x16x64_bf16 v[40:43], v[84:87], a[112:119], v10
v_smfmac_f32_16x16x64_bf16 v[44:47], v[84:87], a[120:127], v10
v_smfmac_f32_16x16x64_bf16 v[48:51], v[64:67], v[96:103], v10
v_smfmac_f32_16x16x64_bf16 v[52:55], v[64:67], v[104:111], v10
v_add_f32 v40, v40, v42
v_smfmac_f32_16x16x64_bf16 v[48:51], v[68:71], v[112:119], v10
v_add_f32 v41, v41, v43
v_smfmac_f32_16x16x64_bf16 v[52:55], v[68:71], v[120:127], v10
ds_read_b128 v[96:99], v1 offset:8192
v_add_f32 v44, v44, v46
v_smfmac_f32_16x16x64_bf16 v[48:51], v[72:75], v[128:135], v10
ds_read_b128 v[100:103], v1 offset:9216
v_add_f32 v45, v45, v47
v_smfmac_f32_16x16x64_bf16 v[52:55], v[72:75], v[136:143], v10
ds_read_b128 v[104:107], v1 offset:10240
buffer_store_dwordx4 v[12:15], v11, s[8:11], s57 offen
v_cvt_pk_bf16_f32 v40, v40, v44
v_smfmac_f32_16x16x64_bf16 v[48:51], v[76:79], v[144:151], v10
ds_read_b128 v[108:111], v1 offset:11264
v_cvt_pk_bf16_f32 v41, v41, v45
v_smfmac_f32_16x16x64_bf16 v[52:55], v[76:79], v[152:159], v10
ds_write_b32 v3, v40 offset:24576
ds_write_b32 v3, v41 offset:24864
v_smfmac_f32_16x16x64_bf16 v[48:51], v[80:83], v[160:167], v10
ds_read_b128 v[112:115], v1 offset:12288
v_smfmac_f32_16x16x64_bf16 v[52:55], v[80:83], v[168:175], v10
ds_read_b128 v[116:119], v1 offset:13312
v_smfmac_f32_16x16x64_bf16 v[48:51], v[84:87], v[176:183], v10
ds_read_b128 v[120:123], v1 offset:14336
v_smfmac_f32_16x16x64_bf16 v[52:55], v[84:87], v[184:191], v10
ds_read_b128 v[124:127], v1 offset:15360
v_smfmac_f32_16x16x64_bf16 v[56:59], v[64:67], a[160:167], v10
v_smfmac_f32_16x16x64_bf16 v[60:63], v[64:67], a[168:175], v10
v_add_f32 v48, v48, v50
v_smfmac_f32_16x16x64_bf16 v[56:59], v[68:71], a[176:183], v10
v_add_f32 v49, v49, v51
v_smfmac_f32_16x16x64_bf16 v[60:63], v[68:71], a[184:191], v10
v_add_f32 v52, v52, v54
v_smfmac_f32_16x16x64_bf16 v[56:59], v[72:75], a[192:199], v10
v_add_f32 v53, v53, v55
v_smfmac_f32_16x16x64_bf16 v[60:63], v[72:75], a[200:207], v10
v_cvt_pk_bf16_f32 v48, v48, v52
v_smfmac_f32_16x16x64_bf16 v[56:59], v[76:79], a[208:215], v10
v_cvt_pk_bf16_f32 v49, v49, v53
v_smfmac_f32_16x16x64_bf16 v[60:63], v[76:79], a[216:223], v10
ds_write_b32 v3, v48 offset:26880
ds_write_b32 v3, v49 offset:27168
v_smfmac_f32_16x16x64_bf16 v[56:59], v[80:83], a[224:231], v10
v_smfmac_f32_16x16x64_bf16 v[60:63], v[80:83], a[232:239], v10
s_waitcnt lgkmcnt(0)
s_barrier
v_smfmac_f32_16x16x64_bf16 v[56:59], v[84:87], a[240:247], v10
ds_read_b128 v[24:27], v4 offset:24576
ds_read_b128 v[28:31], v4 offset:24704
v_smfmac_f32_16x16x64_bf16 v[60:63], v[84:87], a[248:255], v10
ds_read_b128 v[32:35], v4 offset:24640
ds_read_b128 v[36:39], v4 offset:24768
s_cmp_eq_u32 s18, 63
s_cbranch_scc1 C1_last
ds_read_b128 v[64:67], v6 offset:26880
s_waitcnt lgkmcnt(4)
v_mfma_f32_16x16x32_bf16 v[40:43], v[96:99], v[24:27], 0
ds_read_b128 v[68:71], v6 offset:27008
s_mov_b32 m0, 8192
s_nop 0
buffer_load_dwordx4 v1, s[8:11], s28 offen lds
buffer_load_dwordx4 v1, s[8:11], s28 offen offset:1024 lds
s_waitcnt lgkmcnt(4)
v_mfma_f32_16x16x32_bf16 v[40:43], v[100:103], v[28:31], v[40:43]
ds_read_b128 v[72:75], v6 offset:26944
buffer_load_dwordx4 v1, s[8:11], s28 offen offset:2048 lds
buffer_load_dwordx4 v1, s[8:11], s28 offen offset:3072 lds
s_waitcnt lgkmcnt(4)
v_mfma_f32_16x16x32_bf16 v[40:43], v[104:107], v[32:35], v[40:43]
ds_read_b128 v[76:79], v6 offset:27072
s_mov_b32 m0, 12288
s_add_u32 s39, s28, 4096
buffer_load_dwordx4 v1, s[8:11], s39 offen lds
buffer_load_dwordx4 v1, s[8:11], s39 offen offset:1024 lds
s_waitcnt lgkmcnt(4)
v_mfma_f32_16x16x32_bf16 v[40:43], v[108:111], v[36:39], v[40:43]
ds_read_b128 v[80:83], v9 offset:30720
v_mfma_f32_16x16x32_bf16 v[44:47], v[112:115], v[24:27], 0
ds_read_b128 v[84:87], v9 offset:31744
v_mfma_f32_16x16x32_bf16 v[44:47], v[116:119], v[28:31], v[44:47]
v_mfma_f32_16x16x32_bf16 v[44:47], v[120:123], v[32:35], v[44:47]
v_mfma_f32_16x16x32_bf16 v[44:47], v[124:127], v[36:39], v[44:47]
ds_read_b128 v[96:99], v9 offset:26624
s_waitcnt lgkmcnt(6)
v_mfma_f32_16x16x32_bf16 v[48:51], v[64:67], v[24:27], 0
ds_read_b128 v[100:103], v9 offset:27648
v_max3_f32 v52, v40, v41, v42
s_waitcnt lgkmcnt(6)
v_mfma_f32_16x16x32_bf16 v[48:51], v[68:71], v[28:31], v[48:51]
ds_read_b128 v[104:107], v9 offset:20480
v_max3_f32 v53, v43, v44, v45
s_waitcnt lgkmcnt(6)
v_mfma_f32_16x16x32_bf16 v[48:51], v[72:75], v[32:35], v[48:51]
ds_read_b128 v[108:111], v9 offset:21504
v_max3_f32 v52, v52, v46, v47
s_waitcnt lgkmcnt(6)
v_mfma_f32_16x16x32_bf16 v[48:51], v[76:79], v[36:39], v[48:51]
ds_read_b128 v[112:115], v9 offset:16384
v_max_f32 v52, v52, v53
ds_read_b128 v[116:119], v9 offset:17408
ds_read_b128 v[120:123], v9 offset:24576
v_mov_b32 v28, s24
v_mov_b32 v29, s24
v_mov_b32 v30, s24
s_nop 0
v_max3_f32 v52, v52, v48, v49
v_mov_b32 v53, v52
v_mov_b32 v31, s24
v_mov_b32 v50, 0
v_permlane32_swap_b32 v52, v53
v_max_f32 v52, v52, v53
v_mov_b32 v53, v52
ds_read_b128 v[124:127], v9 offset:25600
s_nop 0
v_permlane16_swap_b32 v52, v53
v_max_f32 v52, v52, v53
v_mul_f32 v52, s36, v52
ds_read_b128 v[64:67], v9 offset:28672
ds_read_b128 v[68:71], v9 offset:29696
ds_read_b128 v[72:75], v9 offset:22528
ds_read_b128 v[76:79], v9 offset:23552
v_fma_f32 v40, v40, s36, -v52
v_fma_f32 v41, v41, s36, -v52
v_fma_f32 v42, v42, s36, -v52
v_fma_f32 v43, v43, s36, -v52
v_fma_f32 v44, v44, s36, -v52
v_fma_f32 v45, v45, s36, -v52
v_fma_f32 v46, v46, s36, -v52
v_fma_f32 v47, v47, s36, -v52
v_fma_f32 v48, v48, s36, -v52
v_fma_f32 v49, v49, s36, -v52
v_exp_f32 v40, v40
v_exp_f32 v41, v41
v_exp_f32 v42, v42
v_exp_f32 v43, v43
v_exp_f32 v44, v44
v_exp_f32 v45, v45
v_exp_f32 v46, v46
v_exp_f32 v47, v47
v_exp_f32 v48, v48
v_exp_f32 v49, v49
v_cvt_pk_bf16_f32 v52, v40, v41
v_cvt_pk_bf16_f32 v53, v42, v43
v_cvt_pk_bf16_f32 v54, v44, v45
v_cvt_pk_bf16_f32 v55, v46, v47
s_nop 1
v_mfma_f32_16x16x32_bf16 v[40:43], v[16:19], v[52:55], 0
v_cvt_pk_bf16_f32 v51, v48, v49
v_cvt_pk_bf16_f32 v48, v48, v49
v_mfma_f32_16x16x32_bf16 v[44:47], v[20:23], v[52:55], 0
v_add_f32 v56, v56, v58
v_add_f32 v57, v57, v59
v_mfma_f32_16x16x32_bf16 v[24:27], v[28:31], v[52:55], 0
v_add_f32 v60, v60, v62
v_add_f32 v61, v61, v63
v_mov_b32 v49, 0
v_cvt_pk_bf16_f32 v36, v56, v57
v_cvt_pk_bf16_f32 v37, v60, v61
s_nop 0
v_mfma_f32_16x16x16_bf16 v[24:27], v[28:29], v[48:49], v[24:27]
v_mfma_f32_16x16x16_bf16 v[40:43], v[36:37], v[48:49], v[40:43]
v_mfma_f32_16x16x16_bf16 v[44:47], v[36:37], v[50:51], v[44:47]
v_lshrrev_b32 v0, 1, v1
v_mov_b32 v52, 0
v_mov_b32 v53, 0
v_mov_b32 v54, 0
v_mov_b32 v55, 0
v_rcp_f32 v24, v24
s_nop 0
v_pk_mul_f32 v[40:41], v[40:41], v[24:25] op_sel_hi:[1,0]
v_pk_mul_f32 v[42:43], v[42:43], v[24:25] op_sel_hi:[1,0]
v_pk_mul_f32 v[44:45], v[44:45], v[24:25] op_sel_hi:[1,0]
v_pk_mul_f32 v[46:47], v[46:47], v[24:25] op_sel_hi:[1,0]
v_cvt_pk_bf16_f32 v40, v40, v44
v_cvt_pk_bf16_f32 v41, v41, v45
v_cvt_pk_bf16_f32 v42, v42, v46
v_cvt_pk_bf16_f32 v43, v43, v47
ds_write2_b32 v5, v40, v41 offset0:0 offset1:2
ds_write2_b32 v5, v42, v43 offset0:32 offset1:34
v_mov_b64 v[56:57], 0
v_mov_b64 v[58:59], 0
v_mov_b64 v[60:61], 0
v_mov_b64 v[62:63], 0
v_mov_b64 v[24:25], 0
v_mov_b64 v[26:27], 0
v_mov_b64 v[28:29], 0
v_mov_b64 v[30:31], 0
s_waitcnt lgkmcnt(0)
s_barrier
ds_read_b128 v[16:19], v6 offset:29184
ds_read_b128 v[20:23], v6 offset:29248
ds_write_b64 v0, v[36:37] offset:25088
v_mov_b64 v[40:41], 0
v_mov_b64 v[42:43], 0
v_mov_b64 v[44:45], 0
v_mov_b64 v[46:47], 0
v_mov_b64 v[48:49], 0
v_mov_b64 v[50:51], 0
s_waitcnt lgkmcnt(2)
v_smfmac_f32_16x16x64_bf16 v[56:59], v[16:19], v[192:199], v10
s_waitcnt lgkmcnt(1)
v_smfmac_f32_16x16x64_bf16 v[56:59], v[20:23], v[224:231], v10
v_smfmac_f32_16x16x64_bf16 v[60:63], v[16:19], v[200:207], v10
v_smfmac_f32_16x16x64_bf16 v[60:63], v[20:23], v[232:239], v10
v_add_f32 v56, v56, v58
v_add_f32 v57, v57, v59
v_smfmac_f32_16x16x64_bf16 v[24:27], v[16:19], v[208:215], v10
v_cvt_pk_bf16_f32 v56, v56, v57
v_smfmac_f32_16x16x64_bf16 v[24:27], v[20:23], v[240:247], v10
v_add_f32 v60, v60, v62
v_add_f32 v61, v61, v63
v_smfmac_f32_16x16x64_bf16 v[28:31], v[16:19], v[216:223], v10
buffer_store_dword v56, v7, s[8:11], s22 offen offset:1024
v_cvt_pk_bf16_f32 v60, v60, v61
v_smfmac_f32_16x16x64_bf16 v[28:31], v[20:23], v[248:255], v10
v_add_f32 v24, v24, v26
v_add_f32 v25, v25, v27
v_smfmac_f32_16x16x64_bf16 v[40:43], v[16:19], v[112:119], v10
buffer_store_dword v60, v7, s[8:11], s22 offen offset:1280
v_cvt_pk_bf16_f32 v24, v24, v25
v_smfmac_f32_16x16x64_bf16 v[40:43], v[20:23], v[120:127], v10
v_add_f32 v28, v28, v30
v_add_f32 v29, v29, v31
v_smfmac_f32_16x16x64_bf16 v[44:47], v[16:19], v[88:95], v10
buffer_store_dword v24, v7, s[8:11], s22 offen offset:1536
v_cvt_pk_bf16_f32 v28, v28, v29
v_smfmac_f32_16x16x64_bf16 v[44:47], v[20:23], v[96:103], v10
v_add_f32 v40, v40, v42
v_add_f32 v41, v41, v43
v_smfmac_f32_16x16x64_bf16 v[48:51], v[16:19], v[104:111], v10
buffer_store_dword v28, v7, s[8:11], s22 offen offset:1792
v_cvt_pk_bf16_f32 v40, v40, v41
v_smfmac_f32_16x16x64_bf16 v[48:51], v[20:23], v[64:71], v10
v_add_f32 v44, v44, v46
v_add_f32 v45, v45, v47
v_smfmac_f32_16x16x64_bf16 v[52:55], v[16:19], v[72:79], v10
buffer_store_dword v40, v7, s[8:11], s22 offen offset:0
v_cvt_pk_bf16_f32 v44, v44, v45
v_smfmac_f32_16x16x64_bf16 v[52:55], v[20:23], v[80:87], v10
v_add_f32 v48, v48, v50
v_add_f32 v49, v49, v51
buffer_store_dword v44, v7, s[8:11], s22 offen offset:256
v_cvt_pk_bf16_f32 v48, v48, v49
s_nop 3
v_add_f32 v52, v52, v54
v_add_f32 v53, v53, v55
buffer_store_dword v48, v7, s[8:11], s22 offen offset:512
v_cvt_pk_bf16_f32 v52, v52, v53
buffer_store_dword v52, v7, s[8:11], s22 offen offset:768
ds_read_b128 v[96:99], v9 offset:8192
ds_read_b128 v[100:103], v9 offset:9216
ds_read_b128 v[104:107], v9 offset:10240
ds_read_b128 v[108:111], v9 offset:11264
ds_read_b128 v[112:115], v9 offset:12288
ds_read_b128 v[116:119], v9 offset:13312
ds_read_b128 v[120:123], v9 offset:14336
ds_read_b128 v[124:127], v9 offset:15360
ds_read_b128 v[64:67], v9 offset:0
ds_read_b128 v[68:71], v9 offset:1024
ds_read_b128 v[72:75], v9 offset:2048
ds_read_b128 v[76:79], v9 offset:3072
ds_read_b128 v[80:83], v9 offset:4096
ds_read_b128 v[84:87], v9 offset:5120
ds_read_b128 v[88:91], v9 offset:6144
ds_read_b128 v[92:95], v9 offset:7168
v_mov_b64 v[40:41], 0
v_mov_b64 v[42:43], 0
v_mov_b64 v[44:45], 0
v_mov_b64 v[46:47], 0
v_mov_b64 v[48:49], 0
v_mov_b64 v[50:51], 0
v_mov_b64 v[52:53], 0
v_mov_b64 v[54:55], 0
v_mov_b64 v[56:57], 0
v_mov_b64 v[58:59], 0
v_mov_b64 v[60:61], 0
v_mov_b64 v[62:63], 0
s_add_u32 s22, s22, 524288
s_bitset0_b32 s22, 21
s_add_u32 s57, s57, 524288
s_bitset0_b32 s57, 21
s_xor_b32 s19, s19, 0x2000
s_add_u32 s28, s28, 262144
s_add_u32 s29, s29, 262144
s_add_u32 s31, s31, 65536
s_add_u32 s18, s18, 1
s_waitcnt vmcnt(0)
s_waitcnt lgkmcnt(8)
s_barrier
s_cmp_lt_u32 s18, 64
s_cbranch_scc1 C1_step
C1_last:
s_waitcnt lgkmcnt(0)
s_nop 7
v_add_f32 v56, v56, v58
v_add_f32 v57, v57, v59
v_add_f32 v60, v60, v62
v_add_f32 v61, v61, v63
v_cvt_pk_bf16_f32 v56, v56, v57
v_cvt_pk_bf16_f32 v57, v60, v61
v_lshrrev_b32 v0, 1, v1
s_add_u32 s38, s55, 512
buffer_store_dwordx2 v[56:57], v0, s[8:11], s38 offen sc1
s_waitcnt vmcnt(0)
s_barrier
s_branch C_exit
C_enter2:
ds_read_b128 v[96:99], v9 offset:8192
ds_read_b128 v[100:103], v9 offset:9216
ds_read_b128 v[104:107], v9 offset:10240
ds_read_b128 v[108:111], v9 offset:11264
ds_read_b128 v[112:115], v9 offset:12288
ds_read_b128 v[116:119], v9 offset:13312
ds_read_b128 v[120:123], v9 offset:14336
ds_read_b128 v[124:127], v9 offset:15360
ds_read_b128 v[64:67], v9 offset:0
ds_read_b128 v[68:71], v9 offset:1024
ds_read_b128 v[72:75], v9 offset:2048
ds_read_b128 v[76:79], v9 offset:3072
ds_read_b128 v[80:83], v9 offset:4096
ds_read_b128 v[84:87], v9 offset:5120
ds_read_b128 v[88:91], v9 offset:6144
ds_read_b128 v[92:95], v9 offset:7168
v_mov_b64 v[40:41], 0
v_mov_b64 v[42:43], 0
v_mov_b64 v[44:45], 0
v_mov_b64 v[46:47], 0
v_mov_b64 v[48:49], 0
v_mov_b64 v[50:51], 0
v_mov_b64 v[52:53], 0
v_mov_b64 v[54:55], 0
v_mov_b64 v[56:57], 0
v_mov_b64 v[58:59], 0
v_mov_b64 v[60:61], 0
v_mov_b64 v[62:63], 0
s_add_u32 s57, s64, 1572864
s_add_u32 s58, s65, 1572864
s_add_u32 s59, s66, 1572864
v_mov_b32 v12, -1
v_mov_b32 v13, -1
v_mov_b32 v14, -1
v_mov_b32 v15, -1
C2_step:
s_nop 15
buffer_load_dwordx4 v[16:19], v2, s[8:11], s19 offen sc1
buffer_load_dwordx4 v[20:23], v2, s[8:11], s19 offen offset:1024 sc1
s_nop 15
s_nop 15
buffer_load_dwordx4 v[24:27], v2, s[8:11], s19 offen sc1
buffer_load_dwordx4 v[28:31], v2, s[8:11], s19 offen offset:1024 sc1
C2_ag:
s_waitcnt vmcnt(2)
v_max3_u32 v0, v16, v18, v20
v_max_u32 v0, v0, v22
v_cmp_eq_u32 vcc, -1, v0
s_nop 0
s_cbranch_vccz C2_agA
buffer_load_dwordx4 v[16:19], v2, s[8:11], s19 offen sc1
buffer_load_dwordx4 v[20:23], v2, s[8:11], s19 offen offset:1024 sc1
s_waitcnt vmcnt(2)
v_max3_u32 v0, v24, v26, v28
v_max_u32 v0, v0, v30
v_cmp_eq_u32 vcc, -1, v0
s_nop 0
s_cbranch_vccz C2_agB
buffer_load_dwordx4 v[24:27], v2, s[8:11], s19 offen sc1
buffer_load_dwordx4 v[28:31], v2, s[8:11], s19 offen offset:1024 sc1
s_cmp_eq_u32 s37, 0
s_cbranch_scc1 C2_agA
s_sub_u32 s37, s37, 1
s_branch C2_ag
C2_agB:
ds_write_b128 v2, v[24:27] offset:0
ds_write_b128 v2, v[28:31] offset:1024
v_smfmac_f32_16x16x64_bf16 v[40:43], v[24:27], a[0:7], v10
v_smfmac_f32_16x16x64_bf16 v[44:47], v[24:27], a[8:15], v10
v_smfmac_f32_16x16x64_bf16 v[40:43], v[28:31], a[16:23], v10
v_smfmac_f32_16x16x64_bf16 v[44:47], v[28:31], a[24:31], v10
s_waitcnt lgkmcnt(8)
v_smfmac_f32_16x16x64_bf16 v[48:51], v[24:27], v[64:71], v10
v_xor_b32 v0, 2048, v2
s_waitcnt lgkmcnt(6)
v_smfmac_f32_16x16x64_bf16 v[52:55], v[24:27], v[72:79], v10
s_waitcnt lgkmcnt(0)
s_barrier
v_smfmac_f32_16x16x64_bf16 v[48:51], v[28:31], v[80:87], v10
ds_read_b128 v[64:67], v0 offset:0
v_smfmac_f32_16x16x64_bf16 v[52:55], v[28:31], v[88:95], v10
ds_read_b128 v[68:71], v0 offset:1024
v_xor_b32 v0, 4096, v2
v_smfmac_f32_16x16x64_bf16 v[56:59], v[24:27], a[128:135], v10
ds_read_b128 v[72:75], v0 offset:0
v_smfmac_f32_16x16x64_bf16 v[60:63], v[24:27], a[136:143], v10
ds_read_b128 v[76:79], v0 offset:1024
v_xor_b32 v0, 6144, v2
v_smfmac_f32_16x16x64_bf16 v[56:59], v[28:31], a[144:151], v10
ds_read_b128 v[80:83], v0 offset:0
v_smfmac_f32_16x16x64_bf16 v[60:63], v[28:31], a[152:159], v10
ds_read_b128 v[84:87], v0 offset:1024
s_branch C2_agJ
C2_agA:
ds_write_b128 v2, v[16:19] offset:0
ds_write_b128 v2, v[20:23] offset:1024
v_smfmac_f32_16x16x64_bf16 v[40:43], v[16:19], a[0:7], v10
v_smfmac_f32_16x16x64_bf16 v[44:47], v[16:19], a[8:15], v10
v_smfmac_f32_16x16x64_bf16 v[40:43], v[20:23], a[16:23], v10
v_smfmac_f32_16x16x64_bf16 v[44:47], v[20:23], a[24:31], v10
s_waitcnt lgkmcnt(6)
v_smfmac_f32_16x16x64_bf16 v[48:51], v[16:19], v[64:71], v10
v_xor_b32 v0, 2048, v2
s_waitcnt lgkmcnt(4)
v_smfmac_f32_16x16x64_bf16 v[52:55], v[16:19], v[72:79], v10
s_waitcnt lgkmcnt(0)
s_barrier
v_smfmac_f32_16x16x64_bf16 v[48:51], v[20:23], v[80:87], v10
ds_read_b128 v[64:67], v0 offset:0
v_smfmac_f32_16x16x64_bf16 v[52:55], v[20:23], v[88:95], v10
ds_read_b128 v[68:71], v0 offset:1024
v_xor_b32 v0, 4096, v2
v_smfmac_f32_16x16x64_bf16 v[56:59], v[16:19], a[128:135], v10
ds_read_b128 v[72:75], v0 offset:0
v_smfmac_f32_16x16x64_bf16 v[60:63], v[16:19], a[136:143], v10
ds_read_b128 v[76:79], v0 offset:1024
v_xor_b32 v0, 6144, v2
v_smfmac_f32_16x16x64_bf16 v[56:59], v[20:23], a[144:151], v10
ds_read_b128 v[80:83], v0 offset:0
v_smfmac_f32_16x16x64_bf16 v[60:63], v[20:23], a[152:159], v10
ds_read_b128 v[84:87], v0 offset:1024
C2_agJ:
s_waitcnt lgkmcnt(5)
v_smfmac_f32_16x16x64_bf16 v[40:43], v[64:67], a[32:39], v10
ds_read_b128 v[88:91], v9 offset:18432
v_smfmac_f32_16x16x64_bf16 v[44:47], v[64:67], a[40:47], v10
ds_read_b128 v[92:95], v9 offset:19456
buffer_store_dwordx4 v[12:15], v11, s[8:11], s57 offen
s_waitcnt lgkmcnt(6)
v_smfmac_f32_16x16x64_bf16 v[40:43], v[68:71], a[48:55], v10
v_smfmac_f32_16x16x64_bf16 v[44:47], v[68:71], a[56:63], v10
s_waitcnt lgkmcnt(5)
v_smfmac_f32_16x16x64_bf16 v[40:43], v[72:75], a[64:71], v10
v_smfmac_f32_16x16x64_bf16 v[44:47], v[72:75], a[72:79], v10
s_waitcnt lgkmcnt(4)
v_smfmac_f32_16x16x64_bf16 v[40:43], v[76:79], a[80:87], v10
v_smfmac_f32_16x16x64_bf16 v[44:47], v[76:79], a[88:95], v10
s_waitcnt lgkmcnt(3)
v_smfmac_f32_16x16x64_bf16 v[40:43], v[80:83], a[96:103], v10
s_waitcnt vmcnt(1)
ds_read_b128 v[16:19], v2 offset:16384
buffer_store_dwordx4 v[12:15], v11, s[8:11], s58 offen
v_smfmac_f32_16x16x64_bf16 v[44:47], v[80:83], a[104:111], v10
ds_read_b128 v[20:23], v2 offset:17408
s_waitcnt lgkmcnt(4)
v_smfmac_f32_16x16x64_bf16 v[40:43], v[84:87], a[112:119], v10
v_smfmac_f32_16x16x64_bf16 v[44:47], v[84:87], a[120:127], v10
v_smfmac_f32_16x16x64_bf16 v[48:51], v[64:67], v[96:103], v10
v_smfmac_f32_16x16x64_bf16 v[52:55], v[64:67], v[104:111], v10
buffer_store_dwordx4 v[12:15], v11, s[8:11], s59 offen
v_add_f32 v40, v40, v42
v_smfmac_f32_16x16x64_bf16 v[48:51], v[68:71], v[112:119], v10
v_add_f32 v41, v41, v43
v_smfmac_f32_16x16x64_bf16 v[52:55], v[68:71], v[120:127], v10
ds_read_b128 v[96:99], v1 offset:8192
v_add_f32 v44, v44, v46
v_smfmac_f32_16x16x64_bf16 v[48:51], v[72:75], v[128:135], v10
ds_read_b128 v[100:103], v1 offset:9216
v_add_f32 v45, v45, v47
v_smfmac_f32_16x16x64_bf16 v[52:55], v[72:75], v[136:143], v10
ds_read_b128 v[104:107], v1 offset:10240
v_cvt_pk_bf16_f32 v40, v40, v44
v_smfmac_f32_16x16x64_bf16 v[48:51], v[76:79], v[144:151], v10
ds_read_b128 v[108:111], v1 offset:11264
v_cvt_pk_bf16_f32 v41, v41, v45
v_smfmac_f32_16x16x64_bf16 v[52:55], v[76:79], v[152:159], v10
ds_write_b32 v3, v40 offset:24576
ds_write_b32 v3, v41 offset:24864
v_smfmac_f32_16x16x64_bf16 v[48:51], v[80:83], v[160:167], v10
ds_read_b128 v[112:115], v1 offset:12288
v_smfmac_f32_16x16x64_bf16 v[52:55], v[80:83], v[168:175], v10
ds_read_b128 v[116:119], v1 offset:13312
v_smfmac_f32_16x16x64_bf16 v[48:51], v[84:87], v[176:183], v10
ds_read_b128 v[120:123], v1 offset:14336
v_smfmac_f32_16x16x64_bf16 v[52:55], v[84:87], v[184:191], v10
ds_read_b128 v[124:127], v1 offset:15360
v_smfmac_f32_16x16x64_bf16 v[56:59], v[64:67], a[160:167], v10
s_cmp_ge_u32 s68, 16
s_cbranch_scc1 C2_grpok
v_cmp_ne_u32 vcc, s69, v8
s_nop 1
s_or_b32 s39, vcc_lo, 0x10000
s_ff1_i32_b32 s68, s39
s_add_u32 s38, s18, 2
s_lshr_b32 s38, s38, 2
s_min_u32 s38, s38, 15
s_cmp_lt_u32 s38, s68
s_cbranch_scc1 C2_iss
C2_kvw:
v_lshrrev_b32 v0, 2, v1
v_and_b32 v0, 60, v0
s_lshl_b32 s39, s16, 6
s_add_u32 s39, s39, 82837504
buffer_load_dword v34, v0, s[8:11], s39 offen sc1
s_waitcnt vmcnt(0)
v_cmp_ne_u32 vcc, s69, v34
s_nop 1
s_or_b32 s39, vcc_lo, 0x10000
s_ff1_i32_b32 s68, s39
s_cmp_lt_u32 s38, s68
s_cbranch_scc1 C2_kvw_ok
s_cmp_eq_u32 s37, 0
s_cbranch_scc1 C2_kvw_ok
s_sub_u32 s37, s37, 1
s_sleep 8
s_branch C2_kvw
C2_kvw_ok:
C2_iss:
v_lshrrev_b32 v0, 2, v1
v_and_b32 v0, 60, v0
s_lshl_b32 s39, s16, 6
s_add_u32 s39, s39, 82837504
buffer_load_dword v8, v0, s[8:11], s39 offen sc1
C2_grpok:
v_smfmac_f32_16x16x64_bf16 v[60:63], v[64:67], a[168:175], v10
v_add_f32 v48, v48, v50
v_smfmac_f32_16x16x64_bf16 v[56:59], v[68:71], a[176:183], v10
v_add_f32 v49, v49, v51
v_smfmac_f32_16x16x64_bf16 v[60:63], v[68:71], a[184:191], v10
v_add_f32 v52, v52, v54
v_smfmac_f32_16x16x64_bf16 v[56:59], v[72:75], a[192:199], v10
v_add_f32 v53, v53, v55
v_smfmac_f32_16x16x64_bf16 v[60:63], v[72:75], a[200:207], v10
v_cvt_pk_bf16_f32 v48, v48, v52
v_smfmac_f32_16x16x64_bf16 v[56:59], v[76:79], a[208:215], v10
v_cvt_pk_bf16_f32 v49, v49, v53
v_smfmac_f32_16x16x64_bf16 v[60:63], v[76:79], a[216:223], v10
ds_write_b32 v3, v48 offset:26880
ds_write_b32 v3, v49 offset:27168
v_smfmac_f32_16x16x64_bf16 v[56:59], v[80:83], a[224:231], v10
v_smfmac_f32_16x16x64_bf16 v[60:63], v[80:83], a[232:239], v10
s_waitcnt lgkmcnt(0)
s_barrier
v_smfmac_f32_16x16x64_bf16 v[56:59], v[84:87], a[240:247], v10
ds_read_b128 v[24:27], v4 offset:24576
ds_read_b128 v[28:31], v4 offset:24704
v_smfmac_f32_16x16x64_bf16 v[60:63], v[84:87], a[248:255], v10
ds_read_b128 v[32:35], v4 offset:24640
ds_read_b128 v[36:39], v4 offset:24768
s_cmp_eq_u32 s18, 63
s_cbranch_scc1 C2_last
ds_read_b128 v[64:67], v6 offset:26880
s_waitcnt lgkmcnt(4)
v_mfma_f32_16x16x32_bf16 v[40:43], v[96:99], v[24:27], 0
ds_read_b128 v[68:71], v6 offset:27008
s_mov_b32 m0, 12288
s_add_u32 s39, s28, 4096
buffer_load_dwordx4 v1, s[8:11], s39 offen offset:2048 lds
buffer_load_dwordx4 v1, s[8:11], s39 offen offset:3072 lds
s_waitcnt lgkmcnt(4)
v_mfma_f32_16x16x32_bf16 v[40:43], v[100:103], v[28:31], v[40:43]
ds_read_b128 v[72:75], v6 offset:26944
s_mov_b32 m0, 16384
s_nop 0
buffer_load_dwordx4 v1, s[8:11], s29 offen lds
buffer_load_dwordx4 v1, s[8:11], s29 offen offset:1024 lds
s_waitcnt lgkmcnt(4)
v_mfma_f32_16x16x32_bf16 v[40:43], v[104:107], v[32:35], v[40:43]
ds_read_b128 v[76:79], v6 offset:27072
buffer_load_dwordx4 v1, s[8:11], s29 offen offset:2048 lds
buffer_load_dwordx4 v1, s[8:11], s29 offen offset:3072 lds
s_waitcnt lgkmcnt(4)
v_mfma_f32_16x16x32_bf16 v[40:43], v[108:111], v[36:39], v[40:43]
ds_read_b128 v[80:83], v9 offset:30720
v_mfma_f32_16x16x32_bf16 v[44:47], v[112:115], v[24:27], 0
ds_read_b128 v[84:87], v9 offset:31744
v_mfma_f32_16x16x32_bf16 v[44:47], v[116:119], v[28:31], v[44:47]
v_mfma_f32_16x16x32_bf16 v[44:47], v[120:123], v[32:35], v[44:47]
v_mfma_f32_16x16x32_bf16 v[44:47], v[124:127], v[36:39], v[44:47]
ds_read_b128 v[96:99], v9 offset:26624
s_waitcnt lgkmcnt(6)
v_mfma_f32_16x16x32_bf16 v[48:51], v[64:67], v[24:27], 0
ds_read_b128 v[100:103], v9 offset:27648
v_max3_f32 v52, v40, v41, v42
s_waitcnt lgkmcnt(6)
v_mfma_f32_16x16x32_bf16 v[48:51], v[68:71], v[28:31], v[48:51]
ds_read_b128 v[104:107], v9 offset:20480
v_max3_f32 v53, v43, v44, v45
s_waitcnt lgkmcnt(6)
v_mfma_f32_16x16x32_bf16 v[48:51], v[72:75], v[32:35], v[48:51]
ds_read_b128 v[108:111], v9 offset:21504
v_max3_f32 v52, v52, v46, v47
s_waitcnt lgkmcnt(6)
v_mfma_f32_16x16x32_bf16 v[48:51], v[76:79], v[36:39], v[48:51]
ds_read_b128 v[112:115], v9 offset:16384
v_max_f32 v52, v52, v53
ds_read_b128 v[116:119], v9 offset:17408
ds_read_b128 v[120:123], v9 offset:24576
v_mov_b32 v28, s24
v_mov_b32 v29, s24
v_mov_b32 v30, s24
s_nop 0
v_max3_f32 v52, v52, v48, v49
v_mov_b32 v53, v52
v_mov_b32 v31, s24
v_mov_b32 v50, 0
v_permlane32_swap_b32 v52, v53
v_max_f32 v52, v52, v53
v_mov_b32 v53, v52
ds_read_b128 v[124:127], v9 offset:25600
s_nop 0
v_permlane16_swap_b32 v52, v53
v_max_f32 v52, v52, v53
v_mul_f32 v52, s36, v52
ds_read_b128 v[64:67], v9 offset:28672
ds_read_b128 v[68:71], v9 offset:29696
ds_read_b128 v[72:75], v9 offset:22528
ds_read_b128 v[76:79], v9 offset:23552
v_fma_f32 v40, v40, s36, -v52
v_fma_f32 v41, v41, s36, -v52
v_fma_f32 v42, v42, s36, -v52
v_fma_f32 v43, v43, s36, -v52
v_fma_f32 v44, v44, s36, -v52
v_fma_f32 v45, v45, s36, -v52
v_fma_f32 v46, v46, s36, -v52
v_fma_f32 v47, v47, s36, -v52
v_fma_f32 v48, v48, s36, -v52
v_fma_f32 v49, v49, s36, -v52
v_exp_f32 v40, v40
v_exp_f32 v41, v41
v_exp_f32 v42, v42
v_exp_f32 v43, v43
v_exp_f32 v44, v44
v_exp_f32 v45, v45
v_exp_f32 v46, v46
v_exp_f32 v47, v47
v_exp_f32 v48, v48
v_exp_f32 v49, v49
v_cvt_pk_bf16_f32 v52, v40, v41
v_cvt_pk_bf16_f32 v53, v42, v43
v_cvt_pk_bf16_f32 v54, v44, v45
v_cvt_pk_bf16_f32 v55, v46, v47
s_nop 1
v_mfma_f32_16x16x32_bf16 v[40:43], v[16:19], v[52:55], 0
v_cvt_pk_bf16_f32 v51, v48, v49
v_cvt_pk_bf16_f32 v48, v48, v49
v_mfma_f32_16x16x32_bf16 v[44:47], v[20:23], v[52:55], 0
v_add_f32 v56, v56, v58
v_add_f32 v57, v57, v59
v_mfma_f32_16x16x32_bf16 v[24:27], v[28:31], v[52:55], 0
v_add_f32 v60, v60, v62
v_add_f32 v61, v61, v63
v_mov_b32 v49, 0
v_cvt_pk_bf16_f32 v36, v56, v57
v_cvt_pk_bf16_f32 v37, v60, v61
s_nop 0
v_mfma_f32_16x16x16_bf16 v[24:27], v[28:29], v[48:49], v[24:27]
v_mfma_f32_16x16x16_bf16 v[40:43], v[36:37], v[48:49], v[40:43]
v_mfma_f32_16x16x16_bf16 v[44:47], v[36:37], v[50:51], v[44:47]
v_lshrrev_b32 v0, 1, v1
v_mov_b32 v52, 0
v_mov_b32 v53, 0
v_mov_b32 v54, 0
v_mov_b32 v55, 0
v_rcp_f32 v24, v24
s_nop 0
v_pk_mul_f32 v[40:41], v[40:41], v[24:25] op_sel_hi:[1,0]
v_pk_mul_f32 v[42:43], v[42:43], v[24:25] op_sel_hi:[1,0]
v_pk_mul_f32 v[44:45], v[44:45], v[24:25] op_sel_hi:[1,0]
v_pk_mul_f32 v[46:47], v[46:47], v[24:25] op_sel_hi:[1,0]
v_cvt_pk_bf16_f32 v40, v40, v44
v_cvt_pk_bf16_f32 v41, v41, v45
v_cvt_pk_bf16_f32 v42, v42, v46
v_cvt_pk_bf16_f32 v43, v43, v47
ds_write2_b32 v5, v40, v41 offset0:0 offset1:2
ds_write2_b32 v5, v42, v43 offset0:32 offset1:34
v_mov_b64 v[56:57], 0
v_mov_b64 v[58:59], 0
v_mov_b64 v[60:61], 0
v_mov_b64 v[62:63], 0
v_mov_b64 v[24:25], 0
v_mov_b64 v[26:27], 0
v_mov_b64 v[28:29], 0
v_mov_b64 v[30:31], 0
s_waitcnt lgkmcnt(0)
s_barrier
ds_read_b128 v[16:19], v6 offset:29184
ds_read_b128 v[20:23], v6 offset:29248
ds_write_b64 v0, v[36:37] offset:25600
v_mov_b64 v[40:41], 0
v_mov_b64 v[42:43], 0
v_mov_b64 v[44:45], 0
v_mov_b64 v[46:47], 0
v_mov_b64 v[48:49], 0
v_mov_b64 v[50:51], 0
s_waitcnt lgkmcnt(2)
v_smfmac_f32_16x16x64_bf16 v[56:59], v[16:19], v[192:199], v10
s_waitcnt lgkmcnt(1)
v_smfmac_f32_16x16x64_bf16 v[56:59], v[20:23], v[224:231], v10
v_smfmac_f32_16x16x64_bf16 v[60:63], v[16:19], v[200:207], v10
v_smfmac_f32_16x16x64_bf16 v[60:63], v[20:23], v[232:239], v10
v_add_f32 v56, v56, v58
v_add_f32 v57, v57, v59
v_smfmac_f32_16x16x64_bf16 v[24:27], v[16:19], v[208:215], v10
v_cvt_pk_bf16_f32 v56, v56, v57
v_smfmac_f32_16x16x64_bf16 v[24:27], v[20:23], v[240:247], v10
v_add_f32 v60, v60, v62
v_add_f32 v61, v61, v63
v_smfmac_f32_16x16x64_bf16 v[28:31], v[16:19], v[216:223], v10
buffer_store_dword v56, v7, s[8:11], s22 offen offset:1024
v_cvt_pk_bf16_f32 v60, v60, v61
v_smfmac_f32_16x16x64_bf16 v[28:31], v[20:23], v[248:255], v10
v_add_f32 v24, v24, v26
v_add_f32 v25, v25, v27
v_smfmac_f32_16x16x64_bf16 v[40:43], v[16:19], v[112:119], v10
buffer_store_dword v60, v7, s[8:11], s22 offen offset:1280
v_cvt_pk_bf16_f32 v24, v24, v25
v_smfmac_f32_16x16x64_bf16 v[40:43], v[20:23], v[120:127], v10
v_add_f32 v28, v28, v30
v_add_f32 v29, v29, v31
v_smfmac_f32_16x16x64_bf16 v[44:47], v[16:19], v[88:95], v10
buffer_store_dword v24, v7, s[8:11], s22 offen offset:1536
v_cvt_pk_bf16_f32 v28, v28, v29
v_smfmac_f32_16x16x64_bf16 v[44:47], v[20:23], v[96:103], v10
v_add_f32 v40, v40, v42
v_add_f32 v41, v41, v43
v_smfmac_f32_16x16x64_bf16 v[48:51], v[16:19], v[104:111], v10
buffer_store_dword v28, v7, s[8:11], s22 offen offset:1792
v_cvt_pk_bf16_f32 v40, v40, v41
v_smfmac_f32_16x16x64_bf16 v[48:51], v[20:23], v[64:71], v10
v_add_f32 v44, v44, v46
v_add_f32 v45, v45, v47
v_smfmac_f32_16x16x64_bf16 v[52:55], v[16:19], v[72:79], v10
buffer_store_dword v40, v7, s[8:11], s22 offen offset:0
v_cvt_pk_bf16_f32 v44, v44, v45
v_smfmac_f32_16x16x64_bf16 v[52:55], v[20:23], v[80:87], v10
v_add_f32 v48, v48, v50
v_add_f32 v49, v49, v51
buffer_store_dword v44, v7, s[8:11], s22 offen offset:256
v_cvt_pk_bf16_f32 v48, v48, v49
s_nop 3
v_add_f32 v52, v52, v54
v_add_f32 v53, v53, v55
buffer_store_dword v48, v7, s[8:11], s22 offen offset:512
v_cvt_pk_bf16_f32 v52, v52, v53
buffer_store_dword v52, v7, s[8:11], s22 offen offset:768
ds_read_b128 v[96:99], v9 offset:8192
ds_read_b128 v[100:103], v9 offset:9216
ds_read_b128 v[104:107], v9 offset:10240
ds_read_b128 v[108:111], v9 offset:11264
ds_read_b128 v[112:115], v9 offset:12288
ds_read_b128 v[116:119], v9 offset:13312
ds_read_b128 v[120:123], v9 offset:14336
ds_read_b128 v[124:127], v9 offset:15360
ds_read_b128 v[64:67], v9 offset:0
ds_read_b128 v[68:71], v9 offset:1024
ds_read_b128 v[72:75], v9 offset:2048
ds_read_b128 v[76:79], v9 offset:3072
ds_read_b128 v[80:83], v9 offset:4096
ds_read_b128 v[84:87], v9 offset:5120
ds_read_b128 v[88:91], v9 offset:6144
ds_read_b128 v[92:95], v9 offset:7168
v_mov_b64 v[40:41], 0
v_mov_b64 v[42:43], 0
v_mov_b64 v[44:45], 0
v_mov_b64 v[46:47], 0
v_mov_b64 v[48:49], 0
v_mov_b64 v[50:51], 0
v_mov_b64 v[52:53], 0
v_mov_b64 v[54:55], 0
v_mov_b64 v[56:57], 0
v_mov_b64 v[58:59], 0
v_mov_b64 v[60:61], 0
v_mov_b64 v[62:63], 0
s_add_u32 s22, s22, 524288
s_bitset0_b32 s22, 21
s_add_u32 s57, s57, 524288
s_bitset0_b32 s57, 21
s_add_u32 s58, s58, 524288
s_bitset0_b32 s58, 21
s_add_u32 s59, s59, 524288
s_bitset0_b32 s59, 21
s_xor_b32 s19, s19, 0x2000
s_add_u32 s28, s28, 262144
s_add_u32 s29, s29, 262144
s_add_u32 s18, s18, 1
s_waitcnt vmcnt(0)
s_waitcnt lgkmcnt(8)
s_barrier
s_cmp_lt_u32 s18, 64
s_cbranch_scc1 C2_step
C2_last:
s_waitcnt lgkmcnt(0)
s_nop 7
v_add_f32 v56, v56, v58
v_add_f32 v57, v57, v59
v_add_f32 v60, v60, v62
v_add_f32 v61, v61, v63
v_cvt_pk_bf16_f32 v56, v56, v57
v_cvt_pk_bf16_f32 v57, v60, v61
v_lshrrev_b32 v0, 1, v1
s_add_u32 s38, s55, 1024
buffer_store_dwordx2 v[56:57], v0, s[8:11], s38 offen sc1
s_waitcnt vmcnt(0)
s_barrier
s_branch C_exit
C_enter3:
ds_read_b128 v[96:99], v9 offset:8192
ds_read_b128 v[100:103], v9 offset:9216
ds_read_b128 v[104:107], v9 offset:10240
ds_read_b128 v[108:111], v9 offset:11264
ds_read_b128 v[112:115], v9 offset:12288
ds_read_b128 v[116:119], v9 offset:13312
ds_read_b128 v[120:123], v9 offset:14336
ds_read_b128 v[124:127], v9 offset:15360
ds_read_b128 v[64:67], v9 offset:0
ds_read_b128 v[68:71], v9 offset:1024
ds_read_b128 v[72:75], v9 offset:2048
ds_read_b128 v[76:79], v9 offset:3072
ds_read_b128 v[80:83], v9 offset:4096
ds_read_b128 v[84:87], v9 offset:5120
ds_read_b128 v[88:91], v9 offset:6144
ds_read_b128 v[92:95], v9 offset:7168
v_mov_b64 v[40:41], 0
v_mov_b64 v[42:43], 0
v_mov_b64 v[44:45], 0
v_mov_b64 v[46:47], 0
v_mov_b64 v[48:49], 0
v_mov_b64 v[50:51], 0
v_mov_b64 v[52:53], 0
v_mov_b64 v[54:55], 0
v_mov_b64 v[56:57], 0
v_mov_b64 v[58:59], 0
v_mov_b64 v[60:61], 0
v_mov_b64 v[62:63], 0
s_add_u32 s57, s67, 1572864
v_mov_b32 v12, -1
v_mov_b32 v13, -1
v_mov_b32 v14, -1
v_mov_b32 v15, -1
v_mov_b32 v8, s69
C3_step:
ds_read_b128 v[32:35], v6 offset:26880
ds_read_b128 v[36:39], v6 offset:26944
s_nop 15
buffer_load_dwordx4 v[16:19], v2, s[8:11], s19 offen sc1
buffer_load_dwordx4 v[20:23], v2, s[8:11], s19 offen offset:1024 sc1
s_nop 15
s_nop 15
buffer_load_dwordx4 v[24:27], v2, s[8:11], s19 offen sc1
buffer_load_dwordx4 v[28:31], v2, s[8:11], s19 offen offset:1024 sc1
C3_ag:
s_waitcnt vmcnt(2)
v_max3_u32 v0, v16, v18, v20
v_max_u32 v0, v0, v22
v_cmp_eq_u32 vcc, -1, v0
s_nop 0
s_cbranch_vccz C3_agA
buffer_load_dwordx4 v[16:19], v2, s[8:11], s19 offen sc1
buffer_load_dwordx4 v[20:23], v2, s[8:11], s19 offen offset:1024 sc1
s_waitcnt vmcnt(2)
v_max3_u32 v0, v24, v26, v28
v_max_u32 v0, v0, v30
v_cmp_eq_u32 vcc, -1, v0
s_nop 0
s_cbranch_vccz C3_agB
buffer_load_dwordx4 v[24:27], v2, s[8:11], s19 offen sc1
buffer_load_dwordx4 v[28:31], v2, s[8:11], s19 offen offset:1024 sc1
s_cmp_eq_u32 s37, 0
s_cbranch_scc1 C3_agA
s_sub_u32 s37, s37, 1
s_branch C3_ag
C3_agB:
ds_write_b128 v2, v[24:27] offset:0
ds_write_b128 v2, v[28:31] offset:1024
v_smfmac_f32_16x16x64_bf16 v[40:43], v[24:27], a[0:7], v10
v_smfmac_f32_16x16x64_bf16 v[44:47], v[24:27], a[8:15], v10
v_smfmac_f32_16x16x64_bf16 v[40:43], v[28:31], a[16:23], v10
v_smfmac_f32_16x16x64_bf16 v[44:47], v[28:31], a[24:31], v10
s_waitcnt lgkmcnt(10)
v_smfmac_f32_16x16x64_bf16 v[48:51], v[24:27], v[64:71], v10
v_xor_b32 v0, 2048, v2
s_waitcnt lgkmcnt(8)
v_smfmac_f32_16x16x64_bf16 v[52:55], v[24:27], v[72:79], v10
s_waitcnt lgkmcnt(0)
s_barrier
v_smfmac_f32_16x16x64_bf16 v[48:51], v[28:31], v[80:87], v10
ds_read_b128 v[64:67], v0 offset:0
v_smfmac_f32_16x16x64_bf16 v[52:55], v[28:31], v[88:95], v10
ds_read_b128 v[68:71], v0 offset:1024
v_xor_b32 v0, 4096, v2
v_smfmac_f32_16x16x64_bf16 v[56:59], v[24:27], a[128:135], v10
ds_read_b128 v[72:75], v0 offset:0
v_smfmac_f32_16x16x64_bf16 v[60:63], v[24:27], a[136:143], v10
ds_read_b128 v[76:79], v0 offset:1024
v_xor_b32 v0, 6144, v2
v_smfmac_f32_16x16x64_bf16 v[56:59], v[28:31], a[144:151], v10
ds_read_b128 v[80:83], v0 offset:0
v_smfmac_f32_16x16x64_bf16 v[60:63], v[28:31], a[152:159], v10
ds_read_b128 v[84:87], v0 offset:1024
s_branch C3_agJ
C3_agA:
ds_write_b128 v2, v[16:19] offset:0
ds_write_b128 v2, v[20:23] offset:1024
v_smfmac_f32_16x16x64_bf16 v[40:43], v[16:19], a[0:7], v10
v_smfmac_f32_16x16x64_bf16 v[44:47], v[16:19], a[8:15], v10
v_smfmac_f32_16x16x64_bf16 v[40:43], v[20:23], a[16:23], v10
v_smfmac_f32_16x16x64_bf16 v[44:47], v[20:23], a[24:31], v10
s_waitcnt lgkmcnt(6)
v_smfmac_f32_16x16x64_bf16 v[48:51], v[16:19], v[64:71], v10
v_xor_b32 v0, 2048, v2
s_waitcnt lgkmcnt(4)
v_smfmac_f32_16x16x64_bf16 v[52:55], v[16:19], v[72:79], v10
s_waitcnt lgkmcnt(0)
s_barrier
v_smfmac_f32_16x16x64_bf16 v[48:51], v[20:23], v[80:87], v10
ds_read_b128 v[64:67], v0 offset:0
v_smfmac_f32_16x16x64_bf16 v[52:55], v[20:23], v[88:95], v10
ds_read_b128 v[68:71], v0 offset:1024
v_xor_b32 v0, 4096, v2
v_smfmac_f32_16x16x64_bf16 v[56:59], v[16:19], a[128:135], v10
ds_read_b128 v[72:75], v0 offset:0
v_smfmac_f32_16x16x64_bf16 v[60:63], v[16:19], a[136:143], v10
ds_read_b128 v[76:79], v0 offset:1024
v_xor_b32 v0, 6144, v2
v_smfmac_f32_16x16x64_bf16 v[56:59], v[20:23], a[144:151], v10
ds_read_b128 v[80:83], v0 offset:0
v_smfmac_f32_16x16x64_bf16 v[60:63], v[20:23], a[152:159], v10
ds_read_b128 v[84:87], v0 offset:1024
C3_agJ:
s_waitcnt lgkmcnt(5)
v_smfmac_f32_16x16x64_bf16 v[40:43], v[64:67], a[32:39], v10
ds_read_b128 v[88:91], v9 offset:18432
v_smfmac_f32_16x16x64_bf16 v[44:47], v[64:67], a[40:47], v10
ds_read_b128 v[92:95], v9 offset:19456
s_waitcnt lgkmcnt(6)
v_smfmac_f32_16x16x64_bf16 v[40:43], v[68:71], a[48:55], v10
v_smfmac_f32_16x16x64_bf16 v[44:47], v[68:71], a[56:63], v10
s_waitcnt lgkmcnt(5)
v_smfmac_f32_16x16x64_bf16 v[40:43], v[72:75], a[64:71], v10
buffer_store_dwordx4 v[32:35], v1, s[8:11], s30 offen offset:0 sc1
v_smfmac_f32_16x16x64_bf16 v[44:47], v[72:75], a[72:79], v10
s_waitcnt lgkmcnt(4)
v_smfmac_f32_16x16x64_bf16 v[40:43], v[76:79], a[80:87], v10
v_smfmac_f32_16x16x64_bf16 v[44:47], v[76:79], a[88:95], v10
buffer_store_dwordx4 v[36:39], v1, s[8:11], s30 offen offset:1024 sc1
s_waitcnt lgkmcnt(3)
v_smfmac_f32_16x16x64_bf16 v[40:43], v[80:83], a[96:103], v10
s_waitcnt vmcnt(2)
ds_read_b128 v[16:19], v2 offset:16384
v_smfmac_f32_16x16x64_bf16 v[44:47], v[80:83], a[104:111], v10
ds_read_b128 v[20:23], v2 offset:17408
s_waitcnt lgkmcnt(4)
v_smfmac_f32_16x16x64_bf16 v[40:43], v[84:87], a[112:119], v10
s_mov_b64 exec, 1
buffer_store_dword v8, off, s[8:11], s47 sc1
s_mov_b64 exec, -1
s_add_u32 s47, s47, 128
v_smfmac_f32_16x16x64_bf16 v[44:47], v[84:87], a[120:127], v10
v_smfmac_f32_16x16x64_bf16 v[48:51], v[64:67], v[96:103], v10
v_smfmac_f32_16x16x64_bf16 v[52:55], v[64:67], v[104:111], v10
v_add_f32 v40, v40, v42
v_smfmac_f32_16x16x64_bf16 v[48:51], v[68:71], v[112:119], v10
v_add_f32 v41, v41, v43
v_smfmac_f32_16x16x64_bf16 v[52:55], v[68:71], v[120:127], v10
ds_read_b128 v[96:99], v1 offset:8192
v_add_f32 v44, v44, v46
v_smfmac_f32_16x16x64_bf16 v[48:51], v[72:75], v[128:135], v10
ds_read_b128 v[100:103], v1 offset:9216
v_add_f32 v45, v45, v47
v_smfmac_f32_16x16x64_bf16 v[52:55], v[72:75], v[136:143], v10
ds_read_b128 v[104:107], v1 offset:10240
v_cvt_pk_bf16_f32 v40, v40, v44
v_smfmac_f32_16x16x64_bf16 v[48:51], v[76:79], v[144:151], v10
ds_read_b128 v[108:111], v1 offset:11264
v_cvt_pk_bf16_f32 v41, v41, v45
v_smfmac_f32_16x16x64_bf16 v[52:55], v[76:79], v[152:159], v10
ds_write_b32 v3, v40 offset:24576
ds_write_b32 v3, v41 offset:24864
v_smfmac_f32_16x16x64_bf16 v[48:51], v[80:83], v[160:167], v10
ds_read_b128 v[112:115], v1 offset:12288
v_smfmac_f32_16x16x64_bf16 v[52:55], v[80:83], v[168:175], v10
ds_read_b128 v[116:119], v1 offset:13312
buffer_store_dwordx4 v[12:15], v11, s[8:11], s57 offen
v_smfmac_f32_16x16x64_bf16 v[48:51], v[84:87], v[176:183], v10
ds_read_b128 v[120:123], v1 offset:14336
v_smfmac_f32_16x16x64_bf16 v[52:55], v[84:87], v[184:191], v10
ds_read_b128 v[124:127], v1 offset:15360
v_smfmac_f32_16x16x64_bf16 v[56:59], v[64:67], a[160:167], v10
v_smfmac_f32_16x16x64_bf16 v[60:63], v[64:67], a[168:175], v10
v_add_f32 v48, v48, v50
v_smfmac_f32_16x16x64_bf16 v[56:59], v[68:71], a[176:183], v10
v_add_f32 v49, v49, v51
v_smfmac_f32_16x16x64_bf16 v[60:63], v[68:71], a[184:191], v10
v_add_f32 v52, v52, v54
v_smfmac_f32_16x16x64_bf16 v[56:59], v[72:75], a[192:199], v10
v_add_f32 v53, v53, v55
v_smfmac_f32_16x16x64_bf16 v[60:63], v[72:75], a[200:207], v10
v_cvt_pk_bf16_f32 v48, v48, v52
v_smfmac_f32_16x16x64_bf16 v[56:59], v[76:79], a[208:215], v10
v_cvt_pk_bf16_f32 v49, v49, v53
v_smfmac_f32_16x16x64_bf16 v[60:63], v[76:79], a[216:223], v10
ds_write_b32 v3, v48 offset:26880
ds_write_b32 v3, v49 offset:27168
v_smfmac_f32_16x16x64_bf16 v[56:59], v[80:83], a[224:231], v10
v_smfmac_f32_16x16x64_bf16 v[60:63], v[80:83], a[232:239], v10
s_waitcnt lgkmcnt(0)
s_barrier
v_smfmac_f32_16x16x64_bf16 v[56:59], v[84:87], a[240:247], v10
ds_read_b128 v[24:27], v4 offset:24576
ds_read_b128 v[28:31], v4 offset:24704
v_smfmac_f32_16x16x64_bf16 v[60:63], v[84:87], a[248:255], v10
ds_read_b128 v[32:35], v4 offset:24640
ds_read_b128 v[36:39], v4 offset:24768
s_cmp_eq_u32 s18, 63
s_cbranch_scc1 C3_last
ds_read_b128 v[64:67], v6 offset:26880
s_waitcnt lgkmcnt(4)
v_mfma_f32_16x16x32_bf16 v[40:43], v[96:99], v[24:27], 0
ds_read_b128 v[68:71], v6 offset:27008
s_mov_b32 m0, 20480
s_add_u32 s39, s29, 4096
buffer_load_dwordx4 v1, s[8:11], s39 offen lds
s_waitcnt lgkmcnt(4)
v_mfma_f32_16x16x32_bf16 v[40:43], v[100:103], v[28:31], v[40:43]
ds_read_b128 v[72:75], v6 offset:26944
buffer_load_dwordx4 v1, s[8:11], s39 offen offset:1024 lds
s_waitcnt lgkmcnt(4)
v_mfma_f32_16x16x32_bf16 v[40:43], v[104:107], v[32:35], v[40:43]
ds_read_b128 v[76:79], v6 offset:27072
buffer_load_dwordx4 v1, s[8:11], s39 offen offset:2048 lds
s_waitcnt lgkmcnt(4)
v_mfma_f32_16x16x32_bf16 v[40:43], v[108:111], v[36:39], v[40:43]
ds_read_b128 v[80:83], v9 offset:30720
buffer_load_dwordx4 v1, s[8:11], s39 offen offset:3072 lds
v_mfma_f32_16x16x32_bf16 v[44:47], v[112:115], v[24:27], 0
ds_read_b128 v[84:87], v9 offset:31744
v_mfma_f32_16x16x32_bf16 v[44:47], v[116:119], v[28:31], v[44:47]
v_mfma_f32_16x16x32_bf16 v[44:47], v[120:123], v[32:35], v[44:47]
v_mfma_f32_16x16x32_bf16 v[44:47], v[124:127], v[36:39], v[44:47]
ds_read_b128 v[96:99], v9 offset:26624
s_waitcnt lgkmcnt(6)
v_mfma_f32_16x16x32_bf16 v[48:51], v[64:67], v[24:27], 0
ds_read_b128 v[100:103], v9 offset:27648
v_max3_f32 v52, v40, v41, v42
s_waitcnt lgkmcnt(6)
v_mfma_f32_16x16x32_bf16 v[48:51], v[68:71], v[28:31], v[48:51]
ds_read_b128 v[104:107], v9 offset:20480
v_max3_f32 v53, v43, v44, v45
s_waitcnt lgkmcnt(6)
v_mfma_f32_16x16x32_bf16 v[48:51], v[72:75], v[32:35], v[48:51]
ds_read_b128 v[108:111], v9 offset:21504
v_max3_f32 v52, v52, v46, v47
s_waitcnt lgkmcnt(6)
v_mfma_f32_16x16x32_bf16 v[48:51], v[76:79], v[36:39], v[48:51]
ds_read_b128 v[112:115], v9 offset:16384
v_max_f32 v52, v52, v53
ds_read_b128 v[116:119], v9 offset:17408
ds_read_b128 v[120:123], v9 offset:24576
v_mov_b32 v28, s24
v_mov_b32 v29, s24
v_mov_b32 v30, s24
s_nop 0
v_max3_f32 v52, v52, v48, v49
v_mov_b32 v53, v52
v_mov_b32 v31, s24
v_mov_b32 v50, 0
v_permlane32_swap_b32 v52, v53
v_max_f32 v52, v52, v53
v_mov_b32 v53, v52
ds_read_b128 v[124:127], v9 offset:25600
s_nop 0
v_permlane16_swap_b32 v52, v53
v_max_f32 v52, v52, v53
v_mul_f32 v52, s36, v52
ds_read_b128 v[64:67], v9 offset:28672
ds_read_b128 v[68:71], v9 offset:29696
ds_read_b128 v[72:75], v9 offset:22528
ds_read_b128 v[76:79], v9 offset:23552
v_fma_f32 v40, v40, s36, -v52
v_fma_f32 v41, v41, s36, -v52
v_fma_f32 v42, v42, s36, -v52
v_fma_f32 v43, v43, s36, -v52
v_fma_f32 v44, v44, s36, -v52
v_fma_f32 v45, v45, s36, -v52
v_fma_f32 v46, v46, s36, -v52
v_fma_f32 v47, v47, s36, -v52
v_fma_f32 v48, v48, s36, -v52
v_fma_f32 v49, v49, s36, -v52
v_exp_f32 v40, v40
v_exp_f32 v41, v41
v_exp_f32 v42, v42
v_exp_f32 v43, v43
v_exp_f32 v44, v44
v_exp_f32 v45, v45
v_exp_f32 v46, v46
v_exp_f32 v47, v47
v_exp_f32 v48, v48
v_exp_f32 v49, v49
v_cvt_pk_bf16_f32 v52, v40, v41
v_cvt_pk_bf16_f32 v53, v42, v43
v_cvt_pk_bf16_f32 v54, v44, v45
v_cvt_pk_bf16_f32 v55, v46, v47
s_nop 1
v_mfma_f32_16x16x32_bf16 v[40:43], v[16:19], v[52:55], 0
v_cvt_pk_bf16_f32 v51, v48, v49
v_cvt_pk_bf16_f32 v48, v48, v49
v_mfma_f32_16x16x32_bf16 v[44:47], v[20:23], v[52:55], 0
v_add_f32 v56, v56, v58
v_add_f32 v57, v57, v59
v_mfma_f32_16x16x32_bf16 v[24:27], v[28:31], v[52:55], 0
v_add_f32 v60, v60, v62
v_add_f32 v61, v61, v63
v_mov_b32 v49, 0
v_cvt_pk_bf16_f32 v36, v56, v57
v_cvt_pk_bf16_f32 v37, v60, v61
s_nop 0
v_mfma_f32_16x16x16_bf16 v[24:27], v[28:29], v[48:49], v[24:27]
v_mfma_f32_16x16x16_bf16 v[40:43], v[36:37], v[48:49], v[40:43]
v_mfma_f32_16x16x16_bf16 v[44:47], v[36:37], v[50:51], v[44:47]
v_lshrrev_b32 v0, 1, v1
v_mov_b32 v52, 0
v_mov_b32 v53, 0
v_mov_b32 v54, 0
v_mov_b32 v55, 0
v_rcp_f32 v24, v24
s_nop 0
v_pk_mul_f32 v[40:41], v[40:41], v[24:25] op_sel_hi:[1,0]
v_pk_mul_f32 v[42:43], v[42:43], v[24:25] op_sel_hi:[1,0]
v_pk_mul_f32 v[44:45], v[44:45], v[24:25] op_sel_hi:[1,0]
v_pk_mul_f32 v[46:47], v[46:47], v[24:25] op_sel_hi:[1,0]
v_cvt_pk_bf16_f32 v40, v40, v44
v_cvt_pk_bf16_f32 v41, v41, v45
v_cvt_pk_bf16_f32 v42, v42, v46
v_cvt_pk_bf16_f32 v43, v43, v47
ds_write2_b32 v5, v40, v41 offset0:0 offset1:2
ds_write2_b32 v5, v42, v43 offset0:32 offset1:34
v_mov_b64 v[56:57], 0
v_mov_b64 v[58:59], 0
v_mov_b64 v[60:61], 0
v_mov_b64 v[62:63], 0
v_mov_b64 v[24:25], 0
v_mov_b64 v[26:27], 0
v_mov_b64 v[28:29], 0
v_mov_b64 v[30:31], 0
s_waitcnt lgkmcnt(0)
s_barrier
ds_read_b128 v[16:19], v6 offset:29184
ds_read_b128 v[20:23], v6 offset:29248
ds_write_b64 v0, v[36:37] offset:26112
v_mov_b64 v[40:41], 0
v_mov_b64 v[42:43], 0
v_mov_b64 v[44:45], 0
v_mov_b64 v[46:47], 0
v_mov_b64 v[48:49], 0
v_mov_b64 v[50:51], 0
s_waitcnt lgkmcnt(2)
v_smfmac_f32_16x16x64_bf16 v[56:59], v[16:19], v[192:199], v10
s_waitcnt lgkmcnt(1)
v_smfmac_f32_16x16x64_bf16 v[56:59], v[20:23], v[224:231], v10
v_smfmac_f32_16x16x64_bf16 v[60:63], v[16:19], v[200:207], v10
v_smfmac_f32_16x16x64_bf16 v[60:63], v[20:23], v[232:239], v10
v_add_f32 v56, v56, v58
v_add_f32 v57, v57, v59
v_smfmac_f32_16x16x64_bf16 v[24:27], v[16:19], v[208:215], v10
v_cvt_pk_bf16_f32 v56, v56, v57
v_smfmac_f32_16x16x64_bf16 v[24:27], v[20:23], v[240:247], v10
v_add_f32 v60, v60, v62
v_add_f32 v61, v61, v63
v_smfmac_f32_16x16x64_bf16 v[28:31], v[16:19], v[216:223], v10
buffer_store_dword v56, v7, s[8:11], s22 offen offset:1024
v_cvt_pk_bf16_f32 v60, v60, v61
v_smfmac_f32_16x16x64_bf16 v[28:31], v[20:23], v[248:255], v10
v_add_f32 v24, v24, v26
v_add_f32 v25, v25, v27
v_smfmac_f32_16x16x64_bf16 v[40:43], v[16:19], v[112:119], v10
buffer_store_dword v60, v7, s[8:11], s22 offen offset:1280
v_cvt_pk_bf16_f32 v24, v24, v25
v_smfmac_f32_16x16x64_bf16 v[40:43], v[20:23], v[120:127], v10
v_add_f32 v28, v28, v30
v_add_f32 v29, v29, v31
v_smfmac_f32_16x16x64_bf16 v[44:47], v[16:19], v[88:95], v10
buffer_store_dword v24, v7, s[8:11], s22 offen offset:1536
v_cvt_pk_bf16_f32 v28, v28, v29
v_smfmac_f32_16x16x64_bf16 v[44:47], v[20:23], v[96:103], v10
v_add_f32 v40, v40, v42
v_add_f32 v41, v41, v43
v_smfmac_f32_16x16x64_bf16 v[48:51], v[16:19], v[104:111], v10
buffer_store_dword v28, v7, s[8:11], s22 offen offset:1792
v_cvt_pk_bf16_f32 v40, v40, v41
v_smfmac_f32_16x16x64_bf16 v[48:51], v[20:23], v[64:71], v10
v_add_f32 v44, v44, v46
v_add_f32 v45, v45, v47
v_smfmac_f32_16x16x64_bf16 v[52:55], v[16:19], v[72:79], v10
buffer_store_dword v40, v7, s[8:11], s22 offen offset:0
v_cvt_pk_bf16_f32 v44, v44, v45
v_smfmac_f32_16x16x64_bf16 v[52:55], v[20:23], v[80:87], v10
v_add_f32 v48, v48, v50
v_add_f32 v49, v49, v51
buffer_store_dword v44, v7, s[8:11], s22 offen offset:256
v_cvt_pk_bf16_f32 v48, v48, v49
s_nop 3
v_add_f32 v52, v52, v54
v_add_f32 v53, v53, v55
buffer_store_dword v48, v7, s[8:11], s22 offen offset:512
v_cvt_pk_bf16_f32 v52, v52, v53
buffer_store_dword v52, v7, s[8:11], s22 offen offset:768
ds_read_b128 v[96:99], v9 offset:8192
ds_read_b128 v[100:103], v9 offset:9216
ds_read_b128 v[104:107], v9 offset:10240
ds_read_b128 v[108:111], v9 offset:11264
ds_read_b128 v[112:115], v9 offset:12288
ds_read_b128 v[116:119], v9 offset:13312
ds_read_b128 v[120:123], v9 offset:14336
ds_read_b128 v[124:127], v9 offset:15360
ds_read_b128 v[64:67], v9 offset:0
ds_read_b128 v[68:71], v9 offset:1024
ds_read_b128 v[72:75], v9 offset:2048
ds_read_b128 v[76:79], v9 offset:3072
ds_read_b128 v[80:83], v9 offset:4096
ds_read_b128 v[84:87], v9 offset:5120
ds_read_b128 v[88:91], v9 offset:6144
ds_read_b128 v[92:95], v9 offset:7168
v_mov_b64 v[40:41], 0
v_mov_b64 v[42:43], 0
v_mov_b64 v[44:45], 0
v_mov_b64 v[46:47], 0
v_mov_b64 v[48:49], 0
v_mov_b64 v[50:51], 0
v_mov_b64 v[52:53], 0
v_mov_b64 v[54:55], 0
v_mov_b64 v[56:57], 0
v_mov_b64 v[58:59], 0
v_mov_b64 v[60:61], 0
v_mov_b64 v[62:63], 0
s_add_u32 s22, s22, 524288
s_bitset0_b32 s22, 21
s_add_u32 s57, s57, 524288
s_bitset0_b32 s57, 21
s_xor_b32 s19, s19, 0x2000
s_add_u32 s28, s28, 262144
s_add_u32 s29, s29, 262144
s_add_u32 s31, s31, 65536
s_add_u32 s30, s30, 65536
s_add_u32 s18, s18, 1
s_waitcnt vmcnt(0)
s_waitcnt lgkmcnt(8)
s_barrier
s_cmp_lt_u32 s18, 64
s_cbranch_scc1 C3_step
C3_last:
s_waitcnt lgkmcnt(0)
s_nop 7
v_add_f32 v56, v56, v58
v_add_f32 v57, v57, v59
v_add_f32 v60, v60, v62
v_add_f32 v61, v61, v63
v_cvt_pk_bf16_f32 v56, v56, v57
v_cvt_pk_bf16_f32 v57, v60, v61
v_lshrrev_b32 v0, 1, v1
s_add_u32 s38, s55, 1536
buffer_store_dwordx2 v[56:57], v0, s[8:11], s38 offen sc1
ds_read_b128 v[96:99], v6 offset:26880
ds_read_b128 v[100:103], v6 offset:26944
s_add_u32 s38, s30, 65536
s_waitcnt lgkmcnt(1)
buffer_store_dwordx4 v[96:99], v1, s[8:11], s38 offen offset:0 sc1
s_waitcnt lgkmcnt(0)
buffer_store_dwordx4 v[100:103], v1, s[8:11], s38 offen offset:1024 sc1
s_waitcnt vmcnt(0)
s_barrier
s_mov_b64 exec, 1
v_mov_b32 v0, s69
v_mov_b32 v24, 0
buffer_store_dword v0, v24, s[8:11], s47 offen sc1
buffer_store_dword v0, v24, s[8:11], s47 offen offset:128 sc1
s_mov_b64 exec, -1
C_exit:
s_branch L_end
W_start:
s_sub_u32 s49, s3, 1
s_mov_b32 s65, 0x100000
s_cmp_ge_u32 s16, 32
s_cbranch_scc1 L_end
s_load_dwordx2 s[28:29], s[0:1], 128
s_waitcnt lgkmcnt(0)
s_and_b32 s29, s29, 0xffff
s_mov_b32 s30, 8388608
s_mov_b32 s31, 0x20000
v_and_b32 v4, 63, v0
v_lshlrev_b32 v1, 4, v4
s_mov_b32 s50, 0x05040100
s_mov_b32 s51, 0x07060302
s_mov_b32 s63, 0
s_mov_b32 s70, 0
s_load_dwordx2 s[12:13], s[0:1], 0
s_waitcnt lgkmcnt(0)
s_and_b32 s13, s13, 0xffff
s_mov_b32 s14, 2097152
s_mov_b32 s15, 0x20000
s_cmp_lg_u32 s63, 0
s_cbranch_scc1 P0_later
s_cmp_eq_u32 s49, 6
s_cbranch_scc1 P0_n0
s_mov_b32 s43, 0
s_cmp_ge_u32 s49, 4
s_cselect_b32 s66, 1, 0
s_and_b32 s44, s49, 3
s_branch P0_dec
P0_n0:
s_mov_b32 s42, 0
s_branch P0_n
P0_later:
s_cmp_lt_u32 s49, 5
s_cbranch_scc1 P_end
s_lshl_b32 s42, s63, 1
s_add_u32 s42, s42, s49
s_sub_u32 s42, s42, 6
s_cmp_gt_u32 s42, 17
s_cbranch_scc1 P_end
P0_n:
s_mul_i32 s43, s42, 43
s_lshr_b32 s43, s43, 8
s_mul_i32 s44, s43, 6
s_sub_u32 s44, s42, s44
s_mul_i32 s44, s44, 5
s_mov_b32 s42, 310614180
s_cmp_eq_u32 s43, 1
s_cselect_b32 s42, 449499498, s42
s_cmp_eq_u32 s43, 2
s_cselect_b32 s42, 1003282926, s42
s_lshr_b32 s42, s42, s44
s_bfe_u32 s66, s42, 65540
s_bfe_u32 s43, s42, 131074
s_and_b32 s44, s42, 3
P0_dec:
s_lshl_b32 s32, s43, 2
s_lshr_b32 s38, s16, 3
s_add_u32 s32, s32, s38
s_lshl_b32 s33, s44, 3
s_and_b32 s38, s16, 7
s_add_u32 s33, s33, s38
s_lshl_b32 s42, s32, 7
s_lshl_b32 s38, s17, 5
s_add_u32 s39, s38, s42
s_mul_i32 s39, s39, 1024
s_add_u32 s39, s39, 0
s_mul_i32 s38, s38, 1040
s_add_u32 m0, s38, 0
s_add_u32 s40, s39, 0
buffer_load_dwordx4 v1, s[12:15], s40 offen lds
s_add_u32 m0, s38, 1040
s_add_u32 s40, s39, 1024
buffer_load_dwordx4 v1, s[12:15], s40 offen lds
s_add_u32 m0, s38, 2080
s_add_u32 s40, s39, 2048
buffer_load_dwordx4 v1, s[12:15], s40 offen lds
s_add_u32 m0, s38, 3120
s_add_u32 s40, s39, 3072
buffer_load_dwordx4 v1, s[12:15], s40 offen lds
s_add_u32 m0, s38, 4160
s_add_u32 s40, s39, 4096
buffer_load_dwordx4 v1, s[12:15], s40 offen lds
s_add_u32 m0, s38, 5200
s_add_u32 s40, s39, 5120
buffer_load_dwordx4 v1, s[12:15], s40 offen lds
s_add_u32 m0, s38, 6240
s_add_u32 s40, s39, 6144
buffer_load_dwordx4 v1, s[12:15], s40 offen lds
s_add_u32 m0, s38, 7280
s_add_u32 s40, s39, 7168
buffer_load_dwordx4 v1, s[12:15], s40 offen lds
s_add_u32 m0, s38, 8320
s_add_u32 s40, s39, 8192
buffer_load_dwordx4 v1, s[12:15], s40 offen lds
s_add_u32 m0, s38, 9360
s_add_u32 s40, s39, 9216
buffer_load_dwordx4 v1, s[12:15], s40 offen lds
s_add_u32 m0, s38, 10400
s_add_u32 s40, s39, 10240
buffer_load_dwordx4 v1, s[12:15], s40 offen lds
s_add_u32 m0, s38, 11440
s_add_u32 s40, s39, 11264
buffer_load_dwordx4 v1, s[12:15], s40 offen lds
s_add_u32 m0, s38, 12480
s_add_u32 s40, s39, 12288
buffer_load_dwordx4 v1, s[12:15], s40 offen lds
s_add_u32 m0, s38, 13520
s_add_u32 s40, s39, 13312
buffer_load_dwordx4 v1, s[12:15], s40 offen lds
s_add_u32 m0, s38, 14560
s_add_u32 s40, s39, 14336
buffer_load_dwordx4 v1, s[12:15], s40 offen lds
s_add_u32 m0, s38, 15600
s_add_u32 s40, s39, 15360
buffer_load_dwordx4 v1, s[12:15], s40 offen lds
s_add_u32 m0, s38, 16640
s_add_u32 s40, s39, 16384
buffer_load_dwordx4 v1, s[12:15], s40 offen lds
s_add_u32 m0, s38, 17680
s_add_u32 s40, s39, 17408
buffer_load_dwordx4 v1, s[12:15], s40 offen lds
s_add_u32 m0, s38, 18720
s_add_u32 s40, s39, 18432
buffer_load_dwordx4 v1, s[12:15], s40 offen lds
s_add_u32 m0, s38, 19760
s_add_u32 s40, s39, 19456
buffer_load_dwordx4 v1, s[12:15], s40 offen lds
s_add_u32 m0, s38, 20800
s_add_u32 s40, s39, 20480
buffer_load_dwordx4 v1, s[12:15], s40 offen lds
s_add_u32 m0, s38, 21840
s_add_u32 s40, s39, 21504
buffer_load_dwordx4 v1, s[12:15], s40 offen lds
s_add_u32 m0, s38, 22880
s_add_u32 s40, s39, 22528
buffer_load_dwordx4 v1, s[12:15], s40 offen lds
s_add_u32 m0, s38, 23920
s_add_u32 s40, s39, 23552
buffer_load_dwordx4 v1, s[12:15], s40 offen lds
s_add_u32 m0, s38, 24960
s_add_u32 s40, s39, 24576
buffer_load_dwordx4 v1, s[12:15], s40 offen lds
s_add_u32 m0, s38, 26000
s_add_u32 s40, s39, 25600
buffer_load_dwordx4 v1, s[12:15], s40 offen lds
s_add_u32 m0, s38, 27040
s_add_u32 s40, s39, 26624
buffer_load_dwordx4 v1, s[12:15], s40 offen lds
s_add_u32 m0, s38, 28080
s_add_u32 s40, s39, 27648
buffer_load_dwordx4 v1, s[12:15], s40 offen lds
s_add_u32 m0, s38, 29120
s_add_u32 s40, s39, 28672
buffer_load_dwordx4 v1, s[12:15], s40 offen lds
s_add_u32 m0, s38, 30160
s_add_u32 s40, s39, 29696
buffer_load_dwordx4 v1, s[12:15], s40 offen lds
s_add_u32 m0, s38, 31200
s_add_u32 s40, s39, 30720
buffer_load_dwordx4 v1, s[12:15], s40 offen lds
s_add_u32 m0, s38, 32240
s_add_u32 s40, s39, 31744
buffer_load_dwordx4 v1, s[12:15], s40 offen lds
P_round:
v_lshrrev_b32 v4, 4, v1
v_lshrrev_b32 v5, 4, v4
v_lshlrev_b32 v3, 16, v5
v_and_b32 v5, 15, v4
v_lshl_add_u32 v3, v5, 3, v3
s_and_b32 s43, s17, 1
s_lshr_b32 s44, s17, 1
s_lshl_b32 s45, s33, 1
s_add_u32 s45, s45, s44
s_cmp_eq_u32 s66, 1
s_cselect_b32 s45, s45, s33
s_lshl_b32 s34, s45, 8
s_lshl_b32 s38, s43, 7
s_add_u32 s34, s34, s38
s_lshl_b32 s35, s32, 20
s_lshl_b32 s38, s45, 13
s_add_u32 s35, s35, s38
s_lshl_b32 s71, s33, 6
s_lshl_b32 s38, s32, 2
s_add_u32 s71, s71, s38
s_lshl_b32 s38, s66, 12
s_add_u32 s71, s71, s38
s_add_u32 s71, s71, 82837504
s_cmp_eq_u32 s66, 1
s_cbranch_scc1 P_mq
s_cmp_eq_u32 s44, 1
s_cbranch_scc1 P_v
s_load_dwordx2 s[20:21], s[0:1], 24
s_waitcnt lgkmcnt(0)
s_and_b32 s21, s21, 0xffff
s_mov_b32 s22, 4194304
s_mov_b32 s23, 0x20000
s_add_u32 s35, s35, 0
s_branch P_t
P_mq:
s_load_dwordx2 s[20:21], s[0:1], 16
s_waitcnt lgkmcnt(0)
s_and_b32 s21, s21, 0xffff
s_mov_b32 s22, 4194304
s_mov_b32 s23, 0x20000
s_add_u32 s35, s35, 33554432
P_t:
s_lshl_b32 s38, s43, 11
s_add_u32 s35, s35, s38
v_lshrrev_b32 v4, 4, v1
v_and_b32 v5, 15, v4
v_mul_u32_u24 v8, 1040, v5
v_lshrrev_b32 v4, 4, v4
v_lshl_add_u32 v8, v4, 4, v8
v_add_u32 v9, 66560, v8
s_add_u32 s38, s34, 0
buffer_load_dwordx2 v[16:17], v3, s[20:23], s38 offen
s_add_u32 s38, s34, 8192
buffer_load_dwordx2 v[18:19], v3, s[20:23], s38 offen
s_add_u32 s38, s34, 16384
buffer_load_dwordx2 v[20:21], v3, s[20:23], s38 offen
s_add_u32 s38, s34, 24576
buffer_load_dwordx2 v[22:23], v3, s[20:23], s38 offen
s_add_u32 s38, s34, 32768
buffer_load_dwordx2 v[24:25], v3, s[20:23], s38 offen
s_add_u32 s38, s34, 40960
buffer_load_dwordx2 v[26:27], v3, s[20:23], s38 offen
s_add_u32 s38, s34, 49152
buffer_load_dwordx2 v[28:29], v3, s[20:23], s38 offen
s_add_u32 s38, s34, 57344
buffer_load_dwordx2 v[30:31], v3, s[20:23], s38 offen
s_add_u32 s38, s34, 262144
buffer_load_dwordx2 v[32:33], v3, s[20:23], s38 offen
s_add_u32 s38, s34, 270336
buffer_load_dwordx2 v[34:35], v3, s[20:23], s38 offen
s_add_u32 s38, s34, 278528
buffer_load_dwordx2 v[36:37], v3, s[20:23], s38 offen
s_add_u32 s38, s34, 286720
buffer_load_dwordx2 v[38:39], v3, s[20:23], s38 offen
s_add_u32 s38, s34, 294912
buffer_load_dwordx2 v[40:41], v3, s[20:23], s38 offen
s_add_u32 s38, s34, 303104
buffer_load_dwordx2 v[42:43], v3, s[20:23], s38 offen
s_add_u32 s38, s34, 311296
buffer_load_dwordx2 v[44:45], v3, s[20:23], s38 offen
s_add_u32 s38, s34, 319488
buffer_load_dwordx2 v[46:47], v3, s[20:23], s38 offen
s_add_u32 s38, s34, 524288
buffer_load_dwordx2 v[48:49], v3, s[20:23], s38 offen
s_add_u32 s38, s34, 532480
buffer_load_dwordx2 v[50:51], v3, s[20:23], s38 offen
s_add_u32 s38, s34, 540672
buffer_load_dwordx2 v[52:53], v3, s[20:23], s38 offen
s_add_u32 s38, s34, 548864
buffer_load_dwordx2 v[54:55], v3, s[20:23], s38 offen
s_add_u32 s38, s34, 557056
buffer_load_dwordx2 v[56:57], v3, s[20:23], s38 offen
s_add_u32 s38, s34, 565248
buffer_load_dwordx2 v[58:59], v3, s[20:23], s38 offen
s_add_u32 s38, s34, 573440
buffer_load_dwordx2 v[60:61], v3, s[20:23], s38 offen
s_add_u32 s38, s34, 581632
buffer_load_dwordx2 v[62:63], v3, s[20:23], s38 offen
s_add_u32 s38, s34, 786432
buffer_load_dwordx2 v[64:65], v3, s[20:23], s38 offen
s_add_u32 s38, s34, 794624
buffer_load_dwordx2 v[66:67], v3, s[20:23], s38 offen
s_add_u32 s38, s34, 802816
buffer_load_dwordx2 v[68:69], v3, s[20:23], s38 offen
s_add_u32 s38, s34, 811008
buffer_load_dwordx2 v[70:71], v3, s[20:23], s38 offen
s_add_u32 s38, s34, 819200
buffer_load_dwordx2 v[72:73], v3, s[20:23], s38 offen
s_add_u32 s38, s34, 827392
buffer_load_dwordx2 v[74:75], v3, s[20:23], s38 offen
s_add_u32 s38, s34, 835584
buffer_load_dwordx2 v[76:77], v3, s[20:23], s38 offen
s_add_u32 s38, s34, 843776
buffer_load_dwordx2 v[78:79], v3, s[20:23], s38 offen
s_waitcnt vmcnt(0)
s_barrier
s_cmp_eq_u32 s70, 0
s_cbranch_scc1 PT_nf
s_cmp_lg_u32 s17, 0
s_cbranch_scc1 PT_nf
s_cmp_lg_u32 s63, 1
s_cbranch_scc1 PT_hn
v_mov_b32 v4, 64
s_mov_b32 s41, 0x40000
PT_nonce:
global_load_dword v5, v4, s[52:53] sc1
s_waitcnt vmcnt(0)
v_readfirstlane_b32 s69, v5
s_nop 0
s_cmp_lg_u32 s69, 0
s_cbranch_scc1 PT_nonce_ok
s_sub_u32 s41, s41, 1
s_cbranch_scc1 PT_nonce_ok
s_sleep 4
s_branch PT_nonce
PT_nonce_ok:
PT_hn:
s_mov_b64 exec, 1
v_mov_b32 v4, s69
v_mov_b32 v5, 0
buffer_store_dword v4, v5, s[8:11], s70 offen sc1
s_mov_b64 exec, -1
PT_nf:
ds_read_b128 a[0:3], v8 offset:0
ds_read_b128 a[4:7], v8 offset:16640
ds_read_b128 a[8:11], v8 offset:33280
ds_read_b128 a[12:15], v8 offset:49920
ds_read_b128 a[16:19], v9 offset:0
ds_read_b128 a[20:23], v9 offset:16640
ds_read_b128 a[24:27], v9 offset:33280
ds_read_b128 a[28:31], v9 offset:49920
v_perm_b32 v96, v18, v16, s50
v_perm_b32 v97, v22, v20, s50
v_perm_b32 v98, v26, v24, s50
v_perm_b32 v99, v30, v28, s50
v_perm_b32 v100, v18, v16, s51
v_perm_b32 v101, v22, v20, s51
v_perm_b32 v102, v26, v24, s51
v_perm_b32 v103, v30, v28, s51
v_perm_b32 v104, v19, v17, s50
v_perm_b32 v105, v23, v21, s50
v_perm_b32 v106, v27, v25, s50
v_perm_b32 v107, v31, v29, s50
v_perm_b32 v108, v19, v17, s51
v_perm_b32 v109, v23, v21, s51
v_perm_b32 v110, v27, v25, s51
v_perm_b32 v111, v31, v29, s51
s_waitcnt lgkmcnt(7)
v_mfma_f32_16x16x32_bf16 v[128:131], v[96:99], a[0:3], 0
v_mfma_f32_16x16x32_bf16 v[132:135], v[100:103], a[0:3], 0
ds_read_b128 a[32:35], v8 offset:64
v_mfma_f32_16x16x32_bf16 v[136:139], v[104:107], a[0:3], 0
v_mfma_f32_16x16x32_bf16 v[140:143], v[108:111], a[0:3], 0
s_add_u32 s38, s34, 1048576
buffer_load_dwordx2 v[80:81], v3, s[20:23], s38 offen
s_waitcnt lgkmcnt(7)
v_mfma_f32_16x16x32_bf16 v[144:147], v[96:99], a[4:7], 0
v_mfma_f32_16x16x32_bf16 v[148:151], v[100:103], a[4:7], 0
ds_read_b128 a[36:39], v8 offset:16704
v_mfma_f32_16x16x32_bf16 v[152:155], v[104:107], a[4:7], 0
v_mfma_f32_16x16x32_bf16 v[156:159], v[108:111], a[4:7], 0
s_add_u32 s38, s34, 1056768
buffer_load_dwordx2 v[82:83], v3, s[20:23], s38 offen
s_waitcnt lgkmcnt(7)
v_mfma_f32_16x16x32_bf16 v[160:163], v[96:99], a[8:11], 0
v_perm_b32 v112, v34, v32, s50
v_perm_b32 v113, v38, v36, s50
v_mfma_f32_16x16x32_bf16 v[164:167], v[100:103], a[8:11], 0
ds_read_b128 a[40:43], v8 offset:33344
v_mfma_f32_16x16x32_bf16 v[168:171], v[104:107], a[8:11], 0
v_perm_b32 v114, v42, v40, s50
v_mfma_f32_16x16x32_bf16 v[172:175], v[108:111], a[8:11], 0
s_add_u32 s38, s34, 1064960
buffer_load_dwordx2 v[84:85], v3, s[20:23], s38 offen
s_waitcnt lgkmcnt(7)
v_mfma_f32_16x16x32_bf16 v[176:179], v[96:99], a[12:15], 0
v_perm_b32 v115, v46, v44, s50
v_perm_b32 v116, v34, v32, s51
v_mfma_f32_16x16x32_bf16 v[180:183], v[100:103], a[12:15], 0
ds_read_b128 a[44:47], v8 offset:49984
v_mfma_f32_16x16x32_bf16 v[184:187], v[104:107], a[12:15], 0
v_perm_b32 v117, v38, v36, s51
v_mfma_f32_16x16x32_bf16 v[188:191], v[108:111], a[12:15], 0
s_add_u32 s38, s34, 1073152
buffer_load_dwordx2 v[86:87], v3, s[20:23], s38 offen
s_waitcnt lgkmcnt(7)
v_mfma_f32_16x16x32_bf16 v[192:195], v[96:99], a[16:19], 0
v_perm_b32 v118, v42, v40, s51
v_perm_b32 v119, v46, v44, s51
v_mfma_f32_16x16x32_bf16 v[196:199], v[100:103], a[16:19], 0
ds_read_b128 a[48:51], v9 offset:64
v_mfma_f32_16x16x32_bf16 v[200:203], v[104:107], a[16:19], 0
v_perm_b32 v120, v35, v33, s50
v_mfma_f32_16x16x32_bf16 v[204:207], v[108:111], a[16:19], 0
s_add_u32 s38, s34, 1081344
buffer_load_dwordx2 v[88:89], v3, s[20:23], s38 offen
s_waitcnt lgkmcnt(7)
v_mfma_f32_16x16x32_bf16 v[208:211], v[96:99], a[20:23], 0
v_perm_b32 v121, v39, v37, s50
v_perm_b32 v122, v43, v41, s50
v_mfma_f32_16x16x32_bf16 v[212:215], v[100:103], a[20:23], 0
ds_read_b128 a[52:55], v9 offset:16704
v_mfma_f32_16x16x32_bf16 v[216:219], v[104:107], a[20:23], 0
v_perm_b32 v123, v47, v45, s50
v_mfma_f32_16x16x32_bf16 v[220:223], v[108:111], a[20:23], 0
s_add_u32 s38, s34, 1089536
buffer_load_dwordx2 v[90:91], v3, s[20:23], s38 offen
s_waitcnt lgkmcnt(7)
v_mfma_f32_16x16x32_bf16 v[224:227], v[96:99], a[24:27], 0
v_perm_b32 v124, v35, v33, s51
v_perm_b32 v125, v39, v37, s51
v_mfma_f32_16x16x32_bf16 v[228:231], v[100:103], a[24:27], 0
ds_read_b128 a[56:59], v9 offset:33344
v_perm_b32 v126, v43, v41, s51
v_mfma_f32_16x16x32_bf16 v[232:235], v[104:107], a[24:27], 0
v_perm_b32 v127, v47, v45, s51
v_mfma_f32_16x16x32_bf16 v[236:239], v[108:111], a[24:27], 0
s_add_u32 s38, s34, 1097728
buffer_load_dwordx2 v[92:93], v3, s[20:23], s38 offen
s_waitcnt lgkmcnt(7)
v_mfma_f32_16x16x32_bf16 v[240:243], v[96:99], a[28:31], 0
v_mfma_f32_16x16x32_bf16 v[244:247], v[100:103], a[28:31], 0
ds_read_b128 a[60:63], v9 offset:49984
v_mfma_f32_16x16x32_bf16 v[248:251], v[104:107], a[28:31], 0
v_mfma_f32_16x16x32_bf16 v[252:255], v[108:111], a[28:31], 0
s_add_u32 s38, s34, 1105920
buffer_load_dwordx2 v[94:95], v3, s[20:23], s38 offen
s_waitcnt lgkmcnt(7)
v_mfma_f32_16x16x32_bf16 v[128:131], v[112:115], a[32:35], v[128:131]
v_mfma_f32_16x16x32_bf16 v[132:135], v[116:119], a[32:35], v[132:135]
ds_read_b128 a[0:3], v8 offset:128
v_mfma_f32_16x16x32_bf16 v[136:139], v[120:123], a[32:35], v[136:139]
v_mfma_f32_16x16x32_bf16 v[140:143], v[124:127], a[32:35], v[140:143]
s_add_u32 s38, s34, 1310720
buffer_load_dwordx2 v[16:17], v3, s[20:23], s38 offen
s_waitcnt lgkmcnt(7)
v_mfma_f32_16x16x32_bf16 v[144:147], v[112:115], a[36:39], v[144:147]
v_mfma_f32_16x16x32_bf16 v[148:151], v[116:119], a[36:39], v[148:151]
ds_read_b128 a[4:7], v8 offset:16768
v_mfma_f32_16x16x32_bf16 v[152:155], v[120:123], a[36:39], v[152:155]
v_mfma_f32_16x16x32_bf16 v[156:159], v[124:127], a[36:39], v[156:159]
s_add_u32 s38, s34, 1318912
buffer_load_dwordx2 v[18:19], v3, s[20:23], s38 offen
s_waitcnt lgkmcnt(7)
v_mfma_f32_16x16x32_bf16 v[160:163], v[112:115], a[40:43], v[160:163]
v_perm_b32 v96, v50, v48, s50
v_perm_b32 v97, v54, v52, s50
v_mfma_f32_16x16x32_bf16 v[164:167], v[116:119], a[40:43], v[164:167]
ds_read_b128 a[8:11], v8 offset:33408
v_mfma_f32_16x16x32_bf16 v[168:171], v[120:123], a[40:43], v[168:171]
v_perm_b32 v98, v58, v56, s50
v_mfma_f32_16x16x32_bf16 v[172:175], v[124:127], a[40:43], v[172:175]
s_add_u32 s38, s34, 1327104
buffer_load_dwordx2 v[20:21], v3, s[20:23], s38 offen
s_waitcnt lgkmcnt(7)
v_mfma_f32_16x16x32_bf16 v[176:179], v[112:115], a[44:47], v[176:179]
v_perm_b32 v99, v62, v60, s50
v_perm_b32 v100, v50, v48, s51
v_mfma_f32_16x16x32_bf16 v[180:183], v[116:119], a[44:47], v[180:183]
ds_read_b128 a[12:15], v8 offset:50048
v_mfma_f32_16x16x32_bf16 v[184:187], v[120:123], a[44:47], v[184:187]
v_perm_b32 v101, v54, v52, s51
v_mfma_f32_16x16x32_bf16 v[188:191], v[124:127], a[44:47], v[188:191]
s_add_u32 s38, s34, 1335296
buffer_load_dwordx2 v[22:23], v3, s[20:23], s38 offen
s_waitcnt lgkmcnt(7)
v_mfma_f32_16x16x32_bf16 v[192:195], v[112:115], a[48:51], v[192:195]
v_perm_b32 v102, v58, v56, s51
v_perm_b32 v103, v62, v60, s51
v_mfma_f32_16x16x32_bf16 v[196:199], v[116:119], a[48:51], v[196:199]
ds_read_b128 a[16:19], v9 offset:128
v_mfma_f32_16x16x32_bf16 v[200:203], v[120:123], a[48:51], v[200:203]
v_perm_b32 v104, v51, v49, s50
v_mfma_f32_16x16x32_bf16 v[204:207], v[124:127], a[48:51], v[204:207]
s_add_u32 s38, s34, 1343488
buffer_load_dwordx2 v[24:25], v3, s[20:23], s38 offen
s_waitcnt lgkmcnt(7)
v_mfma_f32_16x16x32_bf16 v[208:211], v[112:115], a[52:55], v[208:211]
v_perm_b32 v105, v55, v53, s50
v_perm_b32 v106, v59, v57, s50
v_mfma_f32_16x16x32_bf16 v[212:215], v[116:119], a[52:55], v[212:215]
ds_read_b128 a[20:23], v9 offset:16768
v_mfma_f32_16x16x32_bf16 v[216:219], v[120:123], a[52:55], v[216:219]
v_perm_b32 v107, v63, v61, s50
v_mfma_f32_16x16x32_bf16 v[220:223], v[124:127], a[52:55], v[220:223]
s_add_u32 s38, s34, 1351680
buffer_load_dwordx2 v[26:27], v3, s[20:23], s38 offen
s_waitcnt lgkmcnt(7)
v_mfma_f32_16x16x32_bf16 v[224:227], v[112:115], a[56:59], v[224:227]
v_perm_b32 v108, v51, v49, s51
v_perm_b32 v109, v55, v53, s51
v_mfma_f32_16x16x32_bf16 v[228:231], v[116:119], a[56:59], v[228:231]
ds_read_b128 a[24:27], v9 offset:33408
v_perm_b32 v110, v59, v57, s51
v_mfma_f32_16x16x32_bf16 v[232:235], v[120:123], a[56:59], v[232:235]
v_perm_b32 v111, v63, v61, s51
v_mfma_f32_16x16x32_bf16 v[236:239], v[124:127], a[56:59], v[236:239]
s_add_u32 s38, s34, 1359872
buffer_load_dwordx2 v[28:29], v3, s[20:23], s38 offen
s_waitcnt lgkmcnt(7)
v_mfma_f32_16x16x32_bf16 v[240:243], v[112:115], a[60:63], v[240:243]
v_mfma_f32_16x16x32_bf16 v[244:247], v[116:119], a[60:63], v[244:247]
ds_read_b128 a[28:31], v9 offset:50048
v_mfma_f32_16x16x32_bf16 v[248:251], v[120:123], a[60:63], v[248:251]
v_mfma_f32_16x16x32_bf16 v[252:255], v[124:127], a[60:63], v[252:255]
s_add_u32 s38, s34, 1368064
buffer_load_dwordx2 v[30:31], v3, s[20:23], s38 offen
s_waitcnt lgkmcnt(7)
v_mfma_f32_16x16x32_bf16 v[128:131], v[96:99], a[0:3], v[128:131]
v_mfma_f32_16x16x32_bf16 v[132:135], v[100:103], a[0:3], v[132:135]
ds_read_b128 a[32:35], v8 offset:192
v_mfma_f32_16x16x32_bf16 v[136:139], v[104:107], a[0:3], v[136:139]
v_mfma_f32_16x16x32_bf16 v[140:143], v[108:111], a[0:3], v[140:143]
s_add_u32 s38, s34, 1572864
buffer_load_dwordx2 v[32:33], v3, s[20:23], s38 offen
s_waitcnt lgkmcnt(7)
v_mfma_f32_16x16x32_bf16 v[144:147], v[96:99], a[4:7], v[144:147]
v_mfma_f32_16x16x32_bf16 v[148:151], v[100:103], a[4:7], v[148:151]
ds_read_b128 a[36:39], v8 offset:16832
v_mfma_f32_16x16x32_bf16 v[152:155], v[104:107], a[4:7], v[152:155]
v_mfma_f32_16x16x32_bf16 v[156:159], v[108:111], a[4:7], v[156:159]
s_add_u32 s38, s34, 1581056
buffer_load_dwordx2 v[34:35], v3, s[20:23], s38 offen
s_waitcnt lgkmcnt(7)
v_mfma_f32_16x16x32_bf16 v[160:163], v[96:99], a[8:11], v[160:163]
v_perm_b32 v112, v66, v64, s50
v_perm_b32 v113, v70, v68, s50
v_mfma_f32_16x16x32_bf16 v[164:167], v[100:103], a[8:11], v[164:167]
ds_read_b128 a[40:43], v8 offset:33472
v_mfma_f32_16x16x32_bf16 v[168:171], v[104:107], a[8:11], v[168:171]
v_perm_b32 v114, v74, v72, s50
v_mfma_f32_16x16x32_bf16 v[172:175], v[108:111], a[8:11], v[172:175]
s_add_u32 s38, s34, 1589248
buffer_load_dwordx2 v[36:37], v3, s[20:23], s38 offen
s_waitcnt lgkmcnt(7)
v_mfma_f32_16x16x32_bf16 v[176:179], v[96:99], a[12:15], v[176:179]
v_perm_b32 v115, v78, v76, s50
v_perm_b32 v116, v66, v64, s51
v_mfma_f32_16x16x32_bf16 v[180:183], v[100:103], a[12:15], v[180:183]
ds_read_b128 a[44:47], v8 offset:50112
v_mfma_f32_16x16x32_bf16 v[184:187], v[104:107], a[12:15], v[184:187]
v_perm_b32 v117, v70, v68, s51
v_mfma_f32_16x16x32_bf16 v[188:191], v[108:111], a[12:15], v[188:191]
s_add_u32 s38, s34, 1597440
buffer_load_dwordx2 v[38:39], v3, s[20:23], s38 offen
s_waitcnt lgkmcnt(7)
v_mfma_f32_16x16x32_bf16 v[192:195], v[96:99], a[16:19], v[192:195]
v_perm_b32 v118, v74, v72, s51
v_perm_b32 v119, v78, v76, s51
v_mfma_f32_16x16x32_bf16 v[196:199], v[100:103], a[16:19], v[196:199]
ds_read_b128 a[48:51], v9 offset:192
v_mfma_f32_16x16x32_bf16 v[200:203], v[104:107], a[16:19], v[200:203]
v_perm_b32 v120, v67, v65, s50
v_mfma_f32_16x16x32_bf16 v[204:207], v[108:111], a[16:19], v[204:207]
s_add_u32 s38, s34, 1605632
buffer_load_dwordx2 v[40:41], v3, s[20:23], s38 offen
s_waitcnt lgkmcnt(7)
v_mfma_f32_16x16x32_bf16 v[208:211], v[96:99], a[20:23], v[208:211]
v_perm_b32 v121, v71, v69, s50
v_perm_b32 v122, v75, v73, s50
v_mfma_f32_16x16x32_bf16 v[212:215], v[100:103], a[20:23], v[212:215]
ds_read_b128 a[52:55], v9 offset:16832
v_mfma_f32_16x16x32_bf16 v[216:219], v[104:107], a[20:23], v[216:219]
v_perm_b32 v123, v79, v77, s50
v_mfma_f32_16x16x32_bf16 v[220:223], v[108:111], a[20:23], v[220:223]
s_add_u32 s38, s34, 1613824
buffer_load_dwordx2 v[42:43], v3, s[20:23], s38 offen
s_waitcnt lgkmcnt(7)
v_mfma_f32_16x16x32_bf16 v[224:227], v[96:99], a[24:27], v[224:227]
v_perm_b32 v124, v67, v65, s51
v_perm_b32 v125, v71, v69, s51
v_mfma_f32_16x16x32_bf16 v[228:231], v[100:103], a[24:27], v[228:231]
ds_read_b128 a[56:59], v9 offset:33472
v_perm_b32 v126, v75, v73, s51
v_mfma_f32_16x16x32_bf16 v[232:235], v[104:107], a[24:27], v[232:235]
v_perm_b32 v127, v79, v77, s51
v_mfma_f32_16x16x32_bf16 v[236:239], v[108:111], a[24:27], v[236:239]
s_add_u32 s38, s34, 1622016
buffer_load_dwordx2 v[44:45], v3, s[20:23], s38 offen
s_waitcnt lgkmcnt(7)
v_mfma_f32_16x16x32_bf16 v[240:243], v[96:99], a[28:31], v[240:243]
v_mfma_f32_16x16x32_bf16 v[244:247], v[100:103], a[28:31], v[244:247]
ds_read_b128 a[60:63], v9 offset:50112
v_mfma_f32_16x16x32_bf16 v[248:251], v[104:107], a[28:31], v[248:251]
v_mfma_f32_16x16x32_bf16 v[252:255], v[108:111], a[28:31], v[252:255]
s_add_u32 s38, s34, 1630208
buffer_load_dwordx2 v[46:47], v3, s[20:23], s38 offen
s_waitcnt lgkmcnt(7)
v_mfma_f32_16x16x32_bf16 v[128:131], v[112:115], a[32:35], v[128:131]
v_mfma_f32_16x16x32_bf16 v[132:135], v[116:119], a[32:35], v[132:135]
ds_read_b128 a[0:3], v8 offset:256
v_mfma_f32_16x16x32_bf16 v[136:139], v[120:123], a[32:35], v[136:139]
v_mfma_f32_16x16x32_bf16 v[140:143], v[124:127], a[32:35], v[140:143]
s_add_u32 s38, s34, 1835008
buffer_load_dwordx2 v[48:49], v3, s[20:23], s38 offen
s_waitcnt lgkmcnt(7)
v_mfma_f32_16x16x32_bf16 v[144:147], v[112:115], a[36:39], v[144:147]
v_mfma_f32_16x16x32_bf16 v[148:151], v[116:119], a[36:39], v[148:151]
ds_read_b128 a[4:7], v8 offset:16896
v_mfma_f32_16x16x32_bf16 v[152:155], v[120:123], a[36:39], v[152:155]
v_mfma_f32_16x16x32_bf16 v[156:159], v[124:127], a[36:39], v[156:159]
s_add_u32 s38, s34, 1843200
buffer_load_dwordx2 v[50:51], v3, s[20:23], s38 offen
s_waitcnt lgkmcnt(7)
v_mfma_f32_16x16x32_bf16 v[160:163], v[112:115], a[40:43], v[160:163]
s_waitcnt vmcnt(24)
v_perm_b32 v96, v82, v80, s50
s_waitcnt vmcnt(22)
v_perm_b32 v97, v86, v84, s50
v_mfma_f32_16x16x32_bf16 v[164:167], v[116:119], a[40:43], v[164:167]
ds_read_b128 a[8:11], v8 offset:33536
v_mfma_f32_16x16x32_bf16 v[168:171], v[120:123], a[40:43], v[168:171]
s_waitcnt vmcnt(20)
v_perm_b32 v98, v90, v88, s50
v_mfma_f32_16x16x32_bf16 v[172:175], v[124:127], a[40:43], v[172:175]
s_add_u32 s38, s34, 1851392
buffer_load_dwordx2 v[52:53], v3, s[20:23], s38 offen
s_waitcnt lgkmcnt(7)
v_mfma_f32_16x16x32_bf16 v[176:179], v[112:115], a[44:47], v[176:179]
s_waitcnt vmcnt(19)
v_perm_b32 v99, v94, v92, s50
v_perm_b32 v100, v82, v80, s51
v_mfma_f32_16x16x32_bf16 v[180:183], v[116:119], a[44:47], v[180:183]
ds_read_b128 a[12:15], v8 offset:50176
v_mfma_f32_16x16x32_bf16 v[184:187], v[120:123], a[44:47], v[184:187]
v_perm_b32 v101, v86, v84, s51
v_mfma_f32_16x16x32_bf16 v[188:191], v[124:127], a[44:47], v[188:191]
s_add_u32 s38, s34, 1859584
buffer_load_dwordx2 v[54:55], v3, s[20:23], s38 offen
s_waitcnt lgkmcnt(7)
v_mfma_f32_16x16x32_bf16 v[192:195], v[112:115], a[48:51], v[192:195]
v_perm_b32 v102, v90, v88, s51
v_perm_b32 v103, v94, v92, s51
v_mfma_f32_16x16x32_bf16 v[196:199], v[116:119], a[48:51], v[196:199]
ds_read_b128 a[16:19], v9 offset:256
v_mfma_f32_16x16x32_bf16 v[200:203], v[120:123], a[48:51], v[200:203]
v_perm_b32 v104, v83, v81, s50
v_mfma_f32_16x16x32_bf16 v[204:207], v[124:127], a[48:51], v[204:207]
s_add_u32 s38, s34, 1867776
buffer_load_dwordx2 v[56:57], v3, s[20:23], s38 offen
s_waitcnt lgkmcnt(7)
v_mfma_f32_16x16x32_bf16 v[208:211], v[112:115], a[52:55], v[208:211]
v_perm_b32 v105, v87, v85, s50
v_perm_b32 v106, v91, v89, s50
v_mfma_f32_16x16x32_bf16 v[212:215], v[116:119], a[52:55], v[212:215]
ds_read_b128 a[20:23], v9 offset:16896
v_mfma_f32_16x16x32_bf16 v[216:219], v[120:123], a[52:55], v[216:219]
v_perm_b32 v107, v95, v93, s50
v_mfma_f32_16x16x32_bf16 v[220:223], v[124:127], a[52:55], v[220:223]
s_add_u32 s38, s34, 1875968
buffer_load_dwordx2 v[58:59], v3, s[20:23], s38 offen
s_waitcnt lgkmcnt(7)
v_mfma_f32_16x16x32_bf16 v[224:227], v[112:115], a[56:59], v[224:227]
v_perm_b32 v108, v83, v81, s51
v_perm_b32 v109, v87, v85, s51
v_mfma_f32_16x16x32_bf16 v[228:231], v[116:119], a[56:59], v[228:231]
ds_read_b128 a[24:27], v9 offset:33536
v_perm_b32 v110, v91, v89, s51
v_mfma_f32_16x16x32_bf16 v[232:235], v[120:123], a[56:59], v[232:235]
v_perm_b32 v111, v95, v93, s51
v_mfma_f32_16x16x32_bf16 v[236:239], v[124:127], a[56:59], v[236:239]
s_add_u32 s38, s34, 1884160
buffer_load_dwordx2 v[60:61], v3, s[20:23], s38 offen
s_waitcnt lgkmcnt(7)
v_mfma_f32_16x16x32_bf16 v[240:243], v[112:115], a[60:63], v[240:243]
v_mfma_f32_16x16x32_bf16 v[244:247], v[116:119], a[60:63], v[244:247]
ds_read_b128 a[28:31], v9 offset:50176
v_mfma_f32_16x16x32_bf16 v[248:251], v[120:123], a[60:63], v[248:251]
v_mfma_f32_16x16x32_bf16 v[252:255], v[124:127], a[60:63], v[252:255]
s_add_u32 s38, s34, 1892352
buffer_load_dwordx2 v[62:63], v3, s[20:23], s38 offen
s_waitcnt lgkmcnt(7)
v_mfma_f32_16x16x32_bf16 v[128:131], v[96:99], a[0:3], v[128:131]
v_mfma_f32_16x16x32_bf16 v[132:135], v[100:103], a[0:3], v[132:135]
ds_read_b128 a[32:35], v8 offset:320
v_mfma_f32_16x16x32_bf16 v[136:139], v[104:107], a[0:3], v[136:139]
v_mfma_f32_16x16x32_bf16 v[140:143], v[108:111], a[0:3], v[140:143]
s_add_u32 s38, s34, 2097152
buffer_load_dwordx2 v[64:65], v3, s[20:23], s38 offen
s_waitcnt lgkmcnt(7)
v_mfma_f32_16x16x32_bf16 v[144:147], v[96:99], a[4:7], v[144:147]
v_mfma_f32_16x16x32_bf16 v[148:151], v[100:103], a[4:7], v[148:151]
ds_read_b128 a[36:39], v8 offset:16960
v_mfma_f32_16x16x32_bf16 v[152:155], v[104:107], a[4:7], v[152:155]
v_mfma_f32_16x16x32_bf16 v[156:159], v[108:111], a[4:7], v[156:159]
s_add_u32 s38, s34, 2105344
buffer_load_dwordx2 v[66:67], v3, s[20:23], s38 offen
s_waitcnt lgkmcnt(7)
v_mfma_f32_16x16x32_bf16 v[160:163], v[96:99], a[8:11], v[160:163]
s_waitcnt vmcnt(24)
v_perm_b32 v112, v18, v16, s50
s_waitcnt vmcnt(22)
v_perm_b32 v113, v22, v20, s50
v_mfma_f32_16x16x32_bf16 v[164:167], v[100:103], a[8:11], v[164:167]
ds_read_b128 a[40:43], v8 offset:33600
v_mfma_f32_16x16x32_bf16 v[168:171], v[104:107], a[8:11], v[168:171]
s_waitcnt vmcnt(20)
v_perm_b32 v114, v26, v24, s50
v_mfma_f32_16x16x32_bf16 v[172:175], v[108:111], a[8:11], v[172:175]
s_add_u32 s38, s34, 2113536
buffer_load_dwordx2 v[68:69], v3, s[20:23], s38 offen
s_waitcnt lgkmcnt(7)
v_mfma_f32_16x16x32_bf16 v[176:179], v[96:99], a[12:15], v[176:179]
s_waitcnt vmcnt(19)
v_perm_b32 v115, v30, v28, s50
v_perm_b32 v116, v18, v16, s51
v_mfma_f32_16x16x32_bf16 v[180:183], v[100:103], a[12:15], v[180:183]
ds_read_b128 a[44:47], v8 offset:50240
v_mfma_f32_16x16x32_bf16 v[184:187], v[104:107], a[12:15], v[184:187]
v_perm_b32 v117, v22, v20, s51
v_mfma_f32_16x16x32_bf16 v[188:191], v[108:111], a[12:15], v[188:191]
s_add_u32 s38, s34, 2121728
buffer_load_dwordx2 v[70:71], v3, s[20:23], s38 offen
s_waitcnt lgkmcnt(7)
v_mfma_f32_16x16x32_bf16 v[192:195], v[96:99], a[16:19], v[192:195]
v_perm_b32 v118, v26, v24, s51
v_perm_b32 v119, v30, v28, s51
v_mfma_f32_16x16x32_bf16 v[196:199], v[100:103], a[16:19], v[196:199]
ds_read_b128 a[48:51], v9 offset:320
v_mfma_f32_16x16x32_bf16 v[200:203], v[104:107], a[16:19], v[200:203]
v_perm_b32 v120, v19, v17, s50
v_mfma_f32_16x16x32_bf16 v[204:207], v[108:111], a[16:19], v[204:207]
s_add_u32 s38, s34, 2129920
buffer_load_dwordx2 v[72:73], v3, s[20:23], s38 offen
s_waitcnt lgkmcnt(7)
v_mfma_f32_16x16x32_bf16 v[208:211], v[96:99], a[20:23], v[208:211]
v_perm_b32 v121, v23, v21, s50
v_perm_b32 v122, v27, v25, s50
v_mfma_f32_16x16x32_bf16 v[212:215], v[100:103], a[20:23], v[212:215]
ds_read_b128 a[52:55], v9 offset:16960
v_mfma_f32_16x16x32_bf16 v[216:219], v[104:107], a[20:23], v[216:219]
v_perm_b32 v123, v31, v29, s50
v_mfma_f32_16x16x32_bf16 v[220:223], v[108:111], a[20:23], v[220:223]
s_add_u32 s38, s34, 2138112
buffer_load_dwordx2 v[74:75], v3, s[20:23], s38 offen
s_waitcnt lgkmcnt(7)
v_mfma_f32_16x16x32_bf16 v[224:227], v[96:99], a[24:27], v[224:227]
v_perm_b32 v124, v19, v17, s51
v_perm_b32 v125, v23, v21, s51
v_mfma_f32_16x16x32_bf16 v[228:231], v[100:103], a[24:27], v[228:231]
ds_read_b128 a[56:59], v9 offset:33600
v_perm_b32 v126, v27, v25, s51
v_mfma_f32_16x16x32_bf16 v[232:235], v[104:107], a[24:27], v[232:235]
v_perm_b32 v127, v31, v29, s51
v_mfma_f32_16x16x32_bf16 v[236:239], v[108:111], a[24:27], v[236:239]
s_add_u32 s38, s34, 2146304
buffer_load_dwordx2 v[76:77], v3, s[20:23], s38 offen
s_waitcnt lgkmcnt(7)
v_mfma_f32_16x16x32_bf16 v[240:243], v[96:99], a[28:31], v[240:243]
v_mfma_f32_16x16x32_bf16 v[244:247], v[100:103], a[28:31], v[244:247]
ds_read_b128 a[60:63], v9 offset:50240
v_mfma_f32_16x16x32_bf16 v[248:251], v[104:107], a[28:31], v[248:251]
v_mfma_f32_16x16x32_bf16 v[252:255], v[108:111], a[28:31], v[252:255]
s_add_u32 s38, s34, 2154496
buffer_load_dwordx2 v[78:79], v3, s[20:23], s38 offen
s_waitcnt lgkmcnt(7)
v_mfma_f32_16x16x32_bf16 v[128:131], v[112:115], a[32:35], v[128:131]
v_mfma_f32_16x16x32_bf16 v[132:135], v[116:119], a[32:35], v[132:135]
ds_read_b128 a[0:3], v8 offset:384
v_mfma_f32_16x16x32_bf16 v[136:139], v[120:123], a[32:35], v[136:139]
v_mfma_f32_16x16x32_bf16 v[140:143], v[124:127], a[32:35], v[140:143]
s_add_u32 s38, s34, 2359296
buffer_load_dwordx2 v[80:81], v3, s[20:23], s38 offen
s_waitcnt lgkmcnt(7)
v_mfma_f32_16x16x32_bf16 v[144:147], v[112:115], a[36:39], v[144:147]
v_mfma_f32_16x16x32_bf16 v[148:151], v[116:119], a[36:39], v[148:151]
ds_read_b128 a[4:7], v8 offset:17024
v_mfma_f32_16x16x32_bf16 v[152:155], v[120:123], a[36:39], v[152:155]
v_mfma_f32_16x16x32_bf16 v[156:159], v[124:127], a[36:39], v[156:159]
s_add_u32 s38, s34, 2367488
buffer_load_dwordx2 v[82:83], v3, s[20:23], s38 offen
s_waitcnt lgkmcnt(7)
v_mfma_f32_16x16x32_bf16 v[160:163], v[112:115], a[40:43], v[160:163]
s_waitcnt vmcnt(24)
v_perm_b32 v96, v34, v32, s50
s_waitcnt vmcnt(22)
v_perm_b32 v97, v38, v36, s50
v_mfma_f32_16x16x32_bf16 v[164:167], v[116:119], a[40:43], v[164:167]
ds_read_b128 a[8:11], v8 offset:33664
v_mfma_f32_16x16x32_bf16 v[168:171], v[120:123], a[40:43], v[168:171]
s_waitcnt vmcnt(20)
v_perm_b32 v98, v42, v40, s50
v_mfma_f32_16x16x32_bf16 v[172:175], v[124:127], a[40:43], v[172:175]
s_add_u32 s38, s34, 2375680
buffer_load_dwordx2 v[84:85], v3, s[20:23], s38 offen
s_waitcnt lgkmcnt(7)
v_mfma_f32_16x16x32_bf16 v[176:179], v[112:115], a[44:47], v[176:179]
s_waitcnt vmcnt(19)
v_perm_b32 v99, v46, v44, s50
v_perm_b32 v100, v34, v32, s51
v_mfma_f32_16x16x32_bf16 v[180:183], v[116:119], a[44:47], v[180:183]
ds_read_b128 a[12:15], v8 offset:50304
v_mfma_f32_16x16x32_bf16 v[184:187], v[120:123], a[44:47], v[184:187]
v_perm_b32 v101, v38, v36, s51
v_mfma_f32_16x16x32_bf16 v[188:191], v[124:127], a[44:47], v[188:191]
s_add_u32 s38, s34, 2383872
buffer_load_dwordx2 v[86:87], v3, s[20:23], s38 offen
s_waitcnt lgkmcnt(7)
v_mfma_f32_16x16x32_bf16 v[192:195], v[112:115], a[48:51], v[192:195]
v_perm_b32 v102, v42, v40, s51
v_perm_b32 v103, v46, v44, s51
v_mfma_f32_16x16x32_bf16 v[196:199], v[116:119], a[48:51], v[196:199]
ds_read_b128 a[16:19], v9 offset:384
v_mfma_f32_16x16x32_bf16 v[200:203], v[120:123], a[48:51], v[200:203]
v_perm_b32 v104, v35, v33, s50
v_mfma_f32_16x16x32_bf16 v[204:207], v[124:127], a[48:51], v[204:207]
s_add_u32 s38, s34, 2392064
buffer_load_dwordx2 v[88:89], v3, s[20:23], s38 offen
s_waitcnt lgkmcnt(7)
v_mfma_f32_16x16x32_bf16 v[208:211], v[112:115], a[52:55], v[208:211]
v_perm_b32 v105, v39, v37, s50
v_perm_b32 v106, v43, v41, s50
v_mfma_f32_16x16x32_bf16 v[212:215], v[116:119], a[52:55], v[212:215]
ds_read_b128 a[20:23], v9 offset:17024
v_mfma_f32_16x16x32_bf16 v[216:219], v[120:123], a[52:55], v[216:219]
v_perm_b32 v107, v47, v45, s50
v_mfma_f32_16x16x32_bf16 v[220:223], v[124:127], a[52:55], v[220:223]
s_add_u32 s38, s34, 2400256
buffer_load_dwordx2 v[90:91], v3, s[20:23], s38 offen
s_waitcnt lgkmcnt(7)
v_mfma_f32_16x16x32_bf16 v[224:227], v[112:115], a[56:59], v[224:227]
v_perm_b32 v108, v35, v33, s51
v_perm_b32 v109, v39, v37, s51
v_mfma_f32_16x16x32_bf16 v[228:231], v[116:119], a[56:59], v[228:231]
ds_read_b128 a[24:27], v9 offset:33664
v_perm_b32 v110, v43, v41, s51
v_mfma_f32_16x16x32_bf16 v[232:235], v[120:123], a[56:59], v[232:235]
v_perm_b32 v111, v47, v45, s51
v_mfma_f32_16x16x32_bf16 v[236:239], v[124:127], a[56:59], v[236:239]
s_add_u32 s38, s34, 2408448
buffer_load_dwordx2 v[92:93], v3, s[20:23], s38 offen
s_waitcnt lgkmcnt(7)
v_mfma_f32_16x16x32_bf16 v[240:243], v[112:115], a[60:63], v[240:243]
v_mfma_f32_16x16x32_bf16 v[244:247], v[116:119], a[60:63], v[244:247]
ds_read_b128 a[28:31], v9 offset:50304
v_mfma_f32_16x16x32_bf16 v[248:251], v[120:123], a[60:63], v[248:251]
v_mfma_f32_16x16x32_bf16 v[252:255], v[124:127], a[60:63], v[252:255]
s_add_u32 s38, s34, 2416640
buffer_load_dwordx2 v[94:95], v3, s[20:23], s38 offen
s_waitcnt lgkmcnt(7)
v_mfma_f32_16x16x32_bf16 v[128:131], v[96:99], a[0:3], v[128:131]
v_mfma_f32_16x16x32_bf16 v[132:135], v[100:103], a[0:3], v[132:135]
ds_read_b128 a[32:35], v8 offset:448
v_mfma_f32_16x16x32_bf16 v[136:139], v[104:107], a[0:3], v[136:139]
v_mfma_f32_16x16x32_bf16 v[140:143], v[108:111], a[0:3], v[140:143]
s_add_u32 s38, s34, 2621440
buffer_load_dwordx2 v[16:17], v3, s[20:23], s38 offen
s_waitcnt lgkmcnt(7)
v_mfma_f32_16x16x32_bf16 v[144:147], v[96:99], a[4:7], v[144:147]
v_mfma_f32_16x16x32_bf16 v[148:151], v[100:103], a[4:7], v[148:151]
ds_read_b128 a[36:39], v8 offset:17088
v_mfma_f32_16x16x32_bf16 v[152:155], v[104:107], a[4:7], v[152:155]
v_mfma_f32_16x16x32_bf16 v[156:159], v[108:111], a[4:7], v[156:159]
s_add_u32 s38, s34, 2629632
buffer_load_dwordx2 v[18:19], v3, s[20:23], s38 offen
s_waitcnt lgkmcnt(7)
v_mfma_f32_16x16x32_bf16 v[160:163], v[96:99], a[8:11], v[160:163]
s_waitcnt vmcnt(24)
v_perm_b32 v112, v50, v48, s50
s_waitcnt vmcnt(22)
v_perm_b32 v113, v54, v52, s50
v_mfma_f32_16x16x32_bf16 v[164:167], v[100:103], a[8:11], v[164:167]
ds_read_b128 a[40:43], v8 offset:33728
v_mfma_f32_16x16x32_bf16 v[168:171], v[104:107], a[8:11], v[168:171]
s_waitcnt vmcnt(20)
v_perm_b32 v114, v58, v56, s50
v_mfma_f32_16x16x32_bf16 v[172:175], v[108:111], a[8:11], v[172:175]
s_add_u32 s38, s34, 2637824
buffer_load_dwordx2 v[20:21], v3, s[20:23], s38 offen
s_waitcnt lgkmcnt(7)
v_mfma_f32_16x16x32_bf16 v[176:179], v[96:99], a[12:15], v[176:179]
s_waitcnt vmcnt(19)
v_perm_b32 v115, v62, v60, s50
v_perm_b32 v116, v50, v48, s51
v_mfma_f32_16x16x32_bf16 v[180:183], v[100:103], a[12:15], v[180:183]
ds_read_b128 a[44:47], v8 offset:50368
v_mfma_f32_16x16x32_bf16 v[184:187], v[104:107], a[12:15], v[184:187]
v_perm_b32 v117, v54, v52, s51
v_mfma_f32_16x16x32_bf16 v[188:191], v[108:111], a[12:15], v[188:191]
s_add_u32 s38, s34, 2646016
buffer_load_dwordx2 v[22:23], v3, s[20:23], s38 offen
s_waitcnt lgkmcnt(7)
v_mfma_f32_16x16x32_bf16 v[192:195], v[96:99], a[16:19], v[192:195]
v_perm_b32 v118, v58, v56, s51
v_perm_b32 v119, v62, v60, s51
v_mfma_f32_16x16x32_bf16 v[196:199], v[100:103], a[16:19], v[196:199]
ds_read_b128 a[48:51], v9 offset:448
v_mfma_f32_16x16x32_bf16 v[200:203], v[104:107], a[16:19], v[200:203]
v_perm_b32 v120, v51, v49, s50
v_mfma_f32_16x16x32_bf16 v[204:207], v[108:111], a[16:19], v[204:207]
s_add_u32 s38, s34, 2654208
buffer_load_dwordx2 v[24:25], v3, s[20:23], s38 offen
s_waitcnt lgkmcnt(7)
v_mfma_f32_16x16x32_bf16 v[208:211], v[96:99], a[20:23], v[208:211]
v_perm_b32 v121, v55, v53, s50
v_perm_b32 v122, v59, v57, s50
v_mfma_f32_16x16x32_bf16 v[212:215], v[100:103], a[20:23], v[212:215]
ds_read_b128 a[52:55], v9 offset:17088
v_mfma_f32_16x16x32_bf16 v[216:219], v[104:107], a[20:23], v[216:219]
v_perm_b32 v123, v63, v61, s50
v_mfma_f32_16x16x32_bf16 v[220:223], v[108:111], a[20:23], v[220:223]
s_add_u32 s38, s34, 2662400
buffer_load_dwordx2 v[26:27], v3, s[20:23], s38 offen
s_waitcnt lgkmcnt(7)
v_mfma_f32_16x16x32_bf16 v[224:227], v[96:99], a[24:27], v[224:227]
v_perm_b32 v124, v51, v49, s51
v_perm_b32 v125, v55, v53, s51
v_mfma_f32_16x16x32_bf16 v[228:231], v[100:103], a[24:27], v[228:231]
ds_read_b128 a[56:59], v9 offset:33728
v_perm_b32 v126, v59, v57, s51
v_mfma_f32_16x16x32_bf16 v[232:235], v[104:107], a[24:27], v[232:235]
v_perm_b32 v127, v63, v61, s51
v_mfma_f32_16x16x32_bf16 v[236:239], v[108:111], a[24:27], v[236:239]
s_add_u32 s38, s34, 2670592
buffer_load_dwordx2 v[28:29], v3, s[20:23], s38 offen
s_waitcnt lgkmcnt(7)
v_mfma_f32_16x16x32_bf16 v[240:243], v[96:99], a[28:31], v[240:243]
v_mfma_f32_16x16x32_bf16 v[244:247], v[100:103], a[28:31], v[244:247]
ds_read_b128 a[60:63], v9 offset:50368
v_mfma_f32_16x16x32_bf16 v[248:251], v[104:107], a[28:31], v[248:251]
v_mfma_f32_16x16x32_bf16 v[252:255], v[108:111], a[28:31], v[252:255]
s_add_u32 s38, s34, 2678784
buffer_load_dwordx2 v[30:31], v3, s[20:23], s38 offen
s_waitcnt lgkmcnt(7)
v_mfma_f32_16x16x32_bf16 v[128:131], v[112:115], a[32:35], v[128:131]
v_mfma_f32_16x16x32_bf16 v[132:135], v[116:119], a[32:35], v[132:135]
ds_read_b128 a[0:3], v8 offset:512
v_mfma_f32_16x16x32_bf16 v[136:139], v[120:123], a[32:35], v[136:139]
v_mfma_f32_16x16x32_bf16 v[140:143], v[124:127], a[32:35], v[140:143]
s_add_u32 s38, s34, 2883584
buffer_load_dwordx2 v[32:33], v3, s[20:23], s38 offen
s_waitcnt lgkmcnt(7)
v_mfma_f32_16x16x32_bf16 v[144:147], v[112:115], a[36:39], v[144:147]
v_mfma_f32_16x16x32_bf16 v[148:151], v[116:119], a[36:39], v[148:151]
ds_read_b128 a[4:7], v8 offset:17152
v_mfma_f32_16x16x32_bf16 v[152:155], v[120:123], a[36:39], v[152:155]
v_mfma_f32_16x16x32_bf16 v[156:159], v[124:127], a[36:39], v[156:159]
s_add_u32 s38, s34, 2891776
buffer_load_dwordx2 v[34:35], v3, s[20:23], s38 offen
s_waitcnt lgkmcnt(7)
v_mfma_f32_16x16x32_bf16 v[160:163], v[112:115], a[40:43], v[160:163]
s_waitcnt vmcnt(24)
v_perm_b32 v96, v66, v64, s50
s_waitcnt vmcnt(22)
v_perm_b32 v97, v70, v68, s50
v_mfma_f32_16x16x32_bf16 v[164:167], v[116:119], a[40:43], v[164:167]
ds_read_b128 a[8:11], v8 offset:33792
v_mfma_f32_16x16x32_bf16 v[168:171], v[120:123], a[40:43], v[168:171]
s_waitcnt vmcnt(20)
v_perm_b32 v98, v74, v72, s50
v_mfma_f32_16x16x32_bf16 v[172:175], v[124:127], a[40:43], v[172:175]
s_add_u32 s38, s34, 2899968
buffer_load_dwordx2 v[36:37], v3, s[20:23], s38 offen
s_waitcnt lgkmcnt(7)
v_mfma_f32_16x16x32_bf16 v[176:179], v[112:115], a[44:47], v[176:179]
s_waitcnt vmcnt(19)
v_perm_b32 v99, v78, v76, s50
v_perm_b32 v100, v66, v64, s51
v_mfma_f32_16x16x32_bf16 v[180:183], v[116:119], a[44:47], v[180:183]
ds_read_b128 a[12:15], v8 offset:50432
v_mfma_f32_16x16x32_bf16 v[184:187], v[120:123], a[44:47], v[184:187]
v_perm_b32 v101, v70, v68, s51
v_mfma_f32_16x16x32_bf16 v[188:191], v[124:127], a[44:47], v[188:191]
s_add_u32 s38, s34, 2908160
buffer_load_dwordx2 v[38:39], v3, s[20:23], s38 offen
s_waitcnt lgkmcnt(7)
v_mfma_f32_16x16x32_bf16 v[192:195], v[112:115], a[48:51], v[192:195]
v_perm_b32 v102, v74, v72, s51
v_perm_b32 v103, v78, v76, s51
v_mfma_f32_16x16x32_bf16 v[196:199], v[116:119], a[48:51], v[196:199]
ds_read_b128 a[16:19], v9 offset:512
v_mfma_f32_16x16x32_bf16 v[200:203], v[120:123], a[48:51], v[200:203]
v_perm_b32 v104, v67, v65, s50
v_mfma_f32_16x16x32_bf16 v[204:207], v[124:127], a[48:51], v[204:207]
s_add_u32 s38, s34, 2916352
buffer_load_dwordx2 v[40:41], v3, s[20:23], s38 offen
s_waitcnt lgkmcnt(7)
v_mfma_f32_16x16x32_bf16 v[208:211], v[112:115], a[52:55], v[208:211]
v_perm_b32 v105, v71, v69, s50
v_perm_b32 v106, v75, v73, s50
v_mfma_f32_16x16x32_bf16 v[212:215], v[116:119], a[52:55], v[212:215]
ds_read_b128 a[20:23], v9 offset:17152
v_mfma_f32_16x16x32_bf16 v[216:219], v[120:123], a[52:55], v[216:219]
v_perm_b32 v107, v79, v77, s50
v_mfma_f32_16x16x32_bf16 v[220:223], v[124:127], a[52:55], v[220:223]
s_add_u32 s38, s34, 2924544
buffer_load_dwordx2 v[42:43], v3, s[20:23], s38 offen
s_waitcnt lgkmcnt(7)
v_mfma_f32_16x16x32_bf16 v[224:227], v[112:115], a[56:59], v[224:227]
v_perm_b32 v108, v67, v65, s51
v_perm_b32 v109, v71, v69, s51
v_mfma_f32_16x16x32_bf16 v[228:231], v[116:119], a[56:59], v[228:231]
ds_read_b128 a[24:27], v9 offset:33792
v_perm_b32 v110, v75, v73, s51
v_mfma_f32_16x16x32_bf16 v[232:235], v[120:123], a[56:59], v[232:235]
v_perm_b32 v111, v79, v77, s51
v_mfma_f32_16x16x32_bf16 v[236:239], v[124:127], a[56:59], v[236:239]
s_add_u32 s38, s34, 2932736
buffer_load_dwordx2 v[44:45], v3, s[20:23], s38 offen
s_waitcnt lgkmcnt(7)
v_mfma_f32_16x16x32_bf16 v[240:243], v[112:115], a[60:63], v[240:243]
v_mfma_f32_16x16x32_bf16 v[244:247], v[116:119], a[60:63], v[244:247]
ds_read_b128 a[28:31], v9 offset:50432
v_mfma_f32_16x16x32_bf16 v[248:251], v[120:123], a[60:63], v[248:251]
v_mfma_f32_16x16x32_bf16 v[252:255], v[124:127], a[60:63], v[252:255]
s_add_u32 s38, s34, 2940928
buffer_load_dwordx2 v[46:47], v3, s[20:23], s38 offen
s_waitcnt lgkmcnt(7)
v_mfma_f32_16x16x32_bf16 v[128:131], v[96:99], a[0:3], v[128:131]
v_mfma_f32_16x16x32_bf16 v[132:135], v[100:103], a[0:3], v[132:135]
ds_read_b128 a[32:35], v8 offset:576
v_mfma_f32_16x16x32_bf16 v[136:139], v[104:107], a[0:3], v[136:139]
v_mfma_f32_16x16x32_bf16 v[140:143], v[108:111], a[0:3], v[140:143]
s_add_u32 s38, s34, 3145728
buffer_load_dwordx2 v[48:49], v3, s[20:23], s38 offen
s_waitcnt lgkmcnt(7)
v_mfma_f32_16x16x32_bf16 v[144:147], v[96:99], a[4:7], v[144:147]
v_mfma_f32_16x16x32_bf16 v[148:151], v[100:103], a[4:7], v[148:151]
ds_read_b128 a[36:39], v8 offset:17216
v_mfma_f32_16x16x32_bf16 v[152:155], v[104:107], a[4:7], v[152:155]
v_mfma_f32_16x16x32_bf16 v[156:159], v[108:111], a[4:7], v[156:159]
s_add_u32 s38, s34, 3153920
buffer_load_dwordx2 v[50:51], v3, s[20:23], s38 offen
s_waitcnt lgkmcnt(7)
v_mfma_f32_16x16x32_bf16 v[160:163], v[96:99], a[8:11], v[160:163]
s_waitcnt vmcnt(24)
v_perm_b32 v112, v82, v80, s50
s_waitcnt vmcnt(22)
v_perm_b32 v113, v86, v84, s50
v_mfma_f32_16x16x32_bf16 v[164:167], v[100:103], a[8:11], v[164:167]
ds_read_b128 a[40:43], v8 offset:33856
v_mfma_f32_16x16x32_bf16 v[168:171], v[104:107], a[8:11], v[168:171]
s_waitcnt vmcnt(20)
v_perm_b32 v114, v90, v88, s50
v_mfma_f32_16x16x32_bf16 v[172:175], v[108:111], a[8:11], v[172:175]
s_add_u32 s38, s34, 3162112
buffer_load_dwordx2 v[52:53], v3, s[20:23], s38 offen
s_waitcnt lgkmcnt(7)
v_mfma_f32_16x16x32_bf16 v[176:179], v[96:99], a[12:15], v[176:179]
s_waitcnt vmcnt(19)
v_perm_b32 v115, v94, v92, s50
v_perm_b32 v116, v82, v80, s51
v_mfma_f32_16x16x32_bf16 v[180:183], v[100:103], a[12:15], v[180:183]
ds_read_b128 a[44:47], v8 offset:50496
v_mfma_f32_16x16x32_bf16 v[184:187], v[104:107], a[12:15], v[184:187]
v_perm_b32 v117, v86, v84, s51
v_mfma_f32_16x16x32_bf16 v[188:191], v[108:111], a[12:15], v[188:191]
s_add_u32 s38, s34, 3170304
buffer_load_dwordx2 v[54:55], v3, s[20:23], s38 offen
s_waitcnt lgkmcnt(7)
v_mfma_f32_16x16x32_bf16 v[192:195], v[96:99], a[16:19], v[192:195]
v_perm_b32 v118, v90, v88, s51
v_perm_b32 v119, v94, v92, s51
v_mfma_f32_16x16x32_bf16 v[196:199], v[100:103], a[16:19], v[196:199]
ds_read_b128 a[48:51], v9 offset:576
v_mfma_f32_16x16x32_bf16 v[200:203], v[104:107], a[16:19], v[200:203]
v_perm_b32 v120, v83, v81, s50
v_mfma_f32_16x16x32_bf16 v[204:207], v[108:111], a[16:19], v[204:207]
s_add_u32 s38, s34, 3178496
buffer_load_dwordx2 v[56:57], v3, s[20:23], s38 offen
s_waitcnt lgkmcnt(7)
v_mfma_f32_16x16x32_bf16 v[208:211], v[96:99], a[20:23], v[208:211]
v_perm_b32 v121, v87, v85, s50
v_perm_b32 v122, v91, v89, s50
v_mfma_f32_16x16x32_bf16 v[212:215], v[100:103], a[20:23], v[212:215]
ds_read_b128 a[52:55], v9 offset:17216
v_mfma_f32_16x16x32_bf16 v[216:219], v[104:107], a[20:23], v[216:219]
v_perm_b32 v123, v95, v93, s50
v_mfma_f32_16x16x32_bf16 v[220:223], v[108:111], a[20:23], v[220:223]
s_add_u32 s38, s34, 3186688
buffer_load_dwordx2 v[58:59], v3, s[20:23], s38 offen
s_waitcnt lgkmcnt(7)
v_mfma_f32_16x16x32_bf16 v[224:227], v[96:99], a[24:27], v[224:227]
v_perm_b32 v124, v83, v81, s51
v_perm_b32 v125, v87, v85, s51
v_mfma_f32_16x16x32_bf16 v[228:231], v[100:103], a[24:27], v[228:231]
ds_read_b128 a[56:59], v9 offset:33856
v_perm_b32 v126, v91, v89, s51
v_mfma_f32_16x16x32_bf16 v[232:235], v[104:107], a[24:27], v[232:235]
v_perm_b32 v127, v95, v93, s51
v_mfma_f32_16x16x32_bf16 v[236:239], v[108:111], a[24:27], v[236:239]
s_add_u32 s38, s34, 3194880
buffer_load_dwordx2 v[60:61], v3, s[20:23], s38 offen
s_waitcnt lgkmcnt(7)
v_mfma_f32_16x16x32_bf16 v[240:243], v[96:99], a[28:31], v[240:243]
v_mfma_f32_16x16x32_bf16 v[244:247], v[100:103], a[28:31], v[244:247]
ds_read_b128 a[60:63], v9 offset:50496
v_mfma_f32_16x16x32_bf16 v[248:251], v[104:107], a[28:31], v[248:251]
v_mfma_f32_16x16x32_bf16 v[252:255], v[108:111], a[28:31], v[252:255]
s_add_u32 s38, s34, 3203072
buffer_load_dwordx2 v[62:63], v3, s[20:23], s38 offen
s_waitcnt lgkmcnt(7)
v_mfma_f32_16x16x32_bf16 v[128:131], v[112:115], a[32:35], v[128:131]
v_mfma_f32_16x16x32_bf16 v[132:135], v[116:119], a[32:35], v[132:135]
ds_read_b128 a[0:3], v8 offset:640
v_mfma_f32_16x16x32_bf16 v[136:139], v[120:123], a[32:35], v[136:139]
v_mfma_f32_16x16x32_bf16 v[140:143], v[124:127], a[32:35], v[140:143]
s_add_u32 s38, s34, 3407872
buffer_load_dwordx2 v[64:65], v3, s[20:23], s38 offen
s_waitcnt lgkmcnt(7)
v_mfma_f32_16x16x32_bf16 v[144:147], v[112:115], a[36:39], v[144:147]
v_mfma_f32_16x16x32_bf16 v[148:151], v[116:119], a[36:39], v[148:151]
ds_read_b128 a[4:7], v8 offset:17280
v_mfma_f32_16x16x32_bf16 v[152:155], v[120:123], a[36:39], v[152:155]
v_mfma_f32_16x16x32_bf16 v[156:159], v[124:127], a[36:39], v[156:159]
s_add_u32 s38, s34, 3416064
buffer_load_dwordx2 v[66:67], v3, s[20:23], s38 offen
s_waitcnt lgkmcnt(7)
v_mfma_f32_16x16x32_bf16 v[160:163], v[112:115], a[40:43], v[160:163]
s_waitcnt vmcnt(24)
v_perm_b32 v96, v18, v16, s50
s_waitcnt vmcnt(22)
v_perm_b32 v97, v22, v20, s50
v_mfma_f32_16x16x32_bf16 v[164:167], v[116:119], a[40:43], v[164:167]
ds_read_b128 a[8:11], v8 offset:33920
v_mfma_f32_16x16x32_bf16 v[168:171], v[120:123], a[40:43], v[168:171]
s_waitcnt vmcnt(20)
v_perm_b32 v98, v26, v24, s50
v_mfma_f32_16x16x32_bf16 v[172:175], v[124:127], a[40:43], v[172:175]
s_add_u32 s38, s34, 3424256
buffer_load_dwordx2 v[68:69], v3, s[20:23], s38 offen
s_waitcnt lgkmcnt(7)
v_mfma_f32_16x16x32_bf16 v[176:179], v[112:115], a[44:47], v[176:179]
s_waitcnt vmcnt(19)
v_perm_b32 v99, v30, v28, s50
v_perm_b32 v100, v18, v16, s51
v_mfma_f32_16x16x32_bf16 v[180:183], v[116:119], a[44:47], v[180:183]
ds_read_b128 a[12:15], v8 offset:50560
v_mfma_f32_16x16x32_bf16 v[184:187], v[120:123], a[44:47], v[184:187]
v_perm_b32 v101, v22, v20, s51
v_mfma_f32_16x16x32_bf16 v[188:191], v[124:127], a[44:47], v[188:191]
s_add_u32 s38, s34, 3432448
buffer_load_dwordx2 v[70:71], v3, s[20:23], s38 offen
s_waitcnt lgkmcnt(7)
v_mfma_f32_16x16x32_bf16 v[192:195], v[112:115], a[48:51], v[192:195]
v_perm_b32 v102, v26, v24, s51
v_perm_b32 v103, v30, v28, s51
v_mfma_f32_16x16x32_bf16 v[196:199], v[116:119], a[48:51], v[196:199]
ds_read_b128 a[16:19], v9 offset:640
v_mfma_f32_16x16x32_bf16 v[200:203], v[120:123], a[48:51], v[200:203]
v_perm_b32 v104, v19, v17, s50
v_mfma_f32_16x16x32_bf16 v[204:207], v[124:127], a[48:51], v[204:207]
s_add_u32 s38, s34, 3440640
buffer_load_dwordx2 v[72:73], v3, s[20:23], s38 offen
s_waitcnt lgkmcnt(7)
v_mfma_f32_16x16x32_bf16 v[208:211], v[112:115], a[52:55], v[208:211]
v_perm_b32 v105, v23, v21, s50
v_perm_b32 v106, v27, v25, s50
v_mfma_f32_16x16x32_bf16 v[212:215], v[116:119], a[52:55], v[212:215]
ds_read_b128 a[20:23], v9 offset:17280
v_mfma_f32_16x16x32_bf16 v[216:219], v[120:123], a[52:55], v[216:219]
v_perm_b32 v107, v31, v29, s50
v_mfma_f32_16x16x32_bf16 v[220:223], v[124:127], a[52:55], v[220:223]
s_add_u32 s38, s34, 3448832
buffer_load_dwordx2 v[74:75], v3, s[20:23], s38 offen
s_waitcnt lgkmcnt(7)
v_mfma_f32_16x16x32_bf16 v[224:227], v[112:115], a[56:59], v[224:227]
v_perm_b32 v108, v19, v17, s51
v_perm_b32 v109, v23, v21, s51
v_mfma_f32_16x16x32_bf16 v[228:231], v[116:119], a[56:59], v[228:231]
ds_read_b128 a[24:27], v9 offset:33920
v_perm_b32 v110, v27, v25, s51
v_mfma_f32_16x16x32_bf16 v[232:235], v[120:123], a[56:59], v[232:235]
v_perm_b32 v111, v31, v29, s51
v_mfma_f32_16x16x32_bf16 v[236:239], v[124:127], a[56:59], v[236:239]
s_add_u32 s38, s34, 3457024
buffer_load_dwordx2 v[76:77], v3, s[20:23], s38 offen
s_waitcnt lgkmcnt(7)
v_mfma_f32_16x16x32_bf16 v[240:243], v[112:115], a[60:63], v[240:243]
v_mfma_f32_16x16x32_bf16 v[244:247], v[116:119], a[60:63], v[244:247]
ds_read_b128 a[28:31], v9 offset:50560
v_mfma_f32_16x16x32_bf16 v[248:251], v[120:123], a[60:63], v[248:251]
v_mfma_f32_16x16x32_bf16 v[252:255], v[124:127], a[60:63], v[252:255]
s_add_u32 s38, s34, 3465216
buffer_load_dwordx2 v[78:79], v3, s[20:23], s38 offen
s_waitcnt lgkmcnt(7)
v_mfma_f32_16x16x32_bf16 v[128:131], v[96:99], a[0:3], v[128:131]
v_mfma_f32_16x16x32_bf16 v[132:135], v[100:103], a[0:3], v[132:135]
ds_read_b128 a[32:35], v8 offset:704
v_mfma_f32_16x16x32_bf16 v[136:139], v[104:107], a[0:3], v[136:139]
v_mfma_f32_16x16x32_bf16 v[140:143], v[108:111], a[0:3], v[140:143]
s_add_u32 s38, s34, 3670016
buffer_load_dwordx2 v[80:81], v3, s[20:23], s38 offen
s_waitcnt lgkmcnt(7)
v_mfma_f32_16x16x32_bf16 v[144:147], v[96:99], a[4:7], v[144:147]
v_mfma_f32_16x16x32_bf16 v[148:151], v[100:103], a[4:7], v[148:151]
ds_read_b128 a[36:39], v8 offset:17344
v_mfma_f32_16x16x32_bf16 v[152:155], v[104:107], a[4:7], v[152:155]
v_mfma_f32_16x16x32_bf16 v[156:159], v[108:111], a[4:7], v[156:159]
s_add_u32 s38, s34, 3678208
buffer_load_dwordx2 v[82:83], v3, s[20:23], s38 offen
s_waitcnt lgkmcnt(7)
v_mfma_f32_16x16x32_bf16 v[160:163], v[96:99], a[8:11], v[160:163]
s_waitcnt vmcnt(24)
v_perm_b32 v112, v34, v32, s50
s_waitcnt vmcnt(22)
v_perm_b32 v113, v38, v36, s50
v_mfma_f32_16x16x32_bf16 v[164:167], v[100:103], a[8:11], v[164:167]
ds_read_b128 a[40:43], v8 offset:33984
v_mfma_f32_16x16x32_bf16 v[168:171], v[104:107], a[8:11], v[168:171]
s_waitcnt vmcnt(20)
v_perm_b32 v114, v42, v40, s50
v_mfma_f32_16x16x32_bf16 v[172:175], v[108:111], a[8:11], v[172:175]
s_add_u32 s38, s34, 3686400
buffer_load_dwordx2 v[84:85], v3, s[20:23], s38 offen
s_waitcnt lgkmcnt(7)
v_mfma_f32_16x16x32_bf16 v[176:179], v[96:99], a[12:15], v[176:179]
s_waitcnt vmcnt(19)
v_perm_b32 v115, v46, v44, s50
v_perm_b32 v116, v34, v32, s51
v_mfma_f32_16x16x32_bf16 v[180:183], v[100:103], a[12:15], v[180:183]
ds_read_b128 a[44:47], v8 offset:50624
v_mfma_f32_16x16x32_bf16 v[184:187], v[104:107], a[12:15], v[184:187]
v_perm_b32 v117, v38, v36, s51
v_mfma_f32_16x16x32_bf16 v[188:191], v[108:111], a[12:15], v[188:191]
s_add_u32 s38, s34, 3694592
buffer_load_dwordx2 v[86:87], v3, s[20:23], s38 offen
s_waitcnt lgkmcnt(7)
v_mfma_f32_16x16x32_bf16 v[192:195], v[96:99], a[16:19], v[192:195]
v_perm_b32 v118, v42, v40, s51
v_perm_b32 v119, v46, v44, s51
v_mfma_f32_16x16x32_bf16 v[196:199], v[100:103], a[16:19], v[196:199]
ds_read_b128 a[48:51], v9 offset:704
v_mfma_f32_16x16x32_bf16 v[200:203], v[104:107], a[16:19], v[200:203]
v_perm_b32 v120, v35, v33, s50
v_mfma_f32_16x16x32_bf16 v[204:207], v[108:111], a[16:19], v[204:207]
s_add_u32 s38, s34, 3702784
buffer_load_dwordx2 v[88:89], v3, s[20:23], s38 offen
s_waitcnt lgkmcnt(7)
v_mfma_f32_16x16x32_bf16 v[208:211], v[96:99], a[20:23], v[208:211]
v_perm_b32 v121, v39, v37, s50
v_perm_b32 v122, v43, v41, s50
v_mfma_f32_16x16x32_bf16 v[212:215], v[100:103], a[20:23], v[212:215]
ds_read_b128 a[52:55], v9 offset:17344
v_mfma_f32_16x16x32_bf16 v[216:219], v[104:107], a[20:23], v[216:219]
v_perm_b32 v123, v47, v45, s50
v_mfma_f32_16x16x32_bf16 v[220:223], v[108:111], a[20:23], v[220:223]
s_add_u32 s38, s34, 3710976
buffer_load_dwordx2 v[90:91], v3, s[20:23], s38 offen
s_waitcnt lgkmcnt(7)
v_mfma_f32_16x16x32_bf16 v[224:227], v[96:99], a[24:27], v[224:227]
v_perm_b32 v124, v35, v33, s51
v_perm_b32 v125, v39, v37, s51
v_mfma_f32_16x16x32_bf16 v[228:231], v[100:103], a[24:27], v[228:231]
ds_read_b128 a[56:59], v9 offset:33984
v_perm_b32 v126, v43, v41, s51
v_mfma_f32_16x16x32_bf16 v[232:235], v[104:107], a[24:27], v[232:235]
v_perm_b32 v127, v47, v45, s51
v_mfma_f32_16x16x32_bf16 v[236:239], v[108:111], a[24:27], v[236:239]
s_add_u32 s38, s34, 3719168
buffer_load_dwordx2 v[92:93], v3, s[20:23], s38 offen
s_waitcnt lgkmcnt(7)
v_mfma_f32_16x16x32_bf16 v[240:243], v[96:99], a[28:31], v[240:243]
v_mfma_f32_16x16x32_bf16 v[244:247], v[100:103], a[28:31], v[244:247]
ds_read_b128 a[60:63], v9 offset:50624
v_mfma_f32_16x16x32_bf16 v[248:251], v[104:107], a[28:31], v[248:251]
v_mfma_f32_16x16x32_bf16 v[252:255], v[108:111], a[28:31], v[252:255]
s_add_u32 s38, s34, 3727360
buffer_load_dwordx2 v[94:95], v3, s[20:23], s38 offen
s_waitcnt lgkmcnt(7)
v_mfma_f32_16x16x32_bf16 v[128:131], v[112:115], a[32:35], v[128:131]
v_mfma_f32_16x16x32_bf16 v[132:135], v[116:119], a[32:35], v[132:135]
ds_read_b128 a[0:3], v8 offset:768
v_mfma_f32_16x16x32_bf16 v[136:139], v[120:123], a[32:35], v[136:139]
v_mfma_f32_16x16x32_bf16 v[140:143], v[124:127], a[32:35], v[140:143]
s_add_u32 s38, s34, 3932160
buffer_load_dwordx2 v[16:17], v3, s[20:23], s38 offen
s_waitcnt lgkmcnt(7)
v_mfma_f32_16x16x32_bf16 v[144:147], v[112:115], a[36:39], v[144:147]
v_mfma_f32_16x16x32_bf16 v[148:151], v[116:119], a[36:39], v[148:151]
ds_read_b128 a[4:7], v8 offset:17408
v_mfma_f32_16x16x32_bf16 v[152:155], v[120:123], a[36:39], v[152:155]
v_mfma_f32_16x16x32_bf16 v[156:159], v[124:127], a[36:39], v[156:159]
s_add_u32 s38, s34, 3940352
buffer_load_dwordx2 v[18:19], v3, s[20:23], s38 offen
s_waitcnt lgkmcnt(7)
v_mfma_f32_16x16x32_bf16 v[160:163], v[112:115], a[40:43], v[160:163]
s_waitcnt vmcnt(24)
v_perm_b32 v96, v50, v48, s50
s_waitcnt vmcnt(22)
v_perm_b32 v97, v54, v52, s50
v_mfma_f32_16x16x32_bf16 v[164:167], v[116:119], a[40:43], v[164:167]
ds_read_b128 a[8:11], v8 offset:34048
v_mfma_f32_16x16x32_bf16 v[168:171], v[120:123], a[40:43], v[168:171]
s_waitcnt vmcnt(20)
v_perm_b32 v98, v58, v56, s50
v_mfma_f32_16x16x32_bf16 v[172:175], v[124:127], a[40:43], v[172:175]
s_add_u32 s38, s34, 3948544
buffer_load_dwordx2 v[20:21], v3, s[20:23], s38 offen
s_waitcnt lgkmcnt(7)
v_mfma_f32_16x16x32_bf16 v[176:179], v[112:115], a[44:47], v[176:179]
s_waitcnt vmcnt(19)
v_perm_b32 v99, v62, v60, s50
v_perm_b32 v100, v50, v48, s51
v_mfma_f32_16x16x32_bf16 v[180:183], v[116:119], a[44:47], v[180:183]
ds_read_b128 a[12:15], v8 offset:50688
v_mfma_f32_16x16x32_bf16 v[184:187], v[120:123], a[44:47], v[184:187]
v_perm_b32 v101, v54, v52, s51
v_mfma_f32_16x16x32_bf16 v[188:191], v[124:127], a[44:47], v[188:191]
s_add_u32 s38, s34, 3956736
buffer_load_dwordx2 v[22:23], v3, s[20:23], s38 offen
s_waitcnt lgkmcnt(7)
v_mfma_f32_16x16x32_bf16 v[192:195], v[112:115], a[48:51], v[192:195]
v_perm_b32 v102, v58, v56, s51
v_perm_b32 v103, v62, v60, s51
v_mfma_f32_16x16x32_bf16 v[196:199], v[116:119], a[48:51], v[196:199]
ds_read_b128 a[16:19], v9 offset:768
v_mfma_f32_16x16x32_bf16 v[200:203], v[120:123], a[48:51], v[200:203]
v_perm_b32 v104, v51, v49, s50
v_mfma_f32_16x16x32_bf16 v[204:207], v[124:127], a[48:51], v[204:207]
s_add_u32 s38, s34, 3964928
buffer_load_dwordx2 v[24:25], v3, s[20:23], s38 offen
s_waitcnt lgkmcnt(7)
v_mfma_f32_16x16x32_bf16 v[208:211], v[112:115], a[52:55], v[208:211]
v_perm_b32 v105, v55, v53, s50
v_perm_b32 v106, v59, v57, s50
v_mfma_f32_16x16x32_bf16 v[212:215], v[116:119], a[52:55], v[212:215]
ds_read_b128 a[20:23], v9 offset:17408
v_mfma_f32_16x16x32_bf16 v[216:219], v[120:123], a[52:55], v[216:219]
v_perm_b32 v107, v63, v61, s50
v_mfma_f32_16x16x32_bf16 v[220:223], v[124:127], a[52:55], v[220:223]
s_add_u32 s38, s34, 3973120
buffer_load_dwordx2 v[26:27], v3, s[20:23], s38 offen
s_waitcnt lgkmcnt(7)
v_mfma_f32_16x16x32_bf16 v[224:227], v[112:115], a[56:59], v[224:227]
v_perm_b32 v108, v51, v49, s51
v_perm_b32 v109, v55, v53, s51
v_mfma_f32_16x16x32_bf16 v[228:231], v[116:119], a[56:59], v[228:231]
ds_read_b128 a[24:27], v9 offset:34048
v_perm_b32 v110, v59, v57, s51
v_mfma_f32_16x16x32_bf16 v[232:235], v[120:123], a[56:59], v[232:235]
v_perm_b32 v111, v63, v61, s51
v_mfma_f32_16x16x32_bf16 v[236:239], v[124:127], a[56:59], v[236:239]
s_add_u32 s38, s34, 3981312
buffer_load_dwordx2 v[28:29], v3, s[20:23], s38 offen
s_waitcnt lgkmcnt(7)
v_mfma_f32_16x16x32_bf16 v[240:243], v[112:115], a[60:63], v[240:243]
v_mfma_f32_16x16x32_bf16 v[244:247], v[116:119], a[60:63], v[244:247]
ds_read_b128 a[28:31], v9 offset:50688
v_mfma_f32_16x16x32_bf16 v[248:251], v[120:123], a[60:63], v[248:251]
v_mfma_f32_16x16x32_bf16 v[252:255], v[124:127], a[60:63], v[252:255]
s_add_u32 s38, s34, 3989504
buffer_load_dwordx2 v[30:31], v3, s[20:23], s38 offen
s_waitcnt lgkmcnt(7)
v_mfma_f32_16x16x32_bf16 v[128:131], v[96:99], a[0:3], v[128:131]
v_mfma_f32_16x16x32_bf16 v[132:135], v[100:103], a[0:3], v[132:135]
ds_read_b128 a[32:35], v8 offset:832
v_mfma_f32_16x16x32_bf16 v[136:139], v[104:107], a[0:3], v[136:139]
v_mfma_f32_16x16x32_bf16 v[140:143], v[108:111], a[0:3], v[140:143]
s_waitcnt lgkmcnt(7)
v_mfma_f32_16x16x32_bf16 v[144:147], v[96:99], a[4:7], v[144:147]
v_mfma_f32_16x16x32_bf16 v[148:151], v[100:103], a[4:7], v[148:151]
ds_read_b128 a[36:39], v8 offset:17472
v_mfma_f32_16x16x32_bf16 v[152:155], v[104:107], a[4:7], v[152:155]
v_mfma_f32_16x16x32_bf16 v[156:159], v[108:111], a[4:7], v[156:159]
s_waitcnt lgkmcnt(7)
v_mfma_f32_16x16x32_bf16 v[160:163], v[96:99], a[8:11], v[160:163]
s_waitcnt vmcnt(22)
v_perm_b32 v112, v66, v64, s50
s_waitcnt vmcnt(20)
v_perm_b32 v113, v70, v68, s50
v_mfma_f32_16x16x32_bf16 v[164:167], v[100:103], a[8:11], v[164:167]
ds_read_b128 a[40:43], v8 offset:34112
v_mfma_f32_16x16x32_bf16 v[168:171], v[104:107], a[8:11], v[168:171]
s_waitcnt vmcnt(18)
v_perm_b32 v114, v74, v72, s50
v_mfma_f32_16x16x32_bf16 v[172:175], v[108:111], a[8:11], v[172:175]
s_waitcnt lgkmcnt(7)
v_mfma_f32_16x16x32_bf16 v[176:179], v[96:99], a[12:15], v[176:179]
s_waitcnt vmcnt(16)
v_perm_b32 v115, v78, v76, s50
v_perm_b32 v116, v66, v64, s51
v_mfma_f32_16x16x32_bf16 v[180:183], v[100:103], a[12:15], v[180:183]
ds_read_b128 a[44:47], v8 offset:50752
v_mfma_f32_16x16x32_bf16 v[184:187], v[104:107], a[12:15], v[184:187]
v_perm_b32 v117, v70, v68, s51
v_mfma_f32_16x16x32_bf16 v[188:191], v[108:111], a[12:15], v[188:191]
s_waitcnt lgkmcnt(7)
v_mfma_f32_16x16x32_bf16 v[192:195], v[96:99], a[16:19], v[192:195]
v_perm_b32 v118, v74, v72, s51
v_perm_b32 v119, v78, v76, s51
v_mfma_f32_16x16x32_bf16 v[196:199], v[100:103], a[16:19], v[196:199]
ds_read_b128 a[48:51], v9 offset:832
v_mfma_f32_16x16x32_bf16 v[200:203], v[104:107], a[16:19], v[200:203]
v_perm_b32 v120, v67, v65, s50
v_mfma_f32_16x16x32_bf16 v[204:207], v[108:111], a[16:19], v[204:207]
s_waitcnt lgkmcnt(7)
v_mfma_f32_16x16x32_bf16 v[208:211], v[96:99], a[20:23], v[208:211]
v_perm_b32 v121, v71, v69, s50
v_perm_b32 v122, v75, v73, s50
v_mfma_f32_16x16x32_bf16 v[212:215], v[100:103], a[20:23], v[212:215]
ds_read_b128 a[52:55], v9 offset:17472
v_mfma_f32_16x16x32_bf16 v[216:219], v[104:107], a[20:23], v[216:219]
v_perm_b32 v123, v79, v77, s50
v_mfma_f32_16x16x32_bf16 v[220:223], v[108:111], a[20:23], v[220:223]
s_waitcnt lgkmcnt(7)
v_mfma_f32_16x16x32_bf16 v[224:227], v[96:99], a[24:27], v[224:227]
v_perm_b32 v124, v67, v65, s51
v_perm_b32 v125, v71, v69, s51
v_mfma_f32_16x16x32_bf16 v[228:231], v[100:103], a[24:27], v[228:231]
ds_read_b128 a[56:59], v9 offset:34112
v_perm_b32 v126, v75, v73, s51
v_mfma_f32_16x16x32_bf16 v[232:235], v[104:107], a[24:27], v[232:235]
v_perm_b32 v127, v79, v77, s51
v_mfma_f32_16x16x32_bf16 v[236:239], v[108:111], a[24:27], v[236:239]
s_waitcnt lgkmcnt(7)
v_mfma_f32_16x16x32_bf16 v[240:243], v[96:99], a[28:31], v[240:243]
v_mfma_f32_16x16x32_bf16 v[244:247], v[100:103], a[28:31], v[244:247]
ds_read_b128 a[60:63], v9 offset:50752
v_mfma_f32_16x16x32_bf16 v[248:251], v[104:107], a[28:31], v[248:251]
v_mfma_f32_16x16x32_bf16 v[252:255], v[108:111], a[28:31], v[252:255]
s_waitcnt lgkmcnt(7)
v_mfma_f32_16x16x32_bf16 v[128:131], v[112:115], a[32:35], v[128:131]
v_mfma_f32_16x16x32_bf16 v[132:135], v[116:119], a[32:35], v[132:135]
ds_read_b128 a[0:3], v8 offset:896
v_mfma_f32_16x16x32_bf16 v[136:139], v[120:123], a[32:35], v[136:139]
v_mfma_f32_16x16x32_bf16 v[140:143], v[124:127], a[32:35], v[140:143]
s_waitcnt lgkmcnt(7)
v_mfma_f32_16x16x32_bf16 v[144:147], v[112:115], a[36:39], v[144:147]
v_mfma_f32_16x16x32_bf16 v[148:151], v[116:119], a[36:39], v[148:151]
ds_read_b128 a[4:7], v8 offset:17536
v_mfma_f32_16x16x32_bf16 v[152:155], v[120:123], a[36:39], v[152:155]
v_mfma_f32_16x16x32_bf16 v[156:159], v[124:127], a[36:39], v[156:159]
s_waitcnt lgkmcnt(7)
v_mfma_f32_16x16x32_bf16 v[160:163], v[112:115], a[40:43], v[160:163]
s_waitcnt vmcnt(14)
v_perm_b32 v96, v82, v80, s50
s_waitcnt vmcnt(12)
v_perm_b32 v97, v86, v84, s50
v_mfma_f32_16x16x32_bf16 v[164:167], v[116:119], a[40:43], v[164:167]
ds_read_b128 a[8:11], v8 offset:34176
v_mfma_f32_16x16x32_bf16 v[168:171], v[120:123], a[40:43], v[168:171]
s_waitcnt vmcnt(10)
v_perm_b32 v98, v90, v88, s50
v_mfma_f32_16x16x32_bf16 v[172:175], v[124:127], a[40:43], v[172:175]
s_waitcnt lgkmcnt(7)
v_mfma_f32_16x16x32_bf16 v[176:179], v[112:115], a[44:47], v[176:179]
s_waitcnt vmcnt(8)
v_perm_b32 v99, v94, v92, s50
v_perm_b32 v100, v82, v80, s51
v_mfma_f32_16x16x32_bf16 v[180:183], v[116:119], a[44:47], v[180:183]
ds_read_b128 a[12:15], v8 offset:50816
v_mfma_f32_16x16x32_bf16 v[184:187], v[120:123], a[44:47], v[184:187]
v_perm_b32 v101, v86, v84, s51
v_mfma_f32_16x16x32_bf16 v[188:191], v[124:127], a[44:47], v[188:191]
s_waitcnt lgkmcnt(7)
v_mfma_f32_16x16x32_bf16 v[192:195], v[112:115], a[48:51], v[192:195]
v_perm_b32 v102, v90, v88, s51
v_perm_b32 v103, v94, v92, s51
v_mfma_f32_16x16x32_bf16 v[196:199], v[116:119], a[48:51], v[196:199]
ds_read_b128 a[16:19], v9 offset:896
v_mfma_f32_16x16x32_bf16 v[200:203], v[120:123], a[48:51], v[200:203]
v_perm_b32 v104, v83, v81, s50
v_mfma_f32_16x16x32_bf16 v[204:207], v[124:127], a[48:51], v[204:207]
s_waitcnt lgkmcnt(7)
v_mfma_f32_16x16x32_bf16 v[208:211], v[112:115], a[52:55], v[208:211]
v_perm_b32 v105, v87, v85, s50
v_perm_b32 v106, v91, v89, s50
v_mfma_f32_16x16x32_bf16 v[212:215], v[116:119], a[52:55], v[212:215]
ds_read_b128 a[20:23], v9 offset:17536
v_mfma_f32_16x16x32_bf16 v[216:219], v[120:123], a[52:55], v[216:219]
v_perm_b32 v107, v95, v93, s50
v_mfma_f32_16x16x32_bf16 v[220:223], v[124:127], a[52:55], v[220:223]
s_waitcnt lgkmcnt(7)
v_mfma_f32_16x16x32_bf16 v[224:227], v[112:115], a[56:59], v[224:227]
v_perm_b32 v108, v83, v81, s51
v_perm_b32 v109, v87, v85, s51
v_mfma_f32_16x16x32_bf16 v[228:231], v[116:119], a[56:59], v[228:231]
ds_read_b128 a[24:27], v9 offset:34176
v_perm_b32 v110, v91, v89, s51
v_mfma_f32_16x16x32_bf16 v[232:235], v[120:123], a[56:59], v[232:235]
v_perm_b32 v111, v95, v93, s51
v_mfma_f32_16x16x32_bf16 v[236:239], v[124:127], a[56:59], v[236:239]
s_waitcnt lgkmcnt(7)
v_mfma_f32_16x16x32_bf16 v[240:243], v[112:115], a[60:63], v[240:243]
v_mfma_f32_16x16x32_bf16 v[244:247], v[116:119], a[60:63], v[244:247]
ds_read_b128 a[28:31], v9 offset:50816
v_mfma_f32_16x16x32_bf16 v[248:251], v[120:123], a[60:63], v[248:251]
v_mfma_f32_16x16x32_bf16 v[252:255], v[124:127], a[60:63], v[252:255]
s_waitcnt lgkmcnt(7)
v_mfma_f32_16x16x32_bf16 v[128:131], v[96:99], a[0:3], v[128:131]
v_mfma_f32_16x16x32_bf16 v[132:135], v[100:103], a[0:3], v[132:135]
ds_read_b128 a[32:35], v8 offset:960
v_mfma_f32_16x16x32_bf16 v[136:139], v[104:107], a[0:3], v[136:139]
v_mfma_f32_16x16x32_bf16 v[140:143], v[108:111], a[0:3], v[140:143]
s_waitcnt lgkmcnt(7)
v_mfma_f32_16x16x32_bf16 v[144:147], v[96:99], a[4:7], v[144:147]
v_mfma_f32_16x16x32_bf16 v[148:151], v[100:103], a[4:7], v[148:151]
ds_read_b128 a[36:39], v8 offset:17600
v_mfma_f32_16x16x32_bf16 v[152:155], v[104:107], a[4:7], v[152:155]
v_mfma_f32_16x16x32_bf16 v[156:159], v[108:111], a[4:7], v[156:159]
s_waitcnt lgkmcnt(7)
v_mfma_f32_16x16x32_bf16 v[160:163], v[96:99], a[8:11], v[160:163]
s_waitcnt vmcnt(6)
v_perm_b32 v112, v18, v16, s50
s_waitcnt vmcnt(4)
v_perm_b32 v113, v22, v20, s50
v_mfma_f32_16x16x32_bf16 v[164:167], v[100:103], a[8:11], v[164:167]
ds_read_b128 a[40:43], v8 offset:34240
v_mfma_f32_16x16x32_bf16 v[168:171], v[104:107], a[8:11], v[168:171]
s_waitcnt vmcnt(2)
v_perm_b32 v114, v26, v24, s50
v_mfma_f32_16x16x32_bf16 v[172:175], v[108:111], a[8:11], v[172:175]
s_waitcnt lgkmcnt(7)
v_mfma_f32_16x16x32_bf16 v[176:179], v[96:99], a[12:15], v[176:179]
s_waitcnt vmcnt(0)
v_perm_b32 v115, v30, v28, s50
v_perm_b32 v116, v18, v16, s51
v_mfma_f32_16x16x32_bf16 v[180:183], v[100:103], a[12:15], v[180:183]
ds_read_b128 a[44:47], v8 offset:50880
v_mfma_f32_16x16x32_bf16 v[184:187], v[104:107], a[12:15], v[184:187]
v_perm_b32 v117, v22, v20, s51
v_mfma_f32_16x16x32_bf16 v[188:191], v[108:111], a[12:15], v[188:191]
s_waitcnt lgkmcnt(7)
v_mfma_f32_16x16x32_bf16 v[192:195], v[96:99], a[16:19], v[192:195]
v_perm_b32 v118, v26, v24, s51
v_perm_b32 v119, v30, v28, s51
v_mfma_f32_16x16x32_bf16 v[196:199], v[100:103], a[16:19], v[196:199]
ds_read_b128 a[48:51], v9 offset:960
v_mfma_f32_16x16x32_bf16 v[200:203], v[104:107], a[16:19], v[200:203]
v_perm_b32 v120, v19, v17, s50
v_mfma_f32_16x16x32_bf16 v[204:207], v[108:111], a[16:19], v[204:207]
s_waitcnt lgkmcnt(7)
v_mfma_f32_16x16x32_bf16 v[208:211], v[96:99], a[20:23], v[208:211]
v_perm_b32 v121, v23, v21, s50
v_perm_b32 v122, v27, v25, s50
v_mfma_f32_16x16x32_bf16 v[212:215], v[100:103], a[20:23], v[212:215]
ds_read_b128 a[52:55], v9 offset:17600
v_mfma_f32_16x16x32_bf16 v[216:219], v[104:107], a[20:23], v[216:219]
v_perm_b32 v123, v31, v29, s50
v_mfma_f32_16x16x32_bf16 v[220:223], v[108:111], a[20:23], v[220:223]
s_waitcnt lgkmcnt(7)
v_mfma_f32_16x16x32_bf16 v[224:227], v[96:99], a[24:27], v[224:227]
v_perm_b32 v124, v19, v17, s51
v_perm_b32 v125, v23, v21, s51
v_mfma_f32_16x16x32_bf16 v[228:231], v[100:103], a[24:27], v[228:231]
ds_read_b128 a[56:59], v9 offset:34240
v_perm_b32 v126, v27, v25, s51
v_mfma_f32_16x16x32_bf16 v[232:235], v[104:107], a[24:27], v[232:235]
v_perm_b32 v127, v31, v29, s51
v_mfma_f32_16x16x32_bf16 v[236:239], v[108:111], a[24:27], v[236:239]
s_waitcnt lgkmcnt(7)
v_mfma_f32_16x16x32_bf16 v[240:243], v[96:99], a[28:31], v[240:243]
v_mfma_f32_16x16x32_bf16 v[244:247], v[100:103], a[28:31], v[244:247]
ds_read_b128 a[60:63], v9 offset:50880
v_mfma_f32_16x16x32_bf16 v[248:251], v[104:107], a[28:31], v[248:251]
v_mfma_f32_16x16x32_bf16 v[252:255], v[108:111], a[28:31], v[252:255]
s_waitcnt lgkmcnt(7)
v_mfma_f32_16x16x32_bf16 v[128:131], v[112:115], a[32:35], v[128:131]
v_mfma_f32_16x16x32_bf16 v[132:135], v[116:119], a[32:35], v[132:135]
v_mfma_f32_16x16x32_bf16 v[136:139], v[120:123], a[32:35], v[136:139]
v_mfma_f32_16x16x32_bf16 v[140:143], v[124:127], a[32:35], v[140:143]
s_waitcnt lgkmcnt(6)
v_mfma_f32_16x16x32_bf16 v[144:147], v[112:115], a[36:39], v[144:147]
v_mfma_f32_16x16x32_bf16 v[148:151], v[116:119], a[36:39], v[148:151]
v_mfma_f32_16x16x32_bf16 v[152:155], v[120:123], a[36:39], v[152:155]
v_mfma_f32_16x16x32_bf16 v[156:159], v[124:127], a[36:39], v[156:159]
s_waitcnt lgkmcnt(5)
v_mfma_f32_16x16x32_bf16 v[160:163], v[112:115], a[40:43], v[160:163]
v_mfma_f32_16x16x32_bf16 v[164:167], v[116:119], a[40:43], v[164:167]
v_mfma_f32_16x16x32_bf16 v[168:171], v[120:123], a[40:43], v[168:171]
v_mfma_f32_16x16x32_bf16 v[172:175], v[124:127], a[40:43], v[172:175]
s_waitcnt lgkmcnt(4)
v_mfma_f32_16x16x32_bf16 v[176:179], v[112:115], a[44:47], v[176:179]
v_mfma_f32_16x16x32_bf16 v[180:183], v[116:119], a[44:47], v[180:183]
v_mfma_f32_16x16x32_bf16 v[184:187], v[120:123], a[44:47], v[184:187]
v_mfma_f32_16x16x32_bf16 v[188:191], v[124:127], a[44:47], v[188:191]
s_waitcnt lgkmcnt(3)
v_mfma_f32_16x16x32_bf16 v[192:195], v[112:115], a[48:51], v[192:195]
v_mfma_f32_16x16x32_bf16 v[196:199], v[116:119], a[48:51], v[196:199]
v_mfma_f32_16x16x32_bf16 v[200:203], v[120:123], a[48:51], v[200:203]
v_mfma_f32_16x16x32_bf16 v[204:207], v[124:127], a[48:51], v[204:207]
s_waitcnt lgkmcnt(2)
v_mfma_f32_16x16x32_bf16 v[208:211], v[112:115], a[52:55], v[208:211]
v_mfma_f32_16x16x32_bf16 v[212:215], v[116:119], a[52:55], v[212:215]
v_mfma_f32_16x16x32_bf16 v[216:219], v[120:123], a[52:55], v[216:219]
v_mfma_f32_16x16x32_bf16 v[220:223], v[124:127], a[52:55], v[220:223]
s_waitcnt lgkmcnt(1)
v_mfma_f32_16x16x32_bf16 v[224:227], v[112:115], a[56:59], v[224:227]
v_mfma_f32_16x16x32_bf16 v[228:231], v[116:119], a[56:59], v[228:231]
v_mfma_f32_16x16x32_bf16 v[232:235], v[120:123], a[56:59], v[232:235]
v_mfma_f32_16x16x32_bf16 v[236:239], v[124:127], a[56:59], v[236:239]
s_waitcnt lgkmcnt(0)
v_mfma_f32_16x16x32_bf16 v[240:243], v[112:115], a[60:63], v[240:243]
v_mfma_f32_16x16x32_bf16 v[244:247], v[116:119], a[60:63], v[244:247]
v_mfma_f32_16x16x32_bf16 v[248:251], v[120:123], a[60:63], v[248:251]
v_mfma_f32_16x16x32_bf16 v[252:255], v[124:127], a[60:63], v[252:255]
s_waitcnt lgkmcnt(0)
s_barrier
s_add_u32 s63, s63, 1
s_mov_b32 s72, 0
s_cmp_lg_u32 s63, 0
s_cbranch_scc1 PTn_later
s_cmp_eq_u32 s49, 6
s_cbranch_scc1 PTn_n0
s_mov_b32 s43, 0
s_cmp_ge_u32 s49, 4
s_cselect_b32 s66, 1, 0
s_and_b32 s44, s49, 3
s_branch PTn_dec
PTn_n0:
s_mov_b32 s42, 0
s_branch PTn_n
PTn_later:
s_cmp_lt_u32 s49, 5
s_cbranch_scc1 PTn_none
s_lshl_b32 s42, s63, 1
s_add_u32 s42, s42, s49
s_sub_u32 s42, s42, 6
s_cmp_gt_u32 s42, 17
s_cbranch_scc1 PTn_none
PTn_n:
s_mul_i32 s43, s42, 43
s_lshr_b32 s43, s43, 8
s_mul_i32 s44, s43, 6
s_sub_u32 s44, s42, s44
s_mul_i32 s44, s44, 5
s_mov_b32 s42, 310614180
s_cmp_eq_u32 s43, 1
s_cselect_b32 s42, 449499498, s42
s_cmp_eq_u32 s43, 2
s_cselect_b32 s42, 1003282926, s42
s_lshr_b32 s42, s42, s44
s_bfe_u32 s66, s42, 65540
s_bfe_u32 s43, s42, 131074
s_and_b32 s44, s42, 3
PTn_dec:
s_lshl_b32 s32, s43, 2
s_lshr_b32 s38, s16, 3
s_add_u32 s32, s32, s38
s_lshl_b32 s33, s44, 3
s_and_b32 s38, s16, 7
s_add_u32 s33, s33, s38
s_lshl_b32 s42, s32, 7
s_lshl_b32 s38, s17, 5
s_add_u32 s39, s38, s42
s_mul_i32 s39, s39, 1024
s_add_u32 s39, s39, 0
s_mul_i32 s38, s38, 1040
s_add_u32 m0, s38, 0
s_add_u32 s40, s39, 0
buffer_load_dwordx4 v1, s[12:15], s40 offen lds
s_add_u32 m0, s38, 1040
s_add_u32 s40, s39, 1024
buffer_load_dwordx4 v1, s[12:15], s40 offen lds
s_add_u32 m0, s38, 2080
s_add_u32 s40, s39, 2048
buffer_load_dwordx4 v1, s[12:15], s40 offen lds
s_add_u32 m0, s38, 3120
s_add_u32 s40, s39, 3072
buffer_load_dwordx4 v1, s[12:15], s40 offen lds
s_add_u32 m0, s38, 4160
s_add_u32 s40, s39, 4096
buffer_load_dwordx4 v1, s[12:15], s40 offen lds
s_add_u32 m0, s38, 5200
s_add_u32 s40, s39, 5120
buffer_load_dwordx4 v1, s[12:15], s40 offen lds
s_add_u32 m0, s38, 6240
s_add_u32 s40, s39, 6144
buffer_load_dwordx4 v1, s[12:15], s40 offen lds
s_add_u32 m0, s38, 7280
s_add_u32 s40, s39, 7168
buffer_load_dwordx4 v1, s[12:15], s40 offen lds
s_add_u32 m0, s38, 8320
s_add_u32 s40, s39, 8192
buffer_load_dwordx4 v1, s[12:15], s40 offen lds
s_add_u32 m0, s38, 9360
s_add_u32 s40, s39, 9216
buffer_load_dwordx4 v1, s[12:15], s40 offen lds
s_add_u32 m0, s38, 10400
s_add_u32 s40, s39, 10240
buffer_load_dwordx4 v1, s[12:15], s40 offen lds
s_add_u32 m0, s38, 11440
s_add_u32 s40, s39, 11264
buffer_load_dwordx4 v1, s[12:15], s40 offen lds
s_add_u32 m0, s38, 12480
s_add_u32 s40, s39, 12288
buffer_load_dwordx4 v1, s[12:15], s40 offen lds
s_add_u32 m0, s38, 13520
s_add_u32 s40, s39, 13312
buffer_load_dwordx4 v1, s[12:15], s40 offen lds
s_add_u32 m0, s38, 14560
s_add_u32 s40, s39, 14336
buffer_load_dwordx4 v1, s[12:15], s40 offen lds
s_add_u32 m0, s38, 15600
s_add_u32 s40, s39, 15360
buffer_load_dwordx4 v1, s[12:15], s40 offen lds
s_add_u32 m0, s38, 16640
s_add_u32 s40, s39, 16384
buffer_load_dwordx4 v1, s[12:15], s40 offen lds
s_add_u32 m0, s38, 17680
s_add_u32 s40, s39, 17408
buffer_load_dwordx4 v1, s[12:15], s40 offen lds
s_add_u32 m0, s38, 18720
s_add_u32 s40, s39, 18432
buffer_load_dwordx4 v1, s[12:15], s40 offen lds
s_add_u32 m0, s38, 19760
s_add_u32 s40, s39, 19456
buffer_load_dwordx4 v1, s[12:15], s40 offen lds
s_add_u32 m0, s38, 20800
s_add_u32 s40, s39, 20480
buffer_load_dwordx4 v1, s[12:15], s40 offen lds
s_add_u32 m0, s38, 21840
s_add_u32 s40, s39, 21504
buffer_load_dwordx4 v1, s[12:15], s40 offen lds
s_add_u32 m0, s38, 22880
s_add_u32 s40, s39, 22528
buffer_load_dwordx4 v1, s[12:15], s40 offen lds
s_add_u32 m0, s38, 23920
s_add_u32 s40, s39, 23552
buffer_load_dwordx4 v1, s[12:15], s40 offen lds
s_add_u32 m0, s38, 24960
s_add_u32 s40, s39, 24576
buffer_load_dwordx4 v1, s[12:15], s40 offen lds
s_add_u32 m0, s38, 26000
s_add_u32 s40, s39, 25600
buffer_load_dwordx4 v1, s[12:15], s40 offen lds
s_add_u32 m0, s38, 27040
s_add_u32 s40, s39, 26624
buffer_load_dwordx4 v1, s[12:15], s40 offen lds
s_add_u32 m0, s38, 28080
s_add_u32 s40, s39, 27648
buffer_load_dwordx4 v1, s[12:15], s40 offen lds
s_add_u32 m0, s38, 29120
s_add_u32 s40, s39, 28672
buffer_load_dwordx4 v1, s[12:15], s40 offen lds
s_add_u32 m0, s38, 30160
s_add_u32 s40, s39, 29696
buffer_load_dwordx4 v1, s[12:15], s40 offen lds
s_add_u32 m0, s38, 31200
s_add_u32 s40, s39, 30720
buffer_load_dwordx4 v1, s[12:15], s40 offen lds
s_add_u32 m0, s38, 32240
s_add_u32 s40, s39, 31744
buffer_load_dwordx4 v1, s[12:15], s40 offen lds
s_mov_b32 s72, 1
PTn_none:
v_cvt_pk_bf16_f32 v16, v128, v132
v_cvt_pk_bf16_f32 v17, v136, v140
v_cvt_pk_bf16_f32 v18, v129, v133
v_cvt_pk_bf16_f32 v19, v137, v141
s_add_u32 s38, s35, 0
buffer_store_dwordx4 v[16:19], v1, s[8:11], s38 offen sc1
v_cvt_pk_bf16_f32 v20, v130, v134
v_cvt_pk_bf16_f32 v21, v138, v142
v_cvt_pk_bf16_f32 v22, v131, v135
v_cvt_pk_bf16_f32 v23, v139, v143
s_add_u32 s38, s35, 1024
buffer_store_dwordx4 v[20:23], v1, s[8:11], s38 offen sc1
v_cvt_pk_bf16_f32 v24, v144, v148
v_cvt_pk_bf16_f32 v25, v152, v156
v_cvt_pk_bf16_f32 v26, v145, v149
v_cvt_pk_bf16_f32 v27, v153, v157
s_add_u32 s38, s35, 4096
buffer_store_dwordx4 v[24:27], v1, s[8:11], s38 offen sc1
v_cvt_pk_bf16_f32 v28, v146, v150
v_cvt_pk_bf16_f32 v29, v154, v158
v_cvt_pk_bf16_f32 v30, v147, v151
v_cvt_pk_bf16_f32 v31, v155, v159
s_add_u32 s38, s35, 5120
buffer_store_dwordx4 v[28:31], v1, s[8:11], s38 offen sc1
v_cvt_pk_bf16_f32 v16, v160, v164
v_cvt_pk_bf16_f32 v17, v168, v172
v_cvt_pk_bf16_f32 v18, v161, v165
v_cvt_pk_bf16_f32 v19, v169, v173
s_add_u32 s38, s35, 262144
buffer_store_dwordx4 v[16:19], v1, s[8:11], s38 offen sc1
v_cvt_pk_bf16_f32 v20, v162, v166
v_cvt_pk_bf16_f32 v21, v170, v174
v_cvt_pk_bf16_f32 v22, v163, v167
v_cvt_pk_bf16_f32 v23, v171, v175
s_add_u32 s38, s35, 263168
buffer_store_dwordx4 v[20:23], v1, s[8:11], s38 offen sc1
v_cvt_pk_bf16_f32 v24, v176, v180
v_cvt_pk_bf16_f32 v25, v184, v188
v_cvt_pk_bf16_f32 v26, v177, v181
v_cvt_pk_bf16_f32 v27, v185, v189
s_add_u32 s38, s35, 266240
buffer_store_dwordx4 v[24:27], v1, s[8:11], s38 offen sc1
v_cvt_pk_bf16_f32 v28, v178, v182
v_cvt_pk_bf16_f32 v29, v186, v190
v_cvt_pk_bf16_f32 v30, v179, v183
v_cvt_pk_bf16_f32 v31, v187, v191
s_add_u32 s38, s35, 267264
buffer_store_dwordx4 v[28:31], v1, s[8:11], s38 offen sc1
v_cvt_pk_bf16_f32 v16, v192, v196
v_cvt_pk_bf16_f32 v17, v200, v204
v_cvt_pk_bf16_f32 v18, v193, v197
v_cvt_pk_bf16_f32 v19, v201, v205
s_add_u32 s38, s35, 524288
buffer_store_dwordx4 v[16:19], v1, s[8:11], s38 offen sc1
v_cvt_pk_bf16_f32 v20, v194, v198
v_cvt_pk_bf16_f32 v21, v202, v206
v_cvt_pk_bf16_f32 v22, v195, v199
v_cvt_pk_bf16_f32 v23, v203, v207
s_add_u32 s38, s35, 525312
buffer_store_dwordx4 v[20:23], v1, s[8:11], s38 offen sc1
v_cvt_pk_bf16_f32 v24, v208, v212
v_cvt_pk_bf16_f32 v25, v216, v220
v_cvt_pk_bf16_f32 v26, v209, v213
v_cvt_pk_bf16_f32 v27, v217, v221
s_add_u32 s38, s35, 528384
buffer_store_dwordx4 v[24:27], v1, s[8:11], s38 offen sc1
v_cvt_pk_bf16_f32 v28, v210, v214
v_cvt_pk_bf16_f32 v29, v218, v222
v_cvt_pk_bf16_f32 v30, v211, v215
v_cvt_pk_bf16_f32 v31, v219, v223
s_add_u32 s38, s35, 529408
buffer_store_dwordx4 v[28:31], v1, s[8:11], s38 offen sc1
v_cvt_pk_bf16_f32 v16, v224, v228
v_cvt_pk_bf16_f32 v17, v232, v236
v_cvt_pk_bf16_f32 v18, v225, v229
v_cvt_pk_bf16_f32 v19, v233, v237
s_add_u32 s38, s35, 786432
buffer_store_dwordx4 v[16:19], v1, s[8:11], s38 offen sc1
v_cvt_pk_bf16_f32 v20, v226, v230
v_cvt_pk_bf16_f32 v21, v234, v238
v_cvt_pk_bf16_f32 v22, v227, v231
v_cvt_pk_bf16_f32 v23, v235, v239
s_add_u32 s38, s35, 787456
buffer_store_dwordx4 v[20:23], v1, s[8:11], s38 offen sc1
v_cvt_pk_bf16_f32 v24, v240, v244
v_cvt_pk_bf16_f32 v25, v248, v252
v_cvt_pk_bf16_f32 v26, v241, v245
v_cvt_pk_bf16_f32 v27, v249, v253
s_add_u32 s38, s35, 790528
buffer_store_dwordx4 v[24:27], v1, s[8:11], s38 offen sc1
v_cvt_pk_bf16_f32 v28, v242, v246
v_cvt_pk_bf16_f32 v29, v250, v254
v_cvt_pk_bf16_f32 v30, v243, v247
v_cvt_pk_bf16_f32 v31, v251, v255
s_add_u32 s38, s35, 791552
buffer_store_dwordx4 v[28:31], v1, s[8:11], s38 offen sc1
s_branch P_done
P_v:
s_load_dwordx2 s[20:21], s[0:1], 32
s_waitcnt lgkmcnt(0)
s_and_b32 s21, s21, 0xffff
s_mov_b32 s22, 4194304
s_mov_b32 s23, 0x20000
s_lshl_b32 s38, s43, 12
s_add_u32 s35, s35, s38
s_add_u32 s35, s35, 16777216
v_lshrrev_b32 v4, 4, v1
v_and_b32 v5, 15, v4
v_mul_u32_u24 v8, 1040, v5
v_lshrrev_b32 v4, 4, v4
v_lshl_add_u32 v8, v4, 4, v8
v_add_u32 v9, 66560, v8
s_add_u32 s38, s34, 0
buffer_load_dwordx2 v[16:17], v3, s[20:23], s38 offen
s_add_u32 s38, s34, 8192
buffer_load_dwordx2 v[18:19], v3, s[20:23], s38 offen
s_add_u32 s38, s34, 16384
buffer_load_dwordx2 v[20:21], v3, s[20:23], s38 offen
s_add_u32 s38, s34, 24576
buffer_load_dwordx2 v[22:23], v3, s[20:23], s38 offen
s_add_u32 s38, s34, 32768
buffer_load_dwordx2 v[24:25], v3, s[20:23], s38 offen
s_add_u32 s38, s34, 40960
buffer_load_dwordx2 v[26:27], v3, s[20:23], s38 offen
s_add_u32 s38, s34, 49152
buffer_load_dwordx2 v[28:29], v3, s[20:23], s38 offen
s_add_u32 s38, s34, 57344
buffer_load_dwordx2 v[30:31], v3, s[20:23], s38 offen
s_add_u32 s38, s34, 262144
buffer_load_dwordx2 v[32:33], v3, s[20:23], s38 offen
s_add_u32 s38, s34, 270336
buffer_load_dwordx2 v[34:35], v3, s[20:23], s38 offen
s_add_u32 s38, s34, 278528
buffer_load_dwordx2 v[36:37], v3, s[20:23], s38 offen
s_add_u32 s38, s34, 286720
buffer_load_dwordx2 v[38:39], v3, s[20:23], s38 offen
s_add_u32 s38, s34, 294912
buffer_load_dwordx2 v[40:41], v3, s[20:23], s38 offen
s_add_u32 s38, s34, 303104
buffer_load_dwordx2 v[42:43], v3, s[20:23], s38 offen
s_add_u32 s38, s34, 311296
buffer_load_dwordx2 v[44:45], v3, s[20:23], s38 offen
s_add_u32 s38, s34, 319488
buffer_load_dwordx2 v[46:47], v3, s[20:23], s38 offen
s_add_u32 s38, s34, 524288
buffer_load_dwordx2 v[48:49], v3, s[20:23], s38 offen
s_add_u32 s38, s34, 532480
buffer_load_dwordx2 v[50:51], v3, s[20:23], s38 offen
s_add_u32 s38, s34, 540672
buffer_load_dwordx2 v[52:53], v3, s[20:23], s38 offen
s_add_u32 s38, s34, 548864
buffer_load_dwordx2 v[54:55], v3, s[20:23], s38 offen
s_add_u32 s38, s34, 557056
buffer_load_dwordx2 v[56:57], v3, s[20:23], s38 offen
s_add_u32 s38, s34, 565248
buffer_load_dwordx2 v[58:59], v3, s[20:23], s38 offen
s_add_u32 s38, s34, 573440
buffer_load_dwordx2 v[60:61], v3, s[20:23], s38 offen
s_add_u32 s38, s34, 581632
buffer_load_dwordx2 v[62:63], v3, s[20:23], s38 offen
s_add_u32 s38, s34, 786432
buffer_load_dwordx2 v[64:65], v3, s[20:23], s38 offen
s_add_u32 s38, s34, 794624
buffer_load_dwordx2 v[66:67], v3, s[20:23], s38 offen
s_add_u32 s38, s34, 802816
buffer_load_dwordx2 v[68:69], v3, s[20:23], s38 offen
s_add_u32 s38, s34, 811008
buffer_load_dwordx2 v[70:71], v3, s[20:23], s38 offen
s_add_u32 s38, s34, 819200
buffer_load_dwordx2 v[72:73], v3, s[20:23], s38 offen
s_add_u32 s38, s34, 827392
buffer_load_dwordx2 v[74:75], v3, s[20:23], s38 offen
s_add_u32 s38, s34, 835584
buffer_load_dwordx2 v[76:77], v3, s[20:23], s38 offen
s_add_u32 s38, s34, 843776
buffer_load_dwordx2 v[78:79], v3, s[20:23], s38 offen
s_waitcnt vmcnt(0)
s_barrier
s_cmp_eq_u32 s70, 0
s_cbranch_scc1 PV_nf
s_cmp_lg_u32 s17, 0
s_cbranch_scc1 PV_nf
s_cmp_lg_u32 s63, 1
s_cbranch_scc1 PV_hn
v_mov_b32 v4, 64
s_mov_b32 s41, 0x40000
PV_nonce:
global_load_dword v5, v4, s[52:53] sc1
s_waitcnt vmcnt(0)
v_readfirstlane_b32 s69, v5
s_nop 0
s_cmp_lg_u32 s69, 0
s_cbranch_scc1 PV_nonce_ok
s_sub_u32 s41, s41, 1
s_cbranch_scc1 PV_nonce_ok
s_sleep 4
s_branch PV_nonce
PV_nonce_ok:
PV_hn:
s_mov_b64 exec, 1
v_mov_b32 v4, s69
v_mov_b32 v5, 0
buffer_store_dword v4, v5, s[8:11], s70 offen sc1
s_mov_b64 exec, -1
PV_nf:
ds_read_b128 a[0:3], v8 offset:0
ds_read_b128 a[4:7], v8 offset:16640
ds_read_b128 a[8:11], v8 offset:33280
ds_read_b128 a[12:15], v8 offset:49920
ds_read_b128 a[16:19], v9 offset:0
ds_read_b128 a[20:23], v9 offset:16640
ds_read_b128 a[24:27], v9 offset:33280
ds_read_b128 a[28:31], v9 offset:49920
v_perm_b32 v96, v18, v16, s50
v_perm_b32 v97, v22, v20, s50
v_perm_b32 v98, v26, v24, s50
v_perm_b32 v99, v30, v28, s50
v_perm_b32 v100, v18, v16, s51
v_perm_b32 v101, v22, v20, s51
v_perm_b32 v102, v26, v24, s51
v_perm_b32 v103, v30, v28, s51
v_perm_b32 v104, v19, v17, s50
v_perm_b32 v105, v23, v21, s50
v_perm_b32 v106, v27, v25, s50
v_perm_b32 v107, v31, v29, s50
v_perm_b32 v108, v19, v17, s51
v_perm_b32 v109, v23, v21, s51
v_perm_b32 v110, v27, v25, s51
v_perm_b32 v111, v31, v29, s51
s_waitcnt lgkmcnt(7)
v_mfma_f32_16x16x32_bf16 v[128:131], a[0:3], v[96:99], 0
v_mfma_f32_16x16x32_bf16 v[132:135], a[0:3], v[100:103], 0
ds_read_b128 a[32:35], v8 offset:64
v_mfma_f32_16x16x32_bf16 v[136:139], a[0:3], v[104:107], 0
v_mfma_f32_16x16x32_bf16 v[140:143], a[0:3], v[108:111], 0
s_add_u32 s38, s34, 1048576
buffer_load_dwordx2 v[80:81], v3, s[20:23], s38 offen
s_waitcnt lgkmcnt(7)
v_mfma_f32_16x16x32_bf16 v[144:147], a[4:7], v[96:99], 0
v_mfma_f32_16x16x32_bf16 v[148:151], a[4:7], v[100:103], 0
ds_read_b128 a[36:39], v8 offset:16704
v_mfma_f32_16x16x32_bf16 v[152:155], a[4:7], v[104:107], 0
v_mfma_f32_16x16x32_bf16 v[156:159], a[4:7], v[108:111], 0
s_add_u32 s38, s34, 1056768
buffer_load_dwordx2 v[82:83], v3, s[20:23], s38 offen
s_waitcnt lgkmcnt(7)
v_mfma_f32_16x16x32_bf16 v[160:163], a[8:11], v[96:99], 0
v_perm_b32 v112, v34, v32, s50
v_perm_b32 v113, v38, v36, s50
v_mfma_f32_16x16x32_bf16 v[164:167], a[8:11], v[100:103], 0
ds_read_b128 a[40:43], v8 offset:33344
v_mfma_f32_16x16x32_bf16 v[168:171], a[8:11], v[104:107], 0
v_perm_b32 v114, v42, v40, s50
v_mfma_f32_16x16x32_bf16 v[172:175], a[8:11], v[108:111], 0
s_add_u32 s38, s34, 1064960
buffer_load_dwordx2 v[84:85], v3, s[20:23], s38 offen
s_waitcnt lgkmcnt(7)
v_mfma_f32_16x16x32_bf16 v[176:179], a[12:15], v[96:99], 0
v_perm_b32 v115, v46, v44, s50
v_perm_b32 v116, v34, v32, s51
v_mfma_f32_16x16x32_bf16 v[180:183], a[12:15], v[100:103], 0
ds_read_b128 a[44:47], v8 offset:49984
v_mfma_f32_16x16x32_bf16 v[184:187], a[12:15], v[104:107], 0
v_perm_b32 v117, v38, v36, s51
v_mfma_f32_16x16x32_bf16 v[188:191], a[12:15], v[108:111], 0
s_add_u32 s38, s34, 1073152
buffer_load_dwordx2 v[86:87], v3, s[20:23], s38 offen
s_waitcnt lgkmcnt(7)
v_mfma_f32_16x16x32_bf16 v[192:195], a[16:19], v[96:99], 0
v_perm_b32 v118, v42, v40, s51
v_perm_b32 v119, v46, v44, s51
v_mfma_f32_16x16x32_bf16 v[196:199], a[16:19], v[100:103], 0
ds_read_b128 a[48:51], v9 offset:64
v_mfma_f32_16x16x32_bf16 v[200:203], a[16:19], v[104:107], 0
v_perm_b32 v120, v35, v33, s50
v_mfma_f32_16x16x32_bf16 v[204:207], a[16:19], v[108:111], 0
s_add_u32 s38, s34, 1081344
buffer_load_dwordx2 v[88:89], v3, s[20:23], s38 offen
s_waitcnt lgkmcnt(7)
v_mfma_f32_16x16x32_bf16 v[208:211], a[20:23], v[96:99], 0
v_perm_b32 v121, v39, v37, s50
v_perm_b32 v122, v43, v41, s50
v_mfma_f32_16x16x32_bf16 v[212:215], a[20:23], v[100:103], 0
ds_read_b128 a[52:55], v9 offset:16704
v_mfma_f32_16x16x32_bf16 v[216:219], a[20:23], v[104:107], 0
v_perm_b32 v123, v47, v45, s50
v_mfma_f32_16x16x32_bf16 v[220:223], a[20:23], v[108:111], 0
s_add_u32 s38, s34, 1089536
buffer_load_dwordx2 v[90:91], v3, s[20:23], s38 offen
s_waitcnt lgkmcnt(7)
v_mfma_f32_16x16x32_bf16 v[224:227], a[24:27], v[96:99], 0
v_perm_b32 v124, v35, v33, s51
v_perm_b32 v125, v39, v37, s51
v_mfma_f32_16x16x32_bf16 v[228:231], a[24:27], v[100:103], 0
ds_read_b128 a[56:59], v9 offset:33344
v_perm_b32 v126, v43, v41, s51
v_mfma_f32_16x16x32_bf16 v[232:235], a[24:27], v[104:107], 0
v_perm_b32 v127, v47, v45, s51
v_mfma_f32_16x16x32_bf16 v[236:239], a[24:27], v[108:111], 0
s_add_u32 s38, s34, 1097728
buffer_load_dwordx2 v[92:93], v3, s[20:23], s38 offen
s_waitcnt lgkmcnt(7)
v_mfma_f32_16x16x32_bf16 v[240:243], a[28:31], v[96:99], 0
v_mfma_f32_16x16x32_bf16 v[244:247], a[28:31], v[100:103], 0
ds_read_b128 a[60:63], v9 offset:49984
v_mfma_f32_16x16x32_bf16 v[248:251], a[28:31], v[104:107], 0
v_mfma_f32_16x16x32_bf16 v[252:255], a[28:31], v[108:111], 0
s_add_u32 s38, s34, 1105920
buffer_load_dwordx2 v[94:95], v3, s[20:23], s38 offen
s_waitcnt lgkmcnt(7)
v_mfma_f32_16x16x32_bf16 v[128:131], a[32:35], v[112:115], v[128:131]
v_mfma_f32_16x16x32_bf16 v[132:135], a[32:35], v[116:119], v[132:135]
ds_read_b128 a[0:3], v8 offset:128
v_mfma_f32_16x16x32_bf16 v[136:139], a[32:35], v[120:123], v[136:139]
v_mfma_f32_16x16x32_bf16 v[140:143], a[32:35], v[124:127], v[140:143]
s_add_u32 s38, s34, 1310720
buffer_load_dwordx2 v[16:17], v3, s[20:23], s38 offen
s_waitcnt lgkmcnt(7)
v_mfma_f32_16x16x32_bf16 v[144:147], a[36:39], v[112:115], v[144:147]
v_mfma_f32_16x16x32_bf16 v[148:151], a[36:39], v[116:119], v[148:151]
ds_read_b128 a[4:7], v8 offset:16768
v_mfma_f32_16x16x32_bf16 v[152:155], a[36:39], v[120:123], v[152:155]
v_mfma_f32_16x16x32_bf16 v[156:159], a[36:39], v[124:127], v[156:159]
s_add_u32 s38, s34, 1318912
buffer_load_dwordx2 v[18:19], v3, s[20:23], s38 offen
s_waitcnt lgkmcnt(7)
v_mfma_f32_16x16x32_bf16 v[160:163], a[40:43], v[112:115], v[160:163]
v_perm_b32 v96, v50, v48, s50
v_perm_b32 v97, v54, v52, s50
v_mfma_f32_16x16x32_bf16 v[164:167], a[40:43], v[116:119], v[164:167]
ds_read_b128 a[8:11], v8 offset:33408
v_mfma_f32_16x16x32_bf16 v[168:171], a[40:43], v[120:123], v[168:171]
v_perm_b32 v98, v58, v56, s50
v_mfma_f32_16x16x32_bf16 v[172:175], a[40:43], v[124:127], v[172:175]
s_add_u32 s38, s34, 1327104
buffer_load_dwordx2 v[20:21], v3, s[20:23], s38 offen
s_waitcnt lgkmcnt(7)
v_mfma_f32_16x16x32_bf16 v[176:179], a[44:47], v[112:115], v[176:179]
v_perm_b32 v99, v62, v60, s50
v_perm_b32 v100, v50, v48, s51
v_mfma_f32_16x16x32_bf16 v[180:183], a[44:47], v[116:119], v[180:183]
ds_read_b128 a[12:15], v8 offset:50048
v_mfma_f32_16x16x32_bf16 v[184:187], a[44:47], v[120:123], v[184:187]
v_perm_b32 v101, v54, v52, s51
v_mfma_f32_16x16x32_bf16 v[188:191], a[44:47], v[124:127], v[188:191]
s_add_u32 s38, s34, 1335296
buffer_load_dwordx2 v[22:23], v3, s[20:23], s38 offen
s_waitcnt lgkmcnt(7)
v_mfma_f32_16x16x32_bf16 v[192:195], a[48:51], v[112:115], v[192:195]
v_perm_b32 v102, v58, v56, s51
v_perm_b32 v103, v62, v60, s51
v_mfma_f32_16x16x32_bf16 v[196:199], a[48:51], v[116:119], v[196:199]
ds_read_b128 a[16:19], v9 offset:128
v_mfma_f32_16x16x32_bf16 v[200:203], a[48:51], v[120:123], v[200:203]
v_perm_b32 v104, v51, v49, s50
v_mfma_f32_16x16x32_bf16 v[204:207], a[48:51], v[124:127], v[204:207]
s_add_u32 s38, s34, 1343488
buffer_load_dwordx2 v[24:25], v3, s[20:23], s38 offen
s_waitcnt lgkmcnt(7)
v_mfma_f32_16x16x32_bf16 v[208:211], a[52:55], v[112:115], v[208:211]
v_perm_b32 v105, v55, v53, s50
v_perm_b32 v106, v59, v57, s50
v_mfma_f32_16x16x32_bf16 v[212:215], a[52:55], v[116:119], v[212:215]
ds_read_b128 a[20:23], v9 offset:16768
v_mfma_f32_16x16x32_bf16 v[216:219], a[52:55], v[120:123], v[216:219]
v_perm_b32 v107, v63, v61, s50
v_mfma_f32_16x16x32_bf16 v[220:223], a[52:55], v[124:127], v[220:223]
s_add_u32 s38, s34, 1351680
buffer_load_dwordx2 v[26:27], v3, s[20:23], s38 offen
s_waitcnt lgkmcnt(7)
v_mfma_f32_16x16x32_bf16 v[224:227], a[56:59], v[112:115], v[224:227]
v_perm_b32 v108, v51, v49, s51
v_perm_b32 v109, v55, v53, s51
v_mfma_f32_16x16x32_bf16 v[228:231], a[56:59], v[116:119], v[228:231]
ds_read_b128 a[24:27], v9 offset:33408
v_perm_b32 v110, v59, v57, s51
v_mfma_f32_16x16x32_bf16 v[232:235], a[56:59], v[120:123], v[232:235]
v_perm_b32 v111, v63, v61, s51
v_mfma_f32_16x16x32_bf16 v[236:239], a[56:59], v[124:127], v[236:239]
s_add_u32 s38, s34, 1359872
buffer_load_dwordx2 v[28:29], v3, s[20:23], s38 offen
s_waitcnt lgkmcnt(7)
v_mfma_f32_16x16x32_bf16 v[240:243], a[60:63], v[112:115], v[240:243]
v_mfma_f32_16x16x32_bf16 v[244:247], a[60:63], v[116:119], v[244:247]
ds_read_b128 a[28:31], v9 offset:50048
v_mfma_f32_16x16x32_bf16 v[248:251], a[60:63], v[120:123], v[248:251]
v_mfma_f32_16x16x32_bf16 v[252:255], a[60:63], v[124:127], v[252:255]
s_add_u32 s38, s34, 1368064
buffer_load_dwordx2 v[30:31], v3, s[20:23], s38 offen
s_waitcnt lgkmcnt(7)
v_mfma_f32_16x16x32_bf16 v[128:131], a[0:3], v[96:99], v[128:131]
v_mfma_f32_16x16x32_bf16 v[132:135], a[0:3], v[100:103], v[132:135]
ds_read_b128 a[32:35], v8 offset:192
v_mfma_f32_16x16x32_bf16 v[136:139], a[0:3], v[104:107], v[136:139]
v_mfma_f32_16x16x32_bf16 v[140:143], a[0:3], v[108:111], v[140:143]
s_add_u32 s38, s34, 1572864
buffer_load_dwordx2 v[32:33], v3, s[20:23], s38 offen
s_waitcnt lgkmcnt(7)
v_mfma_f32_16x16x32_bf16 v[144:147], a[4:7], v[96:99], v[144:147]
v_mfma_f32_16x16x32_bf16 v[148:151], a[4:7], v[100:103], v[148:151]
ds_read_b128 a[36:39], v8 offset:16832
v_mfma_f32_16x16x32_bf16 v[152:155], a[4:7], v[104:107], v[152:155]
v_mfma_f32_16x16x32_bf16 v[156:159], a[4:7], v[108:111], v[156:159]
s_add_u32 s38, s34, 1581056
buffer_load_dwordx2 v[34:35], v3, s[20:23], s38 offen
s_waitcnt lgkmcnt(7)
v_mfma_f32_16x16x32_bf16 v[160:163], a[8:11], v[96:99], v[160:163]
v_perm_b32 v112, v66, v64, s50
v_perm_b32 v113, v70, v68, s50
v_mfma_f32_16x16x32_bf16 v[164:167], a[8:11], v[100:103], v[164:167]
ds_read_b128 a[40:43], v8 offset:33472
v_mfma_f32_16x16x32_bf16 v[168:171], a[8:11], v[104:107], v[168:171]
v_perm_b32 v114, v74, v72, s50
v_mfma_f32_16x16x32_bf16 v[172:175], a[8:11], v[108:111], v[172:175]
s_add_u32 s38, s34, 1589248
buffer_load_dwordx2 v[36:37], v3, s[20:23], s38 offen
s_waitcnt lgkmcnt(7)
v_mfma_f32_16x16x32_bf16 v[176:179], a[12:15], v[96:99], v[176:179]
v_perm_b32 v115, v78, v76, s50
v_perm_b32 v116, v66, v64, s51
v_mfma_f32_16x16x32_bf16 v[180:183], a[12:15], v[100:103], v[180:183]
ds_read_b128 a[44:47], v8 offset:50112
v_mfma_f32_16x16x32_bf16 v[184:187], a[12:15], v[104:107], v[184:187]
v_perm_b32 v117, v70, v68, s51
v_mfma_f32_16x16x32_bf16 v[188:191], a[12:15], v[108:111], v[188:191]
s_add_u32 s38, s34, 1597440
buffer_load_dwordx2 v[38:39], v3, s[20:23], s38 offen
s_waitcnt lgkmcnt(7)
v_mfma_f32_16x16x32_bf16 v[192:195], a[16:19], v[96:99], v[192:195]
v_perm_b32 v118, v74, v72, s51
v_perm_b32 v119, v78, v76, s51
v_mfma_f32_16x16x32_bf16 v[196:199], a[16:19], v[100:103], v[196:199]
ds_read_b128 a[48:51], v9 offset:192
v_mfma_f32_16x16x32_bf16 v[200:203], a[16:19], v[104:107], v[200:203]
v_perm_b32 v120, v67, v65, s50
v_mfma_f32_16x16x32_bf16 v[204:207], a[16:19], v[108:111], v[204:207]
s_add_u32 s38, s34, 1605632
buffer_load_dwordx2 v[40:41], v3, s[20:23], s38 offen
s_waitcnt lgkmcnt(7)
v_mfma_f32_16x16x32_bf16 v[208:211], a[20:23], v[96:99], v[208:211]
v_perm_b32 v121, v71, v69, s50
v_perm_b32 v122, v75, v73, s50
v_mfma_f32_16x16x32_bf16 v[212:215], a[20:23], v[100:103], v[212:215]
ds_read_b128 a[52:55], v9 offset:16832
v_mfma_f32_16x16x32_bf16 v[216:219], a[20:23], v[104:107], v[216:219]
v_perm_b32 v123, v79, v77, s50
v_mfma_f32_16x16x32_bf16 v[220:223], a[20:23], v[108:111], v[220:223]
s_add_u32 s38, s34, 1613824
buffer_load_dwordx2 v[42:43], v3, s[20:23], s38 offen
s_waitcnt lgkmcnt(7)
v_mfma_f32_16x16x32_bf16 v[224:227], a[24:27], v[96:99], v[224:227]
v_perm_b32 v124, v67, v65, s51
v_perm_b32 v125, v71, v69, s51
v_mfma_f32_16x16x32_bf16 v[228:231], a[24:27], v[100:103], v[228:231]
ds_read_b128 a[56:59], v9 offset:33472
v_perm_b32 v126, v75, v73, s51
v_mfma_f32_16x16x32_bf16 v[232:235], a[24:27], v[104:107], v[232:235]
v_perm_b32 v127, v79, v77, s51
v_mfma_f32_16x16x32_bf16 v[236:239], a[24:27], v[108:111], v[236:239]
s_add_u32 s38, s34, 1622016
buffer_load_dwordx2 v[44:45], v3, s[20:23], s38 offen
s_waitcnt lgkmcnt(7)
v_mfma_f32_16x16x32_bf16 v[240:243], a[28:31], v[96:99], v[240:243]
v_mfma_f32_16x16x32_bf16 v[244:247], a[28:31], v[100:103], v[244:247]
ds_read_b128 a[60:63], v9 offset:50112
v_mfma_f32_16x16x32_bf16 v[248:251], a[28:31], v[104:107], v[248:251]
v_mfma_f32_16x16x32_bf16 v[252:255], a[28:31], v[108:111], v[252:255]
s_add_u32 s38, s34, 1630208
buffer_load_dwordx2 v[46:47], v3, s[20:23], s38 offen
s_waitcnt lgkmcnt(7)
v_mfma_f32_16x16x32_bf16 v[128:131], a[32:35], v[112:115], v[128:131]
v_mfma_f32_16x16x32_bf16 v[132:135], a[32:35], v[116:119], v[132:135]
ds_read_b128 a[0:3], v8 offset:256
v_mfma_f32_16x16x32_bf16 v[136:139], a[32:35], v[120:123], v[136:139]
v_mfma_f32_16x16x32_bf16 v[140:143], a[32:35], v[124:127], v[140:143]
s_add_u32 s38, s34, 1835008
buffer_load_dwordx2 v[48:49], v3, s[20:23], s38 offen
s_waitcnt lgkmcnt(7)
v_mfma_f32_16x16x32_bf16 v[144:147], a[36:39], v[112:115], v[144:147]
v_mfma_f32_16x16x32_bf16 v[148:151], a[36:39], v[116:119], v[148:151]
ds_read_b128 a[4:7], v8 offset:16896
v_mfma_f32_16x16x32_bf16 v[152:155], a[36:39], v[120:123], v[152:155]
v_mfma_f32_16x16x32_bf16 v[156:159], a[36:39], v[124:127], v[156:159]
s_add_u32 s38, s34, 1843200
buffer_load_dwordx2 v[50:51], v3, s[20:23], s38 offen
s_waitcnt lgkmcnt(7)
v_mfma_f32_16x16x32_bf16 v[160:163], a[40:43], v[112:115], v[160:163]
s_waitcnt vmcnt(24)
v_perm_b32 v96, v82, v80, s50
s_waitcnt vmcnt(22)
v_perm_b32 v97, v86, v84, s50
v_mfma_f32_16x16x32_bf16 v[164:167], a[40:43], v[116:119], v[164:167]
ds_read_b128 a[8:11], v8 offset:33536
v_mfma_f32_16x16x32_bf16 v[168:171], a[40:43], v[120:123], v[168:171]
s_waitcnt vmcnt(20)
v_perm_b32 v98, v90, v88, s50
v_mfma_f32_16x16x32_bf16 v[172:175], a[40:43], v[124:127], v[172:175]
s_add_u32 s38, s34, 1851392
buffer_load_dwordx2 v[52:53], v3, s[20:23], s38 offen
s_waitcnt lgkmcnt(7)
v_mfma_f32_16x16x32_bf16 v[176:179], a[44:47], v[112:115], v[176:179]
s_waitcnt vmcnt(19)
v_perm_b32 v99, v94, v92, s50
v_perm_b32 v100, v82, v80, s51
v_mfma_f32_16x16x32_bf16 v[180:183], a[44:47], v[116:119], v[180:183]
ds_read_b128 a[12:15], v8 offset:50176
v_mfma_f32_16x16x32_bf16 v[184:187], a[44:47], v[120:123], v[184:187]
v_perm_b32 v101, v86, v84, s51
v_mfma_f32_16x16x32_bf16 v[188:191], a[44:47], v[124:127], v[188:191]
s_add_u32 s38, s34, 1859584
buffer_load_dwordx2 v[54:55], v3, s[20:23], s38 offen
s_waitcnt lgkmcnt(7)
v_mfma_f32_16x16x32_bf16 v[192:195], a[48:51], v[112:115], v[192:195]
v_perm_b32 v102, v90, v88, s51
v_perm_b32 v103, v94, v92, s51
v_mfma_f32_16x16x32_bf16 v[196:199], a[48:51], v[116:119], v[196:199]
ds_read_b128 a[16:19], v9 offset:256
v_mfma_f32_16x16x32_bf16 v[200:203], a[48:51], v[120:123], v[200:203]
v_perm_b32 v104, v83, v81, s50
v_mfma_f32_16x16x32_bf16 v[204:207], a[48:51], v[124:127], v[204:207]
s_add_u32 s38, s34, 1867776
buffer_load_dwordx2 v[56:57], v3, s[20:23], s38 offen
s_waitcnt lgkmcnt(7)
v_mfma_f32_16x16x32_bf16 v[208:211], a[52:55], v[112:115], v[208:211]
v_perm_b32 v105, v87, v85, s50
v_perm_b32 v106, v91, v89, s50
v_mfma_f32_16x16x32_bf16 v[212:215], a[52:55], v[116:119], v[212:215]
ds_read_b128 a[20:23], v9 offset:16896
v_mfma_f32_16x16x32_bf16 v[216:219], a[52:55], v[120:123], v[216:219]
v_perm_b32 v107, v95, v93, s50
v_mfma_f32_16x16x32_bf16 v[220:223], a[52:55], v[124:127], v[220:223]
s_add_u32 s38, s34, 1875968
buffer_load_dwordx2 v[58:59], v3, s[20:23], s38 offen
s_waitcnt lgkmcnt(7)
v_mfma_f32_16x16x32_bf16 v[224:227], a[56:59], v[112:115], v[224:227]
v_perm_b32 v108, v83, v81, s51
v_perm_b32 v109, v87, v85, s51
v_mfma_f32_16x16x32_bf16 v[228:231], a[56:59], v[116:119], v[228:231]
ds_read_b128 a[24:27], v9 offset:33536
v_perm_b32 v110, v91, v89, s51
v_mfma_f32_16x16x32_bf16 v[232:235], a[56:59], v[120:123], v[232:235]
v_perm_b32 v111, v95, v93, s51
v_mfma_f32_16x16x32_bf16 v[236:239], a[56:59], v[124:127], v[236:239]
s_add_u32 s38, s34, 1884160
buffer_load_dwordx2 v[60:61], v3, s[20:23], s38 offen
s_waitcnt lgkmcnt(7)
v_mfma_f32_16x16x32_bf16 v[240:243], a[60:63], v[112:115], v[240:243]
v_mfma_f32_16x16x32_bf16 v[244:247], a[60:63], v[116:119], v[244:247]
ds_read_b128 a[28:31], v9 offset:50176
v_mfma_f32_16x16x32_bf16 v[248:251], a[60:63], v[120:123], v[248:251]
v_mfma_f32_16x16x32_bf16 v[252:255], a[60:63], v[124:127], v[252:255]
s_add_u32 s38, s34, 1892352
buffer_load_dwordx2 v[62:63], v3, s[20:23], s38 offen
s_waitcnt lgkmcnt(7)
v_mfma_f32_16x16x32_bf16 v[128:131], a[0:3], v[96:99], v[128:131]
v_mfma_f32_16x16x32_bf16 v[132:135], a[0:3], v[100:103], v[132:135]
ds_read_b128 a[32:35], v8 offset:320
v_mfma_f32_16x16x32_bf16 v[136:139], a[0:3], v[104:107], v[136:139]
v_mfma_f32_16x16x32_bf16 v[140:143], a[0:3], v[108:111], v[140:143]
s_add_u32 s38, s34, 2097152
buffer_load_dwordx2 v[64:65], v3, s[20:23], s38 offen
s_waitcnt lgkmcnt(7)
v_mfma_f32_16x16x32_bf16 v[144:147], a[4:7], v[96:99], v[144:147]
v_mfma_f32_16x16x32_bf16 v[148:151], a[4:7], v[100:103], v[148:151]
ds_read_b128 a[36:39], v8 offset:16960
v_mfma_f32_16x16x32_bf16 v[152:155], a[4:7], v[104:107], v[152:155]
v_mfma_f32_16x16x32_bf16 v[156:159], a[4:7], v[108:111], v[156:159]
s_add_u32 s38, s34, 2105344
buffer_load_dwordx2 v[66:67], v3, s[20:23], s38 offen
s_waitcnt lgkmcnt(7)
v_mfma_f32_16x16x32_bf16 v[160:163], a[8:11], v[96:99], v[160:163]
s_waitcnt vmcnt(24)
v_perm_b32 v112, v18, v16, s50
s_waitcnt vmcnt(22)
v_perm_b32 v113, v22, v20, s50
v_mfma_f32_16x16x32_bf16 v[164:167], a[8:11], v[100:103], v[164:167]
ds_read_b128 a[40:43], v8 offset:33600
v_mfma_f32_16x16x32_bf16 v[168:171], a[8:11], v[104:107], v[168:171]
s_waitcnt vmcnt(20)
v_perm_b32 v114, v26, v24, s50
v_mfma_f32_16x16x32_bf16 v[172:175], a[8:11], v[108:111], v[172:175]
s_add_u32 s38, s34, 2113536
buffer_load_dwordx2 v[68:69], v3, s[20:23], s38 offen
s_waitcnt lgkmcnt(7)
v_mfma_f32_16x16x32_bf16 v[176:179], a[12:15], v[96:99], v[176:179]
s_waitcnt vmcnt(19)
v_perm_b32 v115, v30, v28, s50
v_perm_b32 v116, v18, v16, s51
v_mfma_f32_16x16x32_bf16 v[180:183], a[12:15], v[100:103], v[180:183]
ds_read_b128 a[44:47], v8 offset:50240
v_mfma_f32_16x16x32_bf16 v[184:187], a[12:15], v[104:107], v[184:187]
v_perm_b32 v117, v22, v20, s51
v_mfma_f32_16x16x32_bf16 v[188:191], a[12:15], v[108:111], v[188:191]
s_add_u32 s38, s34, 2121728
buffer_load_dwordx2 v[70:71], v3, s[20:23], s38 offen
s_waitcnt lgkmcnt(7)
v_mfma_f32_16x16x32_bf16 v[192:195], a[16:19], v[96:99], v[192:195]
v_perm_b32 v118, v26, v24, s51
v_perm_b32 v119, v30, v28, s51
v_mfma_f32_16x16x32_bf16 v[196:199], a[16:19], v[100:103], v[196:199]
ds_read_b128 a[48:51], v9 offset:320
v_mfma_f32_16x16x32_bf16 v[200:203], a[16:19], v[104:107], v[200:203]
v_perm_b32 v120, v19, v17, s50
v_mfma_f32_16x16x32_bf16 v[204:207], a[16:19], v[108:111], v[204:207]
s_add_u32 s38, s34, 2129920
buffer_load_dwordx2 v[72:73], v3, s[20:23], s38 offen
s_waitcnt lgkmcnt(7)
v_mfma_f32_16x16x32_bf16 v[208:211], a[20:23], v[96:99], v[208:211]
v_perm_b32 v121, v23, v21, s50
v_perm_b32 v122, v27, v25, s50
v_mfma_f32_16x16x32_bf16 v[212:215], a[20:23], v[100:103], v[212:215]
ds_read_b128 a[52:55], v9 offset:16960
v_mfma_f32_16x16x32_bf16 v[216:219], a[20:23], v[104:107], v[216:219]
v_perm_b32 v123, v31, v29, s50
v_mfma_f32_16x16x32_bf16 v[220:223], a[20:23], v[108:111], v[220:223]
s_add_u32 s38, s34, 2138112
buffer_load_dwordx2 v[74:75], v3, s[20:23], s38 offen
s_waitcnt lgkmcnt(7)
v_mfma_f32_16x16x32_bf16 v[224:227], a[24:27], v[96:99], v[224:227]
v_perm_b32 v124, v19, v17, s51
v_perm_b32 v125, v23, v21, s51
v_mfma_f32_16x16x32_bf16 v[228:231], a[24:27], v[100:103], v[228:231]
ds_read_b128 a[56:59], v9 offset:33600
v_perm_b32 v126, v27, v25, s51
v_mfma_f32_16x16x32_bf16 v[232:235], a[24:27], v[104:107], v[232:235]
v_perm_b32 v127, v31, v29, s51
v_mfma_f32_16x16x32_bf16 v[236:239], a[24:27], v[108:111], v[236:239]
s_add_u32 s38, s34, 2146304
buffer_load_dwordx2 v[76:77], v3, s[20:23], s38 offen
s_waitcnt lgkmcnt(7)
v_mfma_f32_16x16x32_bf16 v[240:243], a[28:31], v[96:99], v[240:243]
v_mfma_f32_16x16x32_bf16 v[244:247], a[28:31], v[100:103], v[244:247]
ds_read_b128 a[60:63], v9 offset:50240
v_mfma_f32_16x16x32_bf16 v[248:251], a[28:31], v[104:107], v[248:251]
v_mfma_f32_16x16x32_bf16 v[252:255], a[28:31], v[108:111], v[252:255]
s_add_u32 s38, s34, 2154496
buffer_load_dwordx2 v[78:79], v3, s[20:23], s38 offen
s_waitcnt lgkmcnt(7)
v_mfma_f32_16x16x32_bf16 v[128:131], a[32:35], v[112:115], v[128:131]
v_mfma_f32_16x16x32_bf16 v[132:135], a[32:35], v[116:119], v[132:135]
ds_read_b128 a[0:3], v8 offset:384
v_mfma_f32_16x16x32_bf16 v[136:139], a[32:35], v[120:123], v[136:139]
v_mfma_f32_16x16x32_bf16 v[140:143], a[32:35], v[124:127], v[140:143]
s_add_u32 s38, s34, 2359296
buffer_load_dwordx2 v[80:81], v3, s[20:23], s38 offen
s_waitcnt lgkmcnt(7)
v_mfma_f32_16x16x32_bf16 v[144:147], a[36:39], v[112:115], v[144:147]
v_mfma_f32_16x16x32_bf16 v[148:151], a[36:39], v[116:119], v[148:151]
ds_read_b128 a[4:7], v8 offset:17024
v_mfma_f32_16x16x32_bf16 v[152:155], a[36:39], v[120:123], v[152:155]
v_mfma_f32_16x16x32_bf16 v[156:159], a[36:39], v[124:127], v[156:159]
s_add_u32 s38, s34, 2367488
buffer_load_dwordx2 v[82:83], v3, s[20:23], s38 offen
s_waitcnt lgkmcnt(7)
v_mfma_f32_16x16x32_bf16 v[160:163], a[40:43], v[112:115], v[160:163]
s_waitcnt vmcnt(24)
v_perm_b32 v96, v34, v32, s50
s_waitcnt vmcnt(22)
v_perm_b32 v97, v38, v36, s50
v_mfma_f32_16x16x32_bf16 v[164:167], a[40:43], v[116:119], v[164:167]
ds_read_b128 a[8:11], v8 offset:33664
v_mfma_f32_16x16x32_bf16 v[168:171], a[40:43], v[120:123], v[168:171]
s_waitcnt vmcnt(20)
v_perm_b32 v98, v42, v40, s50
v_mfma_f32_16x16x32_bf16 v[172:175], a[40:43], v[124:127], v[172:175]
s_add_u32 s38, s34, 2375680
buffer_load_dwordx2 v[84:85], v3, s[20:23], s38 offen
s_waitcnt lgkmcnt(7)
v_mfma_f32_16x16x32_bf16 v[176:179], a[44:47], v[112:115], v[176:179]
s_waitcnt vmcnt(19)
v_perm_b32 v99, v46, v44, s50
v_perm_b32 v100, v34, v32, s51
v_mfma_f32_16x16x32_bf16 v[180:183], a[44:47], v[116:119], v[180:183]
ds_read_b128 a[12:15], v8 offset:50304
v_mfma_f32_16x16x32_bf16 v[184:187], a[44:47], v[120:123], v[184:187]
v_perm_b32 v101, v38, v36, s51
v_mfma_f32_16x16x32_bf16 v[188:191], a[44:47], v[124:127], v[188:191]
s_add_u32 s38, s34, 2383872
buffer_load_dwordx2 v[86:87], v3, s[20:23], s38 offen
s_waitcnt lgkmcnt(7)
v_mfma_f32_16x16x32_bf16 v[192:195], a[48:51], v[112:115], v[192:195]
v_perm_b32 v102, v42, v40, s51
v_perm_b32 v103, v46, v44, s51
v_mfma_f32_16x16x32_bf16 v[196:199], a[48:51], v[116:119], v[196:199]
ds_read_b128 a[16:19], v9 offset:384
v_mfma_f32_16x16x32_bf16 v[200:203], a[48:51], v[120:123], v[200:203]
v_perm_b32 v104, v35, v33, s50
v_mfma_f32_16x16x32_bf16 v[204:207], a[48:51], v[124:127], v[204:207]
s_add_u32 s38, s34, 2392064
buffer_load_dwordx2 v[88:89], v3, s[20:23], s38 offen
s_waitcnt lgkmcnt(7)
v_mfma_f32_16x16x32_bf16 v[208:211], a[52:55], v[112:115], v[208:211]
v_perm_b32 v105, v39, v37, s50
v_perm_b32 v106, v43, v41, s50
v_mfma_f32_16x16x32_bf16 v[212:215], a[52:55], v[116:119], v[212:215]
ds_read_b128 a[20:23], v9 offset:17024
v_mfma_f32_16x16x32_bf16 v[216:219], a[52:55], v[120:123], v[216:219]
v_perm_b32 v107, v47, v45, s50
v_mfma_f32_16x16x32_bf16 v[220:223], a[52:55], v[124:127], v[220:223]
s_add_u32 s38, s34, 2400256
buffer_load_dwordx2 v[90:91], v3, s[20:23], s38 offen
s_waitcnt lgkmcnt(7)
v_mfma_f32_16x16x32_bf16 v[224:227], a[56:59], v[112:115], v[224:227]
v_perm_b32 v108, v35, v33, s51
v_perm_b32 v109, v39, v37, s51
v_mfma_f32_16x16x32_bf16 v[228:231], a[56:59], v[116:119], v[228:231]
ds_read_b128 a[24:27], v9 offset:33664
v_perm_b32 v110, v43, v41, s51
v_mfma_f32_16x16x32_bf16 v[232:235], a[56:59], v[120:123], v[232:235]
v_perm_b32 v111, v47, v45, s51
v_mfma_f32_16x16x32_bf16 v[236:239], a[56:59], v[124:127], v[236:239]
s_add_u32 s38, s34, 2408448
buffer_load_dwordx2 v[92:93], v3, s[20:23], s38 offen
s_waitcnt lgkmcnt(7)
v_mfma_f32_16x16x32_bf16 v[240:243], a[60:63], v[112:115], v[240:243]
v_mfma_f32_16x16x32_bf16 v[244:247], a[60:63], v[116:119], v[244:247]
ds_read_b128 a[28:31], v9 offset:50304
v_mfma_f32_16x16x32_bf16 v[248:251], a[60:63], v[120:123], v[248:251]
v_mfma_f32_16x16x32_bf16 v[252:255], a[60:63], v[124:127], v[252:255]
s_add_u32 s38, s34, 2416640
buffer_load_dwordx2 v[94:95], v3, s[20:23], s38 offen
s_waitcnt lgkmcnt(7)
v_mfma_f32_16x16x32_bf16 v[128:131], a[0:3], v[96:99], v[128:131]
v_mfma_f32_16x16x32_bf16 v[132:135], a[0:3], v[100:103], v[132:135]
ds_read_b128 a[32:35], v8 offset:448
v_mfma_f32_16x16x32_bf16 v[136:139], a[0:3], v[104:107], v[136:139]
v_mfma_f32_16x16x32_bf16 v[140:143], a[0:3], v[108:111], v[140:143]
s_add_u32 s38, s34, 2621440
buffer_load_dwordx2 v[16:17], v3, s[20:23], s38 offen
s_waitcnt lgkmcnt(7)
v_mfma_f32_16x16x32_bf16 v[144:147], a[4:7], v[96:99], v[144:147]
v_mfma_f32_16x16x32_bf16 v[148:151], a[4:7], v[100:103], v[148:151]
ds_read_b128 a[36:39], v8 offset:17088
v_mfma_f32_16x16x32_bf16 v[152:155], a[4:7], v[104:107], v[152:155]
v_mfma_f32_16x16x32_bf16 v[156:159], a[4:7], v[108:111], v[156:159]
s_add_u32 s38, s34, 2629632
buffer_load_dwordx2 v[18:19], v3, s[20:23], s38 offen
s_waitcnt lgkmcnt(7)
v_mfma_f32_16x16x32_bf16 v[160:163], a[8:11], v[96:99], v[160:163]
s_waitcnt vmcnt(24)
v_perm_b32 v112, v50, v48, s50
s_waitcnt vmcnt(22)
v_perm_b32 v113, v54, v52, s50
v_mfma_f32_16x16x32_bf16 v[164:167], a[8:11], v[100:103], v[164:167]
ds_read_b128 a[40:43], v8 offset:33728
v_mfma_f32_16x16x32_bf16 v[168:171], a[8:11], v[104:107], v[168:171]
s_waitcnt vmcnt(20)
v_perm_b32 v114, v58, v56, s50
v_mfma_f32_16x16x32_bf16 v[172:175], a[8:11], v[108:111], v[172:175]
s_add_u32 s38, s34, 2637824
buffer_load_dwordx2 v[20:21], v3, s[20:23], s38 offen
s_waitcnt lgkmcnt(7)
v_mfma_f32_16x16x32_bf16 v[176:179], a[12:15], v[96:99], v[176:179]
s_waitcnt vmcnt(19)
v_perm_b32 v115, v62, v60, s50
v_perm_b32 v116, v50, v48, s51
v_mfma_f32_16x16x32_bf16 v[180:183], a[12:15], v[100:103], v[180:183]
ds_read_b128 a[44:47], v8 offset:50368
v_mfma_f32_16x16x32_bf16 v[184:187], a[12:15], v[104:107], v[184:187]
v_perm_b32 v117, v54, v52, s51
v_mfma_f32_16x16x32_bf16 v[188:191], a[12:15], v[108:111], v[188:191]
s_add_u32 s38, s34, 2646016
buffer_load_dwordx2 v[22:23], v3, s[20:23], s38 offen
s_waitcnt lgkmcnt(7)
v_mfma_f32_16x16x32_bf16 v[192:195], a[16:19], v[96:99], v[192:195]
v_perm_b32 v118, v58, v56, s51
v_perm_b32 v119, v62, v60, s51
v_mfma_f32_16x16x32_bf16 v[196:199], a[16:19], v[100:103], v[196:199]
ds_read_b128 a[48:51], v9 offset:448
v_mfma_f32_16x16x32_bf16 v[200:203], a[16:19], v[104:107], v[200:203]
v_perm_b32 v120, v51, v49, s50
v_mfma_f32_16x16x32_bf16 v[204:207], a[16:19], v[108:111], v[204:207]
s_add_u32 s38, s34, 2654208
buffer_load_dwordx2 v[24:25], v3, s[20:23], s38 offen
s_waitcnt lgkmcnt(7)
v_mfma_f32_16x16x32_bf16 v[208:211], a[20:23], v[96:99], v[208:211]
v_perm_b32 v121, v55, v53, s50
v_perm_b32 v122, v59, v57, s50
v_mfma_f32_16x16x32_bf16 v[212:215], a[20:23], v[100:103], v[212:215]
ds_read_b128 a[52:55], v9 offset:17088
v_mfma_f32_16x16x32_bf16 v[216:219], a[20:23], v[104:107], v[216:219]
v_perm_b32 v123, v63, v61, s50
v_mfma_f32_16x16x32_bf16 v[220:223], a[20:23], v[108:111], v[220:223]
s_add_u32 s38, s34, 2662400
buffer_load_dwordx2 v[26:27], v3, s[20:23], s38 offen
s_waitcnt lgkmcnt(7)
v_mfma_f32_16x16x32_bf16 v[224:227], a[24:27], v[96:99], v[224:227]
v_perm_b32 v124, v51, v49, s51
v_perm_b32 v125, v55, v53, s51
v_mfma_f32_16x16x32_bf16 v[228:231], a[24:27], v[100:103], v[228:231]
ds_read_b128 a[56:59], v9 offset:33728
v_perm_b32 v126, v59, v57, s51
v_mfma_f32_16x16x32_bf16 v[232:235], a[24:27], v[104:107], v[232:235]
v_perm_b32 v127, v63, v61, s51
v_mfma_f32_16x16x32_bf16 v[236:239], a[24:27], v[108:111], v[236:239]
s_add_u32 s38, s34, 2670592
buffer_load_dwordx2 v[28:29], v3, s[20:23], s38 offen
s_waitcnt lgkmcnt(7)
v_mfma_f32_16x16x32_bf16 v[240:243], a[28:31], v[96:99], v[240:243]
v_mfma_f32_16x16x32_bf16 v[244:247], a[28:31], v[100:103], v[244:247]
ds_read_b128 a[60:63], v9 offset:50368
v_mfma_f32_16x16x32_bf16 v[248:251], a[28:31], v[104:107], v[248:251]
v_mfma_f32_16x16x32_bf16 v[252:255], a[28:31], v[108:111], v[252:255]
s_add_u32 s38, s34, 2678784
buffer_load_dwordx2 v[30:31], v3, s[20:23], s38 offen
s_waitcnt lgkmcnt(7)
v_mfma_f32_16x16x32_bf16 v[128:131], a[32:35], v[112:115], v[128:131]
v_mfma_f32_16x16x32_bf16 v[132:135], a[32:35], v[116:119], v[132:135]
ds_read_b128 a[0:3], v8 offset:512
v_mfma_f32_16x16x32_bf16 v[136:139], a[32:35], v[120:123], v[136:139]
v_mfma_f32_16x16x32_bf16 v[140:143], a[32:35], v[124:127], v[140:143]
s_add_u32 s38, s34, 2883584
buffer_load_dwordx2 v[32:33], v3, s[20:23], s38 offen
s_waitcnt lgkmcnt(7)
v_mfma_f32_16x16x32_bf16 v[144:147], a[36:39], v[112:115], v[144:147]
v_mfma_f32_16x16x32_bf16 v[148:151], a[36:39], v[116:119], v[148:151]
ds_read_b128 a[4:7], v8 offset:17152
v_mfma_f32_16x16x32_bf16 v[152:155], a[36:39], v[120:123], v[152:155]
v_mfma_f32_16x16x32_bf16 v[156:159], a[36:39], v[124:127], v[156:159]
s_add_u32 s38, s34, 2891776
buffer_load_dwordx2 v[34:35], v3, s[20:23], s38 offen
s_waitcnt lgkmcnt(7)
v_mfma_f32_16x16x32_bf16 v[160:163], a[40:43], v[112:115], v[160:163]
s_waitcnt vmcnt(24)
v_perm_b32 v96, v66, v64, s50
s_waitcnt vmcnt(22)
v_perm_b32 v97, v70, v68, s50
v_mfma_f32_16x16x32_bf16 v[164:167], a[40:43], v[116:119], v[164:167]
ds_read_b128 a[8:11], v8 offset:33792
v_mfma_f32_16x16x32_bf16 v[168:171], a[40:43], v[120:123], v[168:171]
s_waitcnt vmcnt(20)
v_perm_b32 v98, v74, v72, s50
v_mfma_f32_16x16x32_bf16 v[172:175], a[40:43], v[124:127], v[172:175]
s_add_u32 s38, s34, 2899968
buffer_load_dwordx2 v[36:37], v3, s[20:23], s38 offen
s_waitcnt lgkmcnt(7)
v_mfma_f32_16x16x32_bf16 v[176:179], a[44:47], v[112:115], v[176:179]
s_waitcnt vmcnt(19)
v_perm_b32 v99, v78, v76, s50
v_perm_b32 v100, v66, v64, s51
v_mfma_f32_16x16x32_bf16 v[180:183], a[44:47], v[116:119], v[180:183]
ds_read_b128 a[12:15], v8 offset:50432
v_mfma_f32_16x16x32_bf16 v[184:187], a[44:47], v[120:123], v[184:187]
v_perm_b32 v101, v70, v68, s51
v_mfma_f32_16x16x32_bf16 v[188:191], a[44:47], v[124:127], v[188:191]
s_add_u32 s38, s34, 2908160
buffer_load_dwordx2 v[38:39], v3, s[20:23], s38 offen
s_waitcnt lgkmcnt(7)
v_mfma_f32_16x16x32_bf16 v[192:195], a[48:51], v[112:115], v[192:195]
v_perm_b32 v102, v74, v72, s51
v_perm_b32 v103, v78, v76, s51
v_mfma_f32_16x16x32_bf16 v[196:199], a[48:51], v[116:119], v[196:199]
ds_read_b128 a[16:19], v9 offset:512
v_mfma_f32_16x16x32_bf16 v[200:203], a[48:51], v[120:123], v[200:203]
v_perm_b32 v104, v67, v65, s50
v_mfma_f32_16x16x32_bf16 v[204:207], a[48:51], v[124:127], v[204:207]
s_add_u32 s38, s34, 2916352
buffer_load_dwordx2 v[40:41], v3, s[20:23], s38 offen
s_waitcnt lgkmcnt(7)
v_mfma_f32_16x16x32_bf16 v[208:211], a[52:55], v[112:115], v[208:211]
v_perm_b32 v105, v71, v69, s50
v_perm_b32 v106, v75, v73, s50
v_mfma_f32_16x16x32_bf16 v[212:215], a[52:55], v[116:119], v[212:215]
ds_read_b128 a[20:23], v9 offset:17152
v_mfma_f32_16x16x32_bf16 v[216:219], a[52:55], v[120:123], v[216:219]
v_perm_b32 v107, v79, v77, s50
v_mfma_f32_16x16x32_bf16 v[220:223], a[52:55], v[124:127], v[220:223]
s_add_u32 s38, s34, 2924544
buffer_load_dwordx2 v[42:43], v3, s[20:23], s38 offen
s_waitcnt lgkmcnt(7)
v_mfma_f32_16x16x32_bf16 v[224:227], a[56:59], v[112:115], v[224:227]
v_perm_b32 v108, v67, v65, s51
v_perm_b32 v109, v71, v69, s51
v_mfma_f32_16x16x32_bf16 v[228:231], a[56:59], v[116:119], v[228:231]
ds_read_b128 a[24:27], v9 offset:33792
v_perm_b32 v110, v75, v73, s51
v_mfma_f32_16x16x32_bf16 v[232:235], a[56:59], v[120:123], v[232:235]
v_perm_b32 v111, v79, v77, s51
v_mfma_f32_16x16x32_bf16 v[236:239], a[56:59], v[124:127], v[236:239]
s_add_u32 s38, s34, 2932736
buffer_load_dwordx2 v[44:45], v3, s[20:23], s38 offen
s_waitcnt lgkmcnt(7)
v_mfma_f32_16x16x32_bf16 v[240:243], a[60:63], v[112:115], v[240:243]
v_mfma_f32_16x16x32_bf16 v[244:247], a[60:63], v[116:119], v[244:247]
ds_read_b128 a[28:31], v9 offset:50432
v_mfma_f32_16x16x32_bf16 v[248:251], a[60:63], v[120:123], v[248:251]
v_mfma_f32_16x16x32_bf16 v[252:255], a[60:63], v[124:127], v[252:255]
s_add_u32 s38, s34, 2940928
buffer_load_dwordx2 v[46:47], v3, s[20:23], s38 offen
s_waitcnt lgkmcnt(7)
v_mfma_f32_16x16x32_bf16 v[128:131], a[0:3], v[96:99], v[128:131]
v_mfma_f32_16x16x32_bf16 v[132:135], a[0:3], v[100:103], v[132:135]
ds_read_b128 a[32:35], v8 offset:576
v_mfma_f32_16x16x32_bf16 v[136:139], a[0:3], v[104:107], v[136:139]
v_mfma_f32_16x16x32_bf16 v[140:143], a[0:3], v[108:111], v[140:143]
s_add_u32 s38, s34, 3145728
buffer_load_dwordx2 v[48:49], v3, s[20:23], s38 offen
s_waitcnt lgkmcnt(7)
v_mfma_f32_16x16x32_bf16 v[144:147], a[4:7], v[96:99], v[144:147]
v_mfma_f32_16x16x32_bf16 v[148:151], a[4:7], v[100:103], v[148:151]
ds_read_b128 a[36:39], v8 offset:17216
v_mfma_f32_16x16x32_bf16 v[152:155], a[4:7], v[104:107], v[152:155]
v_mfma_f32_16x16x32_bf16 v[156:159], a[4:7], v[108:111], v[156:159]
s_add_u32 s38, s34, 3153920
buffer_load_dwordx2 v[50:51], v3, s[20:23], s38 offen
s_waitcnt lgkmcnt(7)
v_mfma_f32_16x16x32_bf16 v[160:163], a[8:11], v[96:99], v[160:163]
s_waitcnt vmcnt(24)
v_perm_b32 v112, v82, v80, s50
s_waitcnt vmcnt(22)
v_perm_b32 v113, v86, v84, s50
v_mfma_f32_16x16x32_bf16 v[164:167], a[8:11], v[100:103], v[164:167]
ds_read_b128 a[40:43], v8 offset:33856
v_mfma_f32_16x16x32_bf16 v[168:171], a[8:11], v[104:107], v[168:171]
s_waitcnt vmcnt(20)
v_perm_b32 v114, v90, v88, s50
v_mfma_f32_16x16x32_bf16 v[172:175], a[8:11], v[108:111], v[172:175]
s_add_u32 s38, s34, 3162112
buffer_load_dwordx2 v[52:53], v3, s[20:23], s38 offen
s_waitcnt lgkmcnt(7)
v_mfma_f32_16x16x32_bf16 v[176:179], a[12:15], v[96:99], v[176:179]
s_waitcnt vmcnt(19)
v_perm_b32 v115, v94, v92, s50
v_perm_b32 v116, v82, v80, s51
v_mfma_f32_16x16x32_bf16 v[180:183], a[12:15], v[100:103], v[180:183]
ds_read_b128 a[44:47], v8 offset:50496
v_mfma_f32_16x16x32_bf16 v[184:187], a[12:15], v[104:107], v[184:187]
v_perm_b32 v117, v86, v84, s51
v_mfma_f32_16x16x32_bf16 v[188:191], a[12:15], v[108:111], v[188:191]
s_add_u32 s38, s34, 3170304
buffer_load_dwordx2 v[54:55], v3, s[20:23], s38 offen
s_waitcnt lgkmcnt(7)
v_mfma_f32_16x16x32_bf16 v[192:195], a[16:19], v[96:99], v[192:195]
v_perm_b32 v118, v90, v88, s51
v_perm_b32 v119, v94, v92, s51
v_mfma_f32_16x16x32_bf16 v[196:199], a[16:19], v[100:103], v[196:199]
ds_read_b128 a[48:51], v9 offset:576
v_mfma_f32_16x16x32_bf16 v[200:203], a[16:19], v[104:107], v[200:203]
v_perm_b32 v120, v83, v81, s50
v_mfma_f32_16x16x32_bf16 v[204:207], a[16:19], v[108:111], v[204:207]
s_add_u32 s38, s34, 3178496
buffer_load_dwordx2 v[56:57], v3, s[20:23], s38 offen
s_waitcnt lgkmcnt(7)
v_mfma_f32_16x16x32_bf16 v[208:211], a[20:23], v[96:99], v[208:211]
v_perm_b32 v121, v87, v85, s50
v_perm_b32 v122, v91, v89, s50
v_mfma_f32_16x16x32_bf16 v[212:215], a[20:23], v[100:103], v[212:215]
ds_read_b128 a[52:55], v9 offset:17216
v_mfma_f32_16x16x32_bf16 v[216:219], a[20:23], v[104:107], v[216:219]
v_perm_b32 v123, v95, v93, s50
v_mfma_f32_16x16x32_bf16 v[220:223], a[20:23], v[108:111], v[220:223]
s_add_u32 s38, s34, 3186688
buffer_load_dwordx2 v[58:59], v3, s[20:23], s38 offen
s_waitcnt lgkmcnt(7)
v_mfma_f32_16x16x32_bf16 v[224:227], a[24:27], v[96:99], v[224:227]
v_perm_b32 v124, v83, v81, s51
v_perm_b32 v125, v87, v85, s51
v_mfma_f32_16x16x32_bf16 v[228:231], a[24:27], v[100:103], v[228:231]
ds_read_b128 a[56:59], v9 offset:33856
v_perm_b32 v126, v91, v89, s51
v_mfma_f32_16x16x32_bf16 v[232:235], a[24:27], v[104:107], v[232:235]
v_perm_b32 v127, v95, v93, s51
v_mfma_f32_16x16x32_bf16 v[236:239], a[24:27], v[108:111], v[236:239]
s_add_u32 s38, s34, 3194880
buffer_load_dwordx2 v[60:61], v3, s[20:23], s38 offen
s_waitcnt lgkmcnt(7)
v_mfma_f32_16x16x32_bf16 v[240:243], a[28:31], v[96:99], v[240:243]
v_mfma_f32_16x16x32_bf16 v[244:247], a[28:31], v[100:103], v[244:247]
ds_read_b128 a[60:63], v9 offset:50496
v_mfma_f32_16x16x32_bf16 v[248:251], a[28:31], v[104:107], v[248:251]
v_mfma_f32_16x16x32_bf16 v[252:255], a[28:31], v[108:111], v[252:255]
s_add_u32 s38, s34, 3203072
buffer_load_dwordx2 v[62:63], v3, s[20:23], s38 offen
s_waitcnt lgkmcnt(7)
v_mfma_f32_16x16x32_bf16 v[128:131], a[32:35], v[112:115], v[128:131]
v_mfma_f32_16x16x32_bf16 v[132:135], a[32:35], v[116:119], v[132:135]
ds_read_b128 a[0:3], v8 offset:640
v_mfma_f32_16x16x32_bf16 v[136:139], a[32:35], v[120:123], v[136:139]
v_mfma_f32_16x16x32_bf16 v[140:143], a[32:35], v[124:127], v[140:143]
s_add_u32 s38, s34, 3407872
buffer_load_dwordx2 v[64:65], v3, s[20:23], s38 offen
s_waitcnt lgkmcnt(7)
v_mfma_f32_16x16x32_bf16 v[144:147], a[36:39], v[112:115], v[144:147]
v_mfma_f32_16x16x32_bf16 v[148:151], a[36:39], v[116:119], v[148:151]
ds_read_b128 a[4:7], v8 offset:17280
v_mfma_f32_16x16x32_bf16 v[152:155], a[36:39], v[120:123], v[152:155]
v_mfma_f32_16x16x32_bf16 v[156:159], a[36:39], v[124:127], v[156:159]
s_add_u32 s38, s34, 3416064
buffer_load_dwordx2 v[66:67], v3, s[20:23], s38 offen
s_waitcnt lgkmcnt(7)
v_mfma_f32_16x16x32_bf16 v[160:163], a[40:43], v[112:115], v[160:163]
s_waitcnt vmcnt(24)
v_perm_b32 v96, v18, v16, s50
s_waitcnt vmcnt(22)
v_perm_b32 v97, v22, v20, s50
v_mfma_f32_16x16x32_bf16 v[164:167], a[40:43], v[116:119], v[164:167]
ds_read_b128 a[8:11], v8 offset:33920
v_mfma_f32_16x16x32_bf16 v[168:171], a[40:43], v[120:123], v[168:171]
s_waitcnt vmcnt(20)
v_perm_b32 v98, v26, v24, s50
v_mfma_f32_16x16x32_bf16 v[172:175], a[40:43], v[124:127], v[172:175]
s_add_u32 s38, s34, 3424256
buffer_load_dwordx2 v[68:69], v3, s[20:23], s38 offen
s_waitcnt lgkmcnt(7)
v_mfma_f32_16x16x32_bf16 v[176:179], a[44:47], v[112:115], v[176:179]
s_waitcnt vmcnt(19)
v_perm_b32 v99, v30, v28, s50
v_perm_b32 v100, v18, v16, s51
v_mfma_f32_16x16x32_bf16 v[180:183], a[44:47], v[116:119], v[180:183]
ds_read_b128 a[12:15], v8 offset:50560
v_mfma_f32_16x16x32_bf16 v[184:187], a[44:47], v[120:123], v[184:187]
v_perm_b32 v101, v22, v20, s51
v_mfma_f32_16x16x32_bf16 v[188:191], a[44:47], v[124:127], v[188:191]
s_add_u32 s38, s34, 3432448
buffer_load_dwordx2 v[70:71], v3, s[20:23], s38 offen
s_waitcnt lgkmcnt(7)
v_mfma_f32_16x16x32_bf16 v[192:195], a[48:51], v[112:115], v[192:195]
v_perm_b32 v102, v26, v24, s51
v_perm_b32 v103, v30, v28, s51
v_mfma_f32_16x16x32_bf16 v[196:199], a[48:51], v[116:119], v[196:199]
ds_read_b128 a[16:19], v9 offset:640
v_mfma_f32_16x16x32_bf16 v[200:203], a[48:51], v[120:123], v[200:203]
v_perm_b32 v104, v19, v17, s50
v_mfma_f32_16x16x32_bf16 v[204:207], a[48:51], v[124:127], v[204:207]
s_add_u32 s38, s34, 3440640
buffer_load_dwordx2 v[72:73], v3, s[20:23], s38 offen
s_waitcnt lgkmcnt(7)
v_mfma_f32_16x16x32_bf16 v[208:211], a[52:55], v[112:115], v[208:211]
v_perm_b32 v105, v23, v21, s50
v_perm_b32 v106, v27, v25, s50
v_mfma_f32_16x16x32_bf16 v[212:215], a[52:55], v[116:119], v[212:215]
ds_read_b128 a[20:23], v9 offset:17280
v_mfma_f32_16x16x32_bf16 v[216:219], a[52:55], v[120:123], v[216:219]
v_perm_b32 v107, v31, v29, s50
v_mfma_f32_16x16x32_bf16 v[220:223], a[52:55], v[124:127], v[220:223]
s_add_u32 s38, s34, 3448832
buffer_load_dwordx2 v[74:75], v3, s[20:23], s38 offen
s_waitcnt lgkmcnt(7)
v_mfma_f32_16x16x32_bf16 v[224:227], a[56:59], v[112:115], v[224:227]
v_perm_b32 v108, v19, v17, s51
v_perm_b32 v109, v23, v21, s51
v_mfma_f32_16x16x32_bf16 v[228:231], a[56:59], v[116:119], v[228:231]
ds_read_b128 a[24:27], v9 offset:33920
v_perm_b32 v110, v27, v25, s51
v_mfma_f32_16x16x32_bf16 v[232:235], a[56:59], v[120:123], v[232:235]
v_perm_b32 v111, v31, v29, s51
v_mfma_f32_16x16x32_bf16 v[236:239], a[56:59], v[124:127], v[236:239]
s_add_u32 s38, s34, 3457024
buffer_load_dwordx2 v[76:77], v3, s[20:23], s38 offen
s_waitcnt lgkmcnt(7)
v_mfma_f32_16x16x32_bf16 v[240:243], a[60:63], v[112:115], v[240:243]
v_mfma_f32_16x16x32_bf16 v[244:247], a[60:63], v[116:119], v[244:247]
ds_read_b128 a[28:31], v9 offset:50560
v_mfma_f32_16x16x32_bf16 v[248:251], a[60:63], v[120:123], v[248:251]
v_mfma_f32_16x16x32_bf16 v[252:255], a[60:63], v[124:127], v[252:255]
s_add_u32 s38, s34, 3465216
buffer_load_dwordx2 v[78:79], v3, s[20:23], s38 offen
s_waitcnt lgkmcnt(7)
v_mfma_f32_16x16x32_bf16 v[128:131], a[0:3], v[96:99], v[128:131]
v_mfma_f32_16x16x32_bf16 v[132:135], a[0:3], v[100:103], v[132:135]
ds_read_b128 a[32:35], v8 offset:704
v_mfma_f32_16x16x32_bf16 v[136:139], a[0:3], v[104:107], v[136:139]
v_mfma_f32_16x16x32_bf16 v[140:143], a[0:3], v[108:111], v[140:143]
s_add_u32 s38, s34, 3670016
buffer_load_dwordx2 v[80:81], v3, s[20:23], s38 offen
s_waitcnt lgkmcnt(7)
v_mfma_f32_16x16x32_bf16 v[144:147], a[4:7], v[96:99], v[144:147]
v_mfma_f32_16x16x32_bf16 v[148:151], a[4:7], v[100:103], v[148:151]
ds_read_b128 a[36:39], v8 offset:17344
v_mfma_f32_16x16x32_bf16 v[152:155], a[4:7], v[104:107], v[152:155]
v_mfma_f32_16x16x32_bf16 v[156:159], a[4:7], v[108:111], v[156:159]
s_add_u32 s38, s34, 3678208
buffer_load_dwordx2 v[82:83], v3, s[20:23], s38 offen
s_waitcnt lgkmcnt(7)
v_mfma_f32_16x16x32_bf16 v[160:163], a[8:11], v[96:99], v[160:163]
s_waitcnt vmcnt(24)
v_perm_b32 v112, v34, v32, s50
s_waitcnt vmcnt(22)
v_perm_b32 v113, v38, v36, s50
v_mfma_f32_16x16x32_bf16 v[164:167], a[8:11], v[100:103], v[164:167]
ds_read_b128 a[40:43], v8 offset:33984
v_mfma_f32_16x16x32_bf16 v[168:171], a[8:11], v[104:107], v[168:171]
s_waitcnt vmcnt(20)
v_perm_b32 v114, v42, v40, s50
v_mfma_f32_16x16x32_bf16 v[172:175], a[8:11], v[108:111], v[172:175]
s_add_u32 s38, s34, 3686400
buffer_load_dwordx2 v[84:85], v3, s[20:23], s38 offen
s_waitcnt lgkmcnt(7)
v_mfma_f32_16x16x32_bf16 v[176:179], a[12:15], v[96:99], v[176:179]
s_waitcnt vmcnt(19)
v_perm_b32 v115, v46, v44, s50
v_perm_b32 v116, v34, v32, s51
v_mfma_f32_16x16x32_bf16 v[180:183], a[12:15], v[100:103], v[180:183]
ds_read_b128 a[44:47], v8 offset:50624
v_mfma_f32_16x16x32_bf16 v[184:187], a[12:15], v[104:107], v[184:187]
v_perm_b32 v117, v38, v36, s51
v_mfma_f32_16x16x32_bf16 v[188:191], a[12:15], v[108:111], v[188:191]
s_add_u32 s38, s34, 3694592
buffer_load_dwordx2 v[86:87], v3, s[20:23], s38 offen
s_waitcnt lgkmcnt(7)
v_mfma_f32_16x16x32_bf16 v[192:195], a[16:19], v[96:99], v[192:195]
v_perm_b32 v118, v42, v40, s51
v_perm_b32 v119, v46, v44, s51
v_mfma_f32_16x16x32_bf16 v[196:199], a[16:19], v[100:103], v[196:199]
ds_read_b128 a[48:51], v9 offset:704
v_mfma_f32_16x16x32_bf16 v[200:203], a[16:19], v[104:107], v[200:203]
v_perm_b32 v120, v35, v33, s50
v_mfma_f32_16x16x32_bf16 v[204:207], a[16:19], v[108:111], v[204:207]
s_add_u32 s38, s34, 3702784
buffer_load_dwordx2 v[88:89], v3, s[20:23], s38 offen
s_waitcnt lgkmcnt(7)
v_mfma_f32_16x16x32_bf16 v[208:211], a[20:23], v[96:99], v[208:211]
v_perm_b32 v121, v39, v37, s50
v_perm_b32 v122, v43, v41, s50
v_mfma_f32_16x16x32_bf16 v[212:215], a[20:23], v[100:103], v[212:215]
ds_read_b128 a[52:55], v9 offset:17344
v_mfma_f32_16x16x32_bf16 v[216:219], a[20:23], v[104:107], v[216:219]
v_perm_b32 v123, v47, v45, s50
v_mfma_f32_16x16x32_bf16 v[220:223], a[20:23], v[108:111], v[220:223]
s_add_u32 s38, s34, 3710976
buffer_load_dwordx2 v[90:91], v3, s[20:23], s38 offen
s_waitcnt lgkmcnt(7)
v_mfma_f32_16x16x32_bf16 v[224:227], a[24:27], v[96:99], v[224:227]
v_perm_b32 v124, v35, v33, s51
v_perm_b32 v125, v39, v37, s51
v_mfma_f32_16x16x32_bf16 v[228:231], a[24:27], v[100:103], v[228:231]
ds_read_b128 a[56:59], v9 offset:33984
v_perm_b32 v126, v43, v41, s51
v_mfma_f32_16x16x32_bf16 v[232:235], a[24:27], v[104:107], v[232:235]
v_perm_b32 v127, v47, v45, s51
v_mfma_f32_16x16x32_bf16 v[236:239], a[24:27], v[108:111], v[236:239]
s_add_u32 s38, s34, 3719168
buffer_load_dwordx2 v[92:93], v3, s[20:23], s38 offen
s_waitcnt lgkmcnt(7)
v_mfma_f32_16x16x32_bf16 v[240:243], a[28:31], v[96:99], v[240:243]
v_mfma_f32_16x16x32_bf16 v[244:247], a[28:31], v[100:103], v[244:247]
ds_read_b128 a[60:63], v9 offset:50624
v_mfma_f32_16x16x32_bf16 v[248:251], a[28:31], v[104:107], v[248:251]
v_mfma_f32_16x16x32_bf16 v[252:255], a[28:31], v[108:111], v[252:255]
s_add_u32 s38, s34, 3727360
buffer_load_dwordx2 v[94:95], v3, s[20:23], s38 offen
s_waitcnt lgkmcnt(7)
v_mfma_f32_16x16x32_bf16 v[128:131], a[32:35], v[112:115], v[128:131]
v_mfma_f32_16x16x32_bf16 v[132:135], a[32:35], v[116:119], v[132:135]
ds_read_b128 a[0:3], v8 offset:768
v_mfma_f32_16x16x32_bf16 v[136:139], a[32:35], v[120:123], v[136:139]
v_mfma_f32_16x16x32_bf16 v[140:143], a[32:35], v[124:127], v[140:143]
s_add_u32 s38, s34, 3932160
buffer_load_dwordx2 v[16:17], v3, s[20:23], s38 offen
s_waitcnt lgkmcnt(7)
v_mfma_f32_16x16x32_bf16 v[144:147], a[36:39], v[112:115], v[144:147]
v_mfma_f32_16x16x32_bf16 v[148:151], a[36:39], v[116:119], v[148:151]
ds_read_b128 a[4:7], v8 offset:17408
v_mfma_f32_16x16x32_bf16 v[152:155], a[36:39], v[120:123], v[152:155]
v_mfma_f32_16x16x32_bf16 v[156:159], a[36:39], v[124:127], v[156:159]
s_add_u32 s38, s34, 3940352
buffer_load_dwordx2 v[18:19], v3, s[20:23], s38 offen
s_waitcnt lgkmcnt(7)
v_mfma_f32_16x16x32_bf16 v[160:163], a[40:43], v[112:115], v[160:163]
s_waitcnt vmcnt(24)
v_perm_b32 v96, v50, v48, s50
s_waitcnt vmcnt(22)
v_perm_b32 v97, v54, v52, s50
v_mfma_f32_16x16x32_bf16 v[164:167], a[40:43], v[116:119], v[164:167]
ds_read_b128 a[8:11], v8 offset:34048
v_mfma_f32_16x16x32_bf16 v[168:171], a[40:43], v[120:123], v[168:171]
s_waitcnt vmcnt(20)
v_perm_b32 v98, v58, v56, s50
v_mfma_f32_16x16x32_bf16 v[172:175], a[40:43], v[124:127], v[172:175]
s_add_u32 s38, s34, 3948544
buffer_load_dwordx2 v[20:21], v3, s[20:23], s38 offen
s_waitcnt lgkmcnt(7)
v_mfma_f32_16x16x32_bf16 v[176:179], a[44:47], v[112:115], v[176:179]
s_waitcnt vmcnt(19)
v_perm_b32 v99, v62, v60, s50
v_perm_b32 v100, v50, v48, s51
v_mfma_f32_16x16x32_bf16 v[180:183], a[44:47], v[116:119], v[180:183]
ds_read_b128 a[12:15], v8 offset:50688
v_mfma_f32_16x16x32_bf16 v[184:187], a[44:47], v[120:123], v[184:187]
v_perm_b32 v101, v54, v52, s51
v_mfma_f32_16x16x32_bf16 v[188:191], a[44:47], v[124:127], v[188:191]
s_add_u32 s38, s34, 3956736
buffer_load_dwordx2 v[22:23], v3, s[20:23], s38 offen
s_waitcnt lgkmcnt(7)
v_mfma_f32_16x16x32_bf16 v[192:195], a[48:51], v[112:115], v[192:195]
v_perm_b32 v102, v58, v56, s51
v_perm_b32 v103, v62, v60, s51
v_mfma_f32_16x16x32_bf16 v[196:199], a[48:51], v[116:119], v[196:199]
ds_read_b128 a[16:19], v9 offset:768
v_mfma_f32_16x16x32_bf16 v[200:203], a[48:51], v[120:123], v[200:203]
v_perm_b32 v104, v51, v49, s50
v_mfma_f32_16x16x32_bf16 v[204:207], a[48:51], v[124:127], v[204:207]
s_add_u32 s38, s34, 3964928
buffer_load_dwordx2 v[24:25], v3, s[20:23], s38 offen
s_waitcnt lgkmcnt(7)
v_mfma_f32_16x16x32_bf16 v[208:211], a[52:55], v[112:115], v[208:211]
v_perm_b32 v105, v55, v53, s50
v_perm_b32 v106, v59, v57, s50
v_mfma_f32_16x16x32_bf16 v[212:215], a[52:55], v[116:119], v[212:215]
ds_read_b128 a[20:23], v9 offset:17408
v_mfma_f32_16x16x32_bf16 v[216:219], a[52:55], v[120:123], v[216:219]
v_perm_b32 v107, v63, v61, s50
v_mfma_f32_16x16x32_bf16 v[220:223], a[52:55], v[124:127], v[220:223]
s_add_u32 s38, s34, 3973120
buffer_load_dwordx2 v[26:27], v3, s[20:23], s38 offen
s_waitcnt lgkmcnt(7)
v_mfma_f32_16x16x32_bf16 v[224:227], a[56:59], v[112:115], v[224:227]
v_perm_b32 v108, v51, v49, s51
v_perm_b32 v109, v55, v53, s51
v_mfma_f32_16x16x32_bf16 v[228:231], a[56:59], v[116:119], v[228:231]
ds_read_b128 a[24:27], v9 offset:34048
v_perm_b32 v110, v59, v57, s51
v_mfma_f32_16x16x32_bf16 v[232:235], a[56:59], v[120:123], v[232:235]
v_perm_b32 v111, v63, v61, s51
v_mfma_f32_16x16x32_bf16 v[236:239], a[56:59], v[124:127], v[236:239]
s_add_u32 s38, s34, 3981312
buffer_load_dwordx2 v[28:29], v3, s[20:23], s38 offen
s_waitcnt lgkmcnt(7)
v_mfma_f32_16x16x32_bf16 v[240:243], a[60:63], v[112:115], v[240:243]
v_mfma_f32_16x16x32_bf16 v[244:247], a[60:63], v[116:119], v[244:247]
ds_read_b128 a[28:31], v9 offset:50688
v_mfma_f32_16x16x32_bf16 v[248:251], a[60:63], v[120:123], v[248:251]
v_mfma_f32_16x16x32_bf16 v[252:255], a[60:63], v[124:127], v[252:255]
s_add_u32 s38, s34, 3989504
buffer_load_dwordx2 v[30:31], v3, s[20:23], s38 offen
s_waitcnt lgkmcnt(7)
v_mfma_f32_16x16x32_bf16 v[128:131], a[0:3], v[96:99], v[128:131]
v_mfma_f32_16x16x32_bf16 v[132:135], a[0:3], v[100:103], v[132:135]
ds_read_b128 a[32:35], v8 offset:832
v_mfma_f32_16x16x32_bf16 v[136:139], a[0:3], v[104:107], v[136:139]
v_mfma_f32_16x16x32_bf16 v[140:143], a[0:3], v[108:111], v[140:143]
s_waitcnt lgkmcnt(7)
v_mfma_f32_16x16x32_bf16 v[144:147], a[4:7], v[96:99], v[144:147]
v_mfma_f32_16x16x32_bf16 v[148:151], a[4:7], v[100:103], v[148:151]
ds_read_b128 a[36:39], v8 offset:17472
v_mfma_f32_16x16x32_bf16 v[152:155], a[4:7], v[104:107], v[152:155]
v_mfma_f32_16x16x32_bf16 v[156:159], a[4:7], v[108:111], v[156:159]
s_waitcnt lgkmcnt(7)
v_mfma_f32_16x16x32_bf16 v[160:163], a[8:11], v[96:99], v[160:163]
s_waitcnt vmcnt(22)
v_perm_b32 v112, v66, v64, s50
s_waitcnt vmcnt(20)
v_perm_b32 v113, v70, v68, s50
v_mfma_f32_16x16x32_bf16 v[164:167], a[8:11], v[100:103], v[164:167]
ds_read_b128 a[40:43], v8 offset:34112
v_mfma_f32_16x16x32_bf16 v[168:171], a[8:11], v[104:107], v[168:171]
s_waitcnt vmcnt(18)
v_perm_b32 v114, v74, v72, s50
v_mfma_f32_16x16x32_bf16 v[172:175], a[8:11], v[108:111], v[172:175]
s_waitcnt lgkmcnt(7)
v_mfma_f32_16x16x32_bf16 v[176:179], a[12:15], v[96:99], v[176:179]
s_waitcnt vmcnt(16)
v_perm_b32 v115, v78, v76, s50
v_perm_b32 v116, v66, v64, s51
v_mfma_f32_16x16x32_bf16 v[180:183], a[12:15], v[100:103], v[180:183]
ds_read_b128 a[44:47], v8 offset:50752
v_mfma_f32_16x16x32_bf16 v[184:187], a[12:15], v[104:107], v[184:187]
v_perm_b32 v117, v70, v68, s51
v_mfma_f32_16x16x32_bf16 v[188:191], a[12:15], v[108:111], v[188:191]
s_waitcnt lgkmcnt(7)
v_mfma_f32_16x16x32_bf16 v[192:195], a[16:19], v[96:99], v[192:195]
v_perm_b32 v118, v74, v72, s51
v_perm_b32 v119, v78, v76, s51
v_mfma_f32_16x16x32_bf16 v[196:199], a[16:19], v[100:103], v[196:199]
ds_read_b128 a[48:51], v9 offset:832
v_mfma_f32_16x16x32_bf16 v[200:203], a[16:19], v[104:107], v[200:203]
v_perm_b32 v120, v67, v65, s50
v_mfma_f32_16x16x32_bf16 v[204:207], a[16:19], v[108:111], v[204:207]
s_waitcnt lgkmcnt(7)
v_mfma_f32_16x16x32_bf16 v[208:211], a[20:23], v[96:99], v[208:211]
v_perm_b32 v121, v71, v69, s50
v_perm_b32 v122, v75, v73, s50
v_mfma_f32_16x16x32_bf16 v[212:215], a[20:23], v[100:103], v[212:215]
ds_read_b128 a[52:55], v9 offset:17472
v_mfma_f32_16x16x32_bf16 v[216:219], a[20:23], v[104:107], v[216:219]
v_perm_b32 v123, v79, v77, s50
v_mfma_f32_16x16x32_bf16 v[220:223], a[20:23], v[108:111], v[220:223]
s_waitcnt lgkmcnt(7)
v_mfma_f32_16x16x32_bf16 v[224:227], a[24:27], v[96:99], v[224:227]
v_perm_b32 v124, v67, v65, s51
v_perm_b32 v125, v71, v69, s51
v_mfma_f32_16x16x32_bf16 v[228:231], a[24:27], v[100:103], v[228:231]
ds_read_b128 a[56:59], v9 offset:34112
v_perm_b32 v126, v75, v73, s51
v_mfma_f32_16x16x32_bf16 v[232:235], a[24:27], v[104:107], v[232:235]
v_perm_b32 v127, v79, v77, s51
v_mfma_f32_16x16x32_bf16 v[236:239], a[24:27], v[108:111], v[236:239]
s_waitcnt lgkmcnt(7)
v_mfma_f32_16x16x32_bf16 v[240:243], a[28:31], v[96:99], v[240:243]
v_mfma_f32_16x16x32_bf16 v[244:247], a[28:31], v[100:103], v[244:247]
ds_read_b128 a[60:63], v9 offset:50752
v_mfma_f32_16x16x32_bf16 v[248:251], a[28:31], v[104:107], v[248:251]
v_mfma_f32_16x16x32_bf16 v[252:255], a[28:31], v[108:111], v[252:255]
s_waitcnt lgkmcnt(7)
v_mfma_f32_16x16x32_bf16 v[128:131], a[32:35], v[112:115], v[128:131]
v_mfma_f32_16x16x32_bf16 v[132:135], a[32:35], v[116:119], v[132:135]
ds_read_b128 a[0:3], v8 offset:896
v_mfma_f32_16x16x32_bf16 v[136:139], a[32:35], v[120:123], v[136:139]
v_mfma_f32_16x16x32_bf16 v[140:143], a[32:35], v[124:127], v[140:143]
s_waitcnt lgkmcnt(7)
v_mfma_f32_16x16x32_bf16 v[144:147], a[36:39], v[112:115], v[144:147]
v_mfma_f32_16x16x32_bf16 v[148:151], a[36:39], v[116:119], v[148:151]
ds_read_b128 a[4:7], v8 offset:17536
v_mfma_f32_16x16x32_bf16 v[152:155], a[36:39], v[120:123], v[152:155]
v_mfma_f32_16x16x32_bf16 v[156:159], a[36:39], v[124:127], v[156:159]
s_waitcnt lgkmcnt(7)
v_mfma_f32_16x16x32_bf16 v[160:163], a[40:43], v[112:115], v[160:163]
s_waitcnt vmcnt(14)
v_perm_b32 v96, v82, v80, s50
s_waitcnt vmcnt(12)
v_perm_b32 v97, v86, v84, s50
v_mfma_f32_16x16x32_bf16 v[164:167], a[40:43], v[116:119], v[164:167]
ds_read_b128 a[8:11], v8 offset:34176
v_mfma_f32_16x16x32_bf16 v[168:171], a[40:43], v[120:123], v[168:171]
s_waitcnt vmcnt(10)
v_perm_b32 v98, v90, v88, s50
v_mfma_f32_16x16x32_bf16 v[172:175], a[40:43], v[124:127], v[172:175]
s_waitcnt lgkmcnt(7)
v_mfma_f32_16x16x32_bf16 v[176:179], a[44:47], v[112:115], v[176:179]
s_waitcnt vmcnt(8)
v_perm_b32 v99, v94, v92, s50
v_perm_b32 v100, v82, v80, s51
v_mfma_f32_16x16x32_bf16 v[180:183], a[44:47], v[116:119], v[180:183]
ds_read_b128 a[12:15], v8 offset:50816
v_mfma_f32_16x16x32_bf16 v[184:187], a[44:47], v[120:123], v[184:187]
v_perm_b32 v101, v86, v84, s51
v_mfma_f32_16x16x32_bf16 v[188:191], a[44:47], v[124:127], v[188:191]
s_waitcnt lgkmcnt(7)
v_mfma_f32_16x16x32_bf16 v[192:195], a[48:51], v[112:115], v[192:195]
v_perm_b32 v102, v90, v88, s51
v_perm_b32 v103, v94, v92, s51
v_mfma_f32_16x16x32_bf16 v[196:199], a[48:51], v[116:119], v[196:199]
ds_read_b128 a[16:19], v9 offset:896
v_mfma_f32_16x16x32_bf16 v[200:203], a[48:51], v[120:123], v[200:203]
v_perm_b32 v104, v83, v81, s50
v_mfma_f32_16x16x32_bf16 v[204:207], a[48:51], v[124:127], v[204:207]
s_waitcnt lgkmcnt(7)
v_mfma_f32_16x16x32_bf16 v[208:211], a[52:55], v[112:115], v[208:211]
v_perm_b32 v105, v87, v85, s50
v_perm_b32 v106, v91, v89, s50
v_mfma_f32_16x16x32_bf16 v[212:215], a[52:55], v[116:119], v[212:215]
ds_read_b128 a[20:23], v9 offset:17536
v_mfma_f32_16x16x32_bf16 v[216:219], a[52:55], v[120:123], v[216:219]
v_perm_b32 v107, v95, v93, s50
v_mfma_f32_16x16x32_bf16 v[220:223], a[52:55], v[124:127], v[220:223]
s_waitcnt lgkmcnt(7)
v_mfma_f32_16x16x32_bf16 v[224:227], a[56:59], v[112:115], v[224:227]
v_perm_b32 v108, v83, v81, s51
v_perm_b32 v109, v87, v85, s51
v_mfma_f32_16x16x32_bf16 v[228:231], a[56:59], v[116:119], v[228:231]
ds_read_b128 a[24:27], v9 offset:34176
v_perm_b32 v110, v91, v89, s51
v_mfma_f32_16x16x32_bf16 v[232:235], a[56:59], v[120:123], v[232:235]
v_perm_b32 v111, v95, v93, s51
v_mfma_f32_16x16x32_bf16 v[236:239], a[56:59], v[124:127], v[236:239]
s_waitcnt lgkmcnt(7)
v_mfma_f32_16x16x32_bf16 v[240:243], a[60:63], v[112:115], v[240:243]
v_mfma_f32_16x16x32_bf16 v[244:247], a[60:63], v[116:119], v[244:247]
ds_read_b128 a[28:31], v9 offset:50816
v_mfma_f32_16x16x32_bf16 v[248:251], a[60:63], v[120:123], v[248:251]
v_mfma_f32_16x16x32_bf16 v[252:255], a[60:63], v[124:127], v[252:255]
s_waitcnt lgkmcnt(7)
v_mfma_f32_16x16x32_bf16 v[128:131], a[0:3], v[96:99], v[128:131]
v_mfma_f32_16x16x32_bf16 v[132:135], a[0:3], v[100:103], v[132:135]
ds_read_b128 a[32:35], v8 offset:960
v_mfma_f32_16x16x32_bf16 v[136:139], a[0:3], v[104:107], v[136:139]
v_mfma_f32_16x16x32_bf16 v[140:143], a[0:3], v[108:111], v[140:143]
s_waitcnt lgkmcnt(7)
v_mfma_f32_16x16x32_bf16 v[144:147], a[4:7], v[96:99], v[144:147]
v_mfma_f32_16x16x32_bf16 v[148:151], a[4:7], v[100:103], v[148:151]
ds_read_b128 a[36:39], v8 offset:17600
v_mfma_f32_16x16x32_bf16 v[152:155], a[4:7], v[104:107], v[152:155]
v_mfma_f32_16x16x32_bf16 v[156:159], a[4:7], v[108:111], v[156:159]
s_waitcnt lgkmcnt(7)
v_mfma_f32_16x16x32_bf16 v[160:163], a[8:11], v[96:99], v[160:163]
s_waitcnt vmcnt(6)
v_perm_b32 v112, v18, v16, s50
s_waitcnt vmcnt(4)
v_perm_b32 v113, v22, v20, s50
v_mfma_f32_16x16x32_bf16 v[164:167], a[8:11], v[100:103], v[164:167]
ds_read_b128 a[40:43], v8 offset:34240
v_mfma_f32_16x16x32_bf16 v[168:171], a[8:11], v[104:107], v[168:171]
s_waitcnt vmcnt(2)
v_perm_b32 v114, v26, v24, s50
v_mfma_f32_16x16x32_bf16 v[172:175], a[8:11], v[108:111], v[172:175]
s_waitcnt lgkmcnt(7)
v_mfma_f32_16x16x32_bf16 v[176:179], a[12:15], v[96:99], v[176:179]
s_waitcnt vmcnt(0)
v_perm_b32 v115, v30, v28, s50
v_perm_b32 v116, v18, v16, s51
v_mfma_f32_16x16x32_bf16 v[180:183], a[12:15], v[100:103], v[180:183]
ds_read_b128 a[44:47], v8 offset:50880
v_mfma_f32_16x16x32_bf16 v[184:187], a[12:15], v[104:107], v[184:187]
v_perm_b32 v117, v22, v20, s51
v_mfma_f32_16x16x32_bf16 v[188:191], a[12:15], v[108:111], v[188:191]
s_waitcnt lgkmcnt(7)
v_mfma_f32_16x16x32_bf16 v[192:195], a[16:19], v[96:99], v[192:195]
v_perm_b32 v118, v26, v24, s51
v_perm_b32 v119, v30, v28, s51
v_mfma_f32_16x16x32_bf16 v[196:199], a[16:19], v[100:103], v[196:199]
ds_read_b128 a[48:51], v9 offset:960
v_mfma_f32_16x16x32_bf16 v[200:203], a[16:19], v[104:107], v[200:203]
v_perm_b32 v120, v19, v17, s50
v_mfma_f32_16x16x32_bf16 v[204:207], a[16:19], v[108:111], v[204:207]
s_waitcnt lgkmcnt(7)
v_mfma_f32_16x16x32_bf16 v[208:211], a[20:23], v[96:99], v[208:211]
v_perm_b32 v121, v23, v21, s50
v_perm_b32 v122, v27, v25, s50
v_mfma_f32_16x16x32_bf16 v[212:215], a[20:23], v[100:103], v[212:215]
ds_read_b128 a[52:55], v9 offset:17600
v_mfma_f32_16x16x32_bf16 v[216:219], a[20:23], v[104:107], v[216:219]
v_perm_b32 v123, v31, v29, s50
v_mfma_f32_16x16x32_bf16 v[220:223], a[20:23], v[108:111], v[220:223]
s_waitcnt lgkmcnt(7)
v_mfma_f32_16x16x32_bf16 v[224:227], a[24:27], v[96:99], v[224:227]
v_perm_b32 v124, v19, v17, s51
v_perm_b32 v125, v23, v21, s51
v_mfma_f32_16x16x32_bf16 v[228:231], a[24:27], v[100:103], v[228:231]
ds_read_b128 a[56:59], v9 offset:34240
v_perm_b32 v126, v27, v25, s51
v_mfma_f32_16x16x32_bf16 v[232:235], a[24:27], v[104:107], v[232:235]
v_perm_b32 v127, v31, v29, s51
v_mfma_f32_16x16x32_bf16 v[236:239], a[24:27], v[108:111], v[236:239]
s_waitcnt lgkmcnt(7)
v_mfma_f32_16x16x32_bf16 v[240:243], a[28:31], v[96:99], v[240:243]
v_mfma_f32_16x16x32_bf16 v[244:247], a[28:31], v[100:103], v[244:247]
ds_read_b128 a[60:63], v9 offset:50880
v_mfma_f32_16x16x32_bf16 v[248:251], a[28:31], v[104:107], v[248:251]
v_mfma_f32_16x16x32_bf16 v[252:255], a[28:31], v[108:111], v[252:255]
s_waitcnt lgkmcnt(7)
v_mfma_f32_16x16x32_bf16 v[128:131], a[32:35], v[112:115], v[128:131]
v_mfma_f32_16x16x32_bf16 v[132:135], a[32:35], v[116:119], v[132:135]
v_mfma_f32_16x16x32_bf16 v[136:139], a[32:35], v[120:123], v[136:139]
v_mfma_f32_16x16x32_bf16 v[140:143], a[32:35], v[124:127], v[140:143]
s_waitcnt lgkmcnt(6)
v_mfma_f32_16x16x32_bf16 v[144:147], a[36:39], v[112:115], v[144:147]
v_mfma_f32_16x16x32_bf16 v[148:151], a[36:39], v[116:119], v[148:151]
v_mfma_f32_16x16x32_bf16 v[152:155], a[36:39], v[120:123], v[152:155]
v_mfma_f32_16x16x32_bf16 v[156:159], a[36:39], v[124:127], v[156:159]
s_waitcnt lgkmcnt(5)
v_mfma_f32_16x16x32_bf16 v[160:163], a[40:43], v[112:115], v[160:163]
v_mfma_f32_16x16x32_bf16 v[164:167], a[40:43], v[116:119], v[164:167]
v_mfma_f32_16x16x32_bf16 v[168:171], a[40:43], v[120:123], v[168:171]
v_mfma_f32_16x16x32_bf16 v[172:175], a[40:43], v[124:127], v[172:175]
s_waitcnt lgkmcnt(4)
v_mfma_f32_16x16x32_bf16 v[176:179], a[44:47], v[112:115], v[176:179]
v_mfma_f32_16x16x32_bf16 v[180:183], a[44:47], v[116:119], v[180:183]
v_mfma_f32_16x16x32_bf16 v[184:187], a[44:47], v[120:123], v[184:187]
v_mfma_f32_16x16x32_bf16 v[188:191], a[44:47], v[124:127], v[188:191]
s_waitcnt lgkmcnt(3)
v_mfma_f32_16x16x32_bf16 v[192:195], a[48:51], v[112:115], v[192:195]
v_mfma_f32_16x16x32_bf16 v[196:199], a[48:51], v[116:119], v[196:199]
v_mfma_f32_16x16x32_bf16 v[200:203], a[48:51], v[120:123], v[200:203]
v_mfma_f32_16x16x32_bf16 v[204:207], a[48:51], v[124:127], v[204:207]
s_waitcnt lgkmcnt(2)
v_mfma_f32_16x16x32_bf16 v[208:211], a[52:55], v[112:115], v[208:211]
v_mfma_f32_16x16x32_bf16 v[212:215], a[52:55], v[116:119], v[212:215]
v_mfma_f32_16x16x32_bf16 v[216:219], a[52:55], v[120:123], v[216:219]
v_mfma_f32_16x16x32_bf16 v[220:223], a[52:55], v[124:127], v[220:223]
s_waitcnt lgkmcnt(1)
v_mfma_f32_16x16x32_bf16 v[224:227], a[56:59], v[112:115], v[224:227]
v_mfma_f32_16x16x32_bf16 v[228:231], a[56:59], v[116:119], v[228:231]
v_mfma_f32_16x16x32_bf16 v[232:235], a[56:59], v[120:123], v[232:235]
v_mfma_f32_16x16x32_bf16 v[236:239], a[56:59], v[124:127], v[236:239]
s_waitcnt lgkmcnt(0)
v_mfma_f32_16x16x32_bf16 v[240:243], a[60:63], v[112:115], v[240:243]
v_mfma_f32_16x16x32_bf16 v[244:247], a[60:63], v[116:119], v[244:247]
v_mfma_f32_16x16x32_bf16 v[248:251], a[60:63], v[120:123], v[248:251]
v_mfma_f32_16x16x32_bf16 v[252:255], a[60:63], v[124:127], v[252:255]
s_waitcnt lgkmcnt(0)
s_barrier
s_add_u32 s63, s63, 1
s_mov_b32 s72, 0
s_cmp_lg_u32 s63, 0
s_cbranch_scc1 PVn_later
s_cmp_eq_u32 s49, 6
s_cbranch_scc1 PVn_n0
s_mov_b32 s43, 0
s_cmp_ge_u32 s49, 4
s_cselect_b32 s66, 1, 0
s_and_b32 s44, s49, 3
s_branch PVn_dec
PVn_n0:
s_mov_b32 s42, 0
s_branch PVn_n
PVn_later:
s_cmp_lt_u32 s49, 5
s_cbranch_scc1 PVn_none
s_lshl_b32 s42, s63, 1
s_add_u32 s42, s42, s49
s_sub_u32 s42, s42, 6
s_cmp_gt_u32 s42, 17
s_cbranch_scc1 PVn_none
PVn_n:
s_mul_i32 s43, s42, 43
s_lshr_b32 s43, s43, 8
s_mul_i32 s44, s43, 6
s_sub_u32 s44, s42, s44
s_mul_i32 s44, s44, 5
s_mov_b32 s42, 310614180
s_cmp_eq_u32 s43, 1
s_cselect_b32 s42, 449499498, s42
s_cmp_eq_u32 s43, 2
s_cselect_b32 s42, 1003282926, s42
s_lshr_b32 s42, s42, s44
s_bfe_u32 s66, s42, 65540
s_bfe_u32 s43, s42, 131074
s_and_b32 s44, s42, 3
PVn_dec:
s_lshl_b32 s32, s43, 2
s_lshr_b32 s38, s16, 3
s_add_u32 s32, s32, s38
s_lshl_b32 s33, s44, 3
s_and_b32 s38, s16, 7
s_add_u32 s33, s33, s38
s_lshl_b32 s42, s32, 7
s_lshl_b32 s38, s17, 5
s_add_u32 s39, s38, s42
s_mul_i32 s39, s39, 1024
s_add_u32 s39, s39, 0
s_mul_i32 s38, s38, 1040
s_add_u32 m0, s38, 0
s_add_u32 s40, s39, 0
buffer_load_dwordx4 v1, s[12:15], s40 offen lds
s_add_u32 m0, s38, 1040
s_add_u32 s40, s39, 1024
buffer_load_dwordx4 v1, s[12:15], s40 offen lds
s_add_u32 m0, s38, 2080
s_add_u32 s40, s39, 2048
buffer_load_dwordx4 v1, s[12:15], s40 offen lds
s_add_u32 m0, s38, 3120
s_add_u32 s40, s39, 3072
buffer_load_dwordx4 v1, s[12:15], s40 offen lds
s_add_u32 m0, s38, 4160
s_add_u32 s40, s39, 4096
buffer_load_dwordx4 v1, s[12:15], s40 offen lds
s_add_u32 m0, s38, 5200
s_add_u32 s40, s39, 5120
buffer_load_dwordx4 v1, s[12:15], s40 offen lds
s_add_u32 m0, s38, 6240
s_add_u32 s40, s39, 6144
buffer_load_dwordx4 v1, s[12:15], s40 offen lds
s_add_u32 m0, s38, 7280
s_add_u32 s40, s39, 7168
buffer_load_dwordx4 v1, s[12:15], s40 offen lds
s_add_u32 m0, s38, 8320
s_add_u32 s40, s39, 8192
buffer_load_dwordx4 v1, s[12:15], s40 offen lds
s_add_u32 m0, s38, 9360
s_add_u32 s40, s39, 9216
buffer_load_dwordx4 v1, s[12:15], s40 offen lds
s_add_u32 m0, s38, 10400
s_add_u32 s40, s39, 10240
buffer_load_dwordx4 v1, s[12:15], s40 offen lds
s_add_u32 m0, s38, 11440
s_add_u32 s40, s39, 11264
buffer_load_dwordx4 v1, s[12:15], s40 offen lds
s_add_u32 m0, s38, 12480
s_add_u32 s40, s39, 12288
buffer_load_dwordx4 v1, s[12:15], s40 offen lds
s_add_u32 m0, s38, 13520
s_add_u32 s40, s39, 13312
buffer_load_dwordx4 v1, s[12:15], s40 offen lds
s_add_u32 m0, s38, 14560
s_add_u32 s40, s39, 14336
buffer_load_dwordx4 v1, s[12:15], s40 offen lds
s_add_u32 m0, s38, 15600
s_add_u32 s40, s39, 15360
buffer_load_dwordx4 v1, s[12:15], s40 offen lds
s_add_u32 m0, s38, 16640
s_add_u32 s40, s39, 16384
buffer_load_dwordx4 v1, s[12:15], s40 offen lds
s_add_u32 m0, s38, 17680
s_add_u32 s40, s39, 17408
buffer_load_dwordx4 v1, s[12:15], s40 offen lds
s_add_u32 m0, s38, 18720
s_add_u32 s40, s39, 18432
buffer_load_dwordx4 v1, s[12:15], s40 offen lds
s_add_u32 m0, s38, 19760
s_add_u32 s40, s39, 19456
buffer_load_dwordx4 v1, s[12:15], s40 offen lds
s_add_u32 m0, s38, 20800
s_add_u32 s40, s39, 20480
buffer_load_dwordx4 v1, s[12:15], s40 offen lds
s_add_u32 m0, s38, 21840
s_add_u32 s40, s39, 21504
buffer_load_dwordx4 v1, s[12:15], s40 offen lds
s_add_u32 m0, s38, 22880
s_add_u32 s40, s39, 22528
buffer_load_dwordx4 v1, s[12:15], s40 offen lds
s_add_u32 m0, s38, 23920
s_add_u32 s40, s39, 23552
buffer_load_dwordx4 v1, s[12:15], s40 offen lds
s_add_u32 m0, s38, 24960
s_add_u32 s40, s39, 24576
buffer_load_dwordx4 v1, s[12:15], s40 offen lds
s_add_u32 m0, s38, 26000
s_add_u32 s40, s39, 25600
buffer_load_dwordx4 v1, s[12:15], s40 offen lds
s_add_u32 m0, s38, 27040
s_add_u32 s40, s39, 26624
buffer_load_dwordx4 v1, s[12:15], s40 offen lds
s_add_u32 m0, s38, 28080
s_add_u32 s40, s39, 27648
buffer_load_dwordx4 v1, s[12:15], s40 offen lds
s_add_u32 m0, s38, 29120
s_add_u32 s40, s39, 28672
buffer_load_dwordx4 v1, s[12:15], s40 offen lds
s_add_u32 m0, s38, 30160
s_add_u32 s40, s39, 29696
buffer_load_dwordx4 v1, s[12:15], s40 offen lds
s_add_u32 m0, s38, 31200
s_add_u32 s40, s39, 30720
buffer_load_dwordx4 v1, s[12:15], s40 offen lds
s_add_u32 m0, s38, 32240
s_add_u32 s40, s39, 31744
buffer_load_dwordx4 v1, s[12:15], s40 offen lds
s_mov_b32 s72, 1
PVn_none:
v_cvt_pk_bf16_f32 v16, v128, v129
v_cvt_pk_bf16_f32 v17, v130, v131
v_cvt_pk_bf16_f32 v18, v144, v145
v_cvt_pk_bf16_f32 v19, v146, v147
s_add_u32 s38, s35, 0
buffer_store_dwordx4 v[16:19], v1, s[8:11], s38 offen sc1
v_cvt_pk_bf16_f32 v20, v132, v133
v_cvt_pk_bf16_f32 v21, v134, v135
v_cvt_pk_bf16_f32 v22, v148, v149
v_cvt_pk_bf16_f32 v23, v150, v151
s_add_u32 s38, s35, 1024
buffer_store_dwordx4 v[20:23], v1, s[8:11], s38 offen sc1
v_cvt_pk_bf16_f32 v24, v136, v137
v_cvt_pk_bf16_f32 v25, v138, v139
v_cvt_pk_bf16_f32 v26, v152, v153
v_cvt_pk_bf16_f32 v27, v154, v155
s_add_u32 s38, s35, 2048
buffer_store_dwordx4 v[24:27], v1, s[8:11], s38 offen sc1
v_cvt_pk_bf16_f32 v28, v140, v141
v_cvt_pk_bf16_f32 v29, v142, v143
v_cvt_pk_bf16_f32 v30, v156, v157
v_cvt_pk_bf16_f32 v31, v158, v159
s_add_u32 s38, s35, 3072
buffer_store_dwordx4 v[28:31], v1, s[8:11], s38 offen sc1
v_cvt_pk_bf16_f32 v16, v160, v161
v_cvt_pk_bf16_f32 v17, v162, v163
v_cvt_pk_bf16_f32 v18, v176, v177
v_cvt_pk_bf16_f32 v19, v178, v179
s_add_u32 s38, s35, 262144
buffer_store_dwordx4 v[16:19], v1, s[8:11], s38 offen sc1
v_cvt_pk_bf16_f32 v20, v164, v165
v_cvt_pk_bf16_f32 v21, v166, v167
v_cvt_pk_bf16_f32 v22, v180, v181
v_cvt_pk_bf16_f32 v23, v182, v183
s_add_u32 s38, s35, 263168
buffer_store_dwordx4 v[20:23], v1, s[8:11], s38 offen sc1
v_cvt_pk_bf16_f32 v24, v168, v169
v_cvt_pk_bf16_f32 v25, v170, v171
v_cvt_pk_bf16_f32 v26, v184, v185
v_cvt_pk_bf16_f32 v27, v186, v187
s_add_u32 s38, s35, 264192
buffer_store_dwordx4 v[24:27], v1, s[8:11], s38 offen sc1
v_cvt_pk_bf16_f32 v28, v172, v173
v_cvt_pk_bf16_f32 v29, v174, v175
v_cvt_pk_bf16_f32 v30, v188, v189
v_cvt_pk_bf16_f32 v31, v190, v191
s_add_u32 s38, s35, 265216
buffer_store_dwordx4 v[28:31], v1, s[8:11], s38 offen sc1
v_cvt_pk_bf16_f32 v16, v192, v193
v_cvt_pk_bf16_f32 v17, v194, v195
v_cvt_pk_bf16_f32 v18, v208, v209
v_cvt_pk_bf16_f32 v19, v210, v211
s_add_u32 s38, s35, 524288
buffer_store_dwordx4 v[16:19], v1, s[8:11], s38 offen sc1
v_cvt_pk_bf16_f32 v20, v196, v197
v_cvt_pk_bf16_f32 v21, v198, v199
v_cvt_pk_bf16_f32 v22, v212, v213
v_cvt_pk_bf16_f32 v23, v214, v215
s_add_u32 s38, s35, 525312
buffer_store_dwordx4 v[20:23], v1, s[8:11], s38 offen sc1
v_cvt_pk_bf16_f32 v24, v200, v201
v_cvt_pk_bf16_f32 v25, v202, v203
v_cvt_pk_bf16_f32 v26, v216, v217
v_cvt_pk_bf16_f32 v27, v218, v219
s_add_u32 s38, s35, 526336
buffer_store_dwordx4 v[24:27], v1, s[8:11], s38 offen sc1
v_cvt_pk_bf16_f32 v28, v204, v205
v_cvt_pk_bf16_f32 v29, v206, v207
v_cvt_pk_bf16_f32 v30, v220, v221
v_cvt_pk_bf16_f32 v31, v222, v223
s_add_u32 s38, s35, 527360
buffer_store_dwordx4 v[28:31], v1, s[8:11], s38 offen sc1
v_cvt_pk_bf16_f32 v16, v224, v225
v_cvt_pk_bf16_f32 v17, v226, v227
v_cvt_pk_bf16_f32 v18, v240, v241
v_cvt_pk_bf16_f32 v19, v242, v243
s_add_u32 s38, s35, 786432
buffer_store_dwordx4 v[16:19], v1, s[8:11], s38 offen sc1
v_cvt_pk_bf16_f32 v20, v228, v229
v_cvt_pk_bf16_f32 v21, v230, v231
v_cvt_pk_bf16_f32 v22, v244, v245
v_cvt_pk_bf16_f32 v23, v246, v247
s_add_u32 s38, s35, 787456
buffer_store_dwordx4 v[20:23], v1, s[8:11], s38 offen sc1
v_cvt_pk_bf16_f32 v24, v232, v233
v_cvt_pk_bf16_f32 v25, v234, v235
v_cvt_pk_bf16_f32 v26, v248, v249
v_cvt_pk_bf16_f32 v27, v250, v251
s_add_u32 s38, s35, 788480
buffer_store_dwordx4 v[24:27], v1, s[8:11], s38 offen sc1
v_cvt_pk_bf16_f32 v28, v236, v237
v_cvt_pk_bf16_f32 v29, v238, v239
v_cvt_pk_bf16_f32 v30, v252, v253
v_cvt_pk_bf16_f32 v31, v254, v255
s_add_u32 s38, s35, 789504
buffer_store_dwordx4 v[28:31], v1, s[8:11], s38 offen sc1
P_done:
s_mov_b32 s70, s71
s_cmp_eq_u32 s72, 1
s_cbranch_scc1 P_round
v_mov_b32 v4, 64
s_mov_b32 s41, 0x40000
W_nonce:
global_load_dword v5, v4, s[52:53] sc1
s_waitcnt vmcnt(0)
v_readfirstlane_b32 s69, v5
s_nop 0
s_cmp_lg_u32 s69, 0
s_cbranch_scc1 W_nonce_ok
s_sub_u32 s41, s41, 1
s_cbranch_scc1 W_nonce_ok
s_sleep 4
s_branch W_nonce
W_nonce_ok:
s_waitcnt vmcnt(0) lgkmcnt(0)
s_barrier
s_cmp_lg_u32 s17, 0
s_cbranch_scc1 SF0
s_mov_b64 exec, 1
v_mov_b32 v4, s69
v_mov_b32 v5, 0
buffer_store_dword v4, v5, s[8:11], s70 offen sc1
s_mov_b64 exec, -1
SF0:
P_end:
s_cmp_eq_u32 s49, 0
s_cbranch_scc1 R_a
s_cmp_ge_u32 s49, 5
s_cbranch_scc1 L_end
s_cmp_ge_u32 s49, 3
s_cbranch_scc1 R_s5
s_sub_u32 s38, s49, 1
s_lshl_b32 s64, s38, 5
s_add_u32 s64, s64, s16
R_o:
s_and_b32 s47, s64, 15
s_lshr_b32 s48, s64, 4
s_cmp_ge_u32 s48, 4
s_cselect_b32 s38, 72, 0
s_add_u32 s48, s48, s38
s_load_dwordx2 s[20:21], s[0:1], 40
s_waitcnt lgkmcnt(0)
s_and_b32 s21, s21, 0xffff
s_mov_b32 s22, 4194304
s_mov_b32 s23, 0x20000
v_and_b32 v4, 63, v0
v_lshrrev_b32 v5, 4, v4
v_lshlrev_b32 v3, 14, v5
v_and_b32 v5, 15, v4
v_lshl_add_u32 v3, v5, 2, v3
s_lshl_b32 s34, s17, 20
s_lshl_b32 s38, s47, 6
s_add_u32 s34, s34, s38
s_add_u32 s38, s34, 0
buffer_load_dword v64, v3, s[20:23], s38 offen
s_add_u32 s38, s34, 1024
buffer_load_dword v65, v3, s[20:23], s38 offen
s_add_u32 s38, s34, 2048
buffer_load_dword v66, v3, s[20:23], s38 offen
s_add_u32 s38, s34, 3072
buffer_load_dword v67, v3, s[20:23], s38 offen
s_add_u32 s38, s34, 4096
buffer_load_dword v68, v3, s[20:23], s38 offen
s_add_u32 s38, s34, 5120
buffer_load_dword v69, v3, s[20:23], s38 offen
s_add_u32 s38, s34, 6144
buffer_load_dword v70, v3, s[20:23], s38 offen
s_add_u32 s38, s34, 7168
buffer_load_dword v71, v3, s[20:23], s38 offen
s_add_u32 s38, s34, 8192
buffer_load_dword v72, v3, s[20:23], s38 offen
s_add_u32 s38, s34, 9216
buffer_load_dword v73, v3, s[20:23], s38 offen
s_add_u32 s38, s34, 10240
buffer_load_dword v74, v3, s[20:23], s38 offen
s_add_u32 s38, s34, 11264
buffer_load_dword v75, v3, s[20:23], s38 offen
s_add_u32 s38, s34, 12288
buffer_load_dword v76, v3, s[20:23], s38 offen
s_add_u32 s38, s34, 13312
buffer_load_dword v77, v3, s[20:23], s38 offen
s_add_u32 s38, s34, 14336
buffer_load_dword v78, v3, s[20:23], s38 offen
s_add_u32 s38, s34, 15360
buffer_load_dword v79, v3, s[20:23], s38 offen
s_add_u32 s38, s34, 65536
buffer_load_dword v80, v3, s[20:23], s38 offen
s_add_u32 s38, s34, 66560
buffer_load_dword v81, v3, s[20:23], s38 offen
s_add_u32 s38, s34, 67584
buffer_load_dword v82, v3, s[20:23], s38 offen
s_add_u32 s38, s34, 68608
buffer_load_dword v83, v3, s[20:23], s38 offen
s_add_u32 s38, s34, 69632
buffer_load_dword v84, v3, s[20:23], s38 offen
s_add_u32 s38, s34, 70656
buffer_load_dword v85, v3, s[20:23], s38 offen
s_add_u32 s38, s34, 71680
buffer_load_dword v86, v3, s[20:23], s38 offen
s_add_u32 s38, s34, 72704
buffer_load_dword v87, v3, s[20:23], s38 offen
s_add_u32 s38, s34, 73728
buffer_load_dword v88, v3, s[20:23], s38 offen
s_add_u32 s38, s34, 74752
buffer_load_dword v89, v3, s[20:23], s38 offen
s_add_u32 s38, s34, 75776
buffer_load_dword v90, v3, s[20:23], s38 offen
s_add_u32 s38, s34, 76800
buffer_load_dword v91, v3, s[20:23], s38 offen
s_add_u32 s38, s34, 77824
buffer_load_dword v92, v3, s[20:23], s38 offen
s_add_u32 s38, s34, 78848
buffer_load_dword v93, v3, s[20:23], s38 offen
s_add_u32 s38, s34, 79872
buffer_load_dword v94, v3, s[20:23], s38 offen
s_add_u32 s38, s34, 80896
buffer_load_dword v95, v3, s[20:23], s38 offen
s_add_u32 s38, s34, 131072
buffer_load_dword v96, v3, s[20:23], s38 offen
s_add_u32 s38, s34, 132096
buffer_load_dword v97, v3, s[20:23], s38 offen
s_add_u32 s38, s34, 133120
buffer_load_dword v98, v3, s[20:23], s38 offen
s_add_u32 s38, s34, 134144
buffer_load_dword v99, v3, s[20:23], s38 offen
s_add_u32 s38, s34, 135168
buffer_load_dword v100, v3, s[20:23], s38 offen
s_add_u32 s38, s34, 136192
buffer_load_dword v101, v3, s[20:23], s38 offen
s_add_u32 s38, s34, 137216
buffer_load_dword v102, v3, s[20:23], s38 offen
s_add_u32 s38, s34, 138240
buffer_load_dword v103, v3, s[20:23], s38 offen
s_add_u32 s38, s34, 139264
buffer_load_dword v104, v3, s[20:23], s38 offen
s_add_u32 s38, s34, 140288
buffer_load_dword v105, v3, s[20:23], s38 offen
s_add_u32 s38, s34, 141312
buffer_load_dword v106, v3, s[20:23], s38 offen
s_add_u32 s38, s34, 142336
buffer_load_dword v107, v3, s[20:23], s38 offen
s_add_u32 s38, s34, 143360
buffer_load_dword v108, v3, s[20:23], s38 offen
s_add_u32 s38, s34, 144384
buffer_load_dword v109, v3, s[20:23], s38 offen
s_add_u32 s38, s34, 145408
buffer_load_dword v110, v3, s[20:23], s38 offen
s_add_u32 s38, s34, 146432
buffer_load_dword v111, v3, s[20:23], s38 offen
s_waitcnt vmcnt(46)
v_perm_b32 v4, v65, v64, s50
v_accvgpr_write_b32 a0, v4
s_waitcnt vmcnt(44)
v_perm_b32 v5, v67, v66, s50
v_accvgpr_write_b32 a1, v5
s_waitcnt vmcnt(42)
v_perm_b32 v4, v69, v68, s50
v_accvgpr_write_b32 a2, v4
s_waitcnt vmcnt(40)
v_perm_b32 v5, v71, v70, s50
v_accvgpr_write_b32 a3, v5
v_perm_b32 v4, v65, v64, s51
v_accvgpr_write_b32 a4, v4
v_perm_b32 v5, v67, v66, s51
v_accvgpr_write_b32 a5, v5
v_perm_b32 v4, v69, v68, s51
v_accvgpr_write_b32 a6, v4
v_perm_b32 v5, v71, v70, s51
v_accvgpr_write_b32 a7, v5
s_add_u32 s38, s34, 196608
buffer_load_dword v112, v3, s[20:23], s38 offen
s_add_u32 s38, s34, 197632
buffer_load_dword v113, v3, s[20:23], s38 offen
s_add_u32 s38, s34, 198656
buffer_load_dword v114, v3, s[20:23], s38 offen
s_add_u32 s38, s34, 199680
buffer_load_dword v115, v3, s[20:23], s38 offen
s_add_u32 s38, s34, 200704
buffer_load_dword v116, v3, s[20:23], s38 offen
s_add_u32 s38, s34, 201728
buffer_load_dword v117, v3, s[20:23], s38 offen
s_add_u32 s38, s34, 202752
buffer_load_dword v118, v3, s[20:23], s38 offen
s_add_u32 s38, s34, 203776
buffer_load_dword v119, v3, s[20:23], s38 offen
s_waitcnt vmcnt(46)
v_perm_b32 v4, v73, v72, s50
v_accvgpr_write_b32 a8, v4
s_waitcnt vmcnt(44)
v_perm_b32 v5, v75, v74, s50
v_accvgpr_write_b32 a9, v5
s_waitcnt vmcnt(42)
v_perm_b32 v4, v77, v76, s50
v_accvgpr_write_b32 a10, v4
s_waitcnt vmcnt(40)
v_perm_b32 v5, v79, v78, s50
v_accvgpr_write_b32 a11, v5
v_perm_b32 v4, v73, v72, s51
v_accvgpr_write_b32 a12, v4
v_perm_b32 v5, v75, v74, s51
v_accvgpr_write_b32 a13, v5
v_perm_b32 v4, v77, v76, s51
v_accvgpr_write_b32 a14, v4
v_perm_b32 v5, v79, v78, s51
v_accvgpr_write_b32 a15, v5
s_add_u32 s38, s34, 204800
buffer_load_dword v64, v3, s[20:23], s38 offen
s_add_u32 s38, s34, 205824
buffer_load_dword v65, v3, s[20:23], s38 offen
s_add_u32 s38, s34, 206848
buffer_load_dword v66, v3, s[20:23], s38 offen
s_add_u32 s38, s34, 207872
buffer_load_dword v67, v3, s[20:23], s38 offen
s_add_u32 s38, s34, 208896
buffer_load_dword v68, v3, s[20:23], s38 offen
s_add_u32 s38, s34, 209920
buffer_load_dword v69, v3, s[20:23], s38 offen
s_add_u32 s38, s34, 210944
buffer_load_dword v70, v3, s[20:23], s38 offen
s_add_u32 s38, s34, 211968
buffer_load_dword v71, v3, s[20:23], s38 offen
s_waitcnt vmcnt(46)
v_perm_b32 v4, v81, v80, s50
v_accvgpr_write_b32 a16, v4
s_waitcnt vmcnt(44)
v_perm_b32 v5, v83, v82, s50
v_accvgpr_write_b32 a17, v5
s_waitcnt vmcnt(42)
v_perm_b32 v4, v85, v84, s50
v_accvgpr_write_b32 a18, v4
s_waitcnt vmcnt(40)
v_perm_b32 v5, v87, v86, s50
v_accvgpr_write_b32 a19, v5
v_perm_b32 v4, v81, v80, s51
v_accvgpr_write_b32 a20, v4
v_perm_b32 v5, v83, v82, s51
v_accvgpr_write_b32 a21, v5
v_perm_b32 v4, v85, v84, s51
v_accvgpr_write_b32 a22, v4
v_perm_b32 v5, v87, v86, s51
v_accvgpr_write_b32 a23, v5
s_add_u32 s38, s34, 262144
buffer_load_dword v72, v3, s[20:23], s38 offen
s_add_u32 s38, s34, 263168
buffer_load_dword v73, v3, s[20:23], s38 offen
s_add_u32 s38, s34, 264192
buffer_load_dword v74, v3, s[20:23], s38 offen
s_add_u32 s38, s34, 265216
buffer_load_dword v75, v3, s[20:23], s38 offen
s_add_u32 s38, s34, 266240
buffer_load_dword v76, v3, s[20:23], s38 offen
s_add_u32 s38, s34, 267264
buffer_load_dword v77, v3, s[20:23], s38 offen
s_add_u32 s38, s34, 268288
buffer_load_dword v78, v3, s[20:23], s38 offen
s_add_u32 s38, s34, 269312
buffer_load_dword v79, v3, s[20:23], s38 offen
s_waitcnt vmcnt(46)
v_perm_b32 v4, v89, v88, s50
v_accvgpr_write_b32 a24, v4
s_waitcnt vmcnt(44)
v_perm_b32 v5, v91, v90, s50
v_accvgpr_write_b32 a25, v5
s_waitcnt vmcnt(42)
v_perm_b32 v4, v93, v92, s50
v_accvgpr_write_b32 a26, v4
s_waitcnt vmcnt(40)
v_perm_b32 v5, v95, v94, s50
v_accvgpr_write_b32 a27, v5
v_perm_b32 v4, v89, v88, s51
v_accvgpr_write_b32 a28, v4
v_perm_b32 v5, v91, v90, s51
v_accvgpr_write_b32 a29, v5
v_perm_b32 v4, v93, v92, s51
v_accvgpr_write_b32 a30, v4
v_perm_b32 v5, v95, v94, s51
v_accvgpr_write_b32 a31, v5
s_add_u32 s38, s34, 270336
buffer_load_dword v80, v3, s[20:23], s38 offen
s_add_u32 s38, s34, 271360
buffer_load_dword v81, v3, s[20:23], s38 offen
s_add_u32 s38, s34, 272384
buffer_load_dword v82, v3, s[20:23], s38 offen
s_add_u32 s38, s34, 273408
buffer_load_dword v83, v3, s[20:23], s38 offen
s_add_u32 s38, s34, 274432
buffer_load_dword v84, v3, s[20:23], s38 offen
s_add_u32 s38, s34, 275456
buffer_load_dword v85, v3, s[20:23], s38 offen
s_add_u32 s38, s34, 276480
buffer_load_dword v86, v3, s[20:23], s38 offen
s_add_u32 s38, s34, 277504
buffer_load_dword v87, v3, s[20:23], s38 offen
s_waitcnt vmcnt(46)
v_perm_b32 v4, v97, v96, s50
v_accvgpr_write_b32 a32, v4
s_waitcnt vmcnt(44)
v_perm_b32 v5, v99, v98, s50
v_accvgpr_write_b32 a33, v5
s_waitcnt vmcnt(42)
v_perm_b32 v4, v101, v100, s50
v_accvgpr_write_b32 a34, v4
s_waitcnt vmcnt(40)
v_perm_b32 v5, v103, v102, s50
v_accvgpr_write_b32 a35, v5
v_perm_b32 v4, v97, v96, s51
v_accvgpr_write_b32 a36, v4
v_perm_b32 v5, v99, v98, s51
v_accvgpr_write_b32 a37, v5
v_perm_b32 v4, v101, v100, s51
v_accvgpr_write_b32 a38, v4
v_perm_b32 v5, v103, v102, s51
v_accvgpr_write_b32 a39, v5
s_add_u32 s38, s34, 327680
buffer_load_dword v88, v3, s[20:23], s38 offen
s_add_u32 s38, s34, 328704
buffer_load_dword v89, v3, s[20:23], s38 offen
s_add_u32 s38, s34, 329728
buffer_load_dword v90, v3, s[20:23], s38 offen
s_add_u32 s38, s34, 330752
buffer_load_dword v91, v3, s[20:23], s38 offen
s_add_u32 s38, s34, 331776
buffer_load_dword v92, v3, s[20:23], s38 offen
s_add_u32 s38, s34, 332800
buffer_load_dword v93, v3, s[20:23], s38 offen
s_add_u32 s38, s34, 333824
buffer_load_dword v94, v3, s[20:23], s38 offen
s_add_u32 s38, s34, 334848
buffer_load_dword v95, v3, s[20:23], s38 offen
s_waitcnt vmcnt(46)
v_perm_b32 v4, v105, v104, s50
v_accvgpr_write_b32 a40, v4
s_waitcnt vmcnt(44)
v_perm_b32 v5, v107, v106, s50
v_accvgpr_write_b32 a41, v5
s_waitcnt vmcnt(42)
v_perm_b32 v4, v109, v108, s50
v_accvgpr_write_b32 a42, v4
s_waitcnt vmcnt(40)
v_perm_b32 v5, v111, v110, s50
v_accvgpr_write_b32 a43, v5
v_perm_b32 v4, v105, v104, s51
v_accvgpr_write_b32 a44, v4
v_perm_b32 v5, v107, v106, s51
v_accvgpr_write_b32 a45, v5
v_perm_b32 v4, v109, v108, s51
v_accvgpr_write_b32 a46, v4
v_perm_b32 v5, v111, v110, s51
v_accvgpr_write_b32 a47, v5
s_add_u32 s38, s34, 335872
buffer_load_dword v96, v3, s[20:23], s38 offen
s_add_u32 s38, s34, 336896
buffer_load_dword v97, v3, s[20:23], s38 offen
s_add_u32 s38, s34, 337920
buffer_load_dword v98, v3, s[20:23], s38 offen
s_add_u32 s38, s34, 338944
buffer_load_dword v99, v3, s[20:23], s38 offen
s_add_u32 s38, s34, 339968
buffer_load_dword v100, v3, s[20:23], s38 offen
s_add_u32 s38, s34, 340992
buffer_load_dword v101, v3, s[20:23], s38 offen
s_add_u32 s38, s34, 342016
buffer_load_dword v102, v3, s[20:23], s38 offen
s_add_u32 s38, s34, 343040
buffer_load_dword v103, v3, s[20:23], s38 offen
s_waitcnt vmcnt(46)
v_perm_b32 v4, v113, v112, s50
v_accvgpr_write_b32 a48, v4
s_waitcnt vmcnt(44)
v_perm_b32 v5, v115, v114, s50
v_accvgpr_write_b32 a49, v5
s_waitcnt vmcnt(42)
v_perm_b32 v4, v117, v116, s50
v_accvgpr_write_b32 a50, v4
s_waitcnt vmcnt(40)
v_perm_b32 v5, v119, v118, s50
v_accvgpr_write_b32 a51, v5
v_perm_b32 v4, v113, v112, s51
v_accvgpr_write_b32 a52, v4
v_perm_b32 v5, v115, v114, s51
v_accvgpr_write_b32 a53, v5
v_perm_b32 v4, v117, v116, s51
v_accvgpr_write_b32 a54, v4
v_perm_b32 v5, v119, v118, s51
v_accvgpr_write_b32 a55, v5
s_add_u32 s38, s34, 393216
buffer_load_dword v104, v3, s[20:23], s38 offen
s_add_u32 s38, s34, 394240
buffer_load_dword v105, v3, s[20:23], s38 offen
s_add_u32 s38, s34, 395264
buffer_load_dword v106, v3, s[20:23], s38 offen
s_add_u32 s38, s34, 396288
buffer_load_dword v107, v3, s[20:23], s38 offen
s_add_u32 s38, s34, 397312
buffer_load_dword v108, v3, s[20:23], s38 offen
s_add_u32 s38, s34, 398336
buffer_load_dword v109, v3, s[20:23], s38 offen
s_add_u32 s38, s34, 399360
buffer_load_dword v110, v3, s[20:23], s38 offen
s_add_u32 s38, s34, 400384
buffer_load_dword v111, v3, s[20:23], s38 offen
s_waitcnt vmcnt(46)
v_perm_b32 v4, v65, v64, s50
v_accvgpr_write_b32 a56, v4
s_waitcnt vmcnt(44)
v_perm_b32 v5, v67, v66, s50
v_accvgpr_write_b32 a57, v5
s_waitcnt vmcnt(42)
v_perm_b32 v4, v69, v68, s50
v_accvgpr_write_b32 a58, v4
s_waitcnt vmcnt(40)
v_perm_b32 v5, v71, v70, s50
v_accvgpr_write_b32 a59, v5
v_perm_b32 v4, v65, v64, s51
v_accvgpr_write_b32 a60, v4
v_perm_b32 v5, v67, v66, s51
v_accvgpr_write_b32 a61, v5
v_perm_b32 v4, v69, v68, s51
v_accvgpr_write_b32 a62, v4
v_perm_b32 v5, v71, v70, s51
v_accvgpr_write_b32 a63, v5
s_add_u32 s38, s34, 401408
buffer_load_dword v112, v3, s[20:23], s38 offen
s_add_u32 s38, s34, 402432
buffer_load_dword v113, v3, s[20:23], s38 offen
s_add_u32 s38, s34, 403456
buffer_load_dword v114, v3, s[20:23], s38 offen
s_add_u32 s38, s34, 404480
buffer_load_dword v115, v3, s[20:23], s38 offen
s_add_u32 s38, s34, 405504
buffer_load_dword v116, v3, s[20:23], s38 offen
s_add_u32 s38, s34, 406528
buffer_load_dword v117, v3, s[20:23], s38 offen
s_add_u32 s38, s34, 407552
buffer_load_dword v118, v3, s[20:23], s38 offen
s_add_u32 s38, s34, 408576
buffer_load_dword v119, v3, s[20:23], s38 offen
s_waitcnt vmcnt(46)
v_perm_b32 v4, v73, v72, s50
v_accvgpr_write_b32 a64, v4
s_waitcnt vmcnt(44)
v_perm_b32 v5, v75, v74, s50
v_accvgpr_write_b32 a65, v5
s_waitcnt vmcnt(42)
v_perm_b32 v4, v77, v76, s50
v_accvgpr_write_b32 a66, v4
s_waitcnt vmcnt(40)
v_perm_b32 v5, v79, v78, s50
v_accvgpr_write_b32 a67, v5
v_perm_b32 v4, v73, v72, s51
v_accvgpr_write_b32 a68, v4
v_perm_b32 v5, v75, v74, s51
v_accvgpr_write_b32 a69, v5
v_perm_b32 v4, v77, v76, s51
v_accvgpr_write_b32 a70, v4
v_perm_b32 v5, v79, v78, s51
v_accvgpr_write_b32 a71, v5
s_add_u32 s38, s34, 458752
buffer_load_dword v64, v3, s[20:23], s38 offen
s_add_u32 s38, s34, 459776
buffer_load_dword v65, v3, s[20:23], s38 offen
s_add_u32 s38, s34, 460800
buffer_load_dword v66, v3, s[20:23], s38 offen
s_add_u32 s38, s34, 461824
buffer_load_dword v67, v3, s[20:23], s38 offen
s_add_u32 s38, s34, 462848
buffer_load_dword v68, v3, s[20:23], s38 offen
s_add_u32 s38, s34, 463872
buffer_load_dword v69, v3, s[20:23], s38 offen
s_add_u32 s38, s34, 464896
buffer_load_dword v70, v3, s[20:23], s38 offen
s_add_u32 s38, s34, 465920
buffer_load_dword v71, v3, s[20:23], s38 offen
s_waitcnt vmcnt(46)
v_perm_b32 v4, v81, v80, s50
v_accvgpr_write_b32 a72, v4
s_waitcnt vmcnt(44)
v_perm_b32 v5, v83, v82, s50
v_accvgpr_write_b32 a73, v5
s_waitcnt vmcnt(42)
v_perm_b32 v4, v85, v84, s50
v_accvgpr_write_b32 a74, v4
s_waitcnt vmcnt(40)
v_perm_b32 v5, v87, v86, s50
v_accvgpr_write_b32 a75, v5
v_perm_b32 v4, v81, v80, s51
v_accvgpr_write_b32 a76, v4
v_perm_b32 v5, v83, v82, s51
v_accvgpr_write_b32 a77, v5
v_perm_b32 v4, v85, v84, s51
v_accvgpr_write_b32 a78, v4
v_perm_b32 v5, v87, v86, s51
v_accvgpr_write_b32 a79, v5
s_add_u32 s38, s34, 466944
buffer_load_dword v72, v3, s[20:23], s38 offen
s_add_u32 s38, s34, 467968
buffer_load_dword v73, v3, s[20:23], s38 offen
s_add_u32 s38, s34, 468992
buffer_load_dword v74, v3, s[20:23], s38 offen
s_add_u32 s38, s34, 470016
buffer_load_dword v75, v3, s[20:23], s38 offen
s_add_u32 s38, s34, 471040
buffer_load_dword v76, v3, s[20:23], s38 offen
s_add_u32 s38, s34, 472064
buffer_load_dword v77, v3, s[20:23], s38 offen
s_add_u32 s38, s34, 473088
buffer_load_dword v78, v3, s[20:23], s38 offen
s_add_u32 s38, s34, 474112
buffer_load_dword v79, v3, s[20:23], s38 offen
s_waitcnt vmcnt(46)
v_perm_b32 v4, v89, v88, s50
v_accvgpr_write_b32 a80, v4
s_waitcnt vmcnt(44)
v_perm_b32 v5, v91, v90, s50
v_accvgpr_write_b32 a81, v5
s_waitcnt vmcnt(42)
v_perm_b32 v4, v93, v92, s50
v_accvgpr_write_b32 a82, v4
s_waitcnt vmcnt(40)
v_perm_b32 v5, v95, v94, s50
v_accvgpr_write_b32 a83, v5
v_perm_b32 v4, v89, v88, s51
v_accvgpr_write_b32 a84, v4
v_perm_b32 v5, v91, v90, s51
v_accvgpr_write_b32 a85, v5
v_perm_b32 v4, v93, v92, s51
v_accvgpr_write_b32 a86, v4
v_perm_b32 v5, v95, v94, s51
v_accvgpr_write_b32 a87, v5
s_add_u32 s38, s34, 524288
buffer_load_dword v80, v3, s[20:23], s38 offen
s_add_u32 s38, s34, 525312
buffer_load_dword v81, v3, s[20:23], s38 offen
s_add_u32 s38, s34, 526336
buffer_load_dword v82, v3, s[20:23], s38 offen
s_add_u32 s38, s34, 527360
buffer_load_dword v83, v3, s[20:23], s38 offen
s_add_u32 s38, s34, 528384
buffer_load_dword v84, v3, s[20:23], s38 offen
s_add_u32 s38, s34, 529408
buffer_load_dword v85, v3, s[20:23], s38 offen
s_add_u32 s38, s34, 530432
buffer_load_dword v86, v3, s[20:23], s38 offen
s_add_u32 s38, s34, 531456
buffer_load_dword v87, v3, s[20:23], s38 offen
s_waitcnt vmcnt(46)
v_perm_b32 v4, v97, v96, s50
v_accvgpr_write_b32 a88, v4
s_waitcnt vmcnt(44)
v_perm_b32 v5, v99, v98, s50
v_accvgpr_write_b32 a89, v5
s_waitcnt vmcnt(42)
v_perm_b32 v4, v101, v100, s50
v_accvgpr_write_b32 a90, v4
s_waitcnt vmcnt(40)
v_perm_b32 v5, v103, v102, s50
v_accvgpr_write_b32 a91, v5
v_perm_b32 v4, v97, v96, s51
v_accvgpr_write_b32 a92, v4
v_perm_b32 v5, v99, v98, s51
v_accvgpr_write_b32 a93, v5
v_perm_b32 v4, v101, v100, s51
v_accvgpr_write_b32 a94, v4
v_perm_b32 v5, v103, v102, s51
v_accvgpr_write_b32 a95, v5
s_add_u32 s38, s34, 532480
buffer_load_dword v88, v3, s[20:23], s38 offen
s_add_u32 s38, s34, 533504
buffer_load_dword v89, v3, s[20:23], s38 offen
s_add_u32 s38, s34, 534528
buffer_load_dword v90, v3, s[20:23], s38 offen
s_add_u32 s38, s34, 535552
buffer_load_dword v91, v3, s[20:23], s38 offen
s_add_u32 s38, s34, 536576
buffer_load_dword v92, v3, s[20:23], s38 offen
s_add_u32 s38, s34, 537600
buffer_load_dword v93, v3, s[20:23], s38 offen
s_add_u32 s38, s34, 538624
buffer_load_dword v94, v3, s[20:23], s38 offen
s_add_u32 s38, s34, 539648
buffer_load_dword v95, v3, s[20:23], s38 offen
s_waitcnt vmcnt(46)
v_perm_b32 v4, v105, v104, s50
v_accvgpr_write_b32 a96, v4
s_waitcnt vmcnt(44)
v_perm_b32 v5, v107, v106, s50
v_accvgpr_write_b32 a97, v5
s_waitcnt vmcnt(42)
v_perm_b32 v4, v109, v108, s50
v_accvgpr_write_b32 a98, v4
s_waitcnt vmcnt(40)
v_perm_b32 v5, v111, v110, s50
v_accvgpr_write_b32 a99, v5
v_perm_b32 v4, v105, v104, s51
v_accvgpr_write_b32 a100, v4
v_perm_b32 v5, v107, v106, s51
v_accvgpr_write_b32 a101, v5
v_perm_b32 v4, v109, v108, s51
v_accvgpr_write_b32 a102, v4
v_perm_b32 v5, v111, v110, s51
v_accvgpr_write_b32 a103, v5
s_add_u32 s38, s34, 589824
buffer_load_dword v96, v3, s[20:23], s38 offen
s_add_u32 s38, s34, 590848
buffer_load_dword v97, v3, s[20:23], s38 offen
s_add_u32 s38, s34, 591872
buffer_load_dword v98, v3, s[20:23], s38 offen
s_add_u32 s38, s34, 592896
buffer_load_dword v99, v3, s[20:23], s38 offen
s_add_u32 s38, s34, 593920
buffer_load_dword v100, v3, s[20:23], s38 offen
s_add_u32 s38, s34, 594944
buffer_load_dword v101, v3, s[20:23], s38 offen
s_add_u32 s38, s34, 595968
buffer_load_dword v102, v3, s[20:23], s38 offen
s_add_u32 s38, s34, 596992
buffer_load_dword v103, v3, s[20:23], s38 offen
s_waitcnt vmcnt(46)
v_perm_b32 v4, v113, v112, s50
v_accvgpr_write_b32 a104, v4
s_waitcnt vmcnt(44)
v_perm_b32 v5, v115, v114, s50
v_accvgpr_write_b32 a105, v5
s_waitcnt vmcnt(42)
v_perm_b32 v4, v117, v116, s50
v_accvgpr_write_b32 a106, v4
s_waitcnt vmcnt(40)
v_perm_b32 v5, v119, v118, s50
v_accvgpr_write_b32 a107, v5
v_perm_b32 v4, v113, v112, s51
v_accvgpr_write_b32 a108, v4
v_perm_b32 v5, v115, v114, s51
v_accvgpr_write_b32 a109, v5
v_perm_b32 v4, v117, v116, s51
v_accvgpr_write_b32 a110, v4
v_perm_b32 v5, v119, v118, s51
v_accvgpr_write_b32 a111, v5
s_add_u32 s38, s34, 598016
buffer_load_dword v104, v3, s[20:23], s38 offen
s_add_u32 s38, s34, 599040
buffer_load_dword v105, v3, s[20:23], s38 offen
s_add_u32 s38, s34, 600064
buffer_load_dword v106, v3, s[20:23], s38 offen
s_add_u32 s38, s34, 601088
buffer_load_dword v107, v3, s[20:23], s38 offen
s_add_u32 s38, s34, 602112
buffer_load_dword v108, v3, s[20:23], s38 offen
s_add_u32 s38, s34, 603136
buffer_load_dword v109, v3, s[20:23], s38 offen
s_add_u32 s38, s34, 604160
buffer_load_dword v110, v3, s[20:23], s38 offen
s_add_u32 s38, s34, 605184
buffer_load_dword v111, v3, s[20:23], s38 offen
s_waitcnt vmcnt(46)
v_perm_b32 v4, v65, v64, s50
v_accvgpr_write_b32 a112, v4
s_waitcnt vmcnt(44)
v_perm_b32 v5, v67, v66, s50
v_accvgpr_write_b32 a113, v5
s_waitcnt vmcnt(42)
v_perm_b32 v4, v69, v68, s50
v_accvgpr_write_b32 a114, v4
s_waitcnt vmcnt(40)
v_perm_b32 v5, v71, v70, s50
v_accvgpr_write_b32 a115, v5
v_perm_b32 v4, v65, v64, s51
v_accvgpr_write_b32 a116, v4
v_perm_b32 v5, v67, v66, s51
v_accvgpr_write_b32 a117, v5
v_perm_b32 v4, v69, v68, s51
v_accvgpr_write_b32 a118, v4
v_perm_b32 v5, v71, v70, s51
v_accvgpr_write_b32 a119, v5
s_add_u32 s38, s34, 655360
buffer_load_dword v112, v3, s[20:23], s38 offen
s_add_u32 s38, s34, 656384
buffer_load_dword v113, v3, s[20:23], s38 offen
s_add_u32 s38, s34, 657408
buffer_load_dword v114, v3, s[20:23], s38 offen
s_add_u32 s38, s34, 658432
buffer_load_dword v115, v3, s[20:23], s38 offen
s_add_u32 s38, s34, 659456
buffer_load_dword v116, v3, s[20:23], s38 offen
s_add_u32 s38, s34, 660480
buffer_load_dword v117, v3, s[20:23], s38 offen
s_add_u32 s38, s34, 661504
buffer_load_dword v118, v3, s[20:23], s38 offen
s_add_u32 s38, s34, 662528
buffer_load_dword v119, v3, s[20:23], s38 offen
s_waitcnt vmcnt(46)
v_perm_b32 v4, v73, v72, s50
v_accvgpr_write_b32 a120, v4
s_waitcnt vmcnt(44)
v_perm_b32 v5, v75, v74, s50
v_accvgpr_write_b32 a121, v5
s_waitcnt vmcnt(42)
v_perm_b32 v4, v77, v76, s50
v_accvgpr_write_b32 a122, v4
s_waitcnt vmcnt(40)
v_perm_b32 v5, v79, v78, s50
v_accvgpr_write_b32 a123, v5
v_perm_b32 v4, v73, v72, s51
v_accvgpr_write_b32 a124, v4
v_perm_b32 v5, v75, v74, s51
v_accvgpr_write_b32 a125, v5
v_perm_b32 v4, v77, v76, s51
v_accvgpr_write_b32 a126, v4
v_perm_b32 v5, v79, v78, s51
v_accvgpr_write_b32 a127, v5
s_add_u32 s38, s34, 663552
buffer_load_dword v64, v3, s[20:23], s38 offen
s_add_u32 s38, s34, 664576
buffer_load_dword v65, v3, s[20:23], s38 offen
s_add_u32 s38, s34, 665600
buffer_load_dword v66, v3, s[20:23], s38 offen
s_add_u32 s38, s34, 666624
buffer_load_dword v67, v3, s[20:23], s38 offen
s_add_u32 s38, s34, 667648
buffer_load_dword v68, v3, s[20:23], s38 offen
s_add_u32 s38, s34, 668672
buffer_load_dword v69, v3, s[20:23], s38 offen
s_add_u32 s38, s34, 669696
buffer_load_dword v70, v3, s[20:23], s38 offen
s_add_u32 s38, s34, 670720
buffer_load_dword v71, v3, s[20:23], s38 offen
s_waitcnt vmcnt(46)
v_perm_b32 v4, v81, v80, s50
v_accvgpr_write_b32 a128, v4
s_waitcnt vmcnt(44)
v_perm_b32 v5, v83, v82, s50
v_accvgpr_write_b32 a129, v5
s_waitcnt vmcnt(42)
v_perm_b32 v4, v85, v84, s50
v_accvgpr_write_b32 a130, v4
s_waitcnt vmcnt(40)
v_perm_b32 v5, v87, v86, s50
v_accvgpr_write_b32 a131, v5
v_perm_b32 v4, v81, v80, s51
v_accvgpr_write_b32 a132, v4
v_perm_b32 v5, v83, v82, s51
v_accvgpr_write_b32 a133, v5
v_perm_b32 v4, v85, v84, s51
v_accvgpr_write_b32 a134, v4
v_perm_b32 v5, v87, v86, s51
v_accvgpr_write_b32 a135, v5
s_add_u32 s38, s34, 720896
buffer_load_dword v72, v3, s[20:23], s38 offen
s_add_u32 s38, s34, 721920
buffer_load_dword v73, v3, s[20:23], s38 offen
s_add_u32 s38, s34, 722944
buffer_load_dword v74, v3, s[20:23], s38 offen
s_add_u32 s38, s34, 723968
buffer_load_dword v75, v3, s[20:23], s38 offen
s_add_u32 s38, s34, 724992
buffer_load_dword v76, v3, s[20:23], s38 offen
s_add_u32 s38, s34, 726016
buffer_load_dword v77, v3, s[20:23], s38 offen
s_add_u32 s38, s34, 727040
buffer_load_dword v78, v3, s[20:23], s38 offen
s_add_u32 s38, s34, 728064
buffer_load_dword v79, v3, s[20:23], s38 offen
s_waitcnt vmcnt(46)
v_perm_b32 v4, v89, v88, s50
v_accvgpr_write_b32 a136, v4
s_waitcnt vmcnt(44)
v_perm_b32 v5, v91, v90, s50
v_accvgpr_write_b32 a137, v5
s_waitcnt vmcnt(42)
v_perm_b32 v4, v93, v92, s50
v_accvgpr_write_b32 a138, v4
s_waitcnt vmcnt(40)
v_perm_b32 v5, v95, v94, s50
v_accvgpr_write_b32 a139, v5
v_perm_b32 v4, v89, v88, s51
v_accvgpr_write_b32 a140, v4
v_perm_b32 v5, v91, v90, s51
v_accvgpr_write_b32 a141, v5
v_perm_b32 v4, v93, v92, s51
v_accvgpr_write_b32 a142, v4
v_perm_b32 v5, v95, v94, s51
v_accvgpr_write_b32 a143, v5
s_add_u32 s38, s34, 729088
buffer_load_dword v80, v3, s[20:23], s38 offen
s_add_u32 s38, s34, 730112
buffer_load_dword v81, v3, s[20:23], s38 offen
s_add_u32 s38, s34, 731136
buffer_load_dword v82, v3, s[20:23], s38 offen
s_add_u32 s38, s34, 732160
buffer_load_dword v83, v3, s[20:23], s38 offen
s_add_u32 s38, s34, 733184
buffer_load_dword v84, v3, s[20:23], s38 offen
s_add_u32 s38, s34, 734208
buffer_load_dword v85, v3, s[20:23], s38 offen
s_add_u32 s38, s34, 735232
buffer_load_dword v86, v3, s[20:23], s38 offen
s_add_u32 s38, s34, 736256
buffer_load_dword v87, v3, s[20:23], s38 offen
s_waitcnt vmcnt(46)
v_perm_b32 v4, v97, v96, s50
v_accvgpr_write_b32 a144, v4
s_waitcnt vmcnt(44)
v_perm_b32 v5, v99, v98, s50
v_accvgpr_write_b32 a145, v5
s_waitcnt vmcnt(42)
v_perm_b32 v4, v101, v100, s50
v_accvgpr_write_b32 a146, v4
s_waitcnt vmcnt(40)
v_perm_b32 v5, v103, v102, s50
v_accvgpr_write_b32 a147, v5
v_perm_b32 v4, v97, v96, s51
v_accvgpr_write_b32 a148, v4
v_perm_b32 v5, v99, v98, s51
v_accvgpr_write_b32 a149, v5
v_perm_b32 v4, v101, v100, s51
v_accvgpr_write_b32 a150, v4
v_perm_b32 v5, v103, v102, s51
v_accvgpr_write_b32 a151, v5
s_add_u32 s38, s34, 786432
buffer_load_dword v88, v3, s[20:23], s38 offen
s_add_u32 s38, s34, 787456
buffer_load_dword v89, v3, s[20:23], s38 offen
s_add_u32 s38, s34, 788480
buffer_load_dword v90, v3, s[20:23], s38 offen
s_add_u32 s38, s34, 789504
buffer_load_dword v91, v3, s[20:23], s38 offen
s_add_u32 s38, s34, 790528
buffer_load_dword v92, v3, s[20:23], s38 offen
s_add_u32 s38, s34, 791552
buffer_load_dword v93, v3, s[20:23], s38 offen
s_add_u32 s38, s34, 792576
buffer_load_dword v94, v3, s[20:23], s38 offen
s_add_u32 s38, s34, 793600
buffer_load_dword v95, v3, s[20:23], s38 offen
s_waitcnt vmcnt(46)
v_perm_b32 v4, v105, v104, s50
v_accvgpr_write_b32 a152, v4
s_waitcnt vmcnt(44)
v_perm_b32 v5, v107, v106, s50
v_accvgpr_write_b32 a153, v5
s_waitcnt vmcnt(42)
v_perm_b32 v4, v109, v108, s50
v_accvgpr_write_b32 a154, v4
s_waitcnt vmcnt(40)
v_perm_b32 v5, v111, v110, s50
v_accvgpr_write_b32 a155, v5
v_perm_b32 v4, v105, v104, s51
v_accvgpr_write_b32 a156, v4
v_perm_b32 v5, v107, v106, s51
v_accvgpr_write_b32 a157, v5
v_perm_b32 v4, v109, v108, s51
v_accvgpr_write_b32 a158, v4
v_perm_b32 v5, v111, v110, s51
v_accvgpr_write_b32 a159, v5
s_add_u32 s38, s34, 794624
buffer_load_dword v96, v3, s[20:23], s38 offen
s_add_u32 s38, s34, 795648
buffer_load_dword v97, v3, s[20:23], s38 offen
s_add_u32 s38, s34, 796672
buffer_load_dword v98, v3, s[20:23], s38 offen
s_add_u32 s38, s34, 797696
buffer_load_dword v99, v3, s[20:23], s38 offen
s_add_u32 s38, s34, 798720
buffer_load_dword v100, v3, s[20:23], s38 offen
s_add_u32 s38, s34, 799744
buffer_load_dword v101, v3, s[20:23], s38 offen
s_add_u32 s38, s34, 800768
buffer_load_dword v102, v3, s[20:23], s38 offen
s_add_u32 s38, s34, 801792
buffer_load_dword v103, v3, s[20:23], s38 offen
s_waitcnt vmcnt(46)
v_perm_b32 v4, v113, v112, s50
v_accvgpr_write_b32 a160, v4
s_waitcnt vmcnt(44)
v_perm_b32 v5, v115, v114, s50
v_accvgpr_write_b32 a161, v5
s_waitcnt vmcnt(42)
v_perm_b32 v4, v117, v116, s50
v_accvgpr_write_b32 a162, v4
s_waitcnt vmcnt(40)
v_perm_b32 v5, v119, v118, s50
v_accvgpr_write_b32 a163, v5
v_perm_b32 v4, v113, v112, s51
v_accvgpr_write_b32 a164, v4
v_perm_b32 v5, v115, v114, s51
v_accvgpr_write_b32 a165, v5
v_perm_b32 v4, v117, v116, s51
v_accvgpr_write_b32 a166, v4
v_perm_b32 v5, v119, v118, s51
v_accvgpr_write_b32 a167, v5
s_add_u32 s38, s34, 851968
buffer_load_dword v104, v3, s[20:23], s38 offen
s_add_u32 s38, s34, 852992
buffer_load_dword v105, v3, s[20:23], s38 offen
s_add_u32 s38, s34, 854016
buffer_load_dword v106, v3, s[20:23], s38 offen
s_add_u32 s38, s34, 855040
buffer_load_dword v107, v3, s[20:23], s38 offen
s_add_u32 s38, s34, 856064
buffer_load_dword v108, v3, s[20:23], s38 offen
s_add_u32 s38, s34, 857088
buffer_load_dword v109, v3, s[20:23], s38 offen
s_add_u32 s38, s34, 858112
buffer_load_dword v110, v3, s[20:23], s38 offen
s_add_u32 s38, s34, 859136
buffer_load_dword v111, v3, s[20:23], s38 offen
s_waitcnt vmcnt(46)
v_perm_b32 v4, v65, v64, s50
v_accvgpr_write_b32 a168, v4
s_waitcnt vmcnt(44)
v_perm_b32 v5, v67, v66, s50
v_accvgpr_write_b32 a169, v5
s_waitcnt vmcnt(42)
v_perm_b32 v4, v69, v68, s50
v_accvgpr_write_b32 a170, v4
s_waitcnt vmcnt(40)
v_perm_b32 v5, v71, v70, s50
v_accvgpr_write_b32 a171, v5
v_perm_b32 v4, v65, v64, s51
v_accvgpr_write_b32 a172, v4
v_perm_b32 v5, v67, v66, s51
v_accvgpr_write_b32 a173, v5
v_perm_b32 v4, v69, v68, s51
v_accvgpr_write_b32 a174, v4
v_perm_b32 v5, v71, v70, s51
v_accvgpr_write_b32 a175, v5
s_add_u32 s38, s34, 860160
buffer_load_dword v112, v3, s[20:23], s38 offen
s_add_u32 s38, s34, 861184
buffer_load_dword v113, v3, s[20:23], s38 offen
s_add_u32 s38, s34, 862208
buffer_load_dword v114, v3, s[20:23], s38 offen
s_add_u32 s38, s34, 863232
buffer_load_dword v115, v3, s[20:23], s38 offen
s_add_u32 s38, s34, 864256
buffer_load_dword v116, v3, s[20:23], s38 offen
s_add_u32 s38, s34, 865280
buffer_load_dword v117, v3, s[20:23], s38 offen
s_add_u32 s38, s34, 866304
buffer_load_dword v118, v3, s[20:23], s38 offen
s_add_u32 s38, s34, 867328
buffer_load_dword v119, v3, s[20:23], s38 offen
s_waitcnt vmcnt(46)
v_perm_b32 v4, v73, v72, s50
v_accvgpr_write_b32 a176, v4
s_waitcnt vmcnt(44)
v_perm_b32 v5, v75, v74, s50
v_accvgpr_write_b32 a177, v5
s_waitcnt vmcnt(42)
v_perm_b32 v4, v77, v76, s50
v_accvgpr_write_b32 a178, v4
s_waitcnt vmcnt(40)
v_perm_b32 v5, v79, v78, s50
v_accvgpr_write_b32 a179, v5
v_perm_b32 v4, v73, v72, s51
v_accvgpr_write_b32 a180, v4
v_perm_b32 v5, v75, v74, s51
v_accvgpr_write_b32 a181, v5
v_perm_b32 v4, v77, v76, s51
v_accvgpr_write_b32 a182, v4
v_perm_b32 v5, v79, v78, s51
v_accvgpr_write_b32 a183, v5
s_add_u32 s38, s34, 917504
buffer_load_dword v64, v3, s[20:23], s38 offen
s_add_u32 s38, s34, 918528
buffer_load_dword v65, v3, s[20:23], s38 offen
s_add_u32 s38, s34, 919552
buffer_load_dword v66, v3, s[20:23], s38 offen
s_add_u32 s38, s34, 920576
buffer_load_dword v67, v3, s[20:23], s38 offen
s_add_u32 s38, s34, 921600
buffer_load_dword v68, v3, s[20:23], s38 offen
s_add_u32 s38, s34, 922624
buffer_load_dword v69, v3, s[20:23], s38 offen
s_add_u32 s38, s34, 923648
buffer_load_dword v70, v3, s[20:23], s38 offen
s_add_u32 s38, s34, 924672
buffer_load_dword v71, v3, s[20:23], s38 offen
s_waitcnt vmcnt(46)
v_perm_b32 v4, v81, v80, s50
v_accvgpr_write_b32 a184, v4
s_waitcnt vmcnt(44)
v_perm_b32 v5, v83, v82, s50
v_accvgpr_write_b32 a185, v5
s_waitcnt vmcnt(42)
v_perm_b32 v4, v85, v84, s50
v_accvgpr_write_b32 a186, v4
s_waitcnt vmcnt(40)
v_perm_b32 v5, v87, v86, s50
v_accvgpr_write_b32 a187, v5
v_perm_b32 v4, v81, v80, s51
v_accvgpr_write_b32 a188, v4
v_perm_b32 v5, v83, v82, s51
v_accvgpr_write_b32 a189, v5
v_perm_b32 v4, v85, v84, s51
v_accvgpr_write_b32 a190, v4
v_perm_b32 v5, v87, v86, s51
v_accvgpr_write_b32 a191, v5
s_add_u32 s38, s34, 925696
buffer_load_dword v72, v3, s[20:23], s38 offen
s_add_u32 s38, s34, 926720
buffer_load_dword v73, v3, s[20:23], s38 offen
s_add_u32 s38, s34, 927744
buffer_load_dword v74, v3, s[20:23], s38 offen
s_add_u32 s38, s34, 928768
buffer_load_dword v75, v3, s[20:23], s38 offen
s_add_u32 s38, s34, 929792
buffer_load_dword v76, v3, s[20:23], s38 offen
s_add_u32 s38, s34, 930816
buffer_load_dword v77, v3, s[20:23], s38 offen
s_add_u32 s38, s34, 931840
buffer_load_dword v78, v3, s[20:23], s38 offen
s_add_u32 s38, s34, 932864
buffer_load_dword v79, v3, s[20:23], s38 offen
s_waitcnt vmcnt(46)
v_perm_b32 v4, v89, v88, s50
v_accvgpr_write_b32 a192, v4
s_waitcnt vmcnt(44)
v_perm_b32 v5, v91, v90, s50
v_accvgpr_write_b32 a193, v5
s_waitcnt vmcnt(42)
v_perm_b32 v4, v93, v92, s50
v_accvgpr_write_b32 a194, v4
s_waitcnt vmcnt(40)
v_perm_b32 v5, v95, v94, s50
v_accvgpr_write_b32 a195, v5
v_perm_b32 v4, v89, v88, s51
v_accvgpr_write_b32 a196, v4
v_perm_b32 v5, v91, v90, s51
v_accvgpr_write_b32 a197, v5
v_perm_b32 v4, v93, v92, s51
v_accvgpr_write_b32 a198, v4
v_perm_b32 v5, v95, v94, s51
v_accvgpr_write_b32 a199, v5
s_add_u32 s38, s34, 983040
buffer_load_dword v80, v3, s[20:23], s38 offen
s_add_u32 s38, s34, 984064
buffer_load_dword v81, v3, s[20:23], s38 offen
s_add_u32 s38, s34, 985088
buffer_load_dword v82, v3, s[20:23], s38 offen
s_add_u32 s38, s34, 986112
buffer_load_dword v83, v3, s[20:23], s38 offen
s_add_u32 s38, s34, 987136
buffer_load_dword v84, v3, s[20:23], s38 offen
s_add_u32 s38, s34, 988160
buffer_load_dword v85, v3, s[20:23], s38 offen
s_add_u32 s38, s34, 989184
buffer_load_dword v86, v3, s[20:23], s38 offen
s_add_u32 s38, s34, 990208
buffer_load_dword v87, v3, s[20:23], s38 offen
s_waitcnt vmcnt(46)
v_perm_b32 v4, v97, v96, s50
v_accvgpr_write_b32 a200, v4
s_waitcnt vmcnt(44)
v_perm_b32 v5, v99, v98, s50
v_accvgpr_write_b32 a201, v5
s_waitcnt vmcnt(42)
v_perm_b32 v4, v101, v100, s50
v_accvgpr_write_b32 a202, v4
s_waitcnt vmcnt(40)
v_perm_b32 v5, v103, v102, s50
v_accvgpr_write_b32 a203, v5
v_perm_b32 v4, v97, v96, s51
v_accvgpr_write_b32 a204, v4
v_perm_b32 v5, v99, v98, s51
v_accvgpr_write_b32 a205, v5
v_perm_b32 v4, v101, v100, s51
v_accvgpr_write_b32 a206, v4
v_perm_b32 v5, v103, v102, s51
v_accvgpr_write_b32 a207, v5
s_add_u32 s38, s34, 991232
buffer_load_dword v88, v3, s[20:23], s38 offen
s_add_u32 s38, s34, 992256
buffer_load_dword v89, v3, s[20:23], s38 offen
s_add_u32 s38, s34, 993280
buffer_load_dword v90, v3, s[20:23], s38 offen
s_add_u32 s38, s34, 994304
buffer_load_dword v91, v3, s[20:23], s38 offen
s_add_u32 s38, s34, 995328
buffer_load_dword v92, v3, s[20:23], s38 offen
s_add_u32 s38, s34, 996352
buffer_load_dword v93, v3, s[20:23], s38 offen
s_add_u32 s38, s34, 997376
buffer_load_dword v94, v3, s[20:23], s38 offen
s_add_u32 s38, s34, 998400
buffer_load_dword v95, v3, s[20:23], s38 offen
s_waitcnt vmcnt(46)
v_perm_b32 v4, v105, v104, s50
v_accvgpr_write_b32 a208, v4
s_waitcnt vmcnt(44)
v_perm_b32 v5, v107, v106, s50
v_accvgpr_write_b32 a209, v5
s_waitcnt vmcnt(42)
v_perm_b32 v4, v109, v108, s50
v_accvgpr_write_b32 a210, v4
s_waitcnt vmcnt(40)
v_perm_b32 v5, v111, v110, s50
v_accvgpr_write_b32 a211, v5
v_perm_b32 v4, v105, v104, s51
v_accvgpr_write_b32 a212, v4
v_perm_b32 v5, v107, v106, s51
v_accvgpr_write_b32 a213, v5
v_perm_b32 v4, v109, v108, s51
v_accvgpr_write_b32 a214, v4
v_perm_b32 v5, v111, v110, s51
v_accvgpr_write_b32 a215, v5
s_waitcnt vmcnt(38)
v_perm_b32 v4, v113, v112, s50
v_accvgpr_write_b32 a216, v4
s_waitcnt vmcnt(36)
v_perm_b32 v5, v115, v114, s50
v_accvgpr_write_b32 a217, v5
s_waitcnt vmcnt(34)
v_perm_b32 v4, v117, v116, s50
v_accvgpr_write_b32 a218, v4
s_waitcnt vmcnt(32)
v_perm_b32 v5, v119, v118, s50
v_accvgpr_write_b32 a219, v5
v_perm_b32 v4, v113, v112, s51
v_accvgpr_write_b32 a220, v4
v_perm_b32 v5, v115, v114, s51
v_accvgpr_write_b32 a221, v5
v_perm_b32 v4, v117, v116, s51
v_accvgpr_write_b32 a222, v4
v_perm_b32 v5, v119, v118, s51
v_accvgpr_write_b32 a223, v5
s_waitcnt vmcnt(30)
v_perm_b32 v4, v65, v64, s50
v_accvgpr_write_b32 a224, v4
s_waitcnt vmcnt(28)
v_perm_b32 v5, v67, v66, s50
v_accvgpr_write_b32 a225, v5
s_waitcnt vmcnt(26)
v_perm_b32 v4, v69, v68, s50
v_accvgpr_write_b32 a226, v4
s_waitcnt vmcnt(24)
v_perm_b32 v5, v71, v70, s50
v_accvgpr_write_b32 a227, v5
v_perm_b32 v4, v65, v64, s51
v_accvgpr_write_b32 a228, v4
v_perm_b32 v5, v67, v66, s51
v_accvgpr_write_b32 a229, v5
v_perm_b32 v4, v69, v68, s51
v_accvgpr_write_b32 a230, v4
v_perm_b32 v5, v71, v70, s51
v_accvgpr_write_b32 a231, v5
s_waitcnt vmcnt(22)
v_perm_b32 v4, v73, v72, s50
v_accvgpr_write_b32 a232, v4
s_waitcnt vmcnt(20)
v_perm_b32 v5, v75, v74, s50
v_accvgpr_write_b32 a233, v5
s_waitcnt vmcnt(18)
v_perm_b32 v4, v77, v76, s50
v_accvgpr_write_b32 a234, v4
s_waitcnt vmcnt(16)
v_perm_b32 v5, v79, v78, s50
v_accvgpr_write_b32 a235, v5
v_perm_b32 v4, v73, v72, s51
v_accvgpr_write_b32 a236, v4
v_perm_b32 v5, v75, v74, s51
v_accvgpr_write_b32 a237, v5
v_perm_b32 v4, v77, v76, s51
v_accvgpr_write_b32 a238, v4
v_perm_b32 v5, v79, v78, s51
v_accvgpr_write_b32 a239, v5
s_waitcnt vmcnt(14)
v_perm_b32 v4, v81, v80, s50
v_accvgpr_write_b32 a240, v4
s_waitcnt vmcnt(12)
v_perm_b32 v5, v83, v82, s50
v_accvgpr_write_b32 a241, v5
s_waitcnt vmcnt(10)
v_perm_b32 v4, v85, v84, s50
v_accvgpr_write_b32 a242, v4
s_waitcnt vmcnt(8)
v_perm_b32 v5, v87, v86, s50
v_accvgpr_write_b32 a243, v5
v_perm_b32 v4, v81, v80, s51
v_accvgpr_write_b32 a244, v4
v_perm_b32 v5, v83, v82, s51
v_accvgpr_write_b32 a245, v5
v_perm_b32 v4, v85, v84, s51
v_accvgpr_write_b32 a246, v4
v_perm_b32 v5, v87, v86, s51
v_accvgpr_write_b32 a247, v5
s_waitcnt vmcnt(6)
v_perm_b32 v4, v89, v88, s50
v_accvgpr_write_b32 a248, v4
s_waitcnt vmcnt(4)
v_perm_b32 v5, v91, v90, s50
v_accvgpr_write_b32 a249, v5
s_waitcnt vmcnt(2)
v_perm_b32 v4, v93, v92, s50
v_accvgpr_write_b32 a250, v4
s_waitcnt vmcnt(0)
v_perm_b32 v5, v95, v94, s50
v_accvgpr_write_b32 a251, v5
v_perm_b32 v4, v89, v88, s51
v_accvgpr_write_b32 a252, v4
v_perm_b32 v5, v91, v90, s51
v_accvgpr_write_b32 a253, v5
v_perm_b32 v4, v93, v92, s51
v_accvgpr_write_b32 a254, v4
v_perm_b32 v5, v95, v94, s51
v_accvgpr_write_b32 a255, v5
s_waitcnt vmcnt(0)
O_loop:
s_lshr_b32 s67, s48, 1
s_lshl_b32 s67, s67, 7
s_add_u32 s67, s67, 82853888
v_lshrrev_b32 v4, 2, v1
v_min_u32 v4, 124, v4
WF0:
buffer_load_dword v5, v4, s[8:11], s67 offen sc1
s_waitcnt vmcnt(0)
v_cmp_ne_u32 vcc, s69, v5
s_nop 0
s_cbranch_vccz WF0_ok
s_cmp_eq_u32 s65, 0
s_cbranch_scc1 WF0_ok
s_sub_u32 s65, s65, 1
s_sleep 2
s_branch WF0
WF0_ok:
s_lshr_b32 s38, s48, 1
s_lshl_b32 s38, s38, 18
s_and_b32 s39, s48, 1
s_lshl_b32 s39, s39, 12
s_add_u32 s38, s38, s39
s_lshl_b32 s39, s17, 16
s_add_u32 s38, s38, s39
s_add_u32 s42, s38, 50331648
s_add_u32 s38, s42, 0
buffer_load_dwordx4 v[64:67], v1, s[8:11], s38 offen offset:0
buffer_load_dwordx4 v[68:71], v1, s[8:11], s38 offen offset:1024
buffer_load_dwordx4 v[72:75], v1, s[8:11], s38 offen offset:2048
buffer_load_dwordx4 v[76:79], v1, s[8:11], s38 offen offset:3072
s_add_u32 s38, s42, 8192
buffer_load_dwordx4 v[80:83], v1, s[8:11], s38 offen offset:0
buffer_load_dwordx4 v[84:87], v1, s[8:11], s38 offen offset:1024
buffer_load_dwordx4 v[88:91], v1, s[8:11], s38 offen offset:2048
buffer_load_dwordx4 v[92:95], v1, s[8:11], s38 offen offset:3072
s_add_u32 s38, s42, 16384
buffer_load_dwordx4 v[96:99], v1, s[8:11], s38 offen offset:0
buffer_load_dwordx4 v[100:103], v1, s[8:11], s38 offen offset:1024
buffer_load_dwordx4 v[104:107], v1, s[8:11], s38 offen offset:2048
buffer_load_dwordx4 v[108:111], v1, s[8:11], s38 offen offset:3072
s_add_u32 s38, s42, 24576
buffer_load_dwordx4 v[112:115], v1, s[8:11], s38 offen offset:0
buffer_load_dwordx4 v[116:119], v1, s[8:11], s38 offen offset:1024
buffer_load_dwordx4 v[120:123], v1, s[8:11], s38 offen offset:2048
buffer_load_dwordx4 v[124:127], v1, s[8:11], s38 offen offset:3072
s_add_u32 s38, s42, 32768
buffer_load_dwordx4 v[128:131], v1, s[8:11], s38 offen offset:0
buffer_load_dwordx4 v[132:135], v1, s[8:11], s38 offen offset:1024
buffer_load_dwordx4 v[136:139], v1, s[8:11], s38 offen offset:2048
buffer_load_dwordx4 v[140:143], v1, s[8:11], s38 offen offset:3072
s_add_u32 s38, s42, 40960
buffer_load_dwordx4 v[144:147], v1, s[8:11], s38 offen offset:0
buffer_load_dwordx4 v[148:151], v1, s[8:11], s38 offen offset:1024
buffer_load_dwordx4 v[152:155], v1, s[8:11], s38 offen offset:2048
buffer_load_dwordx4 v[156:159], v1, s[8:11], s38 offen offset:3072
s_add_u32 s38, s42, 49152
buffer_load_dwordx4 v[160:163], v1, s[8:11], s38 offen offset:0
buffer_load_dwordx4 v[164:167], v1, s[8:11], s38 offen offset:1024
buffer_load_dwordx4 v[168:171], v1, s[8:11], s38 offen offset:2048
buffer_load_dwordx4 v[172:175], v1, s[8:11], s38 offen offset:3072
s_add_u32 s38, s42, 57344
buffer_load_dwordx4 v[176:179], v1, s[8:11], s38 offen offset:0
buffer_load_dwordx4 v[180:183], v1, s[8:11], s38 offen offset:1024
buffer_load_dwordx4 v[184:187], v1, s[8:11], s38 offen offset:2048
buffer_load_dwordx4 v[188:191], v1, s[8:11], s38 offen offset:3072
s_waitcnt vmcnt(31)
v_mfma_f32_16x16x32_bf16 v[192:195], a[0:3], v[64:67], 0
v_mfma_f32_16x16x32_bf16 v[196:199], a[4:7], v[64:67], 0
s_waitcnt vmcnt(30)
v_mfma_f32_16x16x32_bf16 v[192:195], a[8:11], v[68:71], v[192:195]
v_mfma_f32_16x16x32_bf16 v[196:199], a[12:15], v[68:71], v[196:199]
s_waitcnt vmcnt(29)
v_mfma_f32_16x16x32_bf16 v[192:195], a[16:19], v[72:75], v[192:195]
v_mfma_f32_16x16x32_bf16 v[196:199], a[20:23], v[72:75], v[196:199]
s_waitcnt vmcnt(28)
v_mfma_f32_16x16x32_bf16 v[192:195], a[24:27], v[76:79], v[192:195]
v_mfma_f32_16x16x32_bf16 v[196:199], a[28:31], v[76:79], v[196:199]
s_waitcnt vmcnt(27)
v_mfma_f32_16x16x32_bf16 v[192:195], a[32:35], v[80:83], v[192:195]
v_mfma_f32_16x16x32_bf16 v[196:199], a[36:39], v[80:83], v[196:199]
s_waitcnt vmcnt(26)
v_mfma_f32_16x16x32_bf16 v[192:195], a[40:43], v[84:87], v[192:195]
v_mfma_f32_16x16x32_bf16 v[196:199], a[44:47], v[84:87], v[196:199]
s_waitcnt vmcnt(25)
v_mfma_f32_16x16x32_bf16 v[192:195], a[48:51], v[88:91], v[192:195]
v_mfma_f32_16x16x32_bf16 v[196:199], a[52:55], v[88:91], v[196:199]
s_waitcnt vmcnt(24)
v_mfma_f32_16x16x32_bf16 v[192:195], a[56:59], v[92:95], v[192:195]
v_mfma_f32_16x16x32_bf16 v[196:199], a[60:63], v[92:95], v[196:199]
s_waitcnt vmcnt(23)
v_mfma_f32_16x16x32_bf16 v[192:195], a[64:67], v[96:99], v[192:195]
v_mfma_f32_16x16x32_bf16 v[196:199], a[68:71], v[96:99], v[196:199]
s_waitcnt vmcnt(22)
v_mfma_f32_16x16x32_bf16 v[192:195], a[72:75], v[100:103], v[192:195]
v_mfma_f32_16x16x32_bf16 v[196:199], a[76:79], v[100:103], v[196:199]
s_waitcnt vmcnt(21)
v_mfma_f32_16x16x32_bf16 v[192:195], a[80:83], v[104:107], v[192:195]
v_mfma_f32_16x16x32_bf16 v[196:199], a[84:87], v[104:107], v[196:199]
s_waitcnt vmcnt(20)
v_mfma_f32_16x16x32_bf16 v[192:195], a[88:91], v[108:111], v[192:195]
v_mfma_f32_16x16x32_bf16 v[196:199], a[92:95], v[108:111], v[196:199]
s_waitcnt vmcnt(19)
v_mfma_f32_16x16x32_bf16 v[192:195], a[96:99], v[112:115], v[192:195]
v_mfma_f32_16x16x32_bf16 v[196:199], a[100:103], v[112:115], v[196:199]
s_waitcnt vmcnt(18)
v_mfma_f32_16x16x32_bf16 v[192:195], a[104:107], v[116:119], v[192:195]
v_mfma_f32_16x16x32_bf16 v[196:199], a[108:111], v[116:119], v[196:199]
s_waitcnt vmcnt(17)
v_mfma_f32_16x16x32_bf16 v[192:195], a[112:115], v[120:123], v[192:195]
v_mfma_f32_16x16x32_bf16 v[196:199], a[116:119], v[120:123], v[196:199]
s_waitcnt vmcnt(16)
v_mfma_f32_16x16x32_bf16 v[192:195], a[120:123], v[124:127], v[192:195]
v_mfma_f32_16x16x32_bf16 v[196:199], a[124:127], v[124:127], v[196:199]
s_waitcnt vmcnt(15)
v_mfma_f32_16x16x32_bf16 v[192:195], a[128:131], v[128:131], v[192:195]
v_mfma_f32_16x16x32_bf16 v[196:199], a[132:135], v[128:131], v[196:199]
s_waitcnt vmcnt(14)
v_mfma_f32_16x16x32_bf16 v[192:195], a[136:139], v[132:135], v[192:195]
v_mfma_f32_16x16x32_bf16 v[196:199], a[140:143], v[132:135], v[196:199]
s_waitcnt vmcnt(13)
v_mfma_f32_16x16x32_bf16 v[192:195], a[144:147], v[136:139], v[192:195]
v_mfma_f32_16x16x32_bf16 v[196:199], a[148:151], v[136:139], v[196:199]
s_waitcnt vmcnt(12)
v_mfma_f32_16x16x32_bf16 v[192:195], a[152:155], v[140:143], v[192:195]
v_mfma_f32_16x16x32_bf16 v[196:199], a[156:159], v[140:143], v[196:199]
s_waitcnt vmcnt(11)
v_mfma_f32_16x16x32_bf16 v[192:195], a[160:163], v[144:147], v[192:195]
v_mfma_f32_16x16x32_bf16 v[196:199], a[164:167], v[144:147], v[196:199]
s_waitcnt vmcnt(10)
v_mfma_f32_16x16x32_bf16 v[192:195], a[168:171], v[148:151], v[192:195]
v_mfma_f32_16x16x32_bf16 v[196:199], a[172:175], v[148:151], v[196:199]
s_waitcnt vmcnt(9)
v_mfma_f32_16x16x32_bf16 v[192:195], a[176:179], v[152:155], v[192:195]
v_mfma_f32_16x16x32_bf16 v[196:199], a[180:183], v[152:155], v[196:199]
s_waitcnt vmcnt(8)
v_mfma_f32_16x16x32_bf16 v[192:195], a[184:187], v[156:159], v[192:195]
v_mfma_f32_16x16x32_bf16 v[196:199], a[188:191], v[156:159], v[196:199]
s_waitcnt vmcnt(7)
v_mfma_f32_16x16x32_bf16 v[192:195], a[192:195], v[160:163], v[192:195]
v_mfma_f32_16x16x32_bf16 v[196:199], a[196:199], v[160:163], v[196:199]
s_waitcnt vmcnt(6)
v_mfma_f32_16x16x32_bf16 v[192:195], a[200:203], v[164:167], v[192:195]
v_mfma_f32_16x16x32_bf16 v[196:199], a[204:207], v[164:167], v[196:199]
s_waitcnt vmcnt(5)
v_mfma_f32_16x16x32_bf16 v[192:195], a[208:211], v[168:171], v[192:195]
v_mfma_f32_16x16x32_bf16 v[196:199], a[212:215], v[168:171], v[196:199]
s_waitcnt vmcnt(4)
v_mfma_f32_16x16x32_bf16 v[192:195], a[216:219], v[172:175], v[192:195]
v_mfma_f32_16x16x32_bf16 v[196:199], a[220:223], v[172:175], v[196:199]
s_waitcnt vmcnt(3)
v_mfma_f32_16x16x32_bf16 v[192:195], a[224:227], v[176:179], v[192:195]
v_mfma_f32_16x16x32_bf16 v[196:199], a[228:231], v[176:179], v[196:199]
s_waitcnt vmcnt(2)
v_mfma_f32_16x16x32_bf16 v[192:195], a[232:235], v[180:183], v[192:195]
v_mfma_f32_16x16x32_bf16 v[196:199], a[236:239], v[180:183], v[196:199]
s_waitcnt vmcnt(1)
v_mfma_f32_16x16x32_bf16 v[192:195], a[240:243], v[184:187], v[192:195]
v_mfma_f32_16x16x32_bf16 v[196:199], a[244:247], v[184:187], v[196:199]
s_waitcnt vmcnt(0)
v_mfma_f32_16x16x32_bf16 v[192:195], a[248:251], v[188:191], v[192:195]
v_mfma_f32_16x16x32_bf16 v[196:199], a[252:255], v[188:191], v[196:199]
s_lshl_b32 s38, s17, 11
v_lshlrev_b32 v4, 1, v1
v_add_u32 v4, s38, v4
s_nop 0
ds_write_b128 v4, v[192:195] offset:0
s_nop 2
ds_write_b128 v4, v[196:199] offset:16
s_waitcnt lgkmcnt(0)
s_barrier
s_cmp_lg_u32 s17, 0
s_cbranch_scc1 OU0_skip
v_lshlrev_b32 v4, 1, v1
ds_read_b128 v[200:203], v4 offset:2048
ds_read_b128 v[204:207], v4 offset:2064
ds_read_b128 v[208:211], v4 offset:4096
ds_read_b128 v[212:215], v4 offset:4112
ds_read_b128 v[216:219], v4 offset:6144
ds_read_b128 v[220:223], v4 offset:6160
s_waitcnt lgkmcnt(5)
v_add_f32 v192, v192, v200
v_add_f32 v193, v193, v201
v_add_f32 v194, v194, v202
v_add_f32 v195, v195, v203
s_waitcnt lgkmcnt(4)
v_add_f32 v196, v196, v204
v_add_f32 v197, v197, v205
v_add_f32 v198, v198, v206
v_add_f32 v199, v199, v207
s_waitcnt lgkmcnt(3)
v_add_f32 v192, v192, v208
v_add_f32 v193, v193, v209
v_add_f32 v194, v194, v210
v_add_f32 v195, v195, v211
s_waitcnt lgkmcnt(2)
v_add_f32 v196, v196, v212
v_add_f32 v197, v197, v213
v_add_f32 v198, v198, v214
v_add_f32 v199, v199, v215
s_waitcnt lgkmcnt(1)
v_add_f32 v192, v192, v216
v_add_f32 v193, v193, v217
v_add_f32 v194, v194, v218
v_add_f32 v195, v195, v219
s_waitcnt lgkmcnt(0)
v_add_f32 v196, v196, v220
v_add_f32 v197, v197, v221
v_add_f32 v198, v198, v222
v_add_f32 v199, v199, v223
v_cvt_pk_bf16_f32 v200, v192, v196
v_cvt_pk_bf16_f32 v201, v193, v197
v_cvt_pk_bf16_f32 v202, v194, v198
v_cvt_pk_bf16_f32 v203, v195, v199
v_lshlrev_b32 v208, 16, v200
v_and_b32 v209, 0xffff0000, v200
v_lshlrev_b32 v210, 16, v201
v_and_b32 v211, 0xffff0000, v201
v_lshlrev_b32 v212, 16, v202
v_and_b32 v213, 0xffff0000, v202
v_lshlrev_b32 v214, 16, v203
v_and_b32 v215, 0xffff0000, v203
v_lshrrev_b32 v4, 4, v1
v_and_b32 v5, 15, v4
v_lshlrev_b32 v5, 12, v5
v_lshrrev_b32 v4, 4, v4
v_lshl_add_u32 v5, v4, 5, v5
s_lshl_b32 s38, s48, 16
s_lshl_b32 s39, s47, 7
s_add_u32 s38, s38, s39
buffer_store_dwordx4 v[208:211], v5, s[28:31], s38 offen
buffer_store_dwordx4 v[212:215], v5, s[28:31], s38 offen offset:16
OU0_skip:
s_cmp_ge_u32 s48, 72
s_cselect_b32 s38, 8, 4
s_add_u32 s48, s48, s38
s_cmp_ge_u32 s48, 128
s_cbranch_scc1 O_end
s_lshr_b32 s67, s48, 1
s_lshl_b32 s67, s67, 7
s_add_u32 s67, s67, 82853888
v_lshrrev_b32 v4, 2, v1
v_min_u32 v4, 124, v4
WF1:
buffer_load_dword v5, v4, s[8:11], s67 offen sc1
s_waitcnt vmcnt(0)
v_cmp_ne_u32 vcc, s69, v5
s_nop 0
s_cbranch_vccz WF1_ok
s_cmp_eq_u32 s65, 0
s_cbranch_scc1 WF1_ok
s_sub_u32 s65, s65, 1
s_sleep 2
s_branch WF1
WF1_ok:
s_lshr_b32 s38, s48, 1
s_lshl_b32 s38, s38, 18
s_and_b32 s39, s48, 1
s_lshl_b32 s39, s39, 12
s_add_u32 s38, s38, s39
s_lshl_b32 s39, s17, 16
s_add_u32 s38, s38, s39
s_add_u32 s42, s38, 50331648
s_add_u32 s38, s42, 0
buffer_load_dwordx4 v[64:67], v1, s[8:11], s38 offen offset:0
buffer_load_dwordx4 v[68:71], v1, s[8:11], s38 offen offset:1024
buffer_load_dwordx4 v[72:75], v1, s[8:11], s38 offen offset:2048
buffer_load_dwordx4 v[76:79], v1, s[8:11], s38 offen offset:3072
s_add_u32 s38, s42, 8192
buffer_load_dwordx4 v[80:83], v1, s[8:11], s38 offen offset:0
buffer_load_dwordx4 v[84:87], v1, s[8:11], s38 offen offset:1024
buffer_load_dwordx4 v[88:91], v1, s[8:11], s38 offen offset:2048
buffer_load_dwordx4 v[92:95], v1, s[8:11], s38 offen offset:3072
s_add_u32 s38, s42, 16384
buffer_load_dwordx4 v[96:99], v1, s[8:11], s38 offen offset:0
buffer_load_dwordx4 v[100:103], v1, s[8:11], s38 offen offset:1024
buffer_load_dwordx4 v[104:107], v1, s[8:11], s38 offen offset:2048
buffer_load_dwordx4 v[108:111], v1, s[8:11], s38 offen offset:3072
s_add_u32 s38, s42, 24576
buffer_load_dwordx4 v[112:115], v1, s[8:11], s38 offen offset:0
buffer_load_dwordx4 v[116:119], v1, s[8:11], s38 offen offset:1024
buffer_load_dwordx4 v[120:123], v1, s[8:11], s38 offen offset:2048
buffer_load_dwordx4 v[124:127], v1, s[8:11], s38 offen offset:3072
s_add_u32 s38, s42, 32768
buffer_load_dwordx4 v[128:131], v1, s[8:11], s38 offen offset:0
buffer_load_dwordx4 v[132:135], v1, s[8:11], s38 offen offset:1024
buffer_load_dwordx4 v[136:139], v1, s[8:11], s38 offen offset:2048
buffer_load_dwordx4 v[140:143], v1, s[8:11], s38 offen offset:3072
s_add_u32 s38, s42, 40960
buffer_load_dwordx4 v[144:147], v1, s[8:11], s38 offen offset:0
buffer_load_dwordx4 v[148:151], v1, s[8:11], s38 offen offset:1024
buffer_load_dwordx4 v[152:155], v1, s[8:11], s38 offen offset:2048
buffer_load_dwordx4 v[156:159], v1, s[8:11], s38 offen offset:3072
s_add_u32 s38, s42, 49152
buffer_load_dwordx4 v[160:163], v1, s[8:11], s38 offen offset:0
buffer_load_dwordx4 v[164:167], v1, s[8:11], s38 offen offset:1024
buffer_load_dwordx4 v[168:171], v1, s[8:11], s38 offen offset:2048
buffer_load_dwordx4 v[172:175], v1, s[8:11], s38 offen offset:3072
s_add_u32 s38, s42, 57344
buffer_load_dwordx4 v[176:179], v1, s[8:11], s38 offen offset:0
buffer_load_dwordx4 v[180:183], v1, s[8:11], s38 offen offset:1024
buffer_load_dwordx4 v[184:187], v1, s[8:11], s38 offen offset:2048
buffer_load_dwordx4 v[188:191], v1, s[8:11], s38 offen offset:3072
s_waitcnt vmcnt(31)
v_mfma_f32_16x16x32_bf16 v[192:195], a[0:3], v[64:67], 0
v_mfma_f32_16x16x32_bf16 v[196:199], a[4:7], v[64:67], 0
s_waitcnt vmcnt(30)
v_mfma_f32_16x16x32_bf16 v[192:195], a[8:11], v[68:71], v[192:195]
v_mfma_f32_16x16x32_bf16 v[196:199], a[12:15], v[68:71], v[196:199]
s_waitcnt vmcnt(29)
v_mfma_f32_16x16x32_bf16 v[192:195], a[16:19], v[72:75], v[192:195]
v_mfma_f32_16x16x32_bf16 v[196:199], a[20:23], v[72:75], v[196:199]
s_waitcnt vmcnt(28)
v_mfma_f32_16x16x32_bf16 v[192:195], a[24:27], v[76:79], v[192:195]
v_mfma_f32_16x16x32_bf16 v[196:199], a[28:31], v[76:79], v[196:199]
s_waitcnt vmcnt(27)
v_mfma_f32_16x16x32_bf16 v[192:195], a[32:35], v[80:83], v[192:195]
v_mfma_f32_16x16x32_bf16 v[196:199], a[36:39], v[80:83], v[196:199]
s_waitcnt vmcnt(26)
v_mfma_f32_16x16x32_bf16 v[192:195], a[40:43], v[84:87], v[192:195]
v_mfma_f32_16x16x32_bf16 v[196:199], a[44:47], v[84:87], v[196:199]
s_waitcnt vmcnt(25)
v_mfma_f32_16x16x32_bf16 v[192:195], a[48:51], v[88:91], v[192:195]
v_mfma_f32_16x16x32_bf16 v[196:199], a[52:55], v[88:91], v[196:199]
s_waitcnt vmcnt(24)
v_mfma_f32_16x16x32_bf16 v[192:195], a[56:59], v[92:95], v[192:195]
v_mfma_f32_16x16x32_bf16 v[196:199], a[60:63], v[92:95], v[196:199]
s_waitcnt vmcnt(23)
v_mfma_f32_16x16x32_bf16 v[192:195], a[64:67], v[96:99], v[192:195]
v_mfma_f32_16x16x32_bf16 v[196:199], a[68:71], v[96:99], v[196:199]
s_waitcnt vmcnt(22)
v_mfma_f32_16x16x32_bf16 v[192:195], a[72:75], v[100:103], v[192:195]
v_mfma_f32_16x16x32_bf16 v[196:199], a[76:79], v[100:103], v[196:199]
s_waitcnt vmcnt(21)
v_mfma_f32_16x16x32_bf16 v[192:195], a[80:83], v[104:107], v[192:195]
v_mfma_f32_16x16x32_bf16 v[196:199], a[84:87], v[104:107], v[196:199]
s_waitcnt vmcnt(20)
v_mfma_f32_16x16x32_bf16 v[192:195], a[88:91], v[108:111], v[192:195]
v_mfma_f32_16x16x32_bf16 v[196:199], a[92:95], v[108:111], v[196:199]
s_waitcnt vmcnt(19)
v_mfma_f32_16x16x32_bf16 v[192:195], a[96:99], v[112:115], v[192:195]
v_mfma_f32_16x16x32_bf16 v[196:199], a[100:103], v[112:115], v[196:199]
s_waitcnt vmcnt(18)
v_mfma_f32_16x16x32_bf16 v[192:195], a[104:107], v[116:119], v[192:195]
v_mfma_f32_16x16x32_bf16 v[196:199], a[108:111], v[116:119], v[196:199]
s_waitcnt vmcnt(17)
v_mfma_f32_16x16x32_bf16 v[192:195], a[112:115], v[120:123], v[192:195]
v_mfma_f32_16x16x32_bf16 v[196:199], a[116:119], v[120:123], v[196:199]
s_waitcnt vmcnt(16)
v_mfma_f32_16x16x32_bf16 v[192:195], a[120:123], v[124:127], v[192:195]
v_mfma_f32_16x16x32_bf16 v[196:199], a[124:127], v[124:127], v[196:199]
s_waitcnt vmcnt(15)
v_mfma_f32_16x16x32_bf16 v[192:195], a[128:131], v[128:131], v[192:195]
v_mfma_f32_16x16x32_bf16 v[196:199], a[132:135], v[128:131], v[196:199]
s_waitcnt vmcnt(14)
v_mfma_f32_16x16x32_bf16 v[192:195], a[136:139], v[132:135], v[192:195]
v_mfma_f32_16x16x32_bf16 v[196:199], a[140:143], v[132:135], v[196:199]
s_waitcnt vmcnt(13)
v_mfma_f32_16x16x32_bf16 v[192:195], a[144:147], v[136:139], v[192:195]
v_mfma_f32_16x16x32_bf16 v[196:199], a[148:151], v[136:139], v[196:199]
s_waitcnt vmcnt(12)
v_mfma_f32_16x16x32_bf16 v[192:195], a[152:155], v[140:143], v[192:195]
v_mfma_f32_16x16x32_bf16 v[196:199], a[156:159], v[140:143], v[196:199]
s_waitcnt vmcnt(11)
v_mfma_f32_16x16x32_bf16 v[192:195], a[160:163], v[144:147], v[192:195]
v_mfma_f32_16x16x32_bf16 v[196:199], a[164:167], v[144:147], v[196:199]
s_waitcnt vmcnt(10)
v_mfma_f32_16x16x32_bf16 v[192:195], a[168:171], v[148:151], v[192:195]
v_mfma_f32_16x16x32_bf16 v[196:199], a[172:175], v[148:151], v[196:199]
s_waitcnt vmcnt(9)
v_mfma_f32_16x16x32_bf16 v[192:195], a[176:179], v[152:155], v[192:195]
v_mfma_f32_16x16x32_bf16 v[196:199], a[180:183], v[152:155], v[196:199]
s_waitcnt vmcnt(8)
v_mfma_f32_16x16x32_bf16 v[192:195], a[184:187], v[156:159], v[192:195]
v_mfma_f32_16x16x32_bf16 v[196:199], a[188:191], v[156:159], v[196:199]
s_waitcnt vmcnt(7)
v_mfma_f32_16x16x32_bf16 v[192:195], a[192:195], v[160:163], v[192:195]
v_mfma_f32_16x16x32_bf16 v[196:199], a[196:199], v[160:163], v[196:199]
s_waitcnt vmcnt(6)
v_mfma_f32_16x16x32_bf16 v[192:195], a[200:203], v[164:167], v[192:195]
v_mfma_f32_16x16x32_bf16 v[196:199], a[204:207], v[164:167], v[196:199]
s_waitcnt vmcnt(5)
v_mfma_f32_16x16x32_bf16 v[192:195], a[208:211], v[168:171], v[192:195]
v_mfma_f32_16x16x32_bf16 v[196:199], a[212:215], v[168:171], v[196:199]
s_waitcnt vmcnt(4)
v_mfma_f32_16x16x32_bf16 v[192:195], a[216:219], v[172:175], v[192:195]
v_mfma_f32_16x16x32_bf16 v[196:199], a[220:223], v[172:175], v[196:199]
s_waitcnt vmcnt(3)
v_mfma_f32_16x16x32_bf16 v[192:195], a[224:227], v[176:179], v[192:195]
v_mfma_f32_16x16x32_bf16 v[196:199], a[228:231], v[176:179], v[196:199]
s_waitcnt vmcnt(2)
v_mfma_f32_16x16x32_bf16 v[192:195], a[232:235], v[180:183], v[192:195]
v_mfma_f32_16x16x32_bf16 v[196:199], a[236:239], v[180:183], v[196:199]
s_waitcnt vmcnt(1)
v_mfma_f32_16x16x32_bf16 v[192:195], a[240:243], v[184:187], v[192:195]
v_mfma_f32_16x16x32_bf16 v[196:199], a[244:247], v[184:187], v[196:199]
s_waitcnt vmcnt(0)
v_mfma_f32_16x16x32_bf16 v[192:195], a[248:251], v[188:191], v[192:195]
v_mfma_f32_16x16x32_bf16 v[196:199], a[252:255], v[188:191], v[196:199]
s_lshl_b32 s38, s17, 11
v_lshlrev_b32 v4, 1, v1
v_add_u32 v4, s38, v4
s_nop 0
ds_write_b128 v4, v[192:195] offset:8192
s_nop 2
ds_write_b128 v4, v[196:199] offset:8208
s_waitcnt lgkmcnt(0)
s_barrier
s_cmp_lg_u32 s17, 0
s_cbranch_scc1 OU1_skip
v_lshlrev_b32 v4, 1, v1
ds_read_b128 v[200:203], v4 offset:10240
ds_read_b128 v[204:207], v4 offset:10256
ds_read_b128 v[208:211], v4 offset:12288
ds_read_b128 v[212:215], v4 offset:12304
ds_read_b128 v[216:219], v4 offset:14336
ds_read_b128 v[220:223], v4 offset:14352
s_waitcnt lgkmcnt(5)
v_add_f32 v192, v192, v200
v_add_f32 v193, v193, v201
v_add_f32 v194, v194, v202
v_add_f32 v195, v195, v203
s_waitcnt lgkmcnt(4)
v_add_f32 v196, v196, v204
v_add_f32 v197, v197, v205
v_add_f32 v198, v198, v206
v_add_f32 v199, v199, v207
s_waitcnt lgkmcnt(3)
v_add_f32 v192, v192, v208
v_add_f32 v193, v193, v209
v_add_f32 v194, v194, v210
v_add_f32 v195, v195, v211
s_waitcnt lgkmcnt(2)
v_add_f32 v196, v196, v212
v_add_f32 v197, v197, v213
v_add_f32 v198, v198, v214
v_add_f32 v199, v199, v215
s_waitcnt lgkmcnt(1)
v_add_f32 v192, v192, v216
v_add_f32 v193, v193, v217
v_add_f32 v194, v194, v218
v_add_f32 v195, v195, v219
s_waitcnt lgkmcnt(0)
v_add_f32 v196, v196, v220
v_add_f32 v197, v197, v221
v_add_f32 v198, v198, v222
v_add_f32 v199, v199, v223
v_cvt_pk_bf16_f32 v200, v192, v196
v_cvt_pk_bf16_f32 v201, v193, v197
v_cvt_pk_bf16_f32 v202, v194, v198
v_cvt_pk_bf16_f32 v203, v195, v199
v_lshlrev_b32 v208, 16, v200
v_and_b32 v209, 0xffff0000, v200
v_lshlrev_b32 v210, 16, v201
v_and_b32 v211, 0xffff0000, v201
v_lshlrev_b32 v212, 16, v202
v_and_b32 v213, 0xffff0000, v202
v_lshlrev_b32 v214, 16, v203
v_and_b32 v215, 0xffff0000, v203
v_lshrrev_b32 v4, 4, v1
v_and_b32 v5, 15, v4
v_lshlrev_b32 v5, 12, v5
v_lshrrev_b32 v4, 4, v4
v_lshl_add_u32 v5, v4, 5, v5
s_lshl_b32 s38, s48, 16
s_lshl_b32 s39, s47, 7
s_add_u32 s38, s38, s39
buffer_store_dwordx4 v[208:211], v5, s[28:31], s38 offen
buffer_store_dwordx4 v[212:215], v5, s[28:31], s38 offen offset:16
OU1_skip:
s_cmp_ge_u32 s48, 72
s_cselect_b32 s38, 8, 4
s_add_u32 s48, s48, s38
s_cmp_ge_u32 s48, 128
s_cbranch_scc1 O_end
s_branch O_loop
O_end:
s_waitcnt vmcnt(0)
s_branch L_end
R_a:
s_mov_b32 s64, s16
v_and_b32 v4, 63, v0
v_and_b32 v5, 15, v4
v_lshrrev_b32 v4, 4, v4
v_lshlrev_b32 v4, 2, v4
s_mov_b32 s62, 0x3e0293ee
v_add_u32 v6, 0, v4
v_cmp_le_u32 s[54:55], v6, v5
v_add_u32 v6, 1, v4
v_cmp_le_u32 s[56:57], v6, v5
v_add_u32 v6, 2, v4
v_cmp_le_u32 s[58:59], v6, v5
v_add_u32 v6, 3, v4
v_cmp_le_u32 s[60:61], v6, v5
v_mov_b32 v204, 0x3f803f80
v_mov_b32 v205, 0x3f803f80
v_mov_b32 v206, 0x3f803f80
v_mov_b32 v207, 0x3f803f80
s_and_b32 s33, s64, 7
s_lshl_b32 s33, s33, 2
s_add_u32 s33, s33, s17
s_lshr_b32 s46, s64, 3
A_loop:
s_lshr_b32 s40, s46, 2
s_lshl_b32 s40, s40, 2
s_lshl_b32 s67, s33, 6
s_add_u32 s67, s67, s40
s_add_u32 s67, s67, 82837504
v_lshrrev_b32 v4, 2, v1
v_min_u32 v4, 0, v4
WF2:
buffer_load_dword v5, v4, s[8:11], s67 offen sc1
s_waitcnt vmcnt(0)
v_cmp_ne_u32 vcc, s69, v5
s_nop 0
s_cbranch_vccz WF2_ok
s_cmp_eq_u32 s65, 0
s_cbranch_scc1 WF2_ok
s_sub_u32 s65, s65, 1
s_sleep 32
s_branch WF2
WF2_ok:
s_lshr_b32 s40, s46, 2
s_lshl_b32 s40, s40, 2
s_lshr_b32 s67, s33, 1
s_lshl_b32 s67, s67, 6
s_add_u32 s67, s67, s40
s_add_u32 s67, s67, 82841600
v_lshrrev_b32 v4, 2, v1
v_min_u32 v4, 0, v4
WF3:
buffer_load_dword v5, v4, s[8:11], s67 offen sc1
s_waitcnt vmcnt(0)
v_cmp_ne_u32 vcc, s69, v5
s_nop 0
s_cbranch_vccz WF3_ok
s_cmp_eq_u32 s65, 0
s_cbranch_scc1 WF3_ok
s_sub_u32 s65, s65, 1
s_sleep 32
s_branch WF3
WF3_ok:
s_lshl_b32 s42, s46, 5
s_add_u32 s42, s42, s33
s_lshl_b32 s43, s42, 13
s_add_u32 s38, s43, 33554432
s_add_u32 s39, s43, 33558528
buffer_load_dwordx4 v[64:67], v1, s[8:11], s38 offen offset:0
buffer_load_dwordx4 v[68:71], v1, s[8:11], s38 offen offset:1024
buffer_load_dwordx4 v[72:75], v1, s[8:11], s38 offen offset:2048
buffer_load_dwordx4 v[76:79], v1, s[8:11], s38 offen offset:3072
buffer_load_dwordx4 v[80:83], v1, s[8:11], s39 offen offset:0
buffer_load_dwordx4 v[84:87], v1, s[8:11], s39 offen offset:1024
buffer_load_dwordx4 v[88:91], v1, s[8:11], s39 offen offset:2048
buffer_load_dwordx4 v[92:95], v1, s[8:11], s39 offen offset:3072
s_add_u32 s38, s43, 0
s_add_u32 s39, s43, 4096
buffer_load_dwordx4 v[96:99], v1, s[8:11], s38 offen offset:0
buffer_load_dwordx4 v[100:103], v1, s[8:11], s38 offen offset:1024
buffer_load_dwordx4 v[104:107], v1, s[8:11], s38 offen offset:2048
buffer_load_dwordx4 v[108:111], v1, s[8:11], s38 offen offset:3072
buffer_load_dwordx4 v[112:115], v1, s[8:11], s39 offen offset:0
buffer_load_dwordx4 v[116:119], v1, s[8:11], s39 offen offset:1024
buffer_load_dwordx4 v[120:123], v1, s[8:11], s39 offen offset:2048
buffer_load_dwordx4 v[124:127], v1, s[8:11], s39 offen offset:3072
s_add_u32 s38, s43, 16777216
s_add_u32 s39, s43, 16781312
buffer_load_dwordx4 v[144:147], v1, s[8:11], s38 offen offset:0
buffer_load_dwordx4 v[148:151], v1, s[8:11], s38 offen offset:1024
buffer_load_dwordx4 v[152:155], v1, s[8:11], s38 offen offset:2048
buffer_load_dwordx4 v[156:159], v1, s[8:11], s38 offen offset:3072
buffer_load_dwordx4 v[160:163], v1, s[8:11], s39 offen offset:0
buffer_load_dwordx4 v[164:167], v1, s[8:11], s39 offen offset:1024
buffer_load_dwordx4 v[168:171], v1, s[8:11], s39 offen offset:2048
buffer_load_dwordx4 v[172:175], v1, s[8:11], s39 offen offset:3072
s_lshl_b32 s67, s46, 7
s_lshl_b32 s40, s33, 2
s_add_u32 s67, s67, s40
s_add_u32 s67, s67, 82845696
v_lshrrev_b32 v4, 2, v1
v_min_u32 v4, 0, v4
WF4:
buffer_load_dword v5, v4, s[8:11], s67 offen sc1
s_waitcnt vmcnt(0)
v_cmp_ne_u32 vcc, s69, v5
s_nop 0
s_cbranch_vccz WF4_ok
s_cmp_eq_u32 s65, 0
s_cbranch_scc1 WF4_ok
s_sub_u32 s65, s65, 1
s_sleep 2
s_branch WF4
WF4_ok:
s_lshl_b32 s38, s42, 11
s_add_u32 s39, s38, 75890688
s_add_u32 s38, s38, 67371008
v_lshrrev_b32 v4, 1, v1
v_and_b32 v5, 0xffffffdf, v1
v_or_b32 v6, 32, v1
buffer_load_dwordx4 v[128:131], v5, s[8:11], s38 offen offset:0
buffer_load_dwordx4 v[132:135], v6, s[8:11], s38 offen offset:0
buffer_load_dwordx4 v[136:139], v5, s[8:11], s38 offen offset:1024
buffer_load_dwordx4 v[140:143], v6, s[8:11], s38 offen offset:1024
buffer_load_dwordx2 v[176:177], v4, s[8:11], s39 offen offset:0
buffer_load_dwordx2 v[178:179], v4, s[8:11], s39 offen offset:512
buffer_load_dwordx2 v[180:181], v4, s[8:11], s39 offen offset:1024
buffer_load_dwordx2 v[182:183], v4, s[8:11], s39 offen offset:1536
v_mfma_f32_16x16x32_bf16 v[184:187], v[96:99], v[64:67], 0
v_mfma_f32_16x16x32_bf16 v[184:187], v[100:103], v[68:71], v[184:187]
v_mfma_f32_16x16x32_bf16 v[184:187], v[104:107], v[72:75], v[184:187]
v_mfma_f32_16x16x32_bf16 v[184:187], v[108:111], v[76:79], v[184:187]
s_waitcnt vmcnt(7)
v_mfma_f32_16x16x32_bf16 v[192:195], v[128:131], v[64:67], 0
s_waitcnt vmcnt(6)
v_mfma_f32_16x16x32_bf16 v[192:195], v[132:135], v[68:71], v[192:195]
s_waitcnt vmcnt(5)
v_mfma_f32_16x16x32_bf16 v[192:195], v[136:139], v[72:75], v[192:195]
s_waitcnt vmcnt(4)
v_mfma_f32_16x16x32_bf16 v[192:195], v[140:143], v[76:79], v[192:195]
v_mov_b32 v208, 0xf149f2ca
v_cndmask_b32 v184, v208, v184, s[54:55]
v_cndmask_b32 v185, v208, v185, s[56:57]
v_cndmask_b32 v186, v208, v186, s[58:59]
v_cndmask_b32 v187, v208, v187, s[60:61]
v_max3_f32 v208, v184, v185, v186
s_nop 1
v_max3_f32 v208, v208, v187, v192
v_max_f32 v208, v208, v193
v_mov_b32 v209, v208
s_nop 1
v_permlane32_swap_b32 v208, v209
v_max_f32 v208, v208, v209
v_mov_b32 v209, v208
s_nop 1
v_permlane16_swap_b32 v208, v209
v_max_f32 v208, v208, v209
v_mul_f32 v208, s62, v208
v_fma_f32 v184, v184, s62, -v208
v_fma_f32 v185, v185, s62, -v208
v_fma_f32 v186, v186, s62, -v208
v_fma_f32 v187, v187, s62, -v208
v_fma_f32 v192, v192, s62, -v208
v_fma_f32 v193, v193, s62, -v208
v_exp_f32 v184, v184
v_exp_f32 v185, v185
v_exp_f32 v186, v186
v_exp_f32 v187, v187
v_exp_f32 v192, v192
v_exp_f32 v193, v193
v_cvt_pk_bf16_f32 v196, v184, v185
v_cvt_pk_bf16_f32 v197, v186, v187
v_mov_b32 v198, 0
v_mov_b32 v199, 0
v_cvt_pk_bf16_f32 v200, v192, v193
v_mov_b32 v201, 0
v_mov_b32 v202, 0
v_mov_b32 v203, v200
v_mfma_f32_16x16x32_bf16 a[0:3], v[144:147], v[196:199], 0
v_mfma_f32_16x16x32_bf16 a[4:7], v[148:151], v[196:199], 0
v_mfma_f32_16x16x32_bf16 a[8:11], v[152:155], v[196:199], 0
v_mfma_f32_16x16x32_bf16 a[12:15], v[156:159], v[196:199], 0
v_mfma_f32_16x16x32_bf16 a[16:19], v[160:163], v[196:199], 0
v_mfma_f32_16x16x32_bf16 a[20:23], v[164:167], v[196:199], 0
v_mfma_f32_16x16x32_bf16 a[24:27], v[168:171], v[196:199], 0
v_mfma_f32_16x16x32_bf16 a[28:31], v[172:175], v[196:199], 0
v_mfma_f32_16x16x32_bf16 a[32:35], v[204:207], v[196:199], 0
s_waitcnt vmcnt(3)
v_mfma_f32_16x16x16_bf16 a[0:3], v[176:177], v[200:201], a[0:3]
v_mfma_f32_16x16x16_bf16 a[4:7], v[176:177], v[202:203], a[4:7]
s_waitcnt vmcnt(2)
v_mfma_f32_16x16x16_bf16 a[8:11], v[178:179], v[200:201], a[8:11]
v_mfma_f32_16x16x16_bf16 a[12:15], v[178:179], v[202:203], a[12:15]
s_waitcnt vmcnt(1)
v_mfma_f32_16x16x16_bf16 a[16:19], v[180:181], v[200:201], a[16:19]
v_mfma_f32_16x16x16_bf16 a[20:23], v[180:181], v[202:203], a[20:23]
s_waitcnt vmcnt(0)
v_mfma_f32_16x16x16_bf16 a[24:27], v[182:183], v[200:201], a[24:27]
v_mfma_f32_16x16x16_bf16 a[28:31], v[182:183], v[202:203], a[28:31]
v_mfma_f32_16x16x16_bf16 a[32:35], v[204:205], v[200:201], a[32:35]
s_nop 7
v_accvgpr_read_b32 v208, a32
v_rcp_f32 v208, v208
s_lshl_b32 s38, s42, 13
s_add_u32 s38, s38, 50331648
v_accvgpr_read_b32 v216, a0
v_accvgpr_read_b32 v217, a4
v_mul_f32 v216, v216, v208
v_mul_f32 v217, v217, v208
v_cvt_pk_bf16_f32 v212, v216, v217
v_accvgpr_read_b32 v216, a8
v_accvgpr_read_b32 v217, a12
v_mul_f32 v216, v216, v208
v_mul_f32 v217, v217, v208
v_cvt_pk_bf16_f32 v213, v216, v217
v_accvgpr_read_b32 v216, a1
v_accvgpr_read_b32 v217, a5
v_mul_f32 v216, v216, v208
v_mul_f32 v217, v217, v208
v_cvt_pk_bf16_f32 v214, v216, v217
v_accvgpr_read_b32 v216, a9
v_accvgpr_read_b32 v217, a13
v_mul_f32 v216, v216, v208
v_mul_f32 v217, v217, v208
v_cvt_pk_bf16_f32 v215, v216, v217
buffer_store_dwordx4 v[212:215], v1, s[8:11], s38 offen offset:0 sc1
v_accvgpr_read_b32 v224, a2
v_accvgpr_read_b32 v225, a6
v_mul_f32 v224, v224, v208
v_mul_f32 v225, v225, v208
v_cvt_pk_bf16_f32 v220, v224, v225
v_accvgpr_read_b32 v224, a10
v_accvgpr_read_b32 v225, a14
v_mul_f32 v224, v224, v208
v_mul_f32 v225, v225, v208
v_cvt_pk_bf16_f32 v221, v224, v225
v_accvgpr_read_b32 v224, a3
v_accvgpr_read_b32 v225, a7
v_mul_f32 v224, v224, v208
v_mul_f32 v225, v225, v208
v_cvt_pk_bf16_f32 v222, v224, v225
v_accvgpr_read_b32 v224, a11
v_accvgpr_read_b32 v225, a15
v_mul_f32 v224, v224, v208
v_mul_f32 v225, v225, v208
v_cvt_pk_bf16_f32 v223, v224, v225
buffer_store_dwordx4 v[220:223], v1, s[8:11], s38 offen offset:1024 sc1
v_accvgpr_read_b32 v216, a16
v_accvgpr_read_b32 v217, a20
v_mul_f32 v216, v216, v208
v_mul_f32 v217, v217, v208
v_cvt_pk_bf16_f32 v212, v216, v217
v_accvgpr_read_b32 v216, a24
v_accvgpr_read_b32 v217, a28
v_mul_f32 v216, v216, v208
v_mul_f32 v217, v217, v208
v_cvt_pk_bf16_f32 v213, v216, v217
v_accvgpr_read_b32 v216, a17
v_accvgpr_read_b32 v217, a21
v_mul_f32 v216, v216, v208
v_mul_f32 v217, v217, v208
v_cvt_pk_bf16_f32 v214, v216, v217
v_accvgpr_read_b32 v216, a25
v_accvgpr_read_b32 v217, a29
v_mul_f32 v216, v216, v208
v_mul_f32 v217, v217, v208
v_cvt_pk_bf16_f32 v215, v216, v217
buffer_store_dwordx4 v[212:215], v1, s[8:11], s38 offen offset:2048 sc1
v_accvgpr_read_b32 v224, a18
v_accvgpr_read_b32 v225, a22
v_mul_f32 v224, v224, v208
v_mul_f32 v225, v225, v208
v_cvt_pk_bf16_f32 v220, v224, v225
v_accvgpr_read_b32 v224, a26
v_accvgpr_read_b32 v225, a30
v_mul_f32 v224, v224, v208
v_mul_f32 v225, v225, v208
v_cvt_pk_bf16_f32 v221, v224, v225
v_accvgpr_read_b32 v224, a19
v_accvgpr_read_b32 v225, a23
v_mul_f32 v224, v224, v208
v_mul_f32 v225, v225, v208
v_cvt_pk_bf16_f32 v222, v224, v225
v_accvgpr_read_b32 v224, a27
v_accvgpr_read_b32 v225, a31
v_mul_f32 v224, v224, v208
v_mul_f32 v225, v225, v208
v_cvt_pk_bf16_f32 v223, v224, v225
buffer_store_dwordx4 v[220:223], v1, s[8:11], s38 offen offset:3072 sc1
v_mfma_f32_16x16x32_bf16 v[184:187], v[96:99], v[80:83], 0
v_mfma_f32_16x16x32_bf16 v[188:191], v[112:115], v[80:83], 0
v_mfma_f32_16x16x32_bf16 v[184:187], v[100:103], v[84:87], v[184:187]
v_mfma_f32_16x16x32_bf16 v[188:191], v[116:119], v[84:87], v[188:191]
v_mfma_f32_16x16x32_bf16 v[184:187], v[104:107], v[88:91], v[184:187]
v_mfma_f32_16x16x32_bf16 v[188:191], v[120:123], v[88:91], v[188:191]
v_mfma_f32_16x16x32_bf16 v[184:187], v[108:111], v[92:95], v[184:187]
v_mfma_f32_16x16x32_bf16 v[188:191], v[124:127], v[92:95], v[188:191]
v_mfma_f32_16x16x32_bf16 v[192:195], v[128:131], v[80:83], 0
v_mfma_f32_16x16x32_bf16 v[192:195], v[132:135], v[84:87], v[192:195]
v_mfma_f32_16x16x32_bf16 v[192:195], v[136:139], v[88:91], v[192:195]
v_mfma_f32_16x16x32_bf16 v[192:195], v[140:143], v[92:95], v[192:195]
v_mov_b32 v208, 0xf149f2ca
v_cndmask_b32 v188, v208, v188, s[54:55]
v_cndmask_b32 v189, v208, v189, s[56:57]
v_cndmask_b32 v190, v208, v190, s[58:59]
v_cndmask_b32 v191, v208, v191, s[60:61]
v_max3_f32 v208, v184, v185, v186
v_max3_f32 v208, v208, v187, v188
v_max3_f32 v208, v208, v189, v190
v_max3_f32 v208, v208, v191, v192
v_max_f32 v208, v208, v193
v_mov_b32 v209, v208
s_nop 1
v_permlane32_swap_b32 v208, v209
v_max_f32 v208, v208, v209
v_mov_b32 v209, v208
s_nop 1
v_permlane16_swap_b32 v208, v209
v_max_f32 v208, v208, v209
v_mul_f32 v208, s62, v208
v_fma_f32 v184, v184, s62, -v208
v_fma_f32 v185, v185, s62, -v208
v_fma_f32 v186, v186, s62, -v208
v_fma_f32 v187, v187, s62, -v208
v_fma_f32 v188, v188, s62, -v208
v_fma_f32 v189, v189, s62, -v208
v_fma_f32 v190, v190, s62, -v208
v_fma_f32 v191, v191, s62, -v208
v_fma_f32 v192, v192, s62, -v208
v_fma_f32 v193, v193, s62, -v208
v_exp_f32 v184, v184
v_exp_f32 v185, v185
v_exp_f32 v186, v186
v_exp_f32 v187, v187
v_exp_f32 v188, v188
v_exp_f32 v189, v189
v_exp_f32 v190, v190
v_exp_f32 v191, v191
v_exp_f32 v192, v192
v_exp_f32 v193, v193
v_cvt_pk_bf16_f32 v196, v184, v185
v_cvt_pk_bf16_f32 v197, v186, v187
v_cvt_pk_bf16_f32 v198, v188, v189
v_cvt_pk_bf16_f32 v199, v190, v191
v_cvt_pk_bf16_f32 v200, v192, v193
v_mov_b32 v201, 0
v_mov_b32 v202, 0
v_mov_b32 v203, v200
v_mfma_f32_16x16x32_bf16 a[0:3], v[144:147], v[196:199], 0
v_mfma_f32_16x16x32_bf16 a[4:7], v[148:151], v[196:199], 0
v_mfma_f32_16x16x32_bf16 a[8:11], v[152:155], v[196:199], 0
v_mfma_f32_16x16x32_bf16 a[12:15], v[156:159], v[196:199], 0
v_mfma_f32_16x16x32_bf16 a[16:19], v[160:163], v[196:199], 0
v_mfma_f32_16x16x32_bf16 a[20:23], v[164:167], v[196:199], 0
v_mfma_f32_16x16x32_bf16 a[24:27], v[168:171], v[196:199], 0
v_mfma_f32_16x16x32_bf16 a[28:31], v[172:175], v[196:199], 0
v_mfma_f32_16x16x32_bf16 a[32:35], v[204:207], v[196:199], 0
v_mfma_f32_16x16x16_bf16 a[0:3], v[176:177], v[200:201], a[0:3]
v_mfma_f32_16x16x16_bf16 a[4:7], v[176:177], v[202:203], a[4:7]
v_mfma_f32_16x16x16_bf16 a[8:11], v[178:179], v[200:201], a[8:11]
v_mfma_f32_16x16x16_bf16 a[12:15], v[178:179], v[202:203], a[12:15]
v_mfma_f32_16x16x16_bf16 a[16:19], v[180:181], v[200:201], a[16:19]
v_mfma_f32_16x16x16_bf16 a[20:23], v[180:181], v[202:203], a[20:23]
v_mfma_f32_16x16x16_bf16 a[24:27], v[182:183], v[200:201], a[24:27]
v_mfma_f32_16x16x16_bf16 a[28:31], v[182:183], v[202:203], a[28:31]
v_mfma_f32_16x16x16_bf16 a[32:35], v[204:205], v[200:201], a[32:35]
s_nop 7
v_accvgpr_read_b32 v208, a32
v_rcp_f32 v208, v208
s_lshl_b32 s38, s42, 13
s_add_u32 s38, s38, 50335744
v_accvgpr_read_b32 v216, a0
v_accvgpr_read_b32 v217, a4
v_mul_f32 v216, v216, v208
v_mul_f32 v217, v217, v208
v_cvt_pk_bf16_f32 v212, v216, v217
v_accvgpr_read_b32 v216, a8
v_accvgpr_read_b32 v217, a12
v_mul_f32 v216, v216, v208
v_mul_f32 v217, v217, v208
v_cvt_pk_bf16_f32 v213, v216, v217
v_accvgpr_read_b32 v216, a1
v_accvgpr_read_b32 v217, a5
v_mul_f32 v216, v216, v208
v_mul_f32 v217, v217, v208
v_cvt_pk_bf16_f32 v214, v216, v217
v_accvgpr_read_b32 v216, a9
v_accvgpr_read_b32 v217, a13
v_mul_f32 v216, v216, v208
v_mul_f32 v217, v217, v208
v_cvt_pk_bf16_f32 v215, v216, v217
buffer_store_dwordx4 v[212:215], v1, s[8:11], s38 offen offset:0 sc1
v_accvgpr_read_b32 v224, a2
v_accvgpr_read_b32 v225, a6
v_mul_f32 v224, v224, v208
v_mul_f32 v225, v225, v208
v_cvt_pk_bf16_f32 v220, v224, v225
v_accvgpr_read_b32 v224, a10
v_accvgpr_read_b32 v225, a14
v_mul_f32 v224, v224, v208
v_mul_f32 v225, v225, v208
v_cvt_pk_bf16_f32 v221, v224, v225
v_accvgpr_read_b32 v224, a3
v_accvgpr_read_b32 v225, a7
v_mul_f32 v224, v224, v208
v_mul_f32 v225, v225, v208
v_cvt_pk_bf16_f32 v222, v224, v225
v_accvgpr_read_b32 v224, a11
v_accvgpr_read_b32 v225, a15
v_mul_f32 v224, v224, v208
v_mul_f32 v225, v225, v208
v_cvt_pk_bf16_f32 v223, v224, v225
buffer_store_dwordx4 v[220:223], v1, s[8:11], s38 offen offset:1024 sc1
v_accvgpr_read_b32 v216, a16
v_accvgpr_read_b32 v217, a20
v_mul_f32 v216, v216, v208
v_mul_f32 v217, v217, v208
v_cvt_pk_bf16_f32 v212, v216, v217
v_accvgpr_read_b32 v216, a24
v_accvgpr_read_b32 v217, a28
v_mul_f32 v216, v216, v208
v_mul_f32 v217, v217, v208
v_cvt_pk_bf16_f32 v213, v216, v217
v_accvgpr_read_b32 v216, a17
v_accvgpr_read_b32 v217, a21
v_mul_f32 v216, v216, v208
v_mul_f32 v217, v217, v208
v_cvt_pk_bf16_f32 v214, v216, v217
v_accvgpr_read_b32 v216, a25
v_accvgpr_read_b32 v217, a29
v_mul_f32 v216, v216, v208
v_mul_f32 v217, v217, v208
v_cvt_pk_bf16_f32 v215, v216, v217
buffer_store_dwordx4 v[212:215], v1, s[8:11], s38 offen offset:2048 sc1
v_accvgpr_read_b32 v224, a18
v_accvgpr_read_b32 v225, a22
v_mul_f32 v224, v224, v208
v_mul_f32 v225, v225, v208
v_cvt_pk_bf16_f32 v220, v224, v225
v_accvgpr_read_b32 v224, a26
v_accvgpr_read_b32 v225, a30
v_mul_f32 v224, v224, v208
v_mul_f32 v225, v225, v208
v_cvt_pk_bf16_f32 v221, v224, v225
v_accvgpr_read_b32 v224, a19
v_accvgpr_read_b32 v225, a23
v_mul_f32 v224, v224, v208
v_mul_f32 v225, v225, v208
v_cvt_pk_bf16_f32 v222, v224, v225
v_accvgpr_read_b32 v224, a27
v_accvgpr_read_b32 v225, a31
v_mul_f32 v224, v224, v208
v_mul_f32 v225, v225, v208
v_cvt_pk_bf16_f32 v223, v224, v225
buffer_store_dwordx4 v[220:223], v1, s[8:11], s38 offen offset:3072 sc1
s_add_u32 s67, s67, 8192
s_waitcnt vmcnt(0)
s_mov_b64 exec, 1
v_mov_b32 v4, s69
v_mov_b32 v5, 0
buffer_store_dword v4, v5, s[8:11], s67 offen sc1
s_mov_b64 exec, -1
s_add_u32 s46, s46, 4
s_cmp_lt_u32 s46, 64
s_cbranch_scc1 A_loop
s_branch L_end
R_s5:
s_sub_u32 s38, s49, 3
s_lshl_b32 s64, s38, 5
s_add_u32 s64, s64, s16
s_mov_b32 s42, s64
s_cmp_ge_u32 s42, 32
s_cbranch_scc1 S0_c
s_lshr_b32 s43, s42, 4
s_lshl_b32 s38, s43, 3
s_add_u32 s38, s38, 80
s_load_dwordx2 s[12:13], s[0:1], s38
s_waitcnt lgkmcnt(0)
s_and_b32 s13, s13, 0xffff
s_mov_b32 s14, 524288
s_mov_b32 s15, 0x20000
s_and_b32 s44, s42, 15
s_lshl_b32 s38, s17, 3
s_lshl_b32 s39, s44, 5
s_add_u32 s39, s39, s38
s_lshl_b32 s39, s39, 10
s_mul_i32 s38, s38, 1040
s_add_u32 m0, s38, 0
s_add_u32 s40, s39, 0
buffer_load_dwordx4 v1, s[12:15], s40 offen lds
s_add_u32 m0, s38, 1040
s_add_u32 s40, s39, 1024
buffer_load_dwordx4 v1, s[12:15], s40 offen lds
s_add_u32 m0, s38, 2080
s_add_u32 s40, s39, 2048
buffer_load_dwordx4 v1, s[12:15], s40 offen lds
s_add_u32 m0, s38, 3120
s_add_u32 s40, s39, 3072
buffer_load_dwordx4 v1, s[12:15], s40 offen lds
s_add_u32 m0, s38, 4160
s_add_u32 s40, s39, 4096
buffer_load_dwordx4 v1, s[12:15], s40 offen lds
s_add_u32 m0, s38, 5200
s_add_u32 s40, s39, 5120
buffer_load_dwordx4 v1, s[12:15], s40 offen lds
s_add_u32 m0, s38, 6240
s_add_u32 s40, s39, 6144
buffer_load_dwordx4 v1, s[12:15], s40 offen lds
s_add_u32 m0, s38, 7280
s_add_u32 s40, s39, 7168
buffer_load_dwordx4 v1, s[12:15], s40 offen lds
v_lshrrev_b32 v4, 4, v1
v_and_b32 v5, 15, v4
v_mul_u32_u24 v2, 1040, v5
v_lshrrev_b32 v4, 4, v4
v_lshl_add_u32 v2, v4, 4, v2
s_waitcnt vmcnt(0)
s_barrier
s_lshr_b32 s38, s17, 1
s_mul_i32 s39, s38, 16640
s_and_b32 s40, s17, 1
s_lshl_b32 s41, s40, 9
s_add_u32 s39, s39, s41
v_add_u32 v2, s39, v2
s_lshl_b32 s45, s42, 1
s_add_u32 s45, s45, s38
s_lshl_b32 s45, s45, 14
s_lshl_b32 s40, s40, 13
s_add_u32 s45, s45, s40
s_add_u32 s45, s45, 101711872
ds_read_b128 v[16:19], v2 offset:0
ds_read_b128 v[20:23], v2 offset:64
ds_read_b128 v[24:27], v2 offset:128
ds_read_b128 v[28:31], v2 offset:192
ds_read_b128 v[32:35], v2 offset:256
ds_read_b128 v[36:39], v2 offset:320
ds_read_b128 v[40:43], v2 offset:384
ds_read_b128 v[44:47], v2 offset:448
s_add_u32 s38, s45, 0
s_waitcnt lgkmcnt(7)
buffer_store_dwordx4 v[16:19], v1, s[8:11], s38 offen sc1
s_add_u32 s38, s45, 1024
s_waitcnt lgkmcnt(6)
buffer_store_dwordx4 v[20:23], v1, s[8:11], s38 offen sc1
s_add_u32 s38, s45, 2048
s_waitcnt lgkmcnt(5)
buffer_store_dwordx4 v[24:27], v1, s[8:11], s38 offen sc1
s_add_u32 s38, s45, 3072
s_waitcnt lgkmcnt(4)
buffer_store_dwordx4 v[28:31], v1, s[8:11], s38 offen sc1
s_add_u32 s38, s45, 4096
s_waitcnt lgkmcnt(3)
buffer_store_dwordx4 v[32:35], v1, s[8:11], s38 offen sc1
s_add_u32 s38, s45, 5120
s_waitcnt lgkmcnt(2)
buffer_store_dwordx4 v[36:39], v1, s[8:11], s38 offen sc1
s_add_u32 s38, s45, 6144
s_waitcnt lgkmcnt(1)
buffer_store_dwordx4 v[40:43], v1, s[8:11], s38 offen sc1
s_add_u32 s38, s45, 7168
s_waitcnt lgkmcnt(0)
buffer_store_dwordx4 v[44:47], v1, s[8:11], s38 offen sc1
s_branch S0_done
S0_c:
s_load_dwordx2 s[20:21], s[0:1], 96
s_waitcnt lgkmcnt(0)
s_and_b32 s21, s21, 0xffff
s_mov_b32 s22, 524288
s_mov_b32 s23, 0x20000
s_load_dwordx2 s[24:25], s[0:1], 104
s_waitcnt lgkmcnt(0)
s_and_b32 s25, s25, 0xffff
s_mov_b32 s26, 524288
s_mov_b32 s27, 0x20000
s_sub_u32 s44, s42, 32
s_lshl_b32 s38, s17, 2
s_lshl_b32 s39, s44, 4
s_add_u32 s39, s39, s38
s_lshl_b32 s39, s39, 10
s_mul_i32 s38, s38, 1040
s_add_u32 m0, s38, 0
s_add_u32 s40, s39, 0
buffer_load_dwordx4 v1, s[20:23], s40 offen lds
s_add_u32 m0, s38, 1040
s_add_u32 s40, s39, 1024
buffer_load_dwordx4 v1, s[20:23], s40 offen lds
s_add_u32 m0, s38, 2080
s_add_u32 s40, s39, 2048
buffer_load_dwordx4 v1, s[20:23], s40 offen lds
s_add_u32 m0, s38, 3120
s_add_u32 s40, s39, 3072
buffer_load_dwordx4 v1, s[20:23], s40 offen lds
s_add_u32 m0, s38, 16640
s_add_u32 s40, s39, 0
buffer_load_dwordx4 v1, s[24:27], s40 offen lds
s_add_u32 m0, s38, 17680
s_add_u32 s40, s39, 1024
buffer_load_dwordx4 v1, s[24:27], s40 offen lds
s_add_u32 m0, s38, 18720
s_add_u32 s40, s39, 2048
buffer_load_dwordx4 v1, s[24:27], s40 offen lds
s_add_u32 m0, s38, 19760
s_add_u32 s40, s39, 3072
buffer_load_dwordx4 v1, s[24:27], s40 offen lds
v_lshrrev_b32 v4, 4, v1
v_and_b32 v5, 15, v4
v_mul_u32_u24 v2, 1040, v5
v_lshrrev_b32 v4, 4, v4
v_lshl_add_u32 v2, v4, 3, v2
s_lshl_b32 s38, s17, 8
v_add_u32 v2, s38, v2
s_lshl_b32 s45, s44, 15
s_lshl_b32 s38, s17, 13
s_add_u32 s45, s45, s38
s_add_u32 s45, s45, 102760448
s_waitcnt vmcnt(0)
s_barrier
ds_read_b64 v[16:17], v2 offset:0
ds_read_b64 v[18:19], v2 offset:16640
ds_read_b64 v[20:21], v2 offset:32
ds_read_b64 v[22:23], v2 offset:16672
ds_read_b64 v[24:25], v2 offset:64
ds_read_b64 v[26:27], v2 offset:16704
ds_read_b64 v[28:29], v2 offset:96
ds_read_b64 v[30:31], v2 offset:16736
ds_read_b64 v[32:33], v2 offset:128
ds_read_b64 v[34:35], v2 offset:16768
ds_read_b64 v[36:37], v2 offset:160
ds_read_b64 v[38:39], v2 offset:16800
ds_read_b64 v[40:41], v2 offset:192
ds_read_b64 v[42:43], v2 offset:16832
ds_read_b64 v[44:45], v2 offset:224
ds_read_b64 v[46:47], v2 offset:16864
s_waitcnt lgkmcnt(14)
v_perm_b32 v48, v18, v16, s50
v_perm_b32 v49, v18, v16, s51
v_perm_b32 v50, v19, v17, s50
v_perm_b32 v51, v19, v17, s51
s_add_u32 s38, s45, 0
buffer_store_dwordx4 v[48:51], v1, s[8:11], s38 offen sc1
s_waitcnt lgkmcnt(12)
v_perm_b32 v52, v22, v20, s50
v_perm_b32 v53, v22, v20, s51
v_perm_b32 v54, v23, v21, s50
v_perm_b32 v55, v23, v21, s51
s_add_u32 s38, s45, 1024
buffer_store_dwordx4 v[52:55], v1, s[8:11], s38 offen sc1
s_waitcnt lgkmcnt(10)
v_perm_b32 v56, v26, v24, s50
v_perm_b32 v57, v26, v24, s51
v_perm_b32 v58, v27, v25, s50
v_perm_b32 v59, v27, v25, s51
s_add_u32 s38, s45, 2048
buffer_store_dwordx4 v[56:59], v1, s[8:11], s38 offen sc1
s_waitcnt lgkmcnt(8)
v_perm_b32 v60, v30, v28, s50
v_perm_b32 v61, v30, v28, s51
v_perm_b32 v62, v31, v29, s50
v_perm_b32 v63, v31, v29, s51
s_add_u32 s38, s45, 3072
buffer_store_dwordx4 v[60:63], v1, s[8:11], s38 offen sc1
s_waitcnt lgkmcnt(6)
v_perm_b32 v48, v34, v32, s50
v_perm_b32 v49, v34, v32, s51
v_perm_b32 v50, v35, v33, s50
v_perm_b32 v51, v35, v33, s51
s_add_u32 s38, s45, 4096
buffer_store_dwordx4 v[48:51], v1, s[8:11], s38 offen sc1
s_waitcnt lgkmcnt(4)
v_perm_b32 v52, v38, v36, s50
v_perm_b32 v53, v38, v36, s51
v_perm_b32 v54, v39, v37, s50
v_perm_b32 v55, v39, v37, s51
s_add_u32 s38, s45, 5120
buffer_store_dwordx4 v[52:55], v1, s[8:11], s38 offen sc1
s_waitcnt lgkmcnt(2)
v_perm_b32 v56, v42, v40, s50
v_perm_b32 v57, v42, v40, s51
v_perm_b32 v58, v43, v41, s50
v_perm_b32 v59, v43, v41, s51
s_add_u32 s38, s45, 6144
buffer_store_dwordx4 v[56:59], v1, s[8:11], s38 offen sc1
s_waitcnt lgkmcnt(0)
v_perm_b32 v60, v46, v44, s50
v_perm_b32 v61, v46, v44, s51
v_perm_b32 v62, v47, v45, s50
v_perm_b32 v63, v47, v45, s51
s_add_u32 s38, s45, 7168
buffer_store_dwordx4 v[60:63], v1, s[8:11], s38 offen sc1
S0_done:
s_lshl_b32 s67, s64, 2
s_add_u32 s67, s67, 82865152
s_waitcnt vmcnt(0) lgkmcnt(0)
s_barrier
s_cmp_lg_u32 s17, 0
s_cbranch_scc1 SF1
s_mov_b64 exec, 1
v_mov_b32 v4, s69
v_mov_b32 v5, 0
buffer_store_dword v4, v5, s[8:11], s67 offen sc1
s_mov_b64 exec, -1
SF1:
s_mov_b32 s67, 82865152
v_lshrrev_b32 v4, 2, v1
v_min_u32 v4, 124, v4
WF5:
buffer_load_dword v5, v4, s[8:11], s67 offen sc1
s_waitcnt vmcnt(0)
v_cmp_ne_u32 vcc, s69, v5
s_nop 0
s_cbranch_vccz WF5_ok
s_cmp_eq_u32 s65, 0
s_cbranch_scc1 WF5_ok
s_sub_u32 s65, s65, 1
s_sleep 8
s_branch WF5
WF5_ok:
s_lshr_b32 s32, s64, 2
s_and_b32 s47, s64, 3
s_load_dwordx2 s[12:13], s[0:1], 56
s_waitcnt lgkmcnt(0)
s_and_b32 s13, s13, 0xffff
s_mov_b32 s14, 2097152
s_mov_b32 s15, 0x20000
s_lshl_b32 s42, s32, 7
s_lshl_b32 s38, s17, 5
s_add_u32 s39, s38, s42
s_mul_i32 s39, s39, 1024
s_add_u32 s39, s39, 0
s_mul_i32 s38, s38, 1040
s_add_u32 m0, s38, 0
s_add_u32 s40, s39, 0
buffer_load_dwordx4 v1, s[12:15], s40 offen lds
s_add_u32 m0, s38, 1040
s_add_u32 s40, s39, 1024
buffer_load_dwordx4 v1, s[12:15], s40 offen lds
s_add_u32 m0, s38, 2080
s_add_u32 s40, s39, 2048
buffer_load_dwordx4 v1, s[12:15], s40 offen lds
s_add_u32 m0, s38, 3120
s_add_u32 s40, s39, 3072
buffer_load_dwordx4 v1, s[12:15], s40 offen lds
s_add_u32 m0, s38, 4160
s_add_u32 s40, s39, 4096
buffer_load_dwordx4 v1, s[12:15], s40 offen lds
s_add_u32 m0, s38, 5200
s_add_u32 s40, s39, 5120
buffer_load_dwordx4 v1, s[12:15], s40 offen lds
s_add_u32 m0, s38, 6240
s_add_u32 s40, s39, 6144
buffer_load_dwordx4 v1, s[12:15], s40 offen lds
s_add_u32 m0, s38, 7280
s_add_u32 s40, s39, 7168
buffer_load_dwordx4 v1, s[12:15], s40 offen lds
s_add_u32 m0, s38, 8320
s_add_u32 s40, s39, 8192
buffer_load_dwordx4 v1, s[12:15], s40 offen lds
s_add_u32 m0, s38, 9360
s_add_u32 s40, s39, 9216
buffer_load_dwordx4 v1, s[12:15], s40 offen lds
s_add_u32 m0, s38, 10400
s_add_u32 s40, s39, 10240
buffer_load_dwordx4 v1, s[12:15], s40 offen lds
s_add_u32 m0, s38, 11440
s_add_u32 s40, s39, 11264
buffer_load_dwordx4 v1, s[12:15], s40 offen lds
s_add_u32 m0, s38, 12480
s_add_u32 s40, s39, 12288
buffer_load_dwordx4 v1, s[12:15], s40 offen lds
s_add_u32 m0, s38, 13520
s_add_u32 s40, s39, 13312
buffer_load_dwordx4 v1, s[12:15], s40 offen lds
s_add_u32 m0, s38, 14560
s_add_u32 s40, s39, 14336
buffer_load_dwordx4 v1, s[12:15], s40 offen lds
s_add_u32 m0, s38, 15600
s_add_u32 s40, s39, 15360
buffer_load_dwordx4 v1, s[12:15], s40 offen lds
s_add_u32 m0, s38, 16640
s_add_u32 s40, s39, 16384
buffer_load_dwordx4 v1, s[12:15], s40 offen lds
s_add_u32 m0, s38, 17680
s_add_u32 s40, s39, 17408
buffer_load_dwordx4 v1, s[12:15], s40 offen lds
s_add_u32 m0, s38, 18720
s_add_u32 s40, s39, 18432
buffer_load_dwordx4 v1, s[12:15], s40 offen lds
s_add_u32 m0, s38, 19760
s_add_u32 s40, s39, 19456
buffer_load_dwordx4 v1, s[12:15], s40 offen lds
s_add_u32 m0, s38, 20800
s_add_u32 s40, s39, 20480
buffer_load_dwordx4 v1, s[12:15], s40 offen lds
s_add_u32 m0, s38, 21840
s_add_u32 s40, s39, 21504
buffer_load_dwordx4 v1, s[12:15], s40 offen lds
s_add_u32 m0, s38, 22880
s_add_u32 s40, s39, 22528
buffer_load_dwordx4 v1, s[12:15], s40 offen lds
s_add_u32 m0, s38, 23920
s_add_u32 s40, s39, 23552
buffer_load_dwordx4 v1, s[12:15], s40 offen lds
s_add_u32 m0, s38, 24960
s_add_u32 s40, s39, 24576
buffer_load_dwordx4 v1, s[12:15], s40 offen lds
s_add_u32 m0, s38, 26000
s_add_u32 s40, s39, 25600
buffer_load_dwordx4 v1, s[12:15], s40 offen lds
s_add_u32 m0, s38, 27040
s_add_u32 s40, s39, 26624
buffer_load_dwordx4 v1, s[12:15], s40 offen lds
s_add_u32 m0, s38, 28080
s_add_u32 s40, s39, 27648
buffer_load_dwordx4 v1, s[12:15], s40 offen lds
s_add_u32 m0, s38, 29120
s_add_u32 s40, s39, 28672
buffer_load_dwordx4 v1, s[12:15], s40 offen lds
s_add_u32 m0, s38, 30160
s_add_u32 s40, s39, 29696
buffer_load_dwordx4 v1, s[12:15], s40 offen lds
s_add_u32 m0, s38, 31200
s_add_u32 s40, s39, 30720
buffer_load_dwordx4 v1, s[12:15], s40 offen lds
s_add_u32 m0, s38, 32240
s_add_u32 s40, s39, 31744
buffer_load_dwordx4 v1, s[12:15], s40 offen lds
s_lshl_b32 s34, s47, 7
s_lshl_b32 s38, s17, 5
s_add_u32 s43, s34, s38
s_lshl_b32 s34, s43, 10
s_add_u32 s34, s34, 101711872
v_lshrrev_b32 v4, 4, v1
v_and_b32 v5, 15, v4
v_mul_u32_u24 v8, 1040, v5
v_lshrrev_b32 v4, 4, v4
v_lshl_add_u32 v8, v4, 4, v8
v_add_u32 v9, 66560, v8
s_add_u32 s38, s34, 0
buffer_load_dwordx4 v[16:19], v1, s[8:11], s38 offen
s_add_u32 s38, s34, 524288
buffer_load_dwordx4 v[20:23], v1, s[8:11], s38 offen
s_add_u32 s38, s34, 16384
buffer_load_dwordx4 v[24:27], v1, s[8:11], s38 offen
s_add_u32 s38, s34, 540672
buffer_load_dwordx4 v[28:31], v1, s[8:11], s38 offen
s_add_u32 s38, s34, 1024
buffer_load_dwordx4 v[32:35], v1, s[8:11], s38 offen
s_add_u32 s38, s34, 525312
buffer_load_dwordx4 v[36:39], v1, s[8:11], s38 offen
s_add_u32 s38, s34, 17408
buffer_load_dwordx4 v[40:43], v1, s[8:11], s38 offen
s_add_u32 s38, s34, 541696
buffer_load_dwordx4 v[44:47], v1, s[8:11], s38 offen
s_add_u32 s38, s34, 2048
buffer_load_dwordx4 v[48:51], v1, s[8:11], s38 offen
s_add_u32 s38, s34, 526336
buffer_load_dwordx4 v[52:55], v1, s[8:11], s38 offen
s_add_u32 s38, s34, 18432
buffer_load_dwordx4 v[56:59], v1, s[8:11], s38 offen
s_add_u32 s38, s34, 542720
buffer_load_dwordx4 v[60:63], v1, s[8:11], s38 offen
s_add_u32 s38, s34, 3072
buffer_load_dwordx4 v[64:67], v1, s[8:11], s38 offen
s_add_u32 s38, s34, 527360
buffer_load_dwordx4 v[68:71], v1, s[8:11], s38 offen
s_add_u32 s38, s34, 19456
buffer_load_dwordx4 v[72:75], v1, s[8:11], s38 offen
s_add_u32 s38, s34, 543744
buffer_load_dwordx4 v[76:79], v1, s[8:11], s38 offen
s_waitcnt vmcnt(0)
s_barrier
ds_read_b128 a[0:3], v8 offset:0
ds_read_b128 a[4:7], v8 offset:16640
ds_read_b128 a[8:11], v8 offset:33280
ds_read_b128 a[12:15], v8 offset:49920
ds_read_b128 a[16:19], v9 offset:0
ds_read_b128 a[20:23], v9 offset:16640
ds_read_b128 a[24:27], v9 offset:33280
ds_read_b128 a[28:31], v9 offset:49920
s_waitcnt lgkmcnt(7)
v_mfma_f32_16x16x32_bf16 v[128:131], v[16:19], a[0:3], 0
v_mfma_f32_16x16x32_bf16 v[132:135], v[20:23], a[0:3], 0
ds_read_b128 a[32:35], v8 offset:64
v_mfma_f32_16x16x32_bf16 v[136:139], v[24:27], a[0:3], 0
v_mfma_f32_16x16x32_bf16 v[140:143], v[28:31], a[0:3], 0
s_add_u32 s38, s34, 4096
buffer_load_dwordx4 v[80:83], v1, s[8:11], s38 offen
s_waitcnt lgkmcnt(7)
v_mfma_f32_16x16x32_bf16 v[144:147], v[16:19], a[4:7], 0
v_mfma_f32_16x16x32_bf16 v[148:151], v[20:23], a[4:7], 0
ds_read_b128 a[36:39], v8 offset:16704
v_mfma_f32_16x16x32_bf16 v[152:155], v[24:27], a[4:7], 0
v_mfma_f32_16x16x32_bf16 v[156:159], v[28:31], a[4:7], 0
s_add_u32 s38, s34, 528384
buffer_load_dwordx4 v[84:87], v1, s[8:11], s38 offen
s_waitcnt lgkmcnt(7)
v_mfma_f32_16x16x32_bf16 v[160:163], v[16:19], a[8:11], 0
v_mfma_f32_16x16x32_bf16 v[164:167], v[20:23], a[8:11], 0
ds_read_b128 a[40:43], v8 offset:33344
v_mfma_f32_16x16x32_bf16 v[168:171], v[24:27], a[8:11], 0
v_mfma_f32_16x16x32_bf16 v[172:175], v[28:31], a[8:11], 0
s_add_u32 s38, s34, 20480
buffer_load_dwordx4 v[88:91], v1, s[8:11], s38 offen
s_waitcnt lgkmcnt(7)
v_mfma_f32_16x16x32_bf16 v[176:179], v[16:19], a[12:15], 0
v_mfma_f32_16x16x32_bf16 v[180:183], v[20:23], a[12:15], 0
ds_read_b128 a[44:47], v8 offset:49984
v_mfma_f32_16x16x32_bf16 v[184:187], v[24:27], a[12:15], 0
v_mfma_f32_16x16x32_bf16 v[188:191], v[28:31], a[12:15], 0
s_add_u32 s38, s34, 544768
buffer_load_dwordx4 v[92:95], v1, s[8:11], s38 offen
s_waitcnt lgkmcnt(7)
v_mfma_f32_16x16x32_bf16 v[192:195], v[16:19], a[16:19], 0
v_mfma_f32_16x16x32_bf16 v[196:199], v[20:23], a[16:19], 0
ds_read_b128 a[48:51], v9 offset:64
v_mfma_f32_16x16x32_bf16 v[200:203], v[24:27], a[16:19], 0
v_mfma_f32_16x16x32_bf16 v[204:207], v[28:31], a[16:19], 0
s_waitcnt lgkmcnt(7)
v_mfma_f32_16x16x32_bf16 v[208:211], v[16:19], a[20:23], 0
v_mfma_f32_16x16x32_bf16 v[212:215], v[20:23], a[20:23], 0
ds_read_b128 a[52:55], v9 offset:16704
v_mfma_f32_16x16x32_bf16 v[216:219], v[24:27], a[20:23], 0
v_mfma_f32_16x16x32_bf16 v[220:223], v[28:31], a[20:23], 0
s_waitcnt lgkmcnt(7)
v_mfma_f32_16x16x32_bf16 v[224:227], v[16:19], a[24:27], 0
v_mfma_f32_16x16x32_bf16 v[228:231], v[20:23], a[24:27], 0
ds_read_b128 a[56:59], v9 offset:33344
v_mfma_f32_16x16x32_bf16 v[232:235], v[24:27], a[24:27], 0
v_mfma_f32_16x16x32_bf16 v[236:239], v[28:31], a[24:27], 0
s_waitcnt lgkmcnt(7)
v_mfma_f32_16x16x32_bf16 v[240:243], v[16:19], a[28:31], 0
v_mfma_f32_16x16x32_bf16 v[244:247], v[20:23], a[28:31], 0
ds_read_b128 a[60:63], v9 offset:49984
v_mfma_f32_16x16x32_bf16 v[248:251], v[24:27], a[28:31], 0
v_mfma_f32_16x16x32_bf16 v[252:255], v[28:31], a[28:31], 0
s_waitcnt lgkmcnt(7)
v_mfma_f32_16x16x32_bf16 v[128:131], v[32:35], a[32:35], v[128:131]
v_mfma_f32_16x16x32_bf16 v[132:135], v[36:39], a[32:35], v[132:135]
ds_read_b128 a[0:3], v8 offset:128
v_mfma_f32_16x16x32_bf16 v[136:139], v[40:43], a[32:35], v[136:139]
v_mfma_f32_16x16x32_bf16 v[140:143], v[44:47], a[32:35], v[140:143]
s_add_u32 s38, s34, 5120
buffer_load_dwordx4 v[16:19], v1, s[8:11], s38 offen
s_waitcnt lgkmcnt(7)
v_mfma_f32_16x16x32_bf16 v[144:147], v[32:35], a[36:39], v[144:147]
v_mfma_f32_16x16x32_bf16 v[148:151], v[36:39], a[36:39], v[148:151]
ds_read_b128 a[4:7], v8 offset:16768
v_mfma_f32_16x16x32_bf16 v[152:155], v[40:43], a[36:39], v[152:155]
v_mfma_f32_16x16x32_bf16 v[156:159], v[44:47], a[36:39], v[156:159]
s_add_u32 s38, s34, 529408
buffer_load_dwordx4 v[20:23], v1, s[8:11], s38 offen
s_waitcnt lgkmcnt(7)
v_mfma_f32_16x16x32_bf16 v[160:163], v[32:35], a[40:43], v[160:163]
v_mfma_f32_16x16x32_bf16 v[164:167], v[36:39], a[40:43], v[164:167]
ds_read_b128 a[8:11], v8 offset:33408
v_mfma_f32_16x16x32_bf16 v[168:171], v[40:43], a[40:43], v[168:171]
v_mfma_f32_16x16x32_bf16 v[172:175], v[44:47], a[40:43], v[172:175]
s_add_u32 s38, s34, 21504
buffer_load_dwordx4 v[24:27], v1, s[8:11], s38 offen
s_waitcnt lgkmcnt(7)
v_mfma_f32_16x16x32_bf16 v[176:179], v[32:35], a[44:47], v[176:179]
v_mfma_f32_16x16x32_bf16 v[180:183], v[36:39], a[44:47], v[180:183]
ds_read_b128 a[12:15], v8 offset:50048
v_mfma_f32_16x16x32_bf16 v[184:187], v[40:43], a[44:47], v[184:187]
v_mfma_f32_16x16x32_bf16 v[188:191], v[44:47], a[44:47], v[188:191]
s_add_u32 s38, s34, 545792
buffer_load_dwordx4 v[28:31], v1, s[8:11], s38 offen
s_waitcnt lgkmcnt(7)
v_mfma_f32_16x16x32_bf16 v[192:195], v[32:35], a[48:51], v[192:195]
v_mfma_f32_16x16x32_bf16 v[196:199], v[36:39], a[48:51], v[196:199]
ds_read_b128 a[16:19], v9 offset:128
v_mfma_f32_16x16x32_bf16 v[200:203], v[40:43], a[48:51], v[200:203]
v_mfma_f32_16x16x32_bf16 v[204:207], v[44:47], a[48:51], v[204:207]
s_waitcnt lgkmcnt(7)
v_mfma_f32_16x16x32_bf16 v[208:211], v[32:35], a[52:55], v[208:211]
v_mfma_f32_16x16x32_bf16 v[212:215], v[36:39], a[52:55], v[212:215]
ds_read_b128 a[20:23], v9 offset:16768
v_mfma_f32_16x16x32_bf16 v[216:219], v[40:43], a[52:55], v[216:219]
v_mfma_f32_16x16x32_bf16 v[220:223], v[44:47], a[52:55], v[220:223]
s_waitcnt lgkmcnt(7)
v_mfma_f32_16x16x32_bf16 v[224:227], v[32:35], a[56:59], v[224:227]
v_mfma_f32_16x16x32_bf16 v[228:231], v[36:39], a[56:59], v[228:231]
ds_read_b128 a[24:27], v9 offset:33408
v_mfma_f32_16x16x32_bf16 v[232:235], v[40:43], a[56:59], v[232:235]
v_mfma_f32_16x16x32_bf16 v[236:239], v[44:47], a[56:59], v[236:239]
s_waitcnt lgkmcnt(7)
v_mfma_f32_16x16x32_bf16 v[240:243], v[32:35], a[60:63], v[240:243]
v_mfma_f32_16x16x32_bf16 v[244:247], v[36:39], a[60:63], v[244:247]
ds_read_b128 a[28:31], v9 offset:50048
v_mfma_f32_16x16x32_bf16 v[248:251], v[40:43], a[60:63], v[248:251]
v_mfma_f32_16x16x32_bf16 v[252:255], v[44:47], a[60:63], v[252:255]
s_waitcnt lgkmcnt(7)
v_mfma_f32_16x16x32_bf16 v[128:131], v[48:51], a[0:3], v[128:131]
v_mfma_f32_16x16x32_bf16 v[132:135], v[52:55], a[0:3], v[132:135]
ds_read_b128 a[32:35], v8 offset:192
v_mfma_f32_16x16x32_bf16 v[136:139], v[56:59], a[0:3], v[136:139]
v_mfma_f32_16x16x32_bf16 v[140:143], v[60:63], a[0:3], v[140:143]
s_add_u32 s38, s34, 6144
buffer_load_dwordx4 v[32:35], v1, s[8:11], s38 offen
s_waitcnt lgkmcnt(7)
v_mfma_f32_16x16x32_bf16 v[144:147], v[48:51], a[4:7], v[144:147]
v_mfma_f32_16x16x32_bf16 v[148:151], v[52:55], a[4:7], v[148:151]
ds_read_b128 a[36:39], v8 offset:16832
v_mfma_f32_16x16x32_bf16 v[152:155], v[56:59], a[4:7], v[152:155]
v_mfma_f32_16x16x32_bf16 v[156:159], v[60:63], a[4:7], v[156:159]
s_add_u32 s38, s34, 530432
buffer_load_dwordx4 v[36:39], v1, s[8:11], s38 offen
s_waitcnt lgkmcnt(7)
v_mfma_f32_16x16x32_bf16 v[160:163], v[48:51], a[8:11], v[160:163]
v_mfma_f32_16x16x32_bf16 v[164:167], v[52:55], a[8:11], v[164:167]
ds_read_b128 a[40:43], v8 offset:33472
v_mfma_f32_16x16x32_bf16 v[168:171], v[56:59], a[8:11], v[168:171]
v_mfma_f32_16x16x32_bf16 v[172:175], v[60:63], a[8:11], v[172:175]
s_add_u32 s38, s34, 22528
buffer_load_dwordx4 v[40:43], v1, s[8:11], s38 offen
s_waitcnt lgkmcnt(7)
v_mfma_f32_16x16x32_bf16 v[176:179], v[48:51], a[12:15], v[176:179]
v_mfma_f32_16x16x32_bf16 v[180:183], v[52:55], a[12:15], v[180:183]
ds_read_b128 a[44:47], v8 offset:50112
v_mfma_f32_16x16x32_bf16 v[184:187], v[56:59], a[12:15], v[184:187]
v_mfma_f32_16x16x32_bf16 v[188:191], v[60:63], a[12:15], v[188:191]
s_add_u32 s38, s34, 546816
buffer_load_dwordx4 v[44:47], v1, s[8:11], s38 offen
s_waitcnt lgkmcnt(7)
v_mfma_f32_16x16x32_bf16 v[192:195], v[48:51], a[16:19], v[192:195]
v_mfma_f32_16x16x32_bf16 v[196:199], v[52:55], a[16:19], v[196:199]
ds_read_b128 a[48:51], v9 offset:192
v_mfma_f32_16x16x32_bf16 v[200:203], v[56:59], a[16:19], v[200:203]
v_mfma_f32_16x16x32_bf16 v[204:207], v[60:63], a[16:19], v[204:207]
s_waitcnt lgkmcnt(7)
v_mfma_f32_16x16x32_bf16 v[208:211], v[48:51], a[20:23], v[208:211]
v_mfma_f32_16x16x32_bf16 v[212:215], v[52:55], a[20:23], v[212:215]
ds_read_b128 a[52:55], v9 offset:16832
v_mfma_f32_16x16x32_bf16 v[216:219], v[56:59], a[20:23], v[216:219]
v_mfma_f32_16x16x32_bf16 v[220:223], v[60:63], a[20:23], v[220:223]
s_waitcnt lgkmcnt(7)
v_mfma_f32_16x16x32_bf16 v[224:227], v[48:51], a[24:27], v[224:227]
v_mfma_f32_16x16x32_bf16 v[228:231], v[52:55], a[24:27], v[228:231]
ds_read_b128 a[56:59], v9 offset:33472
v_mfma_f32_16x16x32_bf16 v[232:235], v[56:59], a[24:27], v[232:235]
v_mfma_f32_16x16x32_bf16 v[236:239], v[60:63], a[24:27], v[236:239]
s_waitcnt lgkmcnt(7)
v_mfma_f32_16x16x32_bf16 v[240:243], v[48:51], a[28:31], v[240:243]
v_mfma_f32_16x16x32_bf16 v[244:247], v[52:55], a[28:31], v[244:247]
ds_read_b128 a[60:63], v9 offset:50112
v_mfma_f32_16x16x32_bf16 v[248:251], v[56:59], a[28:31], v[248:251]
v_mfma_f32_16x16x32_bf16 v[252:255], v[60:63], a[28:31], v[252:255]
s_waitcnt lgkmcnt(7)
v_mfma_f32_16x16x32_bf16 v[128:131], v[64:67], a[32:35], v[128:131]
v_mfma_f32_16x16x32_bf16 v[132:135], v[68:71], a[32:35], v[132:135]
ds_read_b128 a[0:3], v8 offset:256
v_mfma_f32_16x16x32_bf16 v[136:139], v[72:75], a[32:35], v[136:139]
v_mfma_f32_16x16x32_bf16 v[140:143], v[76:79], a[32:35], v[140:143]
s_add_u32 s38, s34, 7168
buffer_load_dwordx4 v[48:51], v1, s[8:11], s38 offen
s_waitcnt lgkmcnt(7)
v_mfma_f32_16x16x32_bf16 v[144:147], v[64:67], a[36:39], v[144:147]
v_mfma_f32_16x16x32_bf16 v[148:151], v[68:71], a[36:39], v[148:151]
ds_read_b128 a[4:7], v8 offset:16896
v_mfma_f32_16x16x32_bf16 v[152:155], v[72:75], a[36:39], v[152:155]
v_mfma_f32_16x16x32_bf16 v[156:159], v[76:79], a[36:39], v[156:159]
s_add_u32 s38, s34, 531456
buffer_load_dwordx4 v[52:55], v1, s[8:11], s38 offen
s_waitcnt lgkmcnt(7)
v_mfma_f32_16x16x32_bf16 v[160:163], v[64:67], a[40:43], v[160:163]
v_mfma_f32_16x16x32_bf16 v[164:167], v[68:71], a[40:43], v[164:167]
ds_read_b128 a[8:11], v8 offset:33536
v_mfma_f32_16x16x32_bf16 v[168:171], v[72:75], a[40:43], v[168:171]
v_mfma_f32_16x16x32_bf16 v[172:175], v[76:79], a[40:43], v[172:175]
s_add_u32 s38, s34, 23552
buffer_load_dwordx4 v[56:59], v1, s[8:11], s38 offen
s_waitcnt lgkmcnt(7)
v_mfma_f32_16x16x32_bf16 v[176:179], v[64:67], a[44:47], v[176:179]
v_mfma_f32_16x16x32_bf16 v[180:183], v[68:71], a[44:47], v[180:183]
ds_read_b128 a[12:15], v8 offset:50176
v_mfma_f32_16x16x32_bf16 v[184:187], v[72:75], a[44:47], v[184:187]
v_mfma_f32_16x16x32_bf16 v[188:191], v[76:79], a[44:47], v[188:191]
s_add_u32 s38, s34, 547840
buffer_load_dwordx4 v[60:63], v1, s[8:11], s38 offen
s_waitcnt lgkmcnt(7)
v_mfma_f32_16x16x32_bf16 v[192:195], v[64:67], a[48:51], v[192:195]
v_mfma_f32_16x16x32_bf16 v[196:199], v[68:71], a[48:51], v[196:199]
ds_read_b128 a[16:19], v9 offset:256
v_mfma_f32_16x16x32_bf16 v[200:203], v[72:75], a[48:51], v[200:203]
v_mfma_f32_16x16x32_bf16 v[204:207], v[76:79], a[48:51], v[204:207]
s_waitcnt lgkmcnt(7)
v_mfma_f32_16x16x32_bf16 v[208:211], v[64:67], a[52:55], v[208:211]
v_mfma_f32_16x16x32_bf16 v[212:215], v[68:71], a[52:55], v[212:215]
ds_read_b128 a[20:23], v9 offset:16896
v_mfma_f32_16x16x32_bf16 v[216:219], v[72:75], a[52:55], v[216:219]
v_mfma_f32_16x16x32_bf16 v[220:223], v[76:79], a[52:55], v[220:223]
s_waitcnt lgkmcnt(7)
v_mfma_f32_16x16x32_bf16 v[224:227], v[64:67], a[56:59], v[224:227]
v_mfma_f32_16x16x32_bf16 v[228:231], v[68:71], a[56:59], v[228:231]
ds_read_b128 a[24:27], v9 offset:33536
v_mfma_f32_16x16x32_bf16 v[232:235], v[72:75], a[56:59], v[232:235]
v_mfma_f32_16x16x32_bf16 v[236:239], v[76:79], a[56:59], v[236:239]
s_waitcnt lgkmcnt(7)
v_mfma_f32_16x16x32_bf16 v[240:243], v[64:67], a[60:63], v[240:243]
v_mfma_f32_16x16x32_bf16 v[244:247], v[68:71], a[60:63], v[244:247]
ds_read_b128 a[28:31], v9 offset:50176
v_mfma_f32_16x16x32_bf16 v[248:251], v[72:75], a[60:63], v[248:251]
v_mfma_f32_16x16x32_bf16 v[252:255], v[76:79], a[60:63], v[252:255]
s_waitcnt vmcnt(15) lgkmcnt(7)
v_mfma_f32_16x16x32_bf16 v[128:131], v[80:83], a[0:3], v[128:131]
s_waitcnt vmcnt(14)
v_mfma_f32_16x16x32_bf16 v[132:135], v[84:87], a[0:3], v[132:135]
ds_read_b128 a[32:35], v8 offset:320
s_waitcnt vmcnt(13)
v_mfma_f32_16x16x32_bf16 v[136:139], v[88:91], a[0:3], v[136:139]
s_waitcnt vmcnt(12)
v_mfma_f32_16x16x32_bf16 v[140:143], v[92:95], a[0:3], v[140:143]
s_add_u32 s38, s34, 8192
buffer_load_dwordx4 v[64:67], v1, s[8:11], s38 offen
s_waitcnt lgkmcnt(7)
v_mfma_f32_16x16x32_bf16 v[144:147], v[80:83], a[4:7], v[144:147]
v_mfma_f32_16x16x32_bf16 v[148:151], v[84:87], a[4:7], v[148:151]
ds_read_b128 a[36:39], v8 offset:16960
v_mfma_f32_16x16x32_bf16 v[152:155], v[88:91], a[4:7], v[152:155]
v_mfma_f32_16x16x32_bf16 v[156:159], v[92:95], a[4:7], v[156:159]
s_add_u32 s38, s34, 532480
buffer_load_dwordx4 v[68:71], v1, s[8:11], s38 offen
s_waitcnt lgkmcnt(7)
v_mfma_f32_16x16x32_bf16 v[160:163], v[80:83], a[8:11], v[160:163]
v_mfma_f32_16x16x32_bf16 v[164:167], v[84:87], a[8:11], v[164:167]
ds_read_b128 a[40:43], v8 offset:33600
v_mfma_f32_16x16x32_bf16 v[168:171], v[88:91], a[8:11], v[168:171]
v_mfma_f32_16x16x32_bf16 v[172:175], v[92:95], a[8:11], v[172:175]
s_add_u32 s38, s34, 24576
buffer_load_dwordx4 v[72:75], v1, s[8:11], s38 offen
s_waitcnt lgkmcnt(7)
v_mfma_f32_16x16x32_bf16 v[176:179], v[80:83], a[12:15], v[176:179]
v_mfma_f32_16x16x32_bf16 v[180:183], v[84:87], a[12:15], v[180:183]
ds_read_b128 a[44:47], v8 offset:50240
v_mfma_f32_16x16x32_bf16 v[184:187], v[88:91], a[12:15], v[184:187]
v_mfma_f32_16x16x32_bf16 v[188:191], v[92:95], a[12:15], v[188:191]
s_add_u32 s38, s34, 548864
buffer_load_dwordx4 v[76:79], v1, s[8:11], s38 offen
s_waitcnt lgkmcnt(7)
v_mfma_f32_16x16x32_bf16 v[192:195], v[80:83], a[16:19], v[192:195]
v_mfma_f32_16x16x32_bf16 v[196:199], v[84:87], a[16:19], v[196:199]
ds_read_b128 a[48:51], v9 offset:320
v_mfma_f32_16x16x32_bf16 v[200:203], v[88:91], a[16:19], v[200:203]
v_mfma_f32_16x16x32_bf16 v[204:207], v[92:95], a[16:19], v[204:207]
s_waitcnt lgkmcnt(7)
v_mfma_f32_16x16x32_bf16 v[208:211], v[80:83], a[20:23], v[208:211]
v_mfma_f32_16x16x32_bf16 v[212:215], v[84:87], a[20:23], v[212:215]
ds_read_b128 a[52:55], v9 offset:16960
v_mfma_f32_16x16x32_bf16 v[216:219], v[88:91], a[20:23], v[216:219]
v_mfma_f32_16x16x32_bf16 v[220:223], v[92:95], a[20:23], v[220:223]
s_waitcnt lgkmcnt(7)
v_mfma_f32_16x16x32_bf16 v[224:227], v[80:83], a[24:27], v[224:227]
v_mfma_f32_16x16x32_bf16 v[228:231], v[84:87], a[24:27], v[228:231]
ds_read_b128 a[56:59], v9 offset:33600
v_mfma_f32_16x16x32_bf16 v[232:235], v[88:91], a[24:27], v[232:235]
v_mfma_f32_16x16x32_bf16 v[236:239], v[92:95], a[24:27], v[236:239]
s_waitcnt lgkmcnt(7)
v_mfma_f32_16x16x32_bf16 v[240:243], v[80:83], a[28:31], v[240:243]
v_mfma_f32_16x16x32_bf16 v[244:247], v[84:87], a[28:31], v[244:247]
ds_read_b128 a[60:63], v9 offset:50240
v_mfma_f32_16x16x32_bf16 v[248:251], v[88:91], a[28:31], v[248:251]
v_mfma_f32_16x16x32_bf16 v[252:255], v[92:95], a[28:31], v[252:255]
s_waitcnt vmcnt(15) lgkmcnt(7)
v_mfma_f32_16x16x32_bf16 v[128:131], v[16:19], a[32:35], v[128:131]
s_waitcnt vmcnt(14)
v_mfma_f32_16x16x32_bf16 v[132:135], v[20:23], a[32:35], v[132:135]
ds_read_b128 a[0:3], v8 offset:384
s_waitcnt vmcnt(13)
v_mfma_f32_16x16x32_bf16 v[136:139], v[24:27], a[32:35], v[136:139]
s_waitcnt vmcnt(12)
v_mfma_f32_16x16x32_bf16 v[140:143], v[28:31], a[32:35], v[140:143]
s_add_u32 s38, s34, 9216
buffer_load_dwordx4 v[80:83], v1, s[8:11], s38 offen
s_waitcnt lgkmcnt(7)
v_mfma_f32_16x16x32_bf16 v[144:147], v[16:19], a[36:39], v[144:147]
v_mfma_f32_16x16x32_bf16 v[148:151], v[20:23], a[36:39], v[148:151]
ds_read_b128 a[4:7], v8 offset:17024
v_mfma_f32_16x16x32_bf16 v[152:155], v[24:27], a[36:39], v[152:155]
v_mfma_f32_16x16x32_bf16 v[156:159], v[28:31], a[36:39], v[156:159]
s_add_u32 s38, s34, 533504
buffer_load_dwordx4 v[84:87], v1, s[8:11], s38 offen
s_waitcnt lgkmcnt(7)
v_mfma_f32_16x16x32_bf16 v[160:163], v[16:19], a[40:43], v[160:163]
v_mfma_f32_16x16x32_bf16 v[164:167], v[20:23], a[40:43], v[164:167]
ds_read_b128 a[8:11], v8 offset:33664
v_mfma_f32_16x16x32_bf16 v[168:171], v[24:27], a[40:43], v[168:171]
v_mfma_f32_16x16x32_bf16 v[172:175], v[28:31], a[40:43], v[172:175]
s_add_u32 s38, s34, 25600
buffer_load_dwordx4 v[88:91], v1, s[8:11], s38 offen
s_waitcnt lgkmcnt(7)
v_mfma_f32_16x16x32_bf16 v[176:179], v[16:19], a[44:47], v[176:179]
v_mfma_f32_16x16x32_bf16 v[180:183], v[20:23], a[44:47], v[180:183]
ds_read_b128 a[12:15], v8 offset:50304
v_mfma_f32_16x16x32_bf16 v[184:187], v[24:27], a[44:47], v[184:187]
v_mfma_f32_16x16x32_bf16 v[188:191], v[28:31], a[44:47], v[188:191]
s_add_u32 s38, s34, 549888
buffer_load_dwordx4 v[92:95], v1, s[8:11], s38 offen
s_waitcnt lgkmcnt(7)
v_mfma_f32_16x16x32_bf16 v[192:195], v[16:19], a[48:51], v[192:195]
v_mfma_f32_16x16x32_bf16 v[196:199], v[20:23], a[48:51], v[196:199]
ds_read_b128 a[16:19], v9 offset:384
v_mfma_f32_16x16x32_bf16 v[200:203], v[24:27], a[48:51], v[200:203]
v_mfma_f32_16x16x32_bf16 v[204:207], v[28:31], a[48:51], v[204:207]
s_waitcnt lgkmcnt(7)
v_mfma_f32_16x16x32_bf16 v[208:211], v[16:19], a[52:55], v[208:211]
v_mfma_f32_16x16x32_bf16 v[212:215], v[20:23], a[52:55], v[212:215]
ds_read_b128 a[20:23], v9 offset:17024
v_mfma_f32_16x16x32_bf16 v[216:219], v[24:27], a[52:55], v[216:219]
v_mfma_f32_16x16x32_bf16 v[220:223], v[28:31], a[52:55], v[220:223]
s_waitcnt lgkmcnt(7)
v_mfma_f32_16x16x32_bf16 v[224:227], v[16:19], a[56:59], v[224:227]
v_mfma_f32_16x16x32_bf16 v[228:231], v[20:23], a[56:59], v[228:231]
ds_read_b128 a[24:27], v9 offset:33664
v_mfma_f32_16x16x32_bf16 v[232:235], v[24:27], a[56:59], v[232:235]
v_mfma_f32_16x16x32_bf16 v[236:239], v[28:31], a[56:59], v[236:239]
s_waitcnt lgkmcnt(7)
v_mfma_f32_16x16x32_bf16 v[240:243], v[16:19], a[60:63], v[240:243]
v_mfma_f32_16x16x32_bf16 v[244:247], v[20:23], a[60:63], v[244:247]
ds_read_b128 a[28:31], v9 offset:50304
v_mfma_f32_16x16x32_bf16 v[248:251], v[24:27], a[60:63], v[248:251]
v_mfma_f32_16x16x32_bf16 v[252:255], v[28:31], a[60:63], v[252:255]
s_waitcnt vmcnt(15) lgkmcnt(7)
v_mfma_f32_16x16x32_bf16 v[128:131], v[32:35], a[0:3], v[128:131]
s_waitcnt vmcnt(14)
v_mfma_f32_16x16x32_bf16 v[132:135], v[36:39], a[0:3], v[132:135]
ds_read_b128 a[32:35], v8 offset:448
s_waitcnt vmcnt(13)
v_mfma_f32_16x16x32_bf16 v[136:139], v[40:43], a[0:3], v[136:139]
s_waitcnt vmcnt(12)
v_mfma_f32_16x16x32_bf16 v[140:143], v[44:47], a[0:3], v[140:143]
s_add_u32 s38, s34, 10240
buffer_load_dwordx4 v[16:19], v1, s[8:11], s38 offen
s_waitcnt lgkmcnt(7)
v_mfma_f32_16x16x32_bf16 v[144:147], v[32:35], a[4:7], v[144:147]
v_mfma_f32_16x16x32_bf16 v[148:151], v[36:39], a[4:7], v[148:151]
ds_read_b128 a[36:39], v8 offset:17088
v_mfma_f32_16x16x32_bf16 v[152:155], v[40:43], a[4:7], v[152:155]
v_mfma_f32_16x16x32_bf16 v[156:159], v[44:47], a[4:7], v[156:159]
s_add_u32 s38, s34, 534528
buffer_load_dwordx4 v[20:23], v1, s[8:11], s38 offen
s_waitcnt lgkmcnt(7)
v_mfma_f32_16x16x32_bf16 v[160:163], v[32:35], a[8:11], v[160:163]
v_mfma_f32_16x16x32_bf16 v[164:167], v[36:39], a[8:11], v[164:167]
ds_read_b128 a[40:43], v8 offset:33728
v_mfma_f32_16x16x32_bf16 v[168:171], v[40:43], a[8:11], v[168:171]
v_mfma_f32_16x16x32_bf16 v[172:175], v[44:47], a[8:11], v[172:175]
s_add_u32 s38, s34, 26624
buffer_load_dwordx4 v[24:27], v1, s[8:11], s38 offen
s_waitcnt lgkmcnt(7)
v_mfma_f32_16x16x32_bf16 v[176:179], v[32:35], a[12:15], v[176:179]
v_mfma_f32_16x16x32_bf16 v[180:183], v[36:39], a[12:15], v[180:183]
ds_read_b128 a[44:47], v8 offset:50368
v_mfma_f32_16x16x32_bf16 v[184:187], v[40:43], a[12:15], v[184:187]
v_mfma_f32_16x16x32_bf16 v[188:191], v[44:47], a[12:15], v[188:191]
s_add_u32 s38, s34, 550912
buffer_load_dwordx4 v[28:31], v1, s[8:11], s38 offen
s_waitcnt lgkmcnt(7)
v_mfma_f32_16x16x32_bf16 v[192:195], v[32:35], a[16:19], v[192:195]
v_mfma_f32_16x16x32_bf16 v[196:199], v[36:39], a[16:19], v[196:199]
ds_read_b128 a[48:51], v9 offset:448
v_mfma_f32_16x16x32_bf16 v[200:203], v[40:43], a[16:19], v[200:203]
v_mfma_f32_16x16x32_bf16 v[204:207], v[44:47], a[16:19], v[204:207]
s_waitcnt lgkmcnt(7)
v_mfma_f32_16x16x32_bf16 v[208:211], v[32:35], a[20:23], v[208:211]
v_mfma_f32_16x16x32_bf16 v[212:215], v[36:39], a[20:23], v[212:215]
ds_read_b128 a[52:55], v9 offset:17088
v_mfma_f32_16x16x32_bf16 v[216:219], v[40:43], a[20:23], v[216:219]
v_mfma_f32_16x16x32_bf16 v[220:223], v[44:47], a[20:23], v[220:223]
s_waitcnt lgkmcnt(7)
v_mfma_f32_16x16x32_bf16 v[224:227], v[32:35], a[24:27], v[224:227]
v_mfma_f32_16x16x32_bf16 v[228:231], v[36:39], a[24:27], v[228:231]
ds_read_b128 a[56:59], v9 offset:33728
v_mfma_f32_16x16x32_bf16 v[232:235], v[40:43], a[24:27], v[232:235]
v_mfma_f32_16x16x32_bf16 v[236:239], v[44:47], a[24:27], v[236:239]
s_waitcnt lgkmcnt(7)
v_mfma_f32_16x16x32_bf16 v[240:243], v[32:35], a[28:31], v[240:243]
v_mfma_f32_16x16x32_bf16 v[244:247], v[36:39], a[28:31], v[244:247]
ds_read_b128 a[60:63], v9 offset:50368
v_mfma_f32_16x16x32_bf16 v[248:251], v[40:43], a[28:31], v[248:251]
v_mfma_f32_16x16x32_bf16 v[252:255], v[44:47], a[28:31], v[252:255]
s_waitcnt vmcnt(15) lgkmcnt(7)
v_mfma_f32_16x16x32_bf16 v[128:131], v[48:51], a[32:35], v[128:131]
s_waitcnt vmcnt(14)
v_mfma_f32_16x16x32_bf16 v[132:135], v[52:55], a[32:35], v[132:135]
ds_read_b128 a[0:3], v8 offset:512
s_waitcnt vmcnt(13)
v_mfma_f32_16x16x32_bf16 v[136:139], v[56:59], a[32:35], v[136:139]
s_waitcnt vmcnt(12)
v_mfma_f32_16x16x32_bf16 v[140:143], v[60:63], a[32:35], v[140:143]
s_add_u32 s38, s34, 11264
buffer_load_dwordx4 v[32:35], v1, s[8:11], s38 offen
s_waitcnt lgkmcnt(7)
v_mfma_f32_16x16x32_bf16 v[144:147], v[48:51], a[36:39], v[144:147]
v_mfma_f32_16x16x32_bf16 v[148:151], v[52:55], a[36:39], v[148:151]
ds_read_b128 a[4:7], v8 offset:17152
v_mfma_f32_16x16x32_bf16 v[152:155], v[56:59], a[36:39], v[152:155]
v_mfma_f32_16x16x32_bf16 v[156:159], v[60:63], a[36:39], v[156:159]
s_add_u32 s38, s34, 535552
buffer_load_dwordx4 v[36:39], v1, s[8:11], s38 offen
s_waitcnt lgkmcnt(7)
v_mfma_f32_16x16x32_bf16 v[160:163], v[48:51], a[40:43], v[160:163]
v_mfma_f32_16x16x32_bf16 v[164:167], v[52:55], a[40:43], v[164:167]
ds_read_b128 a[8:11], v8 offset:33792
v_mfma_f32_16x16x32_bf16 v[168:171], v[56:59], a[40:43], v[168:171]
v_mfma_f32_16x16x32_bf16 v[172:175], v[60:63], a[40:43], v[172:175]
s_add_u32 s38, s34, 27648
buffer_load_dwordx4 v[40:43], v1, s[8:11], s38 offen
s_waitcnt lgkmcnt(7)
v_mfma_f32_16x16x32_bf16 v[176:179], v[48:51], a[44:47], v[176:179]
v_mfma_f32_16x16x32_bf16 v[180:183], v[52:55], a[44:47], v[180:183]
ds_read_b128 a[12:15], v8 offset:50432
v_mfma_f32_16x16x32_bf16 v[184:187], v[56:59], a[44:47], v[184:187]
v_mfma_f32_16x16x32_bf16 v[188:191], v[60:63], a[44:47], v[188:191]
s_add_u32 s38, s34, 551936
buffer_load_dwordx4 v[44:47], v1, s[8:11], s38 offen
s_waitcnt lgkmcnt(7)
v_mfma_f32_16x16x32_bf16 v[192:195], v[48:51], a[48:51], v[192:195]
v_mfma_f32_16x16x32_bf16 v[196:199], v[52:55], a[48:51], v[196:199]
ds_read_b128 a[16:19], v9 offset:512
v_mfma_f32_16x16x32_bf16 v[200:203], v[56:59], a[48:51], v[200:203]
v_mfma_f32_16x16x32_bf16 v[204:207], v[60:63], a[48:51], v[204:207]
s_waitcnt lgkmcnt(7)
v_mfma_f32_16x16x32_bf16 v[208:211], v[48:51], a[52:55], v[208:211]
v_mfma_f32_16x16x32_bf16 v[212:215], v[52:55], a[52:55], v[212:215]
ds_read_b128 a[20:23], v9 offset:17152
v_mfma_f32_16x16x32_bf16 v[216:219], v[56:59], a[52:55], v[216:219]
v_mfma_f32_16x16x32_bf16 v[220:223], v[60:63], a[52:55], v[220:223]
s_waitcnt lgkmcnt(7)
v_mfma_f32_16x16x32_bf16 v[224:227], v[48:51], a[56:59], v[224:227]
v_mfma_f32_16x16x32_bf16 v[228:231], v[52:55], a[56:59], v[228:231]
ds_read_b128 a[24:27], v9 offset:33792
v_mfma_f32_16x16x32_bf16 v[232:235], v[56:59], a[56:59], v[232:235]
v_mfma_f32_16x16x32_bf16 v[236:239], v[60:63], a[56:59], v[236:239]
s_waitcnt lgkmcnt(7)
v_mfma_f32_16x16x32_bf16 v[240:243], v[48:51], a[60:63], v[240:243]
v_mfma_f32_16x16x32_bf16 v[244:247], v[52:55], a[60:63], v[244:247]
ds_read_b128 a[28:31], v9 offset:50432
v_mfma_f32_16x16x32_bf16 v[248:251], v[56:59], a[60:63], v[248:251]
v_mfma_f32_16x16x32_bf16 v[252:255], v[60:63], a[60:63], v[252:255]
s_waitcnt vmcnt(15) lgkmcnt(7)
v_mfma_f32_16x16x32_bf16 v[128:131], v[64:67], a[0:3], v[128:131]
s_waitcnt vmcnt(14)
v_mfma_f32_16x16x32_bf16 v[132:135], v[68:71], a[0:3], v[132:135]
ds_read_b128 a[32:35], v8 offset:576
s_waitcnt vmcnt(13)
v_mfma_f32_16x16x32_bf16 v[136:139], v[72:75], a[0:3], v[136:139]
s_waitcnt vmcnt(12)
v_mfma_f32_16x16x32_bf16 v[140:143], v[76:79], a[0:3], v[140:143]
s_add_u32 s38, s34, 12288
buffer_load_dwordx4 v[48:51], v1, s[8:11], s38 offen
s_waitcnt lgkmcnt(7)
v_mfma_f32_16x16x32_bf16 v[144:147], v[64:67], a[4:7], v[144:147]
v_mfma_f32_16x16x32_bf16 v[148:151], v[68:71], a[4:7], v[148:151]
ds_read_b128 a[36:39], v8 offset:17216
v_mfma_f32_16x16x32_bf16 v[152:155], v[72:75], a[4:7], v[152:155]
v_mfma_f32_16x16x32_bf16 v[156:159], v[76:79], a[4:7], v[156:159]
s_add_u32 s38, s34, 536576
buffer_load_dwordx4 v[52:55], v1, s[8:11], s38 offen
s_waitcnt lgkmcnt(7)
v_mfma_f32_16x16x32_bf16 v[160:163], v[64:67], a[8:11], v[160:163]
v_mfma_f32_16x16x32_bf16 v[164:167], v[68:71], a[8:11], v[164:167]
ds_read_b128 a[40:43], v8 offset:33856
v_mfma_f32_16x16x32_bf16 v[168:171], v[72:75], a[8:11], v[168:171]
v_mfma_f32_16x16x32_bf16 v[172:175], v[76:79], a[8:11], v[172:175]
s_add_u32 s38, s34, 28672
buffer_load_dwordx4 v[56:59], v1, s[8:11], s38 offen
s_waitcnt lgkmcnt(7)
v_mfma_f32_16x16x32_bf16 v[176:179], v[64:67], a[12:15], v[176:179]
v_mfma_f32_16x16x32_bf16 v[180:183], v[68:71], a[12:15], v[180:183]
ds_read_b128 a[44:47], v8 offset:50496
v_mfma_f32_16x16x32_bf16 v[184:187], v[72:75], a[12:15], v[184:187]
v_mfma_f32_16x16x32_bf16 v[188:191], v[76:79], a[12:15], v[188:191]
s_add_u32 s38, s34, 552960
buffer_load_dwordx4 v[60:63], v1, s[8:11], s38 offen
s_waitcnt lgkmcnt(7)
v_mfma_f32_16x16x32_bf16 v[192:195], v[64:67], a[16:19], v[192:195]
v_mfma_f32_16x16x32_bf16 v[196:199], v[68:71], a[16:19], v[196:199]
ds_read_b128 a[48:51], v9 offset:576
v_mfma_f32_16x16x32_bf16 v[200:203], v[72:75], a[16:19], v[200:203]
v_mfma_f32_16x16x32_bf16 v[204:207], v[76:79], a[16:19], v[204:207]
s_waitcnt lgkmcnt(7)
v_mfma_f32_16x16x32_bf16 v[208:211], v[64:67], a[20:23], v[208:211]
v_mfma_f32_16x16x32_bf16 v[212:215], v[68:71], a[20:23], v[212:215]
ds_read_b128 a[52:55], v9 offset:17216
v_mfma_f32_16x16x32_bf16 v[216:219], v[72:75], a[20:23], v[216:219]
v_mfma_f32_16x16x32_bf16 v[220:223], v[76:79], a[20:23], v[220:223]
s_waitcnt lgkmcnt(7)
v_mfma_f32_16x16x32_bf16 v[224:227], v[64:67], a[24:27], v[224:227]
v_mfma_f32_16x16x32_bf16 v[228:231], v[68:71], a[24:27], v[228:231]
ds_read_b128 a[56:59], v9 offset:33856
v_mfma_f32_16x16x32_bf16 v[232:235], v[72:75], a[24:27], v[232:235]
v_mfma_f32_16x16x32_bf16 v[236:239], v[76:79], a[24:27], v[236:239]
s_waitcnt lgkmcnt(7)
v_mfma_f32_16x16x32_bf16 v[240:243], v[64:67], a[28:31], v[240:243]
v_mfma_f32_16x16x32_bf16 v[244:247], v[68:71], a[28:31], v[244:247]
ds_read_b128 a[60:63], v9 offset:50496
v_mfma_f32_16x16x32_bf16 v[248:251], v[72:75], a[28:31], v[248:251]
v_mfma_f32_16x16x32_bf16 v[252:255], v[76:79], a[28:31], v[252:255]
s_waitcnt vmcnt(15) lgkmcnt(7)
v_mfma_f32_16x16x32_bf16 v[128:131], v[80:83], a[32:35], v[128:131]
s_waitcnt vmcnt(14)
v_mfma_f32_16x16x32_bf16 v[132:135], v[84:87], a[32:35], v[132:135]
ds_read_b128 a[0:3], v8 offset:640
s_waitcnt vmcnt(13)
v_mfma_f32_16x16x32_bf16 v[136:139], v[88:91], a[32:35], v[136:139]
s_waitcnt vmcnt(12)
v_mfma_f32_16x16x32_bf16 v[140:143], v[92:95], a[32:35], v[140:143]
s_add_u32 s38, s34, 13312
buffer_load_dwordx4 v[64:67], v1, s[8:11], s38 offen
s_waitcnt lgkmcnt(7)
v_mfma_f32_16x16x32_bf16 v[144:147], v[80:83], a[36:39], v[144:147]
v_mfma_f32_16x16x32_bf16 v[148:151], v[84:87], a[36:39], v[148:151]
ds_read_b128 a[4:7], v8 offset:17280
v_mfma_f32_16x16x32_bf16 v[152:155], v[88:91], a[36:39], v[152:155]
v_mfma_f32_16x16x32_bf16 v[156:159], v[92:95], a[36:39], v[156:159]
s_add_u32 s38, s34, 537600
buffer_load_dwordx4 v[68:71], v1, s[8:11], s38 offen
s_waitcnt lgkmcnt(7)
v_mfma_f32_16x16x32_bf16 v[160:163], v[80:83], a[40:43], v[160:163]
v_mfma_f32_16x16x32_bf16 v[164:167], v[84:87], a[40:43], v[164:167]
ds_read_b128 a[8:11], v8 offset:33920
v_mfma_f32_16x16x32_bf16 v[168:171], v[88:91], a[40:43], v[168:171]
v_mfma_f32_16x16x32_bf16 v[172:175], v[92:95], a[40:43], v[172:175]
s_add_u32 s38, s34, 29696
buffer_load_dwordx4 v[72:75], v1, s[8:11], s38 offen
s_waitcnt lgkmcnt(7)
v_mfma_f32_16x16x32_bf16 v[176:179], v[80:83], a[44:47], v[176:179]
v_mfma_f32_16x16x32_bf16 v[180:183], v[84:87], a[44:47], v[180:183]
ds_read_b128 a[12:15], v8 offset:50560
v_mfma_f32_16x16x32_bf16 v[184:187], v[88:91], a[44:47], v[184:187]
v_mfma_f32_16x16x32_bf16 v[188:191], v[92:95], a[44:47], v[188:191]
s_add_u32 s38, s34, 553984
buffer_load_dwordx4 v[76:79], v1, s[8:11], s38 offen
s_waitcnt lgkmcnt(7)
v_mfma_f32_16x16x32_bf16 v[192:195], v[80:83], a[48:51], v[192:195]
v_mfma_f32_16x16x32_bf16 v[196:199], v[84:87], a[48:51], v[196:199]
ds_read_b128 a[16:19], v9 offset:640
v_mfma_f32_16x16x32_bf16 v[200:203], v[88:91], a[48:51], v[200:203]
v_mfma_f32_16x16x32_bf16 v[204:207], v[92:95], a[48:51], v[204:207]
s_waitcnt lgkmcnt(7)
v_mfma_f32_16x16x32_bf16 v[208:211], v[80:83], a[52:55], v[208:211]
v_mfma_f32_16x16x32_bf16 v[212:215], v[84:87], a[52:55], v[212:215]
ds_read_b128 a[20:23], v9 offset:17280
v_mfma_f32_16x16x32_bf16 v[216:219], v[88:91], a[52:55], v[216:219]
v_mfma_f32_16x16x32_bf16 v[220:223], v[92:95], a[52:55], v[220:223]
s_waitcnt lgkmcnt(7)
v_mfma_f32_16x16x32_bf16 v[224:227], v[80:83], a[56:59], v[224:227]
v_mfma_f32_16x16x32_bf16 v[228:231], v[84:87], a[56:59], v[228:231]
ds_read_b128 a[24:27], v9 offset:33920
v_mfma_f32_16x16x32_bf16 v[232:235], v[88:91], a[56:59], v[232:235]
v_mfma_f32_16x16x32_bf16 v[236:239], v[92:95], a[56:59], v[236:239]
s_waitcnt lgkmcnt(7)
v_mfma_f32_16x16x32_bf16 v[240:243], v[80:83], a[60:63], v[240:243]
v_mfma_f32_16x16x32_bf16 v[244:247], v[84:87], a[60:63], v[244:247]
ds_read_b128 a[28:31], v9 offset:50560
v_mfma_f32_16x16x32_bf16 v[248:251], v[88:91], a[60:63], v[248:251]
v_mfma_f32_16x16x32_bf16 v[252:255], v[92:95], a[60:63], v[252:255]
s_waitcnt vmcnt(15) lgkmcnt(7)
v_mfma_f32_16x16x32_bf16 v[128:131], v[16:19], a[0:3], v[128:131]
s_waitcnt vmcnt(14)
v_mfma_f32_16x16x32_bf16 v[132:135], v[20:23], a[0:3], v[132:135]
ds_read_b128 a[32:35], v8 offset:704
s_waitcnt vmcnt(13)
v_mfma_f32_16x16x32_bf16 v[136:139], v[24:27], a[0:3], v[136:139]
s_waitcnt vmcnt(12)
v_mfma_f32_16x16x32_bf16 v[140:143], v[28:31], a[0:3], v[140:143]
s_add_u32 s38, s34, 14336
buffer_load_dwordx4 v[80:83], v1, s[8:11], s38 offen
s_waitcnt lgkmcnt(7)
v_mfma_f32_16x16x32_bf16 v[144:147], v[16:19], a[4:7], v[144:147]
v_mfma_f32_16x16x32_bf16 v[148:151], v[20:23], a[4:7], v[148:151]
ds_read_b128 a[36:39], v8 offset:17344
v_mfma_f32_16x16x32_bf16 v[152:155], v[24:27], a[4:7], v[152:155]
v_mfma_f32_16x16x32_bf16 v[156:159], v[28:31], a[4:7], v[156:159]
s_add_u32 s38, s34, 538624
buffer_load_dwordx4 v[84:87], v1, s[8:11], s38 offen
s_waitcnt lgkmcnt(7)
v_mfma_f32_16x16x32_bf16 v[160:163], v[16:19], a[8:11], v[160:163]
v_mfma_f32_16x16x32_bf16 v[164:167], v[20:23], a[8:11], v[164:167]
ds_read_b128 a[40:43], v8 offset:33984
v_mfma_f32_16x16x32_bf16 v[168:171], v[24:27], a[8:11], v[168:171]
v_mfma_f32_16x16x32_bf16 v[172:175], v[28:31], a[8:11], v[172:175]
s_add_u32 s38, s34, 30720
buffer_load_dwordx4 v[88:91], v1, s[8:11], s38 offen
s_waitcnt lgkmcnt(7)
v_mfma_f32_16x16x32_bf16 v[176:179], v[16:19], a[12:15], v[176:179]
v_mfma_f32_16x16x32_bf16 v[180:183], v[20:23], a[12:15], v[180:183]
ds_read_b128 a[44:47], v8 offset:50624
v_mfma_f32_16x16x32_bf16 v[184:187], v[24:27], a[12:15], v[184:187]
v_mfma_f32_16x16x32_bf16 v[188:191], v[28:31], a[12:15], v[188:191]
s_add_u32 s38, s34, 555008
buffer_load_dwordx4 v[92:95], v1, s[8:11], s38 offen
s_waitcnt lgkmcnt(7)
v_mfma_f32_16x16x32_bf16 v[192:195], v[16:19], a[16:19], v[192:195]
v_mfma_f32_16x16x32_bf16 v[196:199], v[20:23], a[16:19], v[196:199]
ds_read_b128 a[48:51], v9 offset:704
v_mfma_f32_16x16x32_bf16 v[200:203], v[24:27], a[16:19], v[200:203]
v_mfma_f32_16x16x32_bf16 v[204:207], v[28:31], a[16:19], v[204:207]
s_waitcnt lgkmcnt(7)
v_mfma_f32_16x16x32_bf16 v[208:211], v[16:19], a[20:23], v[208:211]
v_mfma_f32_16x16x32_bf16 v[212:215], v[20:23], a[20:23], v[212:215]
ds_read_b128 a[52:55], v9 offset:17344
v_mfma_f32_16x16x32_bf16 v[216:219], v[24:27], a[20:23], v[216:219]
v_mfma_f32_16x16x32_bf16 v[220:223], v[28:31], a[20:23], v[220:223]
s_waitcnt lgkmcnt(7)
v_mfma_f32_16x16x32_bf16 v[224:227], v[16:19], a[24:27], v[224:227]
v_mfma_f32_16x16x32_bf16 v[228:231], v[20:23], a[24:27], v[228:231]
ds_read_b128 a[56:59], v9 offset:33984
v_mfma_f32_16x16x32_bf16 v[232:235], v[24:27], a[24:27], v[232:235]
v_mfma_f32_16x16x32_bf16 v[236:239], v[28:31], a[24:27], v[236:239]
s_waitcnt lgkmcnt(7)
v_mfma_f32_16x16x32_bf16 v[240:243], v[16:19], a[28:31], v[240:243]
v_mfma_f32_16x16x32_bf16 v[244:247], v[20:23], a[28:31], v[244:247]
ds_read_b128 a[60:63], v9 offset:50624
v_mfma_f32_16x16x32_bf16 v[248:251], v[24:27], a[28:31], v[248:251]
v_mfma_f32_16x16x32_bf16 v[252:255], v[28:31], a[28:31], v[252:255]
s_waitcnt vmcnt(15) lgkmcnt(7)
v_mfma_f32_16x16x32_bf16 v[128:131], v[32:35], a[32:35], v[128:131]
s_waitcnt vmcnt(14)
v_mfma_f32_16x16x32_bf16 v[132:135], v[36:39], a[32:35], v[132:135]
ds_read_b128 a[0:3], v8 offset:768
s_waitcnt vmcnt(13)
v_mfma_f32_16x16x32_bf16 v[136:139], v[40:43], a[32:35], v[136:139]
s_waitcnt vmcnt(12)
v_mfma_f32_16x16x32_bf16 v[140:143], v[44:47], a[32:35], v[140:143]
s_add_u32 s38, s34, 15360
buffer_load_dwordx4 v[16:19], v1, s[8:11], s38 offen
s_waitcnt lgkmcnt(7)
v_mfma_f32_16x16x32_bf16 v[144:147], v[32:35], a[36:39], v[144:147]
v_mfma_f32_16x16x32_bf16 v[148:151], v[36:39], a[36:39], v[148:151]
ds_read_b128 a[4:7], v8 offset:17408
v_mfma_f32_16x16x32_bf16 v[152:155], v[40:43], a[36:39], v[152:155]
v_mfma_f32_16x16x32_bf16 v[156:159], v[44:47], a[36:39], v[156:159]
s_add_u32 s38, s34, 539648
buffer_load_dwordx4 v[20:23], v1, s[8:11], s38 offen
s_waitcnt lgkmcnt(7)
v_mfma_f32_16x16x32_bf16 v[160:163], v[32:35], a[40:43], v[160:163]
v_mfma_f32_16x16x32_bf16 v[164:167], v[36:39], a[40:43], v[164:167]
ds_read_b128 a[8:11], v8 offset:34048
v_mfma_f32_16x16x32_bf16 v[168:171], v[40:43], a[40:43], v[168:171]
v_mfma_f32_16x16x32_bf16 v[172:175], v[44:47], a[40:43], v[172:175]
s_add_u32 s38, s34, 31744
buffer_load_dwordx4 v[24:27], v1, s[8:11], s38 offen
s_waitcnt lgkmcnt(7)
v_mfma_f32_16x16x32_bf16 v[176:179], v[32:35], a[44:47], v[176:179]
v_mfma_f32_16x16x32_bf16 v[180:183], v[36:39], a[44:47], v[180:183]
ds_read_b128 a[12:15], v8 offset:50688
v_mfma_f32_16x16x32_bf16 v[184:187], v[40:43], a[44:47], v[184:187]
v_mfma_f32_16x16x32_bf16 v[188:191], v[44:47], a[44:47], v[188:191]
s_add_u32 s38, s34, 556032
buffer_load_dwordx4 v[28:31], v1, s[8:11], s38 offen
s_waitcnt lgkmcnt(7)
v_mfma_f32_16x16x32_bf16 v[192:195], v[32:35], a[48:51], v[192:195]
v_mfma_f32_16x16x32_bf16 v[196:199], v[36:39], a[48:51], v[196:199]
ds_read_b128 a[16:19], v9 offset:768
v_mfma_f32_16x16x32_bf16 v[200:203], v[40:43], a[48:51], v[200:203]
v_mfma_f32_16x16x32_bf16 v[204:207], v[44:47], a[48:51], v[204:207]
s_waitcnt lgkmcnt(7)
v_mfma_f32_16x16x32_bf16 v[208:211], v[32:35], a[52:55], v[208:211]
v_mfma_f32_16x16x32_bf16 v[212:215], v[36:39], a[52:55], v[212:215]
ds_read_b128 a[20:23], v9 offset:17408
v_mfma_f32_16x16x32_bf16 v[216:219], v[40:43], a[52:55], v[216:219]
v_mfma_f32_16x16x32_bf16 v[220:223], v[44:47], a[52:55], v[220:223]
s_waitcnt lgkmcnt(7)
v_mfma_f32_16x16x32_bf16 v[224:227], v[32:35], a[56:59], v[224:227]
v_mfma_f32_16x16x32_bf16 v[228:231], v[36:39], a[56:59], v[228:231]
ds_read_b128 a[24:27], v9 offset:34048
v_mfma_f32_16x16x32_bf16 v[232:235], v[40:43], a[56:59], v[232:235]
v_mfma_f32_16x16x32_bf16 v[236:239], v[44:47], a[56:59], v[236:239]
s_waitcnt lgkmcnt(7)
v_mfma_f32_16x16x32_bf16 v[240:243], v[32:35], a[60:63], v[240:243]
v_mfma_f32_16x16x32_bf16 v[244:247], v[36:39], a[60:63], v[244:247]
ds_read_b128 a[28:31], v9 offset:50688
v_mfma_f32_16x16x32_bf16 v[248:251], v[40:43], a[60:63], v[248:251]
v_mfma_f32_16x16x32_bf16 v[252:255], v[44:47], a[60:63], v[252:255]
s_waitcnt vmcnt(15) lgkmcnt(7)
v_mfma_f32_16x16x32_bf16 v[128:131], v[48:51], a[0:3], v[128:131]
s_waitcnt vmcnt(14)
v_mfma_f32_16x16x32_bf16 v[132:135], v[52:55], a[0:3], v[132:135]
ds_read_b128 a[32:35], v8 offset:832
s_waitcnt vmcnt(13)
v_mfma_f32_16x16x32_bf16 v[136:139], v[56:59], a[0:3], v[136:139]
s_waitcnt vmcnt(12)
v_mfma_f32_16x16x32_bf16 v[140:143], v[60:63], a[0:3], v[140:143]
s_waitcnt lgkmcnt(7)
v_mfma_f32_16x16x32_bf16 v[144:147], v[48:51], a[4:7], v[144:147]
v_mfma_f32_16x16x32_bf16 v[148:151], v[52:55], a[4:7], v[148:151]
ds_read_b128 a[36:39], v8 offset:17472
v_mfma_f32_16x16x32_bf16 v[152:155], v[56:59], a[4:7], v[152:155]
v_mfma_f32_16x16x32_bf16 v[156:159], v[60:63], a[4:7], v[156:159]
s_waitcnt lgkmcnt(7)
v_mfma_f32_16x16x32_bf16 v[160:163], v[48:51], a[8:11], v[160:163]
v_mfma_f32_16x16x32_bf16 v[164:167], v[52:55], a[8:11], v[164:167]
ds_read_b128 a[40:43], v8 offset:34112
v_mfma_f32_16x16x32_bf16 v[168:171], v[56:59], a[8:11], v[168:171]
v_mfma_f32_16x16x32_bf16 v[172:175], v[60:63], a[8:11], v[172:175]
s_waitcnt lgkmcnt(7)
v_mfma_f32_16x16x32_bf16 v[176:179], v[48:51], a[12:15], v[176:179]
v_mfma_f32_16x16x32_bf16 v[180:183], v[52:55], a[12:15], v[180:183]
ds_read_b128 a[44:47], v8 offset:50752
v_mfma_f32_16x16x32_bf16 v[184:187], v[56:59], a[12:15], v[184:187]
v_mfma_f32_16x16x32_bf16 v[188:191], v[60:63], a[12:15], v[188:191]
s_waitcnt lgkmcnt(7)
v_mfma_f32_16x16x32_bf16 v[192:195], v[48:51], a[16:19], v[192:195]
v_mfma_f32_16x16x32_bf16 v[196:199], v[52:55], a[16:19], v[196:199]
ds_read_b128 a[48:51], v9 offset:832
v_mfma_f32_16x16x32_bf16 v[200:203], v[56:59], a[16:19], v[200:203]
v_mfma_f32_16x16x32_bf16 v[204:207], v[60:63], a[16:19], v[204:207]
s_waitcnt lgkmcnt(7)
v_mfma_f32_16x16x32_bf16 v[208:211], v[48:51], a[20:23], v[208:211]
v_mfma_f32_16x16x32_bf16 v[212:215], v[52:55], a[20:23], v[212:215]
ds_read_b128 a[52:55], v9 offset:17472
v_mfma_f32_16x16x32_bf16 v[216:219], v[56:59], a[20:23], v[216:219]
v_mfma_f32_16x16x32_bf16 v[220:223], v[60:63], a[20:23], v[220:223]
s_waitcnt lgkmcnt(7)
v_mfma_f32_16x16x32_bf16 v[224:227], v[48:51], a[24:27], v[224:227]
v_mfma_f32_16x16x32_bf16 v[228:231], v[52:55], a[24:27], v[228:231]
ds_read_b128 a[56:59], v9 offset:34112
v_mfma_f32_16x16x32_bf16 v[232:235], v[56:59], a[24:27], v[232:235]
v_mfma_f32_16x16x32_bf16 v[236:239], v[60:63], a[24:27], v[236:239]
s_waitcnt lgkmcnt(7)
v_mfma_f32_16x16x32_bf16 v[240:243], v[48:51], a[28:31], v[240:243]
v_mfma_f32_16x16x32_bf16 v[244:247], v[52:55], a[28:31], v[244:247]
ds_read_b128 a[60:63], v9 offset:50752
v_mfma_f32_16x16x32_bf16 v[248:251], v[56:59], a[28:31], v[248:251]
v_mfma_f32_16x16x32_bf16 v[252:255], v[60:63], a[28:31], v[252:255]
s_waitcnt vmcnt(11) lgkmcnt(7)
v_mfma_f32_16x16x32_bf16 v[128:131], v[64:67], a[32:35], v[128:131]
s_waitcnt vmcnt(10)
v_mfma_f32_16x16x32_bf16 v[132:135], v[68:71], a[32:35], v[132:135]
ds_read_b128 a[0:3], v8 offset:896
s_waitcnt vmcnt(9)
v_mfma_f32_16x16x32_bf16 v[136:139], v[72:75], a[32:35], v[136:139]
s_waitcnt vmcnt(8)
v_mfma_f32_16x16x32_bf16 v[140:143], v[76:79], a[32:35], v[140:143]
s_waitcnt lgkmcnt(7)
v_mfma_f32_16x16x32_bf16 v[144:147], v[64:67], a[36:39], v[144:147]
v_mfma_f32_16x16x32_bf16 v[148:151], v[68:71], a[36:39], v[148:151]
ds_read_b128 a[4:7], v8 offset:17536
v_mfma_f32_16x16x32_bf16 v[152:155], v[72:75], a[36:39], v[152:155]
v_mfma_f32_16x16x32_bf16 v[156:159], v[76:79], a[36:39], v[156:159]
s_waitcnt lgkmcnt(7)
v_mfma_f32_16x16x32_bf16 v[160:163], v[64:67], a[40:43], v[160:163]
v_mfma_f32_16x16x32_bf16 v[164:167], v[68:71], a[40:43], v[164:167]
ds_read_b128 a[8:11], v8 offset:34176
v_mfma_f32_16x16x32_bf16 v[168:171], v[72:75], a[40:43], v[168:171]
v_mfma_f32_16x16x32_bf16 v[172:175], v[76:79], a[40:43], v[172:175]
s_waitcnt lgkmcnt(7)
v_mfma_f32_16x16x32_bf16 v[176:179], v[64:67], a[44:47], v[176:179]
v_mfma_f32_16x16x32_bf16 v[180:183], v[68:71], a[44:47], v[180:183]
ds_read_b128 a[12:15], v8 offset:50816
v_mfma_f32_16x16x32_bf16 v[184:187], v[72:75], a[44:47], v[184:187]
v_mfma_f32_16x16x32_bf16 v[188:191], v[76:79], a[44:47], v[188:191]
s_waitcnt lgkmcnt(7)
v_mfma_f32_16x16x32_bf16 v[192:195], v[64:67], a[48:51], v[192:195]
v_mfma_f32_16x16x32_bf16 v[196:199], v[68:71], a[48:51], v[196:199]
ds_read_b128 a[16:19], v9 offset:896
v_mfma_f32_16x16x32_bf16 v[200:203], v[72:75], a[48:51], v[200:203]
v_mfma_f32_16x16x32_bf16 v[204:207], v[76:79], a[48:51], v[204:207]
s_waitcnt lgkmcnt(7)
v_mfma_f32_16x16x32_bf16 v[208:211], v[64:67], a[52:55], v[208:211]
v_mfma_f32_16x16x32_bf16 v[212:215], v[68:71], a[52:55], v[212:215]
ds_read_b128 a[20:23], v9 offset:17536
v_mfma_f32_16x16x32_bf16 v[216:219], v[72:75], a[52:55], v[216:219]
v_mfma_f32_16x16x32_bf16 v[220:223], v[76:79], a[52:55], v[220:223]
s_waitcnt lgkmcnt(7)
v_mfma_f32_16x16x32_bf16 v[224:227], v[64:67], a[56:59], v[224:227]
v_mfma_f32_16x16x32_bf16 v[228:231], v[68:71], a[56:59], v[228:231]
ds_read_b128 a[24:27], v9 offset:34176
v_mfma_f32_16x16x32_bf16 v[232:235], v[72:75], a[56:59], v[232:235]
v_mfma_f32_16x16x32_bf16 v[236:239], v[76:79], a[56:59], v[236:239]
s_waitcnt lgkmcnt(7)
v_mfma_f32_16x16x32_bf16 v[240:243], v[64:67], a[60:63], v[240:243]
v_mfma_f32_16x16x32_bf16 v[244:247], v[68:71], a[60:63], v[244:247]
ds_read_b128 a[28:31], v9 offset:50816
v_mfma_f32_16x16x32_bf16 v[248:251], v[72:75], a[60:63], v[248:251]
v_mfma_f32_16x16x32_bf16 v[252:255], v[76:79], a[60:63], v[252:255]
s_waitcnt vmcnt(7) lgkmcnt(7)
v_mfma_f32_16x16x32_bf16 v[128:131], v[80:83], a[0:3], v[128:131]
s_waitcnt vmcnt(6)
v_mfma_f32_16x16x32_bf16 v[132:135], v[84:87], a[0:3], v[132:135]
ds_read_b128 a[32:35], v8 offset:960
s_waitcnt vmcnt(5)
v_mfma_f32_16x16x32_bf16 v[136:139], v[88:91], a[0:3], v[136:139]
s_waitcnt vmcnt(4)
v_mfma_f32_16x16x32_bf16 v[140:143], v[92:95], a[0:3], v[140:143]
s_waitcnt lgkmcnt(7)
v_mfma_f32_16x16x32_bf16 v[144:147], v[80:83], a[4:7], v[144:147]
v_mfma_f32_16x16x32_bf16 v[148:151], v[84:87], a[4:7], v[148:151]
ds_read_b128 a[36:39], v8 offset:17600
v_mfma_f32_16x16x32_bf16 v[152:155], v[88:91], a[4:7], v[152:155]
v_mfma_f32_16x16x32_bf16 v[156:159], v[92:95], a[4:7], v[156:159]
s_waitcnt lgkmcnt(7)
v_mfma_f32_16x16x32_bf16 v[160:163], v[80:83], a[8:11], v[160:163]
v_mfma_f32_16x16x32_bf16 v[164:167], v[84:87], a[8:11], v[164:167]
ds_read_b128 a[40:43], v8 offset:34240
v_mfma_f32_16x16x32_bf16 v[168:171], v[88:91], a[8:11], v[168:171]
v_mfma_f32_16x16x32_bf16 v[172:175], v[92:95], a[8:11], v[172:175]
s_waitcnt lgkmcnt(7)
v_mfma_f32_16x16x32_bf16 v[176:179], v[80:83], a[12:15], v[176:179]
v_mfma_f32_16x16x32_bf16 v[180:183], v[84:87], a[12:15], v[180:183]
ds_read_b128 a[44:47], v8 offset:50880
v_mfma_f32_16x16x32_bf16 v[184:187], v[88:91], a[12:15], v[184:187]
v_mfma_f32_16x16x32_bf16 v[188:191], v[92:95], a[12:15], v[188:191]
s_waitcnt lgkmcnt(7)
v_mfma_f32_16x16x32_bf16 v[192:195], v[80:83], a[16:19], v[192:195]
v_mfma_f32_16x16x32_bf16 v[196:199], v[84:87], a[16:19], v[196:199]
ds_read_b128 a[48:51], v9 offset:960
v_mfma_f32_16x16x32_bf16 v[200:203], v[88:91], a[16:19], v[200:203]
v_mfma_f32_16x16x32_bf16 v[204:207], v[92:95], a[16:19], v[204:207]
s_waitcnt lgkmcnt(7)
v_mfma_f32_16x16x32_bf16 v[208:211], v[80:83], a[20:23], v[208:211]
v_mfma_f32_16x16x32_bf16 v[212:215], v[84:87], a[20:23], v[212:215]
ds_read_b128 a[52:55], v9 offset:17600
v_mfma_f32_16x16x32_bf16 v[216:219], v[88:91], a[20:23], v[216:219]
v_mfma_f32_16x16x32_bf16 v[220:223], v[92:95], a[20:23], v[220:223]
s_waitcnt lgkmcnt(7)
v_mfma_f32_16x16x32_bf16 v[224:227], v[80:83], a[24:27], v[224:227]
v_mfma_f32_16x16x32_bf16 v[228:231], v[84:87], a[24:27], v[228:231]
ds_read_b128 a[56:59], v9 offset:34240
v_mfma_f32_16x16x32_bf16 v[232:235], v[88:91], a[24:27], v[232:235]
v_mfma_f32_16x16x32_bf16 v[236:239], v[92:95], a[24:27], v[236:239]
s_waitcnt lgkmcnt(7)
v_mfma_f32_16x16x32_bf16 v[240:243], v[80:83], a[28:31], v[240:243]
v_mfma_f32_16x16x32_bf16 v[244:247], v[84:87], a[28:31], v[244:247]
ds_read_b128 a[60:63], v9 offset:50880
v_mfma_f32_16x16x32_bf16 v[248:251], v[88:91], a[28:31], v[248:251]
v_mfma_f32_16x16x32_bf16 v[252:255], v[92:95], a[28:31], v[252:255]
s_waitcnt vmcnt(3) lgkmcnt(7)
v_mfma_f32_16x16x32_bf16 v[128:131], v[16:19], a[32:35], v[128:131]
s_waitcnt vmcnt(2)
v_mfma_f32_16x16x32_bf16 v[132:135], v[20:23], a[32:35], v[132:135]
s_waitcnt vmcnt(1)
v_mfma_f32_16x16x32_bf16 v[136:139], v[24:27], a[32:35], v[136:139]
s_waitcnt vmcnt(0)
v_mfma_f32_16x16x32_bf16 v[140:143], v[28:31], a[32:35], v[140:143]
s_waitcnt lgkmcnt(6)
v_mfma_f32_16x16x32_bf16 v[144:147], v[16:19], a[36:39], v[144:147]
v_mfma_f32_16x16x32_bf16 v[148:151], v[20:23], a[36:39], v[148:151]
v_mfma_f32_16x16x32_bf16 v[152:155], v[24:27], a[36:39], v[152:155]
v_mfma_f32_16x16x32_bf16 v[156:159], v[28:31], a[36:39], v[156:159]
s_waitcnt lgkmcnt(5)
v_mfma_f32_16x16x32_bf16 v[160:163], v[16:19], a[40:43], v[160:163]
v_mfma_f32_16x16x32_bf16 v[164:167], v[20:23], a[40:43], v[164:167]
v_mfma_f32_16x16x32_bf16 v[168:171], v[24:27], a[40:43], v[168:171]
v_mfma_f32_16x16x32_bf16 v[172:175], v[28:31], a[40:43], v[172:175]
s_waitcnt lgkmcnt(4)
v_mfma_f32_16x16x32_bf16 v[176:179], v[16:19], a[44:47], v[176:179]
v_mfma_f32_16x16x32_bf16 v[180:183], v[20:23], a[44:47], v[180:183]
v_mfma_f32_16x16x32_bf16 v[184:187], v[24:27], a[44:47], v[184:187]
v_mfma_f32_16x16x32_bf16 v[188:191], v[28:31], a[44:47], v[188:191]
s_waitcnt lgkmcnt(3)
v_mfma_f32_16x16x32_bf16 v[192:195], v[16:19], a[48:51], v[192:195]
v_mfma_f32_16x16x32_bf16 v[196:199], v[20:23], a[48:51], v[196:199]
v_mfma_f32_16x16x32_bf16 v[200:203], v[24:27], a[48:51], v[200:203]
v_mfma_f32_16x16x32_bf16 v[204:207], v[28:31], a[48:51], v[204:207]
s_waitcnt lgkmcnt(2)
v_mfma_f32_16x16x32_bf16 v[208:211], v[16:19], a[52:55], v[208:211]
v_mfma_f32_16x16x32_bf16 v[212:215], v[20:23], a[52:55], v[212:215]
v_mfma_f32_16x16x32_bf16 v[216:219], v[24:27], a[52:55], v[216:219]
v_mfma_f32_16x16x32_bf16 v[220:223], v[28:31], a[52:55], v[220:223]
s_waitcnt lgkmcnt(1)
v_mfma_f32_16x16x32_bf16 v[224:227], v[16:19], a[56:59], v[224:227]
v_mfma_f32_16x16x32_bf16 v[228:231], v[20:23], a[56:59], v[228:231]
v_mfma_f32_16x16x32_bf16 v[232:235], v[24:27], a[56:59], v[232:235]
v_mfma_f32_16x16x32_bf16 v[236:239], v[28:31], a[56:59], v[236:239]
s_waitcnt lgkmcnt(0)
v_mfma_f32_16x16x32_bf16 v[240:243], v[16:19], a[60:63], v[240:243]
v_mfma_f32_16x16x32_bf16 v[244:247], v[20:23], a[60:63], v[244:247]
v_mfma_f32_16x16x32_bf16 v[248:251], v[24:27], a[60:63], v[248:251]
v_mfma_f32_16x16x32_bf16 v[252:255], v[28:31], a[60:63], v[252:255]
v_lshrrev_b32 v4, 4, v1
v_and_b32 v5, 15, v4
v_lshlrev_b32 v5, 12, v5
v_lshrrev_b32 v4, 4, v4
v_lshl_add_u32 v5, v4, 5, v5
s_lshl_b32 s35, s32, 19
s_lshl_b32 s38, s43, 3
s_add_u32 s35, s35, s38
s_add_u32 s35, s35, 88080384
v_mov_b32 v16, v128
v_mov_b32 v17, v132
v_mov_b32 v18, v129
v_mov_b32 v19, v133
v_mov_b32 v20, v130
v_mov_b32 v21, v134
v_mov_b32 v22, v131
v_mov_b32 v23, v135
s_add_u32 s38, s35, 0
buffer_store_dwordx4 v[16:19], v5, s[8:11], s38 offen
buffer_store_dwordx4 v[20:23], v5, s[8:11], s38 offen offset:16
v_mov_b32 v24, v136
v_mov_b32 v25, v140
v_mov_b32 v26, v137
v_mov_b32 v27, v141
v_mov_b32 v28, v138
v_mov_b32 v29, v142
v_mov_b32 v30, v139
v_mov_b32 v31, v143
s_add_u32 s38, s35, 128
buffer_store_dwordx4 v[24:27], v5, s[8:11], s38 offen
buffer_store_dwordx4 v[28:31], v5, s[8:11], s38 offen offset:16
v_mov_b32 v32, v144
v_mov_b32 v33, v148
v_mov_b32 v34, v145
v_mov_b32 v35, v149
v_mov_b32 v36, v146
v_mov_b32 v37, v150
v_mov_b32 v38, v147
v_mov_b32 v39, v151
s_add_u32 s38, s35, 65536
buffer_store_dwordx4 v[32:35], v5, s[8:11], s38 offen
buffer_store_dwordx4 v[36:39], v5, s[8:11], s38 offen offset:16
v_mov_b32 v40, v152
v_mov_b32 v41, v156
v_mov_b32 v42, v153
v_mov_b32 v43, v157
v_mov_b32 v44, v154
v_mov_b32 v45, v158
v_mov_b32 v46, v155
v_mov_b32 v47, v159
s_add_u32 s38, s35, 65664
buffer_store_dwordx4 v[40:43], v5, s[8:11], s38 offen
buffer_store_dwordx4 v[44:47], v5, s[8:11], s38 offen offset:16
v_mov_b32 v16, v160
v_mov_b32 v17, v164
v_mov_b32 v18, v161
v_mov_b32 v19, v165
v_mov_b32 v20, v162
v_mov_b32 v21, v166
v_mov_b32 v22, v163
v_mov_b32 v23, v167
s_add_u32 s38, s35, 131072
buffer_store_dwordx4 v[16:19], v5, s[8:11], s38 offen
buffer_store_dwordx4 v[20:23], v5, s[8:11], s38 offen offset:16
v_mov_b32 v24, v168
v_mov_b32 v25, v172
v_mov_b32 v26, v169
v_mov_b32 v27, v173
v_mov_b32 v28, v170
v_mov_b32 v29, v174
v_mov_b32 v30, v171
v_mov_b32 v31, v175
s_add_u32 s38, s35, 131200
buffer_store_dwordx4 v[24:27], v5, s[8:11], s38 offen
buffer_store_dwordx4 v[28:31], v5, s[8:11], s38 offen offset:16
v_mov_b32 v32, v176
v_mov_b32 v33, v180
v_mov_b32 v34, v177
v_mov_b32 v35, v181
v_mov_b32 v36, v178
v_mov_b32 v37, v182
v_mov_b32 v38, v179
v_mov_b32 v39, v183
s_add_u32 s38, s35, 196608
buffer_store_dwordx4 v[32:35], v5, s[8:11], s38 offen
buffer_store_dwordx4 v[36:39], v5, s[8:11], s38 offen offset:16
v_mov_b32 v40, v184
v_mov_b32 v41, v188
v_mov_b32 v42, v185
v_mov_b32 v43, v189
v_mov_b32 v44, v186
v_mov_b32 v45, v190
v_mov_b32 v46, v187
v_mov_b32 v47, v191
s_add_u32 s38, s35, 196736
buffer_store_dwordx4 v[40:43], v5, s[8:11], s38 offen
buffer_store_dwordx4 v[44:47], v5, s[8:11], s38 offen offset:16
v_mov_b32 v16, v192
v_mov_b32 v17, v196
v_mov_b32 v18, v193
v_mov_b32 v19, v197
v_mov_b32 v20, v194
v_mov_b32 v21, v198
v_mov_b32 v22, v195
v_mov_b32 v23, v199
s_add_u32 s38, s35, 262144
buffer_store_dwordx4 v[16:19], v5, s[8:11], s38 offen
buffer_store_dwordx4 v[20:23], v5, s[8:11], s38 offen offset:16
v_mov_b32 v24, v200
v_mov_b32 v25, v204
v_mov_b32 v26, v201
v_mov_b32 v27, v205
v_mov_b32 v28, v202
v_mov_b32 v29, v206
v_mov_b32 v30, v203
v_mov_b32 v31, v207
s_add_u32 s38, s35, 262272
buffer_store_dwordx4 v[24:27], v5, s[8:11], s38 offen
buffer_store_dwordx4 v[28:31], v5, s[8:11], s38 offen offset:16
v_mov_b32 v32, v208
v_mov_b32 v33, v212
v_mov_b32 v34, v209
v_mov_b32 v35, v213
v_mov_b32 v36, v210
v_mov_b32 v37, v214
v_mov_b32 v38, v211
v_mov_b32 v39, v215
s_add_u32 s38, s35, 327680
buffer_store_dwordx4 v[32:35], v5, s[8:11], s38 offen
buffer_store_dwordx4 v[36:39], v5, s[8:11], s38 offen offset:16
v_mov_b32 v40, v216
v_mov_b32 v41, v220
v_mov_b32 v42, v217
v_mov_b32 v43, v221
v_mov_b32 v44, v218
v_mov_b32 v45, v222
v_mov_b32 v46, v219
v_mov_b32 v47, v223
s_add_u32 s38, s35, 327808
buffer_store_dwordx4 v[40:43], v5, s[8:11], s38 offen
buffer_store_dwordx4 v[44:47], v5, s[8:11], s38 offen offset:16
v_mov_b32 v16, v224
v_mov_b32 v17, v228
v_mov_b32 v18, v225
v_mov_b32 v19, v229
v_mov_b32 v20, v226
v_mov_b32 v21, v230
v_mov_b32 v22, v227
v_mov_b32 v23, v231
s_add_u32 s38, s35, 393216
buffer_store_dwordx4 v[16:19], v5, s[8:11], s38 offen
buffer_store_dwordx4 v[20:23], v5, s[8:11], s38 offen offset:16
v_mov_b32 v24, v232
v_mov_b32 v25, v236
v_mov_b32 v26, v233
v_mov_b32 v27, v237
v_mov_b32 v28, v234
v_mov_b32 v29, v238
v_mov_b32 v30, v235
v_mov_b32 v31, v239
s_add_u32 s38, s35, 393344
buffer_store_dwordx4 v[24:27], v5, s[8:11], s38 offen
buffer_store_dwordx4 v[28:31], v5, s[8:11], s38 offen offset:16
v_mov_b32 v32, v240
v_mov_b32 v33, v244
v_mov_b32 v34, v241
v_mov_b32 v35, v245
v_mov_b32 v36, v242
v_mov_b32 v37, v246
v_mov_b32 v38, v243
v_mov_b32 v39, v247
s_add_u32 s38, s35, 458752
buffer_store_dwordx4 v[32:35], v5, s[8:11], s38 offen
buffer_store_dwordx4 v[36:39], v5, s[8:11], s38 offen offset:16
v_mov_b32 v40, v248
v_mov_b32 v41, v252
v_mov_b32 v42, v249
v_mov_b32 v43, v253
v_mov_b32 v44, v250
v_mov_b32 v45, v254
v_mov_b32 v46, v251
v_mov_b32 v47, v255
s_add_u32 s38, s35, 458880
buffer_store_dwordx4 v[40:43], v5, s[8:11], s38 offen
buffer_store_dwordx4 v[44:47], v5, s[8:11], s38 offen offset:16
s_waitcnt vmcnt(0) lgkmcnt(0)
s_barrier
s_lshl_b32 s67, s64, 2
s_add_u32 s67, s67, 82862080
s_waitcnt vmcnt(0) lgkmcnt(0)
s_barrier
s_cmp_lg_u32 s17, 0
s_cbranch_scc1 SF2
s_mov_b64 exec, 1
v_mov_b32 v4, s69
v_mov_b32 v5, 0
buffer_store_dword v4, v5, s[8:11], s67 offen sc1
s_mov_b64 exec, -1
SF2:
s_lshr_b32 s32, s64, 1
s_and_b32 s47, s64, 1
s_load_dwordx2 s[20:21], s[0:1], 64
s_waitcnt lgkmcnt(0)
s_and_b32 s21, s21, 0xffff
s_mov_b32 s22, 1024
s_mov_b32 s23, 0x20000
s_load_dwordx2 s[24:25], s[0:1], 72
s_waitcnt lgkmcnt(0)
s_and_b32 s25, s25, 0xffff
s_mov_b32 s26, 1024
s_mov_b32 s27, 0x20000
s_load_dwordx2 s[12:13], s[0:1], 112
s_waitcnt lgkmcnt(0)
s_and_b32 s13, s13, 0xffff
s_mov_b32 s14, 1024
s_mov_b32 s15, 0x20000
s_lshl_b32 s38, s47, 8
v_add_u32 v4, s38, v0
v_lshlrev_b32 v20, 3, v4
v_lshlrev_b32 v4, 1, v4
buffer_load_ushort v16, v4, s[20:23], 0 offen
buffer_load_ushort v17, v4, s[24:27], 0 offen
buffer_load_ushort v18, v4, s[12:15], 0 offen
s_waitcnt vmcnt(2)
v_lshlrev_b32 v16, 16, v16
s_waitcnt vmcnt(1)
v_lshlrev_b32 v17, 16, v17
s_waitcnt vmcnt(0)
v_lshlrev_b32 v18, 16, v18
v_mul_f32 v18, 0x3fb8aa3b, v18
v_exp_f32 v18, v18
s_nop 0
v_cvt_pk_bf16_f32 v18, v18, v18
v_lshlrev_b32 v18, 16, v18
v_mul_f32 v19, v18, v16
v_mul_f32 v14, v18, v17
v_mul_f32 v19, 0x3fb8aa3b, v19
v_exp_f32 v19, v19
v_mul_f32 v14, 0.15915494, v14
v_rndne_f32 v15, v14
v_sub_f32 v14, v14, v15
v_cos_f32 v8, v14
v_sin_f32 v9, v14
s_nop 0
v_mul_f32 v8, v8, v19
v_mul_f32 v9, v9, v19
v_add_f32 v14, -1.0, v8
v_mul_f32 v15, v16, v16
v_fma_f32 v15, v17, v17, v15
v_rcp_f32 v15, v15
v_mul_f32 v10, v14, v16
v_fma_f32 v10, v9, v17, v10
v_mul_f32 v11, v9, v16
v_fma_f32 v11, -v14, v17, v11
v_mul_f32 v10, v10, v15
v_mul_f32 v11, v11, v15
v_mov_b32 v12, v8
v_mov_b32 v13, v9
v_mul_f32 v16, v13, v13
v_mul_f32 v17, v12, v13
v_fma_f32 v12, v12, v12, -v16
v_add_f32 v13, v17, v17
v_mul_f32 v16, v13, v13
v_mul_f32 v17, v12, v13
v_fma_f32 v12, v12, v12, -v16
v_add_f32 v13, v17, v17
v_mul_f32 v16, v13, v13
v_mul_f32 v17, v12, v13
v_fma_f32 v12, v12, v12, -v16
v_add_f32 v13, v17, v17
v_mul_f32 v16, v13, v13
v_mul_f32 v17, v12, v13
v_fma_f32 v12, v12, v12, -v16
v_add_f32 v13, v17, v17
v_mul_f32 v16, v13, v13
v_mul_f32 v17, v12, v13
v_fma_f32 v12, v12, v12, -v16
v_add_f32 v13, v17, v17
v_mul_f32 v16, v13, v13
v_mul_f32 v17, v12, v13
v_fma_f32 v12, v12, v12, -v16
v_add_f32 v13, v17, v17
s_lshr_b32 s67, s32, 1
s_lshl_b32 s67, s67, 4
s_add_u32 s67, s67, 82862080
v_lshrrev_b32 v4, 2, v1
v_min_u32 v4, 12, v4
WF6:
buffer_load_dword v5, v4, s[8:11], s67 offen sc1
s_waitcnt vmcnt(0)
v_cmp_ne_u32 vcc, s69, v5
s_nop 0
s_cbranch_vccz WF6_ok
s_cmp_eq_u32 s65, 0
s_cbranch_scc1 WF6_ok
s_sub_u32 s65, s65, 1
s_sleep 32
s_branch WF6
WF6_ok:
s_lshl_b32 s42, s32, 18
s_add_u32 s42, s42, 88080384
s_add_u32 s38, s42, 0
buffer_load_dwordx2 v[64:65], v20, s[8:11], s38 offen
s_add_u32 s38, s42, 4096
buffer_load_dwordx2 v[66:67], v20, s[8:11], s38 offen
s_add_u32 s38, s42, 8192
buffer_load_dwordx2 v[68:69], v20, s[8:11], s38 offen
s_add_u32 s38, s42, 12288
buffer_load_dwordx2 v[70:71], v20, s[8:11], s38 offen
s_add_u32 s38, s42, 16384
buffer_load_dwordx2 v[72:73], v20, s[8:11], s38 offen
s_add_u32 s38, s42, 20480
buffer_load_dwordx2 v[74:75], v20, s[8:11], s38 offen
s_add_u32 s38, s42, 24576
buffer_load_dwordx2 v[76:77], v20, s[8:11], s38 offen
s_add_u32 s38, s42, 28672
buffer_load_dwordx2 v[78:79], v20, s[8:11], s38 offen
s_add_u32 s38, s42, 32768
buffer_load_dwordx2 v[80:81], v20, s[8:11], s38 offen
s_add_u32 s38, s42, 36864
buffer_load_dwordx2 v[82:83], v20, s[8:11], s38 offen
s_add_u32 s38, s42, 40960
buffer_load_dwordx2 v[84:85], v20, s[8:11], s38 offen
s_add_u32 s38, s42, 45056
buffer_load_dwordx2 v[86:87], v20, s[8:11], s38 offen
s_add_u32 s38, s42, 49152
buffer_load_dwordx2 v[88:89], v20, s[8:11], s38 offen
s_add_u32 s38, s42, 53248
buffer_load_dwordx2 v[90:91], v20, s[8:11], s38 offen
s_add_u32 s38, s42, 57344
buffer_load_dwordx2 v[92:93], v20, s[8:11], s38 offen
s_add_u32 s38, s42, 61440
buffer_load_dwordx2 v[94:95], v20, s[8:11], s38 offen
s_add_u32 s38, s42, 65536
buffer_load_dwordx2 v[96:97], v20, s[8:11], s38 offen
s_add_u32 s38, s42, 69632
buffer_load_dwordx2 v[98:99], v20, s[8:11], s38 offen
s_add_u32 s38, s42, 73728
buffer_load_dwordx2 v[100:101], v20, s[8:11], s38 offen
s_add_u32 s38, s42, 77824
buffer_load_dwordx2 v[102:103], v20, s[8:11], s38 offen
s_add_u32 s38, s42, 81920
buffer_load_dwordx2 v[104:105], v20, s[8:11], s38 offen
s_add_u32 s38, s42, 86016
buffer_load_dwordx2 v[106:107], v20, s[8:11], s38 offen
s_add_u32 s38, s42, 90112
buffer_load_dwordx2 v[108:109], v20, s[8:11], s38 offen
s_add_u32 s38, s42, 94208
buffer_load_dwordx2 v[110:111], v20, s[8:11], s38 offen
s_add_u32 s38, s42, 98304
buffer_load_dwordx2 v[112:113], v20, s[8:11], s38 offen
s_add_u32 s38, s42, 102400
buffer_load_dwordx2 v[114:115], v20, s[8:11], s38 offen
s_add_u32 s38, s42, 106496
buffer_load_dwordx2 v[116:117], v20, s[8:11], s38 offen
s_add_u32 s38, s42, 110592
buffer_load_dwordx2 v[118:119], v20, s[8:11], s38 offen
s_add_u32 s38, s42, 114688
buffer_load_dwordx2 v[120:121], v20, s[8:11], s38 offen
s_add_u32 s38, s42, 118784
buffer_load_dwordx2 v[122:123], v20, s[8:11], s38 offen
s_add_u32 s38, s42, 122880
buffer_load_dwordx2 v[124:125], v20, s[8:11], s38 offen
s_add_u32 s38, s42, 126976
buffer_load_dwordx2 v[126:127], v20, s[8:11], s38 offen
v_mov_b32 v14, 0
v_mov_b32 v15, 0
s_waitcnt vmcnt(31)
v_fma_f32 v16, -v9, v15, v64
v_fma_f32 v17, v9, v14, v65
v_fma_f32 v14, v8, v14, v16
v_fma_f32 v15, v8, v15, v17
s_lshl_b32 s42, s32, 18
s_add_u32 s42, s42, 88211456
s_add_u32 s38, s42, 0
buffer_load_dwordx2 v[128:129], v20, s[8:11], s38 offen
s_add_u32 s38, s42, 4096
buffer_load_dwordx2 v[130:131], v20, s[8:11], s38 offen
s_add_u32 s38, s42, 8192
buffer_load_dwordx2 v[132:133], v20, s[8:11], s38 offen
s_add_u32 s38, s42, 12288
buffer_load_dwordx2 v[134:135], v20, s[8:11], s38 offen
s_add_u32 s38, s42, 16384
buffer_load_dwordx2 v[136:137], v20, s[8:11], s38 offen
s_add_u32 s38, s42, 20480
buffer_load_dwordx2 v[138:139], v20, s[8:11], s38 offen
s_add_u32 s38, s42, 24576
buffer_load_dwordx2 v[140:141], v20, s[8:11], s38 offen
s_add_u32 s38, s42, 28672
buffer_load_dwordx2 v[142:143], v20, s[8:11], s38 offen
s_add_u32 s38, s42, 32768
buffer_load_dwordx2 v[144:145], v20, s[8:11], s38 offen
s_add_u32 s38, s42, 36864
buffer_load_dwordx2 v[146:147], v20, s[8:11], s38 offen
s_add_u32 s38, s42, 40960
buffer_load_dwordx2 v[148:149], v20, s[8:11], s38 offen
s_add_u32 s38, s42, 45056
buffer_load_dwordx2 v[150:151], v20, s[8:11], s38 offen
s_add_u32 s38, s42, 49152
buffer_load_dwordx2 v[152:153], v20, s[8:11], s38 offen
s_add_u32 s38, s42, 53248
buffer_load_dwordx2 v[154:155], v20, s[8:11], s38 offen
s_add_u32 s38, s42, 57344
buffer_load_dwordx2 v[156:157], v20, s[8:11], s38 offen
s_add_u32 s38, s42, 61440
buffer_load_dwordx2 v[158:159], v20, s[8:11], s38 offen
s_add_u32 s38, s42, 65536
buffer_load_dwordx2 v[160:161], v20, s[8:11], s38 offen
s_add_u32 s38, s42, 69632
buffer_load_dwordx2 v[162:163], v20, s[8:11], s38 offen
s_add_u32 s38, s42, 73728
buffer_load_dwordx2 v[164:165], v20, s[8:11], s38 offen
s_add_u32 s38, s42, 77824
buffer_load_dwordx2 v[166:167], v20, s[8:11], s38 offen
s_add_u32 s38, s42, 81920
buffer_load_dwordx2 v[168:169], v20, s[8:11], s38 offen
s_add_u32 s38, s42, 86016
buffer_load_dwordx2 v[170:171], v20, s[8:11], s38 offen
s_add_u32 s38, s42, 90112
buffer_load_dwordx2 v[172:173], v20, s[8:11], s38 offen
s_add_u32 s38, s42, 94208
buffer_load_dwordx2 v[174:175], v20, s[8:11], s38 offen
s_add_u32 s38, s42, 98304
buffer_load_dwordx2 v[176:177], v20, s[8:11], s38 offen
s_add_u32 s38, s42, 102400
buffer_load_dwordx2 v[178:179], v20, s[8:11], s38 offen
s_add_u32 s38, s42, 106496
buffer_load_dwordx2 v[180:181], v20, s[8:11], s38 offen
s_add_u32 s38, s42, 110592
buffer_load_dwordx2 v[182:183], v20, s[8:11], s38 offen
s_add_u32 s38, s42, 114688
buffer_load_dwordx2 v[184:185], v20, s[8:11], s38 offen
s_add_u32 s38, s42, 118784
buffer_load_dwordx2 v[186:187], v20, s[8:11], s38 offen
s_add_u32 s38, s42, 122880
buffer_load_dwordx2 v[188:189], v20, s[8:11], s38 offen
s_add_u32 s38, s42, 126976
buffer_load_dwordx2 v[190:191], v20, s[8:11], s38 offen
s_waitcnt vmcnt(62)
v_fma_f32 v16, -v9, v15, v66
v_fma_f32 v17, v9, v14, v67
v_fma_f32 v14, v8, v14, v16
v_fma_f32 v15, v8, v15, v17
s_waitcnt vmcnt(61)
v_fma_f32 v16, -v9, v15, v68
v_fma_f32 v17, v9, v14, v69
v_fma_f32 v14, v8, v14, v16
v_fma_f32 v15, v8, v15, v17
s_waitcnt vmcnt(60)
v_fma_f32 v16, -v9, v15, v70
v_fma_f32 v17, v9, v14, v71
v_fma_f32 v14, v8, v14, v16
v_fma_f32 v15, v8, v15, v17
s_waitcnt vmcnt(59)
v_fma_f32 v16, -v9, v15, v72
v_fma_f32 v17, v9, v14, v73
v_fma_f32 v14, v8, v14, v16
v_fma_f32 v15, v8, v15, v17
s_waitcnt vmcnt(58)
v_fma_f32 v16, -v9, v15, v74
v_fma_f32 v17, v9, v14, v75
v_fma_f32 v14, v8, v14, v16
v_fma_f32 v15, v8, v15, v17
s_waitcnt vmcnt(57)
v_fma_f32 v16, -v9, v15, v76
v_fma_f32 v17, v9, v14, v77
v_fma_f32 v14, v8, v14, v16
v_fma_f32 v15, v8, v15, v17
s_waitcnt vmcnt(56)
v_fma_f32 v16, -v9, v15, v78
v_fma_f32 v17, v9, v14, v79
v_fma_f32 v14, v8, v14, v16
v_fma_f32 v15, v8, v15, v17
s_waitcnt vmcnt(55)
v_fma_f32 v16, -v9, v15, v80
v_fma_f32 v17, v9, v14, v81
v_fma_f32 v14, v8, v14, v16
v_fma_f32 v15, v8, v15, v17
s_waitcnt vmcnt(54)
v_fma_f32 v16, -v9, v15, v82
v_fma_f32 v17, v9, v14, v83
v_fma_f32 v14, v8, v14, v16
v_fma_f32 v15, v8, v15, v17
s_waitcnt vmcnt(53)
v_fma_f32 v16, -v9, v15, v84
v_fma_f32 v17, v9, v14, v85
v_fma_f32 v14, v8, v14, v16
v_fma_f32 v15, v8, v15, v17
s_waitcnt vmcnt(52)
v_fma_f32 v16, -v9, v15, v86
v_fma_f32 v17, v9, v14, v87
v_fma_f32 v14, v8, v14, v16
v_fma_f32 v15, v8, v15, v17
s_waitcnt vmcnt(51)
v_fma_f32 v16, -v9, v15, v88
v_fma_f32 v17, v9, v14, v89
v_fma_f32 v14, v8, v14, v16
v_fma_f32 v15, v8, v15, v17
s_waitcnt vmcnt(50)
v_fma_f32 v16, -v9, v15, v90
v_fma_f32 v17, v9, v14, v91
v_fma_f32 v14, v8, v14, v16
v_fma_f32 v15, v8, v15, v17
s_waitcnt vmcnt(49)
v_fma_f32 v16, -v9, v15, v92
v_fma_f32 v17, v9, v14, v93
v_fma_f32 v14, v8, v14, v16
v_fma_f32 v15, v8, v15, v17
s_waitcnt vmcnt(48)
v_fma_f32 v16, -v9, v15, v94
v_fma_f32 v17, v9, v14, v95
v_fma_f32 v14, v8, v14, v16
v_fma_f32 v15, v8, v15, v17
s_waitcnt vmcnt(47)
v_fma_f32 v16, -v9, v15, v96
v_fma_f32 v17, v9, v14, v97
v_fma_f32 v14, v8, v14, v16
v_fma_f32 v15, v8, v15, v17
s_waitcnt vmcnt(46)
v_fma_f32 v16, -v9, v15, v98
v_fma_f32 v17, v9, v14, v99
v_fma_f32 v14, v8, v14, v16
v_fma_f32 v15, v8, v15, v17
s_waitcnt vmcnt(45)
v_fma_f32 v16, -v9, v15, v100
v_fma_f32 v17, v9, v14, v101
v_fma_f32 v14, v8, v14, v16
v_fma_f32 v15, v8, v15, v17
s_waitcnt vmcnt(44)
v_fma_f32 v16, -v9, v15, v102
v_fma_f32 v17, v9, v14, v103
v_fma_f32 v14, v8, v14, v16
v_fma_f32 v15, v8, v15, v17
s_waitcnt vmcnt(43)
v_fma_f32 v16, -v9, v15, v104
v_fma_f32 v17, v9, v14, v105
v_fma_f32 v14, v8, v14, v16
v_fma_f32 v15, v8, v15, v17
s_waitcnt vmcnt(42)
v_fma_f32 v16, -v9, v15, v106
v_fma_f32 v17, v9, v14, v107
v_fma_f32 v14, v8, v14, v16
v_fma_f32 v15, v8, v15, v17
s_waitcnt vmcnt(41)
v_fma_f32 v16, -v9, v15, v108
v_fma_f32 v17, v9, v14, v109
v_fma_f32 v14, v8, v14, v16
v_fma_f32 v15, v8, v15, v17
s_waitcnt vmcnt(40)
v_fma_f32 v16, -v9, v15, v110
v_fma_f32 v17, v9, v14, v111
v_fma_f32 v14, v8, v14, v16
v_fma_f32 v15, v8, v15, v17
s_waitcnt vmcnt(39)
v_fma_f32 v16, -v9, v15, v112
v_fma_f32 v17, v9, v14, v113
v_fma_f32 v14, v8, v14, v16
v_fma_f32 v15, v8, v15, v17
s_waitcnt vmcnt(38)
v_fma_f32 v16, -v9, v15, v114
v_fma_f32 v17, v9, v14, v115
v_fma_f32 v14, v8, v14, v16
v_fma_f32 v15, v8, v15, v17
s_waitcnt vmcnt(37)
v_fma_f32 v16, -v9, v15, v116
v_fma_f32 v17, v9, v14, v117
v_fma_f32 v14, v8, v14, v16
v_fma_f32 v15, v8, v15, v17
s_waitcnt vmcnt(36)
v_fma_f32 v16, -v9, v15, v118
v_fma_f32 v17, v9, v14, v119
v_fma_f32 v14, v8, v14, v16
v_fma_f32 v15, v8, v15, v17
s_waitcnt vmcnt(35)
v_fma_f32 v16, -v9, v15, v120
v_fma_f32 v17, v9, v14, v121
v_fma_f32 v14, v8, v14, v16
v_fma_f32 v15, v8, v15, v17
s_waitcnt vmcnt(34)
v_fma_f32 v16, -v9, v15, v122
v_fma_f32 v17, v9, v14, v123
v_fma_f32 v14, v8, v14, v16
v_fma_f32 v15, v8, v15, v17
s_waitcnt vmcnt(33)
v_fma_f32 v16, -v9, v15, v124
v_fma_f32 v17, v9, v14, v125
v_fma_f32 v14, v8, v14, v16
v_fma_f32 v15, v8, v15, v17
s_waitcnt vmcnt(32)
v_fma_f32 v16, -v9, v15, v126
v_fma_f32 v17, v9, v14, v127
v_fma_f32 v14, v8, v14, v16
v_fma_f32 v15, v8, v15, v17
s_waitcnt vmcnt(31)
v_fma_f32 v16, -v9, v15, v128
v_fma_f32 v17, v9, v14, v129
v_fma_f32 v14, v8, v14, v16
v_fma_f32 v15, v8, v15, v17
s_waitcnt vmcnt(30)
v_fma_f32 v16, -v9, v15, v130
v_fma_f32 v17, v9, v14, v131
v_fma_f32 v14, v8, v14, v16
v_fma_f32 v15, v8, v15, v17
s_waitcnt vmcnt(29)
v_fma_f32 v16, -v9, v15, v132
v_fma_f32 v17, v9, v14, v133
v_fma_f32 v14, v8, v14, v16
v_fma_f32 v15, v8, v15, v17
s_waitcnt vmcnt(28)
v_fma_f32 v16, -v9, v15, v134
v_fma_f32 v17, v9, v14, v135
v_fma_f32 v14, v8, v14, v16
v_fma_f32 v15, v8, v15, v17
s_waitcnt vmcnt(27)
v_fma_f32 v16, -v9, v15, v136
v_fma_f32 v17, v9, v14, v137
v_fma_f32 v14, v8, v14, v16
v_fma_f32 v15, v8, v15, v17
s_waitcnt vmcnt(26)
v_fma_f32 v16, -v9, v15, v138
v_fma_f32 v17, v9, v14, v139
v_fma_f32 v14, v8, v14, v16
v_fma_f32 v15, v8, v15, v17
s_waitcnt vmcnt(25)
v_fma_f32 v16, -v9, v15, v140
v_fma_f32 v17, v9, v14, v141
v_fma_f32 v14, v8, v14, v16
v_fma_f32 v15, v8, v15, v17
s_waitcnt vmcnt(24)
v_fma_f32 v16, -v9, v15, v142
v_fma_f32 v17, v9, v14, v143
v_fma_f32 v14, v8, v14, v16
v_fma_f32 v15, v8, v15, v17
s_waitcnt vmcnt(23)
v_fma_f32 v16, -v9, v15, v144
v_fma_f32 v17, v9, v14, v145
v_fma_f32 v14, v8, v14, v16
v_fma_f32 v15, v8, v15, v17
s_waitcnt vmcnt(22)
v_fma_f32 v16, -v9, v15, v146
v_fma_f32 v17, v9, v14, v147
v_fma_f32 v14, v8, v14, v16
v_fma_f32 v15, v8, v15, v17
s_waitcnt vmcnt(21)
v_fma_f32 v16, -v9, v15, v148
v_fma_f32 v17, v9, v14, v149
v_fma_f32 v14, v8, v14, v16
v_fma_f32 v15, v8, v15, v17
s_waitcnt vmcnt(20)
v_fma_f32 v16, -v9, v15, v150
v_fma_f32 v17, v9, v14, v151
v_fma_f32 v14, v8, v14, v16
v_fma_f32 v15, v8, v15, v17
s_waitcnt vmcnt(19)
v_fma_f32 v16, -v9, v15, v152
v_fma_f32 v17, v9, v14, v153
v_fma_f32 v14, v8, v14, v16
v_fma_f32 v15, v8, v15, v17
s_waitcnt vmcnt(18)
v_fma_f32 v16, -v9, v15, v154
v_fma_f32 v17, v9, v14, v155
v_fma_f32 v14, v8, v14, v16
v_fma_f32 v15, v8, v15, v17
s_waitcnt vmcnt(17)
v_fma_f32 v16, -v9, v15, v156
v_fma_f32 v17, v9, v14, v157
v_fma_f32 v14, v8, v14, v16
v_fma_f32 v15, v8, v15, v17
s_waitcnt vmcnt(16)
v_fma_f32 v16, -v9, v15, v158
v_fma_f32 v17, v9, v14, v159
v_fma_f32 v14, v8, v14, v16
v_fma_f32 v15, v8, v15, v17
s_waitcnt vmcnt(15)
v_fma_f32 v16, -v9, v15, v160
v_fma_f32 v17, v9, v14, v161
v_fma_f32 v14, v8, v14, v16
v_fma_f32 v15, v8, v15, v17
s_waitcnt vmcnt(14)
v_fma_f32 v16, -v9, v15, v162
v_fma_f32 v17, v9, v14, v163
v_fma_f32 v14, v8, v14, v16
v_fma_f32 v15, v8, v15, v17
s_waitcnt vmcnt(13)
v_fma_f32 v16, -v9, v15, v164
v_fma_f32 v17, v9, v14, v165
v_fma_f32 v14, v8, v14, v16
v_fma_f32 v15, v8, v15, v17
s_waitcnt vmcnt(12)
v_fma_f32 v16, -v9, v15, v166
v_fma_f32 v17, v9, v14, v167
v_fma_f32 v14, v8, v14, v16
v_fma_f32 v15, v8, v15, v17
s_waitcnt vmcnt(11)
v_fma_f32 v16, -v9, v15, v168
v_fma_f32 v17, v9, v14, v169
v_fma_f32 v14, v8, v14, v16
v_fma_f32 v15, v8, v15, v17
s_waitcnt vmcnt(10)
v_fma_f32 v16, -v9, v15, v170
v_fma_f32 v17, v9, v14, v171
v_fma_f32 v14, v8, v14, v16
v_fma_f32 v15, v8, v15, v17
s_waitcnt vmcnt(9)
v_fma_f32 v16, -v9, v15, v172
v_fma_f32 v17, v9, v14, v173
v_fma_f32 v14, v8, v14, v16
v_fma_f32 v15, v8, v15, v17
s_waitcnt vmcnt(8)
v_fma_f32 v16, -v9, v15, v174
v_fma_f32 v17, v9, v14, v175
v_fma_f32 v14, v8, v14, v16
v_fma_f32 v15, v8, v15, v17
s_waitcnt vmcnt(7)
v_fma_f32 v16, -v9, v15, v176
v_fma_f32 v17, v9, v14, v177
v_fma_f32 v14, v8, v14, v16
v_fma_f32 v15, v8, v15, v17
s_waitcnt vmcnt(6)
v_fma_f32 v16, -v9, v15, v178
v_fma_f32 v17, v9, v14, v179
v_fma_f32 v14, v8, v14, v16
v_fma_f32 v15, v8, v15, v17
s_waitcnt vmcnt(5)
v_fma_f32 v16, -v9, v15, v180
v_fma_f32 v17, v9, v14, v181
v_fma_f32 v14, v8, v14, v16
v_fma_f32 v15, v8, v15, v17
s_waitcnt vmcnt(4)
v_fma_f32 v16, -v9, v15, v182
v_fma_f32 v17, v9, v14, v183
v_fma_f32 v14, v8, v14, v16
v_fma_f32 v15, v8, v15, v17
s_waitcnt vmcnt(3)
v_fma_f32 v16, -v9, v15, v184
v_fma_f32 v17, v9, v14, v185
v_fma_f32 v14, v8, v14, v16
v_fma_f32 v15, v8, v15, v17
s_waitcnt vmcnt(2)
v_fma_f32 v16, -v9, v15, v186
v_fma_f32 v17, v9, v14, v187
v_fma_f32 v14, v8, v14, v16
v_fma_f32 v15, v8, v15, v17
s_waitcnt vmcnt(1)
v_fma_f32 v16, -v9, v15, v188
v_fma_f32 v17, v9, v14, v189
v_fma_f32 v14, v8, v14, v16
v_fma_f32 v15, v8, v15, v17
s_waitcnt vmcnt(0)
v_fma_f32 v16, -v9, v15, v190
v_fma_f32 v17, v9, v14, v191
v_fma_f32 v14, v8, v14, v16
v_fma_f32 v15, v8, v15, v17
s_lshl_b32 s38, s32, 12
s_add_u32 s38, s38, 100663296
v_mov_b32 v18, v14
v_mov_b32 v19, v15
buffer_store_dwordx2 v[18:19], v20, s[8:11], s38 offen sc1
s_waitcnt vmcnt(0)
s_lshl_b32 s67, s64, 2
s_add_u32 s67, s67, 82863104
s_waitcnt vmcnt(0) lgkmcnt(0)
s_barrier
s_cmp_lg_u32 s17, 0
s_cbranch_scc1 SF3
s_mov_b64 exec, 1
v_mov_b32 v4, s69
v_mov_b32 v5, 0
buffer_store_dword v4, v5, s[8:11], s67 offen sc1
s_mov_b64 exec, -1
SF3:
s_mov_b32 s67, 82863104
v_lshrrev_b32 v4, 2, v1
v_min_u32 v4, 252, v4
WF7:
buffer_load_dword v5, v4, s[8:11], s67 offen sc1
s_waitcnt vmcnt(0)
v_cmp_ne_u32 vcc, s69, v5
s_nop 0
s_cbranch_vccz WF7_ok
s_cmp_eq_u32 s65, 0
s_cbranch_scc1 WF7_ok
s_sub_u32 s65, s65, 1
s_sleep 32
s_branch WF7
WF7_ok:
s_mov_b32 s45, 100663296
s_add_u32 s38, s45, 0
buffer_load_dwordx2 v[192:193], v20, s[8:11], s38 offen
s_add_u32 s38, s45, 4096
buffer_load_dwordx2 v[194:195], v20, s[8:11], s38 offen
s_add_u32 s38, s45, 8192
buffer_load_dwordx2 v[196:197], v20, s[8:11], s38 offen
s_add_u32 s38, s45, 12288
buffer_load_dwordx2 v[198:199], v20, s[8:11], s38 offen
s_add_u32 s38, s45, 16384
buffer_load_dwordx2 v[200:201], v20, s[8:11], s38 offen
s_add_u32 s38, s45, 20480
buffer_load_dwordx2 v[202:203], v20, s[8:11], s38 offen
s_add_u32 s38, s45, 24576
buffer_load_dwordx2 v[204:205], v20, s[8:11], s38 offen
s_add_u32 s38, s45, 28672
buffer_load_dwordx2 v[206:207], v20, s[8:11], s38 offen
s_add_u32 s38, s45, 32768
buffer_load_dwordx2 v[208:209], v20, s[8:11], s38 offen
s_add_u32 s38, s45, 36864
buffer_load_dwordx2 v[210:211], v20, s[8:11], s38 offen
s_add_u32 s38, s45, 40960
buffer_load_dwordx2 v[212:213], v20, s[8:11], s38 offen
s_add_u32 s38, s45, 45056
buffer_load_dwordx2 v[214:215], v20, s[8:11], s38 offen
s_add_u32 s38, s45, 49152
buffer_load_dwordx2 v[216:217], v20, s[8:11], s38 offen
s_add_u32 s38, s45, 53248
buffer_load_dwordx2 v[218:219], v20, s[8:11], s38 offen
s_add_u32 s38, s45, 57344
buffer_load_dwordx2 v[220:221], v20, s[8:11], s38 offen
s_add_u32 s38, s45, 61440
buffer_load_dwordx2 v[222:223], v20, s[8:11], s38 offen
s_add_u32 s38, s45, 65536
buffer_load_dwordx2 v[224:225], v20, s[8:11], s38 offen
s_add_u32 s38, s45, 69632
buffer_load_dwordx2 v[226:227], v20, s[8:11], s38 offen
s_add_u32 s38, s45, 73728
buffer_load_dwordx2 v[228:229], v20, s[8:11], s38 offen
s_add_u32 s38, s45, 77824
buffer_load_dwordx2 v[230:231], v20, s[8:11], s38 offen
s_add_u32 s38, s45, 81920
buffer_load_dwordx2 v[232:233], v20, s[8:11], s38 offen
s_add_u32 s38, s45, 86016
buffer_load_dwordx2 v[234:235], v20, s[8:11], s38 offen
s_add_u32 s38, s45, 90112
buffer_load_dwordx2 v[236:237], v20, s[8:11], s38 offen
s_add_u32 s38, s45, 94208
buffer_load_dwordx2 v[238:239], v20, s[8:11], s38 offen
s_add_u32 s38, s45, 98304
buffer_load_dwordx2 v[240:241], v20, s[8:11], s38 offen
s_add_u32 s38, s45, 102400
buffer_load_dwordx2 v[242:243], v20, s[8:11], s38 offen
s_add_u32 s38, s45, 106496
buffer_load_dwordx2 v[244:245], v20, s[8:11], s38 offen
s_add_u32 s38, s45, 110592
buffer_load_dwordx2 v[246:247], v20, s[8:11], s38 offen
s_add_u32 s38, s45, 114688
buffer_load_dwordx2 v[248:249], v20, s[8:11], s38 offen
s_add_u32 s38, s45, 118784
buffer_load_dwordx2 v[250:251], v20, s[8:11], s38 offen
s_add_u32 s38, s45, 122880
buffer_load_dwordx2 v[252:253], v20, s[8:11], s38 offen
s_lshl_b32 s42, s32, 18
s_add_u32 s42, s42, 88080384
s_add_u32 s38, s42, 0
buffer_load_dwordx2 v[64:65], v20, s[8:11], s38 offen
s_add_u32 s38, s42, 4096
buffer_load_dwordx2 v[66:67], v20, s[8:11], s38 offen
s_add_u32 s38, s42, 8192
buffer_load_dwordx2 v[68:69], v20, s[8:11], s38 offen
s_add_u32 s38, s42, 12288
buffer_load_dwordx2 v[70:71], v20, s[8:11], s38 offen
s_add_u32 s38, s42, 16384
buffer_load_dwordx2 v[72:73], v20, s[8:11], s38 offen
s_add_u32 s38, s42, 20480
buffer_load_dwordx2 v[74:75], v20, s[8:11], s38 offen
s_add_u32 s38, s42, 24576
buffer_load_dwordx2 v[76:77], v20, s[8:11], s38 offen
s_add_u32 s38, s42, 28672
buffer_load_dwordx2 v[78:79], v20, s[8:11], s38 offen
s_add_u32 s38, s42, 32768
buffer_load_dwordx2 v[80:81], v20, s[8:11], s38 offen
s_add_u32 s38, s42, 36864
buffer_load_dwordx2 v[82:83], v20, s[8:11], s38 offen
s_add_u32 s38, s42, 40960
buffer_load_dwordx2 v[84:85], v20, s[8:11], s38 offen
s_add_u32 s38, s42, 45056
buffer_load_dwordx2 v[86:87], v20, s[8:11], s38 offen
s_add_u32 s38, s42, 49152
buffer_load_dwordx2 v[88:89], v20, s[8:11], s38 offen
s_add_u32 s38, s42, 53248
buffer_load_dwordx2 v[90:91], v20, s[8:11], s38 offen
s_add_u32 s38, s42, 57344
buffer_load_dwordx2 v[92:93], v20, s[8:11], s38 offen
s_add_u32 s38, s42, 61440
buffer_load_dwordx2 v[94:95], v20, s[8:11], s38 offen
s_add_u32 s38, s42, 65536
buffer_load_dwordx2 v[96:97], v20, s[8:11], s38 offen
s_add_u32 s38, s42, 69632
buffer_load_dwordx2 v[98:99], v20, s[8:11], s38 offen
s_add_u32 s38, s42, 73728
buffer_load_dwordx2 v[100:101], v20, s[8:11], s38 offen
s_add_u32 s38, s42, 77824
buffer_load_dwordx2 v[102:103], v20, s[8:11], s38 offen
s_add_u32 s38, s42, 81920
buffer_load_dwordx2 v[104:105], v20, s[8:11], s38 offen
s_add_u32 s38, s42, 86016
buffer_load_dwordx2 v[106:107], v20, s[8:11], s38 offen
s_add_u32 s38, s42, 90112
buffer_load_dwordx2 v[108:109], v20, s[8:11], s38 offen
s_add_u32 s38, s42, 94208
buffer_load_dwordx2 v[110:111], v20, s[8:11], s38 offen
s_add_u32 s38, s42, 98304
buffer_load_dwordx2 v[112:113], v20, s[8:11], s38 offen
s_add_u32 s38, s42, 102400
buffer_load_dwordx2 v[114:115], v20, s[8:11], s38 offen
s_add_u32 s38, s42, 106496
buffer_load_dwordx2 v[116:117], v20, s[8:11], s38 offen
s_add_u32 s38, s42, 110592
buffer_load_dwordx2 v[118:119], v20, s[8:11], s38 offen
s_add_u32 s38, s42, 114688
buffer_load_dwordx2 v[120:121], v20, s[8:11], s38 offen
s_add_u32 s38, s42, 118784
buffer_load_dwordx2 v[122:123], v20, s[8:11], s38 offen
s_add_u32 s38, s42, 122880
buffer_load_dwordx2 v[124:125], v20, s[8:11], s38 offen
s_add_u32 s38, s42, 126976
buffer_load_dwordx2 v[126:127], v20, s[8:11], s38 offen
v_mov_b32 v14, 0
v_mov_b32 v15, 0
s_waitcnt vmcnt(32)
s_cmp_le_u32 s32, 0
s_cbranch_scc1 S3_carry
v_fma_f32 v16, -v13, v15, v192
v_fma_f32 v17, v13, v14, v193
v_fma_f32 v14, v12, v14, v16
v_fma_f32 v15, v12, v15, v17
s_cmp_le_u32 s32, 1
s_cbranch_scc1 S3_carry
v_fma_f32 v16, -v13, v15, v194
v_fma_f32 v17, v13, v14, v195
v_fma_f32 v14, v12, v14, v16
v_fma_f32 v15, v12, v15, v17
s_cmp_le_u32 s32, 2
s_cbranch_scc1 S3_carry
v_fma_f32 v16, -v13, v15, v196
v_fma_f32 v17, v13, v14, v197
v_fma_f32 v14, v12, v14, v16
v_fma_f32 v15, v12, v15, v17
s_cmp_le_u32 s32, 3
s_cbranch_scc1 S3_carry
v_fma_f32 v16, -v13, v15, v198
v_fma_f32 v17, v13, v14, v199
v_fma_f32 v14, v12, v14, v16
v_fma_f32 v15, v12, v15, v17
s_cmp_le_u32 s32, 4
s_cbranch_scc1 S3_carry
v_fma_f32 v16, -v13, v15, v200
v_fma_f32 v17, v13, v14, v201
v_fma_f32 v14, v12, v14, v16
v_fma_f32 v15, v12, v15, v17
s_cmp_le_u32 s32, 5
s_cbranch_scc1 S3_carry
v_fma_f32 v16, -v13, v15, v202
v_fma_f32 v17, v13, v14, v203
v_fma_f32 v14, v12, v14, v16
v_fma_f32 v15, v12, v15, v17
s_cmp_le_u32 s32, 6
s_cbranch_scc1 S3_carry
v_fma_f32 v16, -v13, v15, v204
v_fma_f32 v17, v13, v14, v205
v_fma_f32 v14, v12, v14, v16
v_fma_f32 v15, v12, v15, v17
s_cmp_le_u32 s32, 7
s_cbranch_scc1 S3_carry
v_fma_f32 v16, -v13, v15, v206
v_fma_f32 v17, v13, v14, v207
v_fma_f32 v14, v12, v14, v16
v_fma_f32 v15, v12, v15, v17
s_cmp_le_u32 s32, 8
s_cbranch_scc1 S3_carry
v_fma_f32 v16, -v13, v15, v208
v_fma_f32 v17, v13, v14, v209
v_fma_f32 v14, v12, v14, v16
v_fma_f32 v15, v12, v15, v17
s_cmp_le_u32 s32, 9
s_cbranch_scc1 S3_carry
v_fma_f32 v16, -v13, v15, v210
v_fma_f32 v17, v13, v14, v211
v_fma_f32 v14, v12, v14, v16
v_fma_f32 v15, v12, v15, v17
s_cmp_le_u32 s32, 10
s_cbranch_scc1 S3_carry
v_fma_f32 v16, -v13, v15, v212
v_fma_f32 v17, v13, v14, v213
v_fma_f32 v14, v12, v14, v16
v_fma_f32 v15, v12, v15, v17
s_cmp_le_u32 s32, 11
s_cbranch_scc1 S3_carry
v_fma_f32 v16, -v13, v15, v214
v_fma_f32 v17, v13, v14, v215
v_fma_f32 v14, v12, v14, v16
v_fma_f32 v15, v12, v15, v17
s_cmp_le_u32 s32, 12
s_cbranch_scc1 S3_carry
v_fma_f32 v16, -v13, v15, v216
v_fma_f32 v17, v13, v14, v217
v_fma_f32 v14, v12, v14, v16
v_fma_f32 v15, v12, v15, v17
s_cmp_le_u32 s32, 13
s_cbranch_scc1 S3_carry
v_fma_f32 v16, -v13, v15, v218
v_fma_f32 v17, v13, v14, v219
v_fma_f32 v14, v12, v14, v16
v_fma_f32 v15, v12, v15, v17
s_cmp_le_u32 s32, 14
s_cbranch_scc1 S3_carry
v_fma_f32 v16, -v13, v15, v220
v_fma_f32 v17, v13, v14, v221
v_fma_f32 v14, v12, v14, v16
v_fma_f32 v15, v12, v15, v17
s_cmp_le_u32 s32, 15
s_cbranch_scc1 S3_carry
v_fma_f32 v16, -v13, v15, v222
v_fma_f32 v17, v13, v14, v223
v_fma_f32 v14, v12, v14, v16
v_fma_f32 v15, v12, v15, v17
s_cmp_le_u32 s32, 16
s_cbranch_scc1 S3_carry
v_fma_f32 v16, -v13, v15, v224
v_fma_f32 v17, v13, v14, v225
v_fma_f32 v14, v12, v14, v16
v_fma_f32 v15, v12, v15, v17
s_cmp_le_u32 s32, 17
s_cbranch_scc1 S3_carry
v_fma_f32 v16, -v13, v15, v226
v_fma_f32 v17, v13, v14, v227
v_fma_f32 v14, v12, v14, v16
v_fma_f32 v15, v12, v15, v17
s_cmp_le_u32 s32, 18
s_cbranch_scc1 S3_carry
v_fma_f32 v16, -v13, v15, v228
v_fma_f32 v17, v13, v14, v229
v_fma_f32 v14, v12, v14, v16
v_fma_f32 v15, v12, v15, v17
s_cmp_le_u32 s32, 19
s_cbranch_scc1 S3_carry
v_fma_f32 v16, -v13, v15, v230
v_fma_f32 v17, v13, v14, v231
v_fma_f32 v14, v12, v14, v16
v_fma_f32 v15, v12, v15, v17
s_cmp_le_u32 s32, 20
s_cbranch_scc1 S3_carry
v_fma_f32 v16, -v13, v15, v232
v_fma_f32 v17, v13, v14, v233
v_fma_f32 v14, v12, v14, v16
v_fma_f32 v15, v12, v15, v17
s_cmp_le_u32 s32, 21
s_cbranch_scc1 S3_carry
v_fma_f32 v16, -v13, v15, v234
v_fma_f32 v17, v13, v14, v235
v_fma_f32 v14, v12, v14, v16
v_fma_f32 v15, v12, v15, v17
s_cmp_le_u32 s32, 22
s_cbranch_scc1 S3_carry
v_fma_f32 v16, -v13, v15, v236
v_fma_f32 v17, v13, v14, v237
v_fma_f32 v14, v12, v14, v16
v_fma_f32 v15, v12, v15, v17
s_cmp_le_u32 s32, 23
s_cbranch_scc1 S3_carry
v_fma_f32 v16, -v13, v15, v238
v_fma_f32 v17, v13, v14, v239
v_fma_f32 v14, v12, v14, v16
v_fma_f32 v15, v12, v15, v17
s_cmp_le_u32 s32, 24
s_cbranch_scc1 S3_carry
v_fma_f32 v16, -v13, v15, v240
v_fma_f32 v17, v13, v14, v241
v_fma_f32 v14, v12, v14, v16
v_fma_f32 v15, v12, v15, v17
s_cmp_le_u32 s32, 25
s_cbranch_scc1 S3_carry
v_fma_f32 v16, -v13, v15, v242
v_fma_f32 v17, v13, v14, v243
v_fma_f32 v14, v12, v14, v16
v_fma_f32 v15, v12, v15, v17
s_cmp_le_u32 s32, 26
s_cbranch_scc1 S3_carry
v_fma_f32 v16, -v13, v15, v244
v_fma_f32 v17, v13, v14, v245
v_fma_f32 v14, v12, v14, v16
v_fma_f32 v15, v12, v15, v17
s_cmp_le_u32 s32, 27
s_cbranch_scc1 S3_carry
v_fma_f32 v16, -v13, v15, v246
v_fma_f32 v17, v13, v14, v247
v_fma_f32 v14, v12, v14, v16
v_fma_f32 v15, v12, v15, v17
s_cmp_le_u32 s32, 28
s_cbranch_scc1 S3_carry
v_fma_f32 v16, -v13, v15, v248
v_fma_f32 v17, v13, v14, v249
v_fma_f32 v14, v12, v14, v16
v_fma_f32 v15, v12, v15, v17
s_cmp_le_u32 s32, 29
s_cbranch_scc1 S3_carry
v_fma_f32 v16, -v13, v15, v250
v_fma_f32 v17, v13, v14, v251
v_fma_f32 v14, v12, v14, v16
v_fma_f32 v15, v12, v15, v17
s_cmp_le_u32 s32, 30
s_cbranch_scc1 S3_carry
v_fma_f32 v16, -v13, v15, v252
v_fma_f32 v17, v13, v14, v253
v_fma_f32 v14, v12, v14, v16
v_fma_f32 v15, v12, v15, v17
S3_carry:
v_lshrrev_b32 v4, 1, v20
s_lshl_b32 s43, s32, 17
s_add_u32 s43, s43, 96468992
s_waitcnt vmcnt(31)
v_fma_f32 v16, -v9, v15, v64
v_fma_f32 v17, v9, v14, v65
v_fma_f32 v14, v8, v14, v16
v_fma_f32 v15, v8, v15, v17
s_lshl_b32 s42, s32, 18
s_add_u32 s42, s42, 88211456
s_add_u32 s38, s42, 0
buffer_load_dwordx2 v[128:129], v20, s[8:11], s38 offen
s_add_u32 s38, s42, 4096
buffer_load_dwordx2 v[130:131], v20, s[8:11], s38 offen
s_add_u32 s38, s42, 8192
buffer_load_dwordx2 v[132:133], v20, s[8:11], s38 offen
s_add_u32 s38, s42, 12288
buffer_load_dwordx2 v[134:135], v20, s[8:11], s38 offen
s_add_u32 s38, s42, 16384
buffer_load_dwordx2 v[136:137], v20, s[8:11], s38 offen
s_add_u32 s38, s42, 20480
buffer_load_dwordx2 v[138:139], v20, s[8:11], s38 offen
s_add_u32 s38, s42, 24576
buffer_load_dwordx2 v[140:141], v20, s[8:11], s38 offen
s_add_u32 s38, s42, 28672
buffer_load_dwordx2 v[142:143], v20, s[8:11], s38 offen
s_add_u32 s38, s42, 32768
buffer_load_dwordx2 v[144:145], v20, s[8:11], s38 offen
s_add_u32 s38, s42, 36864
buffer_load_dwordx2 v[146:147], v20, s[8:11], s38 offen
s_add_u32 s38, s42, 40960
buffer_load_dwordx2 v[148:149], v20, s[8:11], s38 offen
s_add_u32 s38, s42, 45056
buffer_load_dwordx2 v[150:151], v20, s[8:11], s38 offen
s_add_u32 s38, s42, 49152
buffer_load_dwordx2 v[152:153], v20, s[8:11], s38 offen
s_add_u32 s38, s42, 53248
buffer_load_dwordx2 v[154:155], v20, s[8:11], s38 offen
s_add_u32 s38, s42, 57344
buffer_load_dwordx2 v[156:157], v20, s[8:11], s38 offen
s_add_u32 s38, s42, 61440
buffer_load_dwordx2 v[158:159], v20, s[8:11], s38 offen
s_add_u32 s38, s42, 65536
buffer_load_dwordx2 v[160:161], v20, s[8:11], s38 offen
s_add_u32 s38, s42, 69632
buffer_load_dwordx2 v[162:163], v20, s[8:11], s38 offen
s_add_u32 s38, s42, 73728
buffer_load_dwordx2 v[164:165], v20, s[8:11], s38 offen
s_add_u32 s38, s42, 77824
buffer_load_dwordx2 v[166:167], v20, s[8:11], s38 offen
s_add_u32 s38, s42, 81920
buffer_load_dwordx2 v[168:169], v20, s[8:11], s38 offen
s_add_u32 s38, s42, 86016
buffer_load_dwordx2 v[170:171], v20, s[8:11], s38 offen
s_add_u32 s38, s42, 90112
buffer_load_dwordx2 v[172:173], v20, s[8:11], s38 offen
s_add_u32 s38, s42, 94208
buffer_load_dwordx2 v[174:175], v20, s[8:11], s38 offen
s_add_u32 s38, s42, 98304
buffer_load_dwordx2 v[176:177], v20, s[8:11], s38 offen
s_add_u32 s38, s42, 102400
buffer_load_dwordx2 v[178:179], v20, s[8:11], s38 offen
s_add_u32 s38, s42, 106496
buffer_load_dwordx2 v[180:181], v20, s[8:11], s38 offen
s_add_u32 s38, s42, 110592
buffer_load_dwordx2 v[182:183], v20, s[8:11], s38 offen
s_add_u32 s38, s42, 114688
buffer_load_dwordx2 v[184:185], v20, s[8:11], s38 offen
s_add_u32 s38, s42, 118784
buffer_load_dwordx2 v[186:187], v20, s[8:11], s38 offen
s_add_u32 s38, s42, 122880
buffer_load_dwordx2 v[188:189], v20, s[8:11], s38 offen
s_add_u32 s38, s42, 126976
buffer_load_dwordx2 v[190:191], v20, s[8:11], s38 offen
v_mul_f32 v18, v10, v14
v_mul_f32 v19, v10, v15
v_fma_f32 v18, -v11, v15, v18
v_fma_f32 v19, v11, v14, v19
v_cvt_pk_bf16_f32 v5, v18, -v19
s_add_u32 s38, s43, 0
buffer_store_dword v5, v4, s[8:11], s38 offen
s_waitcnt vmcnt(63)
v_fma_f32 v16, -v9, v15, v66
v_fma_f32 v17, v9, v14, v67
v_fma_f32 v14, v8, v14, v16
v_fma_f32 v15, v8, v15, v17
v_mul_f32 v18, v10, v14
v_mul_f32 v19, v10, v15
v_fma_f32 v18, -v11, v15, v18
v_fma_f32 v19, v11, v14, v19
v_cvt_pk_bf16_f32 v5, v18, -v19
s_add_u32 s38, s43, 2048
buffer_store_dword v5, v4, s[8:11], s38 offen
s_waitcnt vmcnt(63)
v_fma_f32 v16, -v9, v15, v68
v_fma_f32 v17, v9, v14, v69
v_fma_f32 v14, v8, v14, v16
v_fma_f32 v15, v8, v15, v17
v_mul_f32 v18, v10, v14
v_mul_f32 v19, v10, v15
v_fma_f32 v18, -v11, v15, v18
v_fma_f32 v19, v11, v14, v19
v_cvt_pk_bf16_f32 v5, v18, -v19
s_add_u32 s38, s43, 4096
buffer_store_dword v5, v4, s[8:11], s38 offen
s_waitcnt vmcnt(63)
v_fma_f32 v16, -v9, v15, v70
v_fma_f32 v17, v9, v14, v71
v_fma_f32 v14, v8, v14, v16
v_fma_f32 v15, v8, v15, v17
v_mul_f32 v18, v10, v14
v_mul_f32 v19, v10, v15
v_fma_f32 v18, -v11, v15, v18
v_fma_f32 v19, v11, v14, v19
v_cvt_pk_bf16_f32 v5, v18, -v19
s_add_u32 s38, s43, 6144
buffer_store_dword v5, v4, s[8:11], s38 offen
s_waitcnt vmcnt(63)
v_fma_f32 v16, -v9, v15, v72
v_fma_f32 v17, v9, v14, v73
v_fma_f32 v14, v8, v14, v16
v_fma_f32 v15, v8, v15, v17
v_mul_f32 v18, v10, v14
v_mul_f32 v19, v10, v15
v_fma_f32 v18, -v11, v15, v18
v_fma_f32 v19, v11, v14, v19
v_cvt_pk_bf16_f32 v5, v18, -v19
s_add_u32 s38, s43, 8192
buffer_store_dword v5, v4, s[8:11], s38 offen
s_waitcnt vmcnt(63)
v_fma_f32 v16, -v9, v15, v74
v_fma_f32 v17, v9, v14, v75
v_fma_f32 v14, v8, v14, v16
v_fma_f32 v15, v8, v15, v17
v_mul_f32 v18, v10, v14
v_mul_f32 v19, v10, v15
v_fma_f32 v18, -v11, v15, v18
v_fma_f32 v19, v11, v14, v19
v_cvt_pk_bf16_f32 v5, v18, -v19
s_add_u32 s38, s43, 10240
buffer_store_dword v5, v4, s[8:11], s38 offen
s_waitcnt vmcnt(63)
v_fma_f32 v16, -v9, v15, v76
v_fma_f32 v17, v9, v14, v77
v_fma_f32 v14, v8, v14, v16
v_fma_f32 v15, v8, v15, v17
v_mul_f32 v18, v10, v14
v_mul_f32 v19, v10, v15
v_fma_f32 v18, -v11, v15, v18
v_fma_f32 v19, v11, v14, v19
v_cvt_pk_bf16_f32 v5, v18, -v19
s_add_u32 s38, s43, 12288
buffer_store_dword v5, v4, s[8:11], s38 offen
s_waitcnt vmcnt(63)
v_fma_f32 v16, -v9, v15, v78
v_fma_f32 v17, v9, v14, v79
v_fma_f32 v14, v8, v14, v16
v_fma_f32 v15, v8, v15, v17
v_mul_f32 v18, v10, v14
v_mul_f32 v19, v10, v15
v_fma_f32 v18, -v11, v15, v18
v_fma_f32 v19, v11, v14, v19
v_cvt_pk_bf16_f32 v5, v18, -v19
s_add_u32 s38, s43, 14336
buffer_store_dword v5, v4, s[8:11], s38 offen
s_waitcnt vmcnt(63)
v_fma_f32 v16, -v9, v15, v80
v_fma_f32 v17, v9, v14, v81
v_fma_f32 v14, v8, v14, v16
v_fma_f32 v15, v8, v15, v17
v_mul_f32 v18, v10, v14
v_mul_f32 v19, v10, v15
v_fma_f32 v18, -v11, v15, v18
v_fma_f32 v19, v11, v14, v19
v_cvt_pk_bf16_f32 v5, v18, -v19
s_add_u32 s38, s43, 16384
buffer_store_dword v5, v4, s[8:11], s38 offen
s_waitcnt vmcnt(63)
v_fma_f32 v16, -v9, v15, v82
v_fma_f32 v17, v9, v14, v83
v_fma_f32 v14, v8, v14, v16
v_fma_f32 v15, v8, v15, v17
v_mul_f32 v18, v10, v14
v_mul_f32 v19, v10, v15
v_fma_f32 v18, -v11, v15, v18
v_fma_f32 v19, v11, v14, v19
v_cvt_pk_bf16_f32 v5, v18, -v19
s_add_u32 s38, s43, 18432
buffer_store_dword v5, v4, s[8:11], s38 offen
s_waitcnt vmcnt(63)
v_fma_f32 v16, -v9, v15, v84
v_fma_f32 v17, v9, v14, v85
v_fma_f32 v14, v8, v14, v16
v_fma_f32 v15, v8, v15, v17
v_mul_f32 v18, v10, v14
v_mul_f32 v19, v10, v15
v_fma_f32 v18, -v11, v15, v18
v_fma_f32 v19, v11, v14, v19
v_cvt_pk_bf16_f32 v5, v18, -v19
s_add_u32 s38, s43, 20480
buffer_store_dword v5, v4, s[8:11], s38 offen
s_waitcnt vmcnt(63)
v_fma_f32 v16, -v9, v15, v86
v_fma_f32 v17, v9, v14, v87
v_fma_f32 v14, v8, v14, v16
v_fma_f32 v15, v8, v15, v17
v_mul_f32 v18, v10, v14
v_mul_f32 v19, v10, v15
v_fma_f32 v18, -v11, v15, v18
v_fma_f32 v19, v11, v14, v19
v_cvt_pk_bf16_f32 v5, v18, -v19
s_add_u32 s38, s43, 22528
buffer_store_dword v5, v4, s[8:11], s38 offen
s_waitcnt vmcnt(63)
v_fma_f32 v16, -v9, v15, v88
v_fma_f32 v17, v9, v14, v89
v_fma_f32 v14, v8, v14, v16
v_fma_f32 v15, v8, v15, v17
v_mul_f32 v18, v10, v14
v_mul_f32 v19, v10, v15
v_fma_f32 v18, -v11, v15, v18
v_fma_f32 v19, v11, v14, v19
v_cvt_pk_bf16_f32 v5, v18, -v19
s_add_u32 s38, s43, 24576
buffer_store_dword v5, v4, s[8:11], s38 offen
s_waitcnt vmcnt(63)
v_fma_f32 v16, -v9, v15, v90
v_fma_f32 v17, v9, v14, v91
v_fma_f32 v14, v8, v14, v16
v_fma_f32 v15, v8, v15, v17
v_mul_f32 v18, v10, v14
v_mul_f32 v19, v10, v15
v_fma_f32 v18, -v11, v15, v18
v_fma_f32 v19, v11, v14, v19
v_cvt_pk_bf16_f32 v5, v18, -v19
s_add_u32 s38, s43, 26624
buffer_store_dword v5, v4, s[8:11], s38 offen
s_waitcnt vmcnt(63)
v_fma_f32 v16, -v9, v15, v92
v_fma_f32 v17, v9, v14, v93
v_fma_f32 v14, v8, v14, v16
v_fma_f32 v15, v8, v15, v17
v_mul_f32 v18, v10, v14
v_mul_f32 v19, v10, v15
v_fma_f32 v18, -v11, v15, v18
v_fma_f32 v19, v11, v14, v19
v_cvt_pk_bf16_f32 v5, v18, -v19
s_add_u32 s38, s43, 28672
buffer_store_dword v5, v4, s[8:11], s38 offen
s_waitcnt vmcnt(63)
v_fma_f32 v16, -v9, v15, v94
v_fma_f32 v17, v9, v14, v95
v_fma_f32 v14, v8, v14, v16
v_fma_f32 v15, v8, v15, v17
v_mul_f32 v18, v10, v14
v_mul_f32 v19, v10, v15
v_fma_f32 v18, -v11, v15, v18
v_fma_f32 v19, v11, v14, v19
v_cvt_pk_bf16_f32 v5, v18, -v19
s_add_u32 s38, s43, 30720
buffer_store_dword v5, v4, s[8:11], s38 offen
s_waitcnt vmcnt(63)
v_fma_f32 v16, -v9, v15, v96
v_fma_f32 v17, v9, v14, v97
v_fma_f32 v14, v8, v14, v16
v_fma_f32 v15, v8, v15, v17
v_mul_f32 v18, v10, v14
v_mul_f32 v19, v10, v15
v_fma_f32 v18, -v11, v15, v18
v_fma_f32 v19, v11, v14, v19
v_cvt_pk_bf16_f32 v5, v18, -v19
s_add_u32 s38, s43, 32768
buffer_store_dword v5, v4, s[8:11], s38 offen
s_waitcnt vmcnt(63)
v_fma_f32 v16, -v9, v15, v98
v_fma_f32 v17, v9, v14, v99
v_fma_f32 v14, v8, v14, v16
v_fma_f32 v15, v8, v15, v17
v_mul_f32 v18, v10, v14
v_mul_f32 v19, v10, v15
v_fma_f32 v18, -v11, v15, v18
v_fma_f32 v19, v11, v14, v19
v_cvt_pk_bf16_f32 v5, v18, -v19
s_add_u32 s38, s43, 34816
buffer_store_dword v5, v4, s[8:11], s38 offen
s_waitcnt vmcnt(63)
v_fma_f32 v16, -v9, v15, v100
v_fma_f32 v17, v9, v14, v101
v_fma_f32 v14, v8, v14, v16
v_fma_f32 v15, v8, v15, v17
v_mul_f32 v18, v10, v14
v_mul_f32 v19, v10, v15
v_fma_f32 v18, -v11, v15, v18
v_fma_f32 v19, v11, v14, v19
v_cvt_pk_bf16_f32 v5, v18, -v19
s_add_u32 s38, s43, 36864
buffer_store_dword v5, v4, s[8:11], s38 offen
s_waitcnt vmcnt(63)
v_fma_f32 v16, -v9, v15, v102
v_fma_f32 v17, v9, v14, v103
v_fma_f32 v14, v8, v14, v16
v_fma_f32 v15, v8, v15, v17
v_mul_f32 v18, v10, v14
v_mul_f32 v19, v10, v15
v_fma_f32 v18, -v11, v15, v18
v_fma_f32 v19, v11, v14, v19
v_cvt_pk_bf16_f32 v5, v18, -v19
s_add_u32 s38, s43, 38912
buffer_store_dword v5, v4, s[8:11], s38 offen
s_waitcnt vmcnt(63)
v_fma_f32 v16, -v9, v15, v104
v_fma_f32 v17, v9, v14, v105
v_fma_f32 v14, v8, v14, v16
v_fma_f32 v15, v8, v15, v17
v_mul_f32 v18, v10, v14
v_mul_f32 v19, v10, v15
v_fma_f32 v18, -v11, v15, v18
v_fma_f32 v19, v11, v14, v19
v_cvt_pk_bf16_f32 v5, v18, -v19
s_add_u32 s38, s43, 40960
buffer_store_dword v5, v4, s[8:11], s38 offen
s_waitcnt vmcnt(63)
v_fma_f32 v16, -v9, v15, v106
v_fma_f32 v17, v9, v14, v107
v_fma_f32 v14, v8, v14, v16
v_fma_f32 v15, v8, v15, v17
v_mul_f32 v18, v10, v14
v_mul_f32 v19, v10, v15
v_fma_f32 v18, -v11, v15, v18
v_fma_f32 v19, v11, v14, v19
v_cvt_pk_bf16_f32 v5, v18, -v19
s_add_u32 s38, s43, 43008
buffer_store_dword v5, v4, s[8:11], s38 offen
s_waitcnt vmcnt(63)
v_fma_f32 v16, -v9, v15, v108
v_fma_f32 v17, v9, v14, v109
v_fma_f32 v14, v8, v14, v16
v_fma_f32 v15, v8, v15, v17
v_mul_f32 v18, v10, v14
v_mul_f32 v19, v10, v15
v_fma_f32 v18, -v11, v15, v18
v_fma_f32 v19, v11, v14, v19
v_cvt_pk_bf16_f32 v5, v18, -v19
s_add_u32 s38, s43, 45056
buffer_store_dword v5, v4, s[8:11], s38 offen
s_waitcnt vmcnt(63)
v_fma_f32 v16, -v9, v15, v110
v_fma_f32 v17, v9, v14, v111
v_fma_f32 v14, v8, v14, v16
v_fma_f32 v15, v8, v15, v17
v_mul_f32 v18, v10, v14
v_mul_f32 v19, v10, v15
v_fma_f32 v18, -v11, v15, v18
v_fma_f32 v19, v11, v14, v19
v_cvt_pk_bf16_f32 v5, v18, -v19
s_add_u32 s38, s43, 47104
buffer_store_dword v5, v4, s[8:11], s38 offen
s_waitcnt vmcnt(63)
v_fma_f32 v16, -v9, v15, v112
v_fma_f32 v17, v9, v14, v113
v_fma_f32 v14, v8, v14, v16
v_fma_f32 v15, v8, v15, v17
v_mul_f32 v18, v10, v14
v_mul_f32 v19, v10, v15
v_fma_f32 v18, -v11, v15, v18
v_fma_f32 v19, v11, v14, v19
v_cvt_pk_bf16_f32 v5, v18, -v19
s_add_u32 s38, s43, 49152
buffer_store_dword v5, v4, s[8:11], s38 offen
s_waitcnt vmcnt(63)
v_fma_f32 v16, -v9, v15, v114
v_fma_f32 v17, v9, v14, v115
v_fma_f32 v14, v8, v14, v16
v_fma_f32 v15, v8, v15, v17
v_mul_f32 v18, v10, v14
v_mul_f32 v19, v10, v15
v_fma_f32 v18, -v11, v15, v18
v_fma_f32 v19, v11, v14, v19
v_cvt_pk_bf16_f32 v5, v18, -v19
s_add_u32 s38, s43, 51200
buffer_store_dword v5, v4, s[8:11], s38 offen
s_waitcnt vmcnt(63)
v_fma_f32 v16, -v9, v15, v116
v_fma_f32 v17, v9, v14, v117
v_fma_f32 v14, v8, v14, v16
v_fma_f32 v15, v8, v15, v17
v_mul_f32 v18, v10, v14
v_mul_f32 v19, v10, v15
v_fma_f32 v18, -v11, v15, v18
v_fma_f32 v19, v11, v14, v19
v_cvt_pk_bf16_f32 v5, v18, -v19
s_add_u32 s38, s43, 53248
buffer_store_dword v5, v4, s[8:11], s38 offen
s_waitcnt vmcnt(63)
v_fma_f32 v16, -v9, v15, v118
v_fma_f32 v17, v9, v14, v119
v_fma_f32 v14, v8, v14, v16
v_fma_f32 v15, v8, v15, v17
v_mul_f32 v18, v10, v14
v_mul_f32 v19, v10, v15
v_fma_f32 v18, -v11, v15, v18
v_fma_f32 v19, v11, v14, v19
v_cvt_pk_bf16_f32 v5, v18, -v19
s_add_u32 s38, s43, 55296
buffer_store_dword v5, v4, s[8:11], s38 offen
s_waitcnt vmcnt(63)
v_fma_f32 v16, -v9, v15, v120
v_fma_f32 v17, v9, v14, v121
v_fma_f32 v14, v8, v14, v16
v_fma_f32 v15, v8, v15, v17
v_mul_f32 v18, v10, v14
v_mul_f32 v19, v10, v15
v_fma_f32 v18, -v11, v15, v18
v_fma_f32 v19, v11, v14, v19
v_cvt_pk_bf16_f32 v5, v18, -v19
s_add_u32 s38, s43, 57344
buffer_store_dword v5, v4, s[8:11], s38 offen
s_waitcnt vmcnt(63)
v_fma_f32 v16, -v9, v15, v122
v_fma_f32 v17, v9, v14, v123
v_fma_f32 v14, v8, v14, v16
v_fma_f32 v15, v8, v15, v17
v_mul_f32 v18, v10, v14
v_mul_f32 v19, v10, v15
v_fma_f32 v18, -v11, v15, v18
v_fma_f32 v19, v11, v14, v19
v_cvt_pk_bf16_f32 v5, v18, -v19
s_add_u32 s38, s43, 59392
buffer_store_dword v5, v4, s[8:11], s38 offen
s_waitcnt vmcnt(63)
v_fma_f32 v16, -v9, v15, v124
v_fma_f32 v17, v9, v14, v125
v_fma_f32 v14, v8, v14, v16
v_fma_f32 v15, v8, v15, v17
v_mul_f32 v18, v10, v14
v_mul_f32 v19, v10, v15
v_fma_f32 v18, -v11, v15, v18
v_fma_f32 v19, v11, v14, v19
v_cvt_pk_bf16_f32 v5, v18, -v19
s_add_u32 s38, s43, 61440
buffer_store_dword v5, v4, s[8:11], s38 offen
s_waitcnt vmcnt(63)
v_fma_f32 v16, -v9, v15, v126
v_fma_f32 v17, v9, v14, v127
v_fma_f32 v14, v8, v14, v16
v_fma_f32 v15, v8, v15, v17
v_mul_f32 v18, v10, v14
v_mul_f32 v19, v10, v15
v_fma_f32 v18, -v11, v15, v18
v_fma_f32 v19, v11, v14, v19
v_cvt_pk_bf16_f32 v5, v18, -v19
s_add_u32 s38, s43, 63488
buffer_store_dword v5, v4, s[8:11], s38 offen
s_waitcnt vmcnt(63)
v_fma_f32 v16, -v9, v15, v128
v_fma_f32 v17, v9, v14, v129
v_fma_f32 v14, v8, v14, v16
v_fma_f32 v15, v8, v15, v17
v_mul_f32 v18, v10, v14
v_mul_f32 v19, v10, v15
v_fma_f32 v18, -v11, v15, v18
v_fma_f32 v19, v11, v14, v19
v_cvt_pk_bf16_f32 v5, v18, -v19
s_add_u32 s38, s43, 65536
buffer_store_dword v5, v4, s[8:11], s38 offen
s_waitcnt vmcnt(63)
v_fma_f32 v16, -v9, v15, v130
v_fma_f32 v17, v9, v14, v131
v_fma_f32 v14, v8, v14, v16
v_fma_f32 v15, v8, v15, v17
v_mul_f32 v18, v10, v14
v_mul_f32 v19, v10, v15
v_fma_f32 v18, -v11, v15, v18
v_fma_f32 v19, v11, v14, v19
v_cvt_pk_bf16_f32 v5, v18, -v19
s_add_u32 s38, s43, 67584
buffer_store_dword v5, v4, s[8:11], s38 offen
s_waitcnt vmcnt(63)
v_fma_f32 v16, -v9, v15, v132
v_fma_f32 v17, v9, v14, v133
v_fma_f32 v14, v8, v14, v16
v_fma_f32 v15, v8, v15, v17
v_mul_f32 v18, v10, v14
v_mul_f32 v19, v10, v15
v_fma_f32 v18, -v11, v15, v18
v_fma_f32 v19, v11, v14, v19
v_cvt_pk_bf16_f32 v5, v18, -v19
s_add_u32 s38, s43, 69632
buffer_store_dword v5, v4, s[8:11], s38 offen
s_waitcnt vmcnt(63)
v_fma_f32 v16, -v9, v15, v134
v_fma_f32 v17, v9, v14, v135
v_fma_f32 v14, v8, v14, v16
v_fma_f32 v15, v8, v15, v17
v_mul_f32 v18, v10, v14
v_mul_f32 v19, v10, v15
v_fma_f32 v18, -v11, v15, v18
v_fma_f32 v19, v11, v14, v19
v_cvt_pk_bf16_f32 v5, v18, -v19
s_add_u32 s38, s43, 71680
buffer_store_dword v5, v4, s[8:11], s38 offen
s_waitcnt vmcnt(63)
v_fma_f32 v16, -v9, v15, v136
v_fma_f32 v17, v9, v14, v137
v_fma_f32 v14, v8, v14, v16
v_fma_f32 v15, v8, v15, v17
v_mul_f32 v18, v10, v14
v_mul_f32 v19, v10, v15
v_fma_f32 v18, -v11, v15, v18
v_fma_f32 v19, v11, v14, v19
v_cvt_pk_bf16_f32 v5, v18, -v19
s_add_u32 s38, s43, 73728
buffer_store_dword v5, v4, s[8:11], s38 offen
s_waitcnt vmcnt(63)
v_fma_f32 v16, -v9, v15, v138
v_fma_f32 v17, v9, v14, v139
v_fma_f32 v14, v8, v14, v16
v_fma_f32 v15, v8, v15, v17
v_mul_f32 v18, v10, v14
v_mul_f32 v19, v10, v15
v_fma_f32 v18, -v11, v15, v18
v_fma_f32 v19, v11, v14, v19
v_cvt_pk_bf16_f32 v5, v18, -v19
s_add_u32 s38, s43, 75776
buffer_store_dword v5, v4, s[8:11], s38 offen
s_waitcnt vmcnt(63)
v_fma_f32 v16, -v9, v15, v140
v_fma_f32 v17, v9, v14, v141
v_fma_f32 v14, v8, v14, v16
v_fma_f32 v15, v8, v15, v17
v_mul_f32 v18, v10, v14
v_mul_f32 v19, v10, v15
v_fma_f32 v18, -v11, v15, v18
v_fma_f32 v19, v11, v14, v19
v_cvt_pk_bf16_f32 v5, v18, -v19
s_add_u32 s38, s43, 77824
buffer_store_dword v5, v4, s[8:11], s38 offen
s_waitcnt vmcnt(63)
v_fma_f32 v16, -v9, v15, v142
v_fma_f32 v17, v9, v14, v143
v_fma_f32 v14, v8, v14, v16
v_fma_f32 v15, v8, v15, v17
v_mul_f32 v18, v10, v14
v_mul_f32 v19, v10, v15
v_fma_f32 v18, -v11, v15, v18
v_fma_f32 v19, v11, v14, v19
v_cvt_pk_bf16_f32 v5, v18, -v19
s_add_u32 s38, s43, 79872
buffer_store_dword v5, v4, s[8:11], s38 offen
s_waitcnt vmcnt(63)
v_fma_f32 v16, -v9, v15, v144
v_fma_f32 v17, v9, v14, v145
v_fma_f32 v14, v8, v14, v16
v_fma_f32 v15, v8, v15, v17
v_mul_f32 v18, v10, v14
v_mul_f32 v19, v10, v15
v_fma_f32 v18, -v11, v15, v18
v_fma_f32 v19, v11, v14, v19
v_cvt_pk_bf16_f32 v5, v18, -v19
s_add_u32 s38, s43, 81920
buffer_store_dword v5, v4, s[8:11], s38 offen
s_waitcnt vmcnt(63)
v_fma_f32 v16, -v9, v15, v146
v_fma_f32 v17, v9, v14, v147
v_fma_f32 v14, v8, v14, v16
v_fma_f32 v15, v8, v15, v17
v_mul_f32 v18, v10, v14
v_mul_f32 v19, v10, v15
v_fma_f32 v18, -v11, v15, v18
v_fma_f32 v19, v11, v14, v19
v_cvt_pk_bf16_f32 v5, v18, -v19
s_add_u32 s38, s43, 83968
buffer_store_dword v5, v4, s[8:11], s38 offen
s_waitcnt vmcnt(63)
v_fma_f32 v16, -v9, v15, v148
v_fma_f32 v17, v9, v14, v149
v_fma_f32 v14, v8, v14, v16
v_fma_f32 v15, v8, v15, v17
v_mul_f32 v18, v10, v14
v_mul_f32 v19, v10, v15
v_fma_f32 v18, -v11, v15, v18
v_fma_f32 v19, v11, v14, v19
v_cvt_pk_bf16_f32 v5, v18, -v19
s_add_u32 s38, s43, 86016
buffer_store_dword v5, v4, s[8:11], s38 offen
s_waitcnt vmcnt(63)
v_fma_f32 v16, -v9, v15, v150
v_fma_f32 v17, v9, v14, v151
v_fma_f32 v14, v8, v14, v16
v_fma_f32 v15, v8, v15, v17
v_mul_f32 v18, v10, v14
v_mul_f32 v19, v10, v15
v_fma_f32 v18, -v11, v15, v18
v_fma_f32 v19, v11, v14, v19
v_cvt_pk_bf16_f32 v5, v18, -v19
s_add_u32 s38, s43, 88064
buffer_store_dword v5, v4, s[8:11], s38 offen
s_waitcnt vmcnt(63)
v_fma_f32 v16, -v9, v15, v152
v_fma_f32 v17, v9, v14, v153
v_fma_f32 v14, v8, v14, v16
v_fma_f32 v15, v8, v15, v17
v_mul_f32 v18, v10, v14
v_mul_f32 v19, v10, v15
v_fma_f32 v18, -v11, v15, v18
v_fma_f32 v19, v11, v14, v19
v_cvt_pk_bf16_f32 v5, v18, -v19
s_add_u32 s38, s43, 90112
buffer_store_dword v5, v4, s[8:11], s38 offen
s_waitcnt vmcnt(63)
v_fma_f32 v16, -v9, v15, v154
v_fma_f32 v17, v9, v14, v155
v_fma_f32 v14, v8, v14, v16
v_fma_f32 v15, v8, v15, v17
v_mul_f32 v18, v10, v14
v_mul_f32 v19, v10, v15
v_fma_f32 v18, -v11, v15, v18
v_fma_f32 v19, v11, v14, v19
v_cvt_pk_bf16_f32 v5, v18, -v19
s_add_u32 s38, s43, 92160
buffer_store_dword v5, v4, s[8:11], s38 offen
s_waitcnt vmcnt(63)
v_fma_f32 v16, -v9, v15, v156
v_fma_f32 v17, v9, v14, v157
v_fma_f32 v14, v8, v14, v16
v_fma_f32 v15, v8, v15, v17
v_mul_f32 v18, v10, v14
v_mul_f32 v19, v10, v15
v_fma_f32 v18, -v11, v15, v18
v_fma_f32 v19, v11, v14, v19
v_cvt_pk_bf16_f32 v5, v18, -v19
s_add_u32 s38, s43, 94208
buffer_store_dword v5, v4, s[8:11], s38 offen
s_waitcnt vmcnt(63)
v_fma_f32 v16, -v9, v15, v158
v_fma_f32 v17, v9, v14, v159
v_fma_f32 v14, v8, v14, v16
v_fma_f32 v15, v8, v15, v17
v_mul_f32 v18, v10, v14
v_mul_f32 v19, v10, v15
v_fma_f32 v18, -v11, v15, v18
v_fma_f32 v19, v11, v14, v19
v_cvt_pk_bf16_f32 v5, v18, -v19
s_add_u32 s38, s43, 96256
buffer_store_dword v5, v4, s[8:11], s38 offen
s_waitcnt vmcnt(63)
v_fma_f32 v16, -v9, v15, v160
v_fma_f32 v17, v9, v14, v161
v_fma_f32 v14, v8, v14, v16
v_fma_f32 v15, v8, v15, v17
v_mul_f32 v18, v10, v14
v_mul_f32 v19, v10, v15
v_fma_f32 v18, -v11, v15, v18
v_fma_f32 v19, v11, v14, v19
v_cvt_pk_bf16_f32 v5, v18, -v19
s_add_u32 s38, s43, 98304
buffer_store_dword v5, v4, s[8:11], s38 offen
s_waitcnt vmcnt(63)
v_fma_f32 v16, -v9, v15, v162
v_fma_f32 v17, v9, v14, v163
v_fma_f32 v14, v8, v14, v16
v_fma_f32 v15, v8, v15, v17
v_mul_f32 v18, v10, v14
v_mul_f32 v19, v10, v15
v_fma_f32 v18, -v11, v15, v18
v_fma_f32 v19, v11, v14, v19
v_cvt_pk_bf16_f32 v5, v18, -v19
s_add_u32 s38, s43, 100352
buffer_store_dword v5, v4, s[8:11], s38 offen
s_waitcnt vmcnt(63)
v_fma_f32 v16, -v9, v15, v164
v_fma_f32 v17, v9, v14, v165
v_fma_f32 v14, v8, v14, v16
v_fma_f32 v15, v8, v15, v17
v_mul_f32 v18, v10, v14
v_mul_f32 v19, v10, v15
v_fma_f32 v18, -v11, v15, v18
v_fma_f32 v19, v11, v14, v19
v_cvt_pk_bf16_f32 v5, v18, -v19
s_add_u32 s38, s43, 102400
buffer_store_dword v5, v4, s[8:11], s38 offen
s_waitcnt vmcnt(63)
v_fma_f32 v16, -v9, v15, v166
v_fma_f32 v17, v9, v14, v167
v_fma_f32 v14, v8, v14, v16
v_fma_f32 v15, v8, v15, v17
v_mul_f32 v18, v10, v14
v_mul_f32 v19, v10, v15
v_fma_f32 v18, -v11, v15, v18
v_fma_f32 v19, v11, v14, v19
v_cvt_pk_bf16_f32 v5, v18, -v19
s_add_u32 s38, s43, 104448
buffer_store_dword v5, v4, s[8:11], s38 offen
s_waitcnt vmcnt(63)
v_fma_f32 v16, -v9, v15, v168
v_fma_f32 v17, v9, v14, v169
v_fma_f32 v14, v8, v14, v16
v_fma_f32 v15, v8, v15, v17
v_mul_f32 v18, v10, v14
v_mul_f32 v19, v10, v15
v_fma_f32 v18, -v11, v15, v18
v_fma_f32 v19, v11, v14, v19
v_cvt_pk_bf16_f32 v5, v18, -v19
s_add_u32 s38, s43, 106496
buffer_store_dword v5, v4, s[8:11], s38 offen
s_waitcnt vmcnt(63)
v_fma_f32 v16, -v9, v15, v170
v_fma_f32 v17, v9, v14, v171
v_fma_f32 v14, v8, v14, v16
v_fma_f32 v15, v8, v15, v17
v_mul_f32 v18, v10, v14
v_mul_f32 v19, v10, v15
v_fma_f32 v18, -v11, v15, v18
v_fma_f32 v19, v11, v14, v19
v_cvt_pk_bf16_f32 v5, v18, -v19
s_add_u32 s38, s43, 108544
buffer_store_dword v5, v4, s[8:11], s38 offen
s_waitcnt vmcnt(63)
v_fma_f32 v16, -v9, v15, v172
v_fma_f32 v17, v9, v14, v173
v_fma_f32 v14, v8, v14, v16
v_fma_f32 v15, v8, v15, v17
v_mul_f32 v18, v10, v14
v_mul_f32 v19, v10, v15
v_fma_f32 v18, -v11, v15, v18
v_fma_f32 v19, v11, v14, v19
v_cvt_pk_bf16_f32 v5, v18, -v19
s_add_u32 s38, s43, 110592
buffer_store_dword v5, v4, s[8:11], s38 offen
s_waitcnt vmcnt(63)
v_fma_f32 v16, -v9, v15, v174
v_fma_f32 v17, v9, v14, v175
v_fma_f32 v14, v8, v14, v16
v_fma_f32 v15, v8, v15, v17
v_mul_f32 v18, v10, v14
v_mul_f32 v19, v10, v15
v_fma_f32 v18, -v11, v15, v18
v_fma_f32 v19, v11, v14, v19
v_cvt_pk_bf16_f32 v5, v18, -v19
s_add_u32 s38, s43, 112640
buffer_store_dword v5, v4, s[8:11], s38 offen
s_waitcnt vmcnt(63)
v_fma_f32 v16, -v9, v15, v176
v_fma_f32 v17, v9, v14, v177
v_fma_f32 v14, v8, v14, v16
v_fma_f32 v15, v8, v15, v17
v_mul_f32 v18, v10, v14
v_mul_f32 v19, v10, v15
v_fma_f32 v18, -v11, v15, v18
v_fma_f32 v19, v11, v14, v19
v_cvt_pk_bf16_f32 v5, v18, -v19
s_add_u32 s38, s43, 114688
buffer_store_dword v5, v4, s[8:11], s38 offen
s_waitcnt vmcnt(63)
v_fma_f32 v16, -v9, v15, v178
v_fma_f32 v17, v9, v14, v179
v_fma_f32 v14, v8, v14, v16
v_fma_f32 v15, v8, v15, v17
v_mul_f32 v18, v10, v14
v_mul_f32 v19, v10, v15
v_fma_f32 v18, -v11, v15, v18
v_fma_f32 v19, v11, v14, v19
v_cvt_pk_bf16_f32 v5, v18, -v19
s_add_u32 s38, s43, 116736
buffer_store_dword v5, v4, s[8:11], s38 offen
s_waitcnt vmcnt(63)
v_fma_f32 v16, -v9, v15, v180
v_fma_f32 v17, v9, v14, v181
v_fma_f32 v14, v8, v14, v16
v_fma_f32 v15, v8, v15, v17
v_mul_f32 v18, v10, v14
v_mul_f32 v19, v10, v15
v_fma_f32 v18, -v11, v15, v18
v_fma_f32 v19, v11, v14, v19
v_cvt_pk_bf16_f32 v5, v18, -v19
s_add_u32 s38, s43, 118784
buffer_store_dword v5, v4, s[8:11], s38 offen
s_waitcnt vmcnt(63)
v_fma_f32 v16, -v9, v15, v182
v_fma_f32 v17, v9, v14, v183
v_fma_f32 v14, v8, v14, v16
v_fma_f32 v15, v8, v15, v17
v_mul_f32 v18, v10, v14
v_mul_f32 v19, v10, v15
v_fma_f32 v18, -v11, v15, v18
v_fma_f32 v19, v11, v14, v19
v_cvt_pk_bf16_f32 v5, v18, -v19
s_add_u32 s38, s43, 120832
buffer_store_dword v5, v4, s[8:11], s38 offen
s_waitcnt vmcnt(63)
v_fma_f32 v16, -v9, v15, v184
v_fma_f32 v17, v9, v14, v185
v_fma_f32 v14, v8, v14, v16
v_fma_f32 v15, v8, v15, v17
v_mul_f32 v18, v10, v14
v_mul_f32 v19, v10, v15
v_fma_f32 v18, -v11, v15, v18
v_fma_f32 v19, v11, v14, v19
v_cvt_pk_bf16_f32 v5, v18, -v19
s_add_u32 s38, s43, 122880
buffer_store_dword v5, v4, s[8:11], s38 offen
s_waitcnt vmcnt(63)
v_fma_f32 v16, -v9, v15, v186
v_fma_f32 v17, v9, v14, v187
v_fma_f32 v14, v8, v14, v16
v_fma_f32 v15, v8, v15, v17
v_mul_f32 v18, v10, v14
v_mul_f32 v19, v10, v15
v_fma_f32 v18, -v11, v15, v18
v_fma_f32 v19, v11, v14, v19
v_cvt_pk_bf16_f32 v5, v18, -v19
s_add_u32 s38, s43, 124928
buffer_store_dword v5, v4, s[8:11], s38 offen
s_waitcnt vmcnt(63)
v_fma_f32 v16, -v9, v15, v188
v_fma_f32 v17, v9, v14, v189
v_fma_f32 v14, v8, v14, v16
v_fma_f32 v15, v8, v15, v17
v_mul_f32 v18, v10, v14
v_mul_f32 v19, v10, v15
v_fma_f32 v18, -v11, v15, v18
v_fma_f32 v19, v11, v14, v19
v_cvt_pk_bf16_f32 v5, v18, -v19
s_add_u32 s38, s43, 126976
buffer_store_dword v5, v4, s[8:11], s38 offen
s_waitcnt vmcnt(63)
v_fma_f32 v16, -v9, v15, v190
v_fma_f32 v17, v9, v14, v191
v_fma_f32 v14, v8, v14, v16
v_fma_f32 v15, v8, v15, v17
v_mul_f32 v18, v10, v14
v_mul_f32 v19, v10, v15
v_fma_f32 v18, -v11, v15, v18
v_fma_f32 v19, v11, v14, v19
v_cvt_pk_bf16_f32 v5, v18, -v19
s_add_u32 s38, s43, 129024
buffer_store_dword v5, v4, s[8:11], s38 offen
s_waitcnt vmcnt(0)
s_lshl_b32 s67, s64, 2
s_add_u32 s67, s67, 82864128
s_waitcnt vmcnt(0) lgkmcnt(0)
s_barrier
s_cmp_lg_u32 s17, 0
s_cbranch_scc1 SF4
s_mov_b64 exec, 1
v_mov_b32 v4, s69
v_mov_b32 v5, 0
buffer_store_dword v4, v5, s[8:11], s67 offen sc1
s_mov_b64 exec, -1
SF4:
s_and_b32 s38, s64, 31
s_cmp_ge_u32 s38, 16
s_cbranch_scc1 S5_end
s_lshr_b32 s32, s64, 5
s_lshl_b32 s32, s32, 3
s_lshr_b32 s39, s38, 1
s_add_u32 s32, s32, s39
s_and_b32 s47, s38, 1
s_lshl_b32 s67, s32, 4
s_add_u32 s67, s67, 82864128
v_lshrrev_b32 v4, 2, v1
v_min_u32 v4, 12, v4
WF8:
buffer_load_dword v5, v4, s[8:11], s67 offen sc1
s_waitcnt vmcnt(0)
v_cmp_ne_u32 vcc, s69, v5
s_nop 0
s_cbranch_vccz WF8_ok
s_cmp_eq_u32 s65, 0
s_cbranch_scc1 WF8_ok
s_sub_u32 s65, s65, 1
s_sleep 32
s_branch WF8
WF8_ok:
s_mov_b32 s67, 82865280
v_lshrrev_b32 v4, 2, v1
v_min_u32 v4, 124, v4
WF9:
buffer_load_dword v5, v4, s[8:11], s67 offen sc1
s_waitcnt vmcnt(0)
v_cmp_ne_u32 vcc, s69, v5
s_nop 0
s_cbranch_vccz WF9_ok
s_cmp_eq_u32 s65, 0
s_cbranch_scc1 WF9_ok
s_sub_u32 s65, s65, 1
s_sleep 32
s_branch WF9
WF9_ok:
s_add_u32 s12, s8, 96468992
s_addc_u32 s13, s9, 0
s_mov_b32 s14, 4194304
s_mov_b32 s15, 0x20000
s_lshl_b32 s43, s47, 8
s_lshl_b32 s38, s17, 6
s_add_u32 s43, s43, s38
s_lshl_b32 s34, s43, 11
s_add_u32 s34, s34, 102760448
s_lshl_b32 s42, s32, 7
s_lshl_b32 s38, s17, 5
s_add_u32 s39, s38, s42
s_mul_i32 s39, s39, 2048
s_add_u32 s39, s39, 0
s_mul_i32 s38, s38, 1040
s_add_u32 m0, s38, 0
s_add_u32 s40, s39, 0
buffer_load_dwordx4 v1, s[12:15], s40 offen lds
s_add_u32 m0, s38, 1040
s_add_u32 s40, s39, 2048
buffer_load_dwordx4 v1, s[12:15], s40 offen lds
s_add_u32 m0, s38, 2080
s_add_u32 s40, s39, 4096
buffer_load_dwordx4 v1, s[12:15], s40 offen lds
s_add_u32 m0, s38, 3120
s_add_u32 s40, s39, 6144
buffer_load_dwordx4 v1, s[12:15], s40 offen lds
s_add_u32 m0, s38, 4160
s_add_u32 s40, s39, 8192
buffer_load_dwordx4 v1, s[12:15], s40 offen lds
s_add_u32 m0, s38, 5200
s_add_u32 s40, s39, 10240
buffer_load_dwordx4 v1, s[12:15], s40 offen lds
s_add_u32 m0, s38, 6240
s_add_u32 s40, s39, 12288
buffer_load_dwordx4 v1, s[12:15], s40 offen lds
s_add_u32 m0, s38, 7280
s_add_u32 s40, s39, 14336
buffer_load_dwordx4 v1, s[12:15], s40 offen lds
s_add_u32 m0, s38, 8320
s_add_u32 s40, s39, 16384
buffer_load_dwordx4 v1, s[12:15], s40 offen lds
s_add_u32 m0, s38, 9360
s_add_u32 s40, s39, 18432
buffer_load_dwordx4 v1, s[12:15], s40 offen lds
s_add_u32 m0, s38, 10400
s_add_u32 s40, s39, 20480
buffer_load_dwordx4 v1, s[12:15], s40 offen lds
s_add_u32 m0, s38, 11440
s_add_u32 s40, s39, 22528
buffer_load_dwordx4 v1, s[12:15], s40 offen lds
s_add_u32 m0, s38, 12480
s_add_u32 s40, s39, 24576
buffer_load_dwordx4 v1, s[12:15], s40 offen lds
s_add_u32 m0, s38, 13520
s_add_u32 s40, s39, 26624
buffer_load_dwordx4 v1, s[12:15], s40 offen lds
s_add_u32 m0, s38, 14560
s_add_u32 s40, s39, 28672
buffer_load_dwordx4 v1, s[12:15], s40 offen lds
s_add_u32 m0, s38, 15600
s_add_u32 s40, s39, 30720
buffer_load_dwordx4 v1, s[12:15], s40 offen lds
s_add_u32 m0, s38, 16640
s_add_u32 s40, s39, 32768
buffer_load_dwordx4 v1, s[12:15], s40 offen lds
s_add_u32 m0, s38, 17680
s_add_u32 s40, s39, 34816
buffer_load_dwordx4 v1, s[12:15], s40 offen lds
s_add_u32 m0, s38, 18720
s_add_u32 s40, s39, 36864
buffer_load_dwordx4 v1, s[12:15], s40 offen lds
s_add_u32 m0, s38, 19760
s_add_u32 s40, s39, 38912
buffer_load_dwordx4 v1, s[12:15], s40 offen lds
s_add_u32 m0, s38, 20800
s_add_u32 s40, s39, 40960
buffer_load_dwordx4 v1, s[12:15], s40 offen lds
s_add_u32 m0, s38, 21840
s_add_u32 s40, s39, 43008
buffer_load_dwordx4 v1, s[12:15], s40 offen lds
s_add_u32 m0, s38, 22880
s_add_u32 s40, s39, 45056
buffer_load_dwordx4 v1, s[12:15], s40 offen lds
s_add_u32 m0, s38, 23920
s_add_u32 s40, s39, 47104
buffer_load_dwordx4 v1, s[12:15], s40 offen lds
s_add_u32 m0, s38, 24960
s_add_u32 s40, s39, 49152
buffer_load_dwordx4 v1, s[12:15], s40 offen lds
s_add_u32 m0, s38, 26000
s_add_u32 s40, s39, 51200
buffer_load_dwordx4 v1, s[12:15], s40 offen lds
s_add_u32 m0, s38, 27040
s_add_u32 s40, s39, 53248
buffer_load_dwordx4 v1, s[12:15], s40 offen lds
s_add_u32 m0, s38, 28080
s_add_u32 s40, s39, 55296
buffer_load_dwordx4 v1, s[12:15], s40 offen lds
s_add_u32 m0, s38, 29120
s_add_u32 s40, s39, 57344
buffer_load_dwordx4 v1, s[12:15], s40 offen lds
s_add_u32 m0, s38, 30160
s_add_u32 s40, s39, 59392
buffer_load_dwordx4 v1, s[12:15], s40 offen lds
s_add_u32 m0, s38, 31200
s_add_u32 s40, s39, 61440
buffer_load_dwordx4 v1, s[12:15], s40 offen lds
s_add_u32 m0, s38, 32240
s_add_u32 s40, s39, 63488
buffer_load_dwordx4 v1, s[12:15], s40 offen lds
v_lshrrev_b32 v4, 4, v1
v_and_b32 v5, 15, v4
v_mul_u32_u24 v8, 1040, v5
v_lshrrev_b32 v4, 4, v4
v_lshl_add_u32 v8, v4, 4, v8
v_add_u32 v9, 66560, v8
s_add_u32 s38, s34, 0
buffer_load_dwordx4 v[16:19], v1, s[8:11], s38 offen
s_add_u32 s38, s34, 32768
buffer_load_dwordx4 v[20:23], v1, s[8:11], s38 offen
s_add_u32 s38, s34, 65536
buffer_load_dwordx4 v[24:27], v1, s[8:11], s38 offen
s_add_u32 s38, s34, 98304
buffer_load_dwordx4 v[28:31], v1, s[8:11], s38 offen
s_add_u32 s38, s34, 1024
buffer_load_dwordx4 v[32:35], v1, s[8:11], s38 offen
s_add_u32 s38, s34, 33792
buffer_load_dwordx4 v[36:39], v1, s[8:11], s38 offen
s_add_u32 s38, s34, 66560
buffer_load_dwordx4 v[40:43], v1, s[8:11], s38 offen
s_add_u32 s38, s34, 99328
buffer_load_dwordx4 v[44:47], v1, s[8:11], s38 offen
s_add_u32 s38, s34, 2048
buffer_load_dwordx4 v[48:51], v1, s[8:11], s38 offen
s_add_u32 s38, s34, 34816
buffer_load_dwordx4 v[52:55], v1, s[8:11], s38 offen
s_add_u32 s38, s34, 67584
buffer_load_dwordx4 v[56:59], v1, s[8:11], s38 offen
s_add_u32 s38, s34, 100352
buffer_load_dwordx4 v[60:63], v1, s[8:11], s38 offen
s_add_u32 s38, s34, 3072
buffer_load_dwordx4 v[64:67], v1, s[8:11], s38 offen
s_add_u32 s38, s34, 35840
buffer_load_dwordx4 v[68:71], v1, s[8:11], s38 offen
s_add_u32 s38, s34, 68608
buffer_load_dwordx4 v[72:75], v1, s[8:11], s38 offen
s_add_u32 s38, s34, 101376
buffer_load_dwordx4 v[76:79], v1, s[8:11], s38 offen
s_waitcnt vmcnt(0)
s_barrier
ds_read_b128 a[0:3], v8 offset:0
ds_read_b128 a[4:7], v8 offset:16640
ds_read_b128 a[8:11], v8 offset:33280
ds_read_b128 a[12:15], v8 offset:49920
ds_read_b128 a[16:19], v9 offset:0
ds_read_b128 a[20:23], v9 offset:16640
ds_read_b128 a[24:27], v9 offset:33280
ds_read_b128 a[28:31], v9 offset:49920
s_waitcnt lgkmcnt(7)
v_mfma_f32_16x16x32_bf16 v[128:131], v[16:19], a[0:3], 0
v_mfma_f32_16x16x32_bf16 v[132:135], v[20:23], a[0:3], 0
ds_read_b128 a[32:35], v8 offset:64
v_mfma_f32_16x16x32_bf16 v[136:139], v[24:27], a[0:3], 0
v_mfma_f32_16x16x32_bf16 v[140:143], v[28:31], a[0:3], 0
s_add_u32 s38, s34, 4096
buffer_load_dwordx4 v[80:83], v1, s[8:11], s38 offen
s_waitcnt lgkmcnt(7)
v_mfma_f32_16x16x32_bf16 v[144:147], v[16:19], a[4:7], 0
v_mfma_f32_16x16x32_bf16 v[148:151], v[20:23], a[4:7], 0
ds_read_b128 a[36:39], v8 offset:16704
v_mfma_f32_16x16x32_bf16 v[152:155], v[24:27], a[4:7], 0
v_mfma_f32_16x16x32_bf16 v[156:159], v[28:31], a[4:7], 0
s_add_u32 s38, s34, 36864
buffer_load_dwordx4 v[84:87], v1, s[8:11], s38 offen
s_waitcnt lgkmcnt(7)
v_mfma_f32_16x16x32_bf16 v[160:163], v[16:19], a[8:11], 0
v_mfma_f32_16x16x32_bf16 v[164:167], v[20:23], a[8:11], 0
ds_read_b128 a[40:43], v8 offset:33344
v_mfma_f32_16x16x32_bf16 v[168:171], v[24:27], a[8:11], 0
v_mfma_f32_16x16x32_bf16 v[172:175], v[28:31], a[8:11], 0
s_add_u32 s38, s34, 69632
buffer_load_dwordx4 v[88:91], v1, s[8:11], s38 offen
s_waitcnt lgkmcnt(7)
v_mfma_f32_16x16x32_bf16 v[176:179], v[16:19], a[12:15], 0
v_mfma_f32_16x16x32_bf16 v[180:183], v[20:23], a[12:15], 0
ds_read_b128 a[44:47], v8 offset:49984
v_mfma_f32_16x16x32_bf16 v[184:187], v[24:27], a[12:15], 0
v_mfma_f32_16x16x32_bf16 v[188:191], v[28:31], a[12:15], 0
s_add_u32 s38, s34, 102400
buffer_load_dwordx4 v[92:95], v1, s[8:11], s38 offen
s_waitcnt lgkmcnt(7)
v_mfma_f32_16x16x32_bf16 v[192:195], v[16:19], a[16:19], 0
v_mfma_f32_16x16x32_bf16 v[196:199], v[20:23], a[16:19], 0
ds_read_b128 a[48:51], v9 offset:64
v_mfma_f32_16x16x32_bf16 v[200:203], v[24:27], a[16:19], 0
v_mfma_f32_16x16x32_bf16 v[204:207], v[28:31], a[16:19], 0
s_waitcnt lgkmcnt(7)
v_mfma_f32_16x16x32_bf16 v[208:211], v[16:19], a[20:23], 0
v_mfma_f32_16x16x32_bf16 v[212:215], v[20:23], a[20:23], 0
ds_read_b128 a[52:55], v9 offset:16704
v_mfma_f32_16x16x32_bf16 v[216:219], v[24:27], a[20:23], 0
v_mfma_f32_16x16x32_bf16 v[220:223], v[28:31], a[20:23], 0
s_waitcnt lgkmcnt(7)
v_mfma_f32_16x16x32_bf16 v[224:227], v[16:19], a[24:27], 0
v_mfma_f32_16x16x32_bf16 v[228:231], v[20:23], a[24:27], 0
ds_read_b128 a[56:59], v9 offset:33344
v_mfma_f32_16x16x32_bf16 v[232:235], v[24:27], a[24:27], 0
v_mfma_f32_16x16x32_bf16 v[236:239], v[28:31], a[24:27], 0
s_waitcnt lgkmcnt(7)
v_mfma_f32_16x16x32_bf16 v[240:243], v[16:19], a[28:31], 0
v_mfma_f32_16x16x32_bf16 v[244:247], v[20:23], a[28:31], 0
ds_read_b128 a[60:63], v9 offset:49984
v_mfma_f32_16x16x32_bf16 v[248:251], v[24:27], a[28:31], 0
v_mfma_f32_16x16x32_bf16 v[252:255], v[28:31], a[28:31], 0
s_waitcnt lgkmcnt(7)
v_mfma_f32_16x16x32_bf16 v[128:131], v[32:35], a[32:35], v[128:131]
v_mfma_f32_16x16x32_bf16 v[132:135], v[36:39], a[32:35], v[132:135]
ds_read_b128 a[0:3], v8 offset:128
v_mfma_f32_16x16x32_bf16 v[136:139], v[40:43], a[32:35], v[136:139]
v_mfma_f32_16x16x32_bf16 v[140:143], v[44:47], a[32:35], v[140:143]
s_add_u32 s38, s34, 5120
buffer_load_dwordx4 v[16:19], v1, s[8:11], s38 offen
s_waitcnt lgkmcnt(7)
v_mfma_f32_16x16x32_bf16 v[144:147], v[32:35], a[36:39], v[144:147]
v_mfma_f32_16x16x32_bf16 v[148:151], v[36:39], a[36:39], v[148:151]
ds_read_b128 a[4:7], v8 offset:16768
v_mfma_f32_16x16x32_bf16 v[152:155], v[40:43], a[36:39], v[152:155]
v_mfma_f32_16x16x32_bf16 v[156:159], v[44:47], a[36:39], v[156:159]
s_add_u32 s38, s34, 37888
buffer_load_dwordx4 v[20:23], v1, s[8:11], s38 offen
s_waitcnt lgkmcnt(7)
v_mfma_f32_16x16x32_bf16 v[160:163], v[32:35], a[40:43], v[160:163]
v_mfma_f32_16x16x32_bf16 v[164:167], v[36:39], a[40:43], v[164:167]
ds_read_b128 a[8:11], v8 offset:33408
v_mfma_f32_16x16x32_bf16 v[168:171], v[40:43], a[40:43], v[168:171]
v_mfma_f32_16x16x32_bf16 v[172:175], v[44:47], a[40:43], v[172:175]
s_add_u32 s38, s34, 70656
buffer_load_dwordx4 v[24:27], v1, s[8:11], s38 offen
s_waitcnt lgkmcnt(7)
v_mfma_f32_16x16x32_bf16 v[176:179], v[32:35], a[44:47], v[176:179]
v_mfma_f32_16x16x32_bf16 v[180:183], v[36:39], a[44:47], v[180:183]
ds_read_b128 a[12:15], v8 offset:50048
v_mfma_f32_16x16x32_bf16 v[184:187], v[40:43], a[44:47], v[184:187]
v_mfma_f32_16x16x32_bf16 v[188:191], v[44:47], a[44:47], v[188:191]
s_add_u32 s38, s34, 103424
buffer_load_dwordx4 v[28:31], v1, s[8:11], s38 offen
s_waitcnt lgkmcnt(7)
v_mfma_f32_16x16x32_bf16 v[192:195], v[32:35], a[48:51], v[192:195]
v_mfma_f32_16x16x32_bf16 v[196:199], v[36:39], a[48:51], v[196:199]
ds_read_b128 a[16:19], v9 offset:128
v_mfma_f32_16x16x32_bf16 v[200:203], v[40:43], a[48:51], v[200:203]
v_mfma_f32_16x16x32_bf16 v[204:207], v[44:47], a[48:51], v[204:207]
s_waitcnt lgkmcnt(7)
v_mfma_f32_16x16x32_bf16 v[208:211], v[32:35], a[52:55], v[208:211]
v_mfma_f32_16x16x32_bf16 v[212:215], v[36:39], a[52:55], v[212:215]
ds_read_b128 a[20:23], v9 offset:16768
v_mfma_f32_16x16x32_bf16 v[216:219], v[40:43], a[52:55], v[216:219]
v_mfma_f32_16x16x32_bf16 v[220:223], v[44:47], a[52:55], v[220:223]
s_waitcnt lgkmcnt(7)
v_mfma_f32_16x16x32_bf16 v[224:227], v[32:35], a[56:59], v[224:227]
v_mfma_f32_16x16x32_bf16 v[228:231], v[36:39], a[56:59], v[228:231]
ds_read_b128 a[24:27], v9 offset:33408
v_mfma_f32_16x16x32_bf16 v[232:235], v[40:43], a[56:59], v[232:235]
v_mfma_f32_16x16x32_bf16 v[236:239], v[44:47], a[56:59], v[236:239]
s_waitcnt lgkmcnt(7)
v_mfma_f32_16x16x32_bf16 v[240:243], v[32:35], a[60:63], v[240:243]
v_mfma_f32_16x16x32_bf16 v[244:247], v[36:39], a[60:63], v[244:247]
ds_read_b128 a[28:31], v9 offset:50048
v_mfma_f32_16x16x32_bf16 v[248:251], v[40:43], a[60:63], v[248:251]
v_mfma_f32_16x16x32_bf16 v[252:255], v[44:47], a[60:63], v[252:255]
s_waitcnt lgkmcnt(7)
v_mfma_f32_16x16x32_bf16 v[128:131], v[48:51], a[0:3], v[128:131]
v_mfma_f32_16x16x32_bf16 v[132:135], v[52:55], a[0:3], v[132:135]
ds_read_b128 a[32:35], v8 offset:192
v_mfma_f32_16x16x32_bf16 v[136:139], v[56:59], a[0:3], v[136:139]
v_mfma_f32_16x16x32_bf16 v[140:143], v[60:63], a[0:3], v[140:143]
s_add_u32 s38, s34, 6144
buffer_load_dwordx4 v[32:35], v1, s[8:11], s38 offen
s_waitcnt lgkmcnt(7)
v_mfma_f32_16x16x32_bf16 v[144:147], v[48:51], a[4:7], v[144:147]
v_mfma_f32_16x16x32_bf16 v[148:151], v[52:55], a[4:7], v[148:151]
ds_read_b128 a[36:39], v8 offset:16832
v_mfma_f32_16x16x32_bf16 v[152:155], v[56:59], a[4:7], v[152:155]
v_mfma_f32_16x16x32_bf16 v[156:159], v[60:63], a[4:7], v[156:159]
s_add_u32 s38, s34, 38912
buffer_load_dwordx4 v[36:39], v1, s[8:11], s38 offen
s_waitcnt lgkmcnt(7)
v_mfma_f32_16x16x32_bf16 v[160:163], v[48:51], a[8:11], v[160:163]
v_mfma_f32_16x16x32_bf16 v[164:167], v[52:55], a[8:11], v[164:167]
ds_read_b128 a[40:43], v8 offset:33472
v_mfma_f32_16x16x32_bf16 v[168:171], v[56:59], a[8:11], v[168:171]
v_mfma_f32_16x16x32_bf16 v[172:175], v[60:63], a[8:11], v[172:175]
s_add_u32 s38, s34, 71680
buffer_load_dwordx4 v[40:43], v1, s[8:11], s38 offen
s_waitcnt lgkmcnt(7)
v_mfma_f32_16x16x32_bf16 v[176:179], v[48:51], a[12:15], v[176:179]
v_mfma_f32_16x16x32_bf16 v[180:183], v[52:55], a[12:15], v[180:183]
ds_read_b128 a[44:47], v8 offset:50112
v_mfma_f32_16x16x32_bf16 v[184:187], v[56:59], a[12:15], v[184:187]
v_mfma_f32_16x16x32_bf16 v[188:191], v[60:63], a[12:15], v[188:191]
s_add_u32 s38, s34, 104448
buffer_load_dwordx4 v[44:47], v1, s[8:11], s38 offen
s_waitcnt lgkmcnt(7)
v_mfma_f32_16x16x32_bf16 v[192:195], v[48:51], a[16:19], v[192:195]
v_mfma_f32_16x16x32_bf16 v[196:199], v[52:55], a[16:19], v[196:199]
ds_read_b128 a[48:51], v9 offset:192
v_mfma_f32_16x16x32_bf16 v[200:203], v[56:59], a[16:19], v[200:203]
v_mfma_f32_16x16x32_bf16 v[204:207], v[60:63], a[16:19], v[204:207]
s_waitcnt lgkmcnt(7)
v_mfma_f32_16x16x32_bf16 v[208:211], v[48:51], a[20:23], v[208:211]
v_mfma_f32_16x16x32_bf16 v[212:215], v[52:55], a[20:23], v[212:215]
ds_read_b128 a[52:55], v9 offset:16832
v_mfma_f32_16x16x32_bf16 v[216:219], v[56:59], a[20:23], v[216:219]
v_mfma_f32_16x16x32_bf16 v[220:223], v[60:63], a[20:23], v[220:223]
s_waitcnt lgkmcnt(7)
v_mfma_f32_16x16x32_bf16 v[224:227], v[48:51], a[24:27], v[224:227]
v_mfma_f32_16x16x32_bf16 v[228:231], v[52:55], a[24:27], v[228:231]
ds_read_b128 a[56:59], v9 offset:33472
v_mfma_f32_16x16x32_bf16 v[232:235], v[56:59], a[24:27], v[232:235]
v_mfma_f32_16x16x32_bf16 v[236:239], v[60:63], a[24:27], v[236:239]
s_waitcnt lgkmcnt(7)
v_mfma_f32_16x16x32_bf16 v[240:243], v[48:51], a[28:31], v[240:243]
v_mfma_f32_16x16x32_bf16 v[244:247], v[52:55], a[28:31], v[244:247]
ds_read_b128 a[60:63], v9 offset:50112
v_mfma_f32_16x16x32_bf16 v[248:251], v[56:59], a[28:31], v[248:251]
v_mfma_f32_16x16x32_bf16 v[252:255], v[60:63], a[28:31], v[252:255]
s_waitcnt lgkmcnt(7)
v_mfma_f32_16x16x32_bf16 v[128:131], v[64:67], a[32:35], v[128:131]
v_mfma_f32_16x16x32_bf16 v[132:135], v[68:71], a[32:35], v[132:135]
ds_read_b128 a[0:3], v8 offset:256
v_mfma_f32_16x16x32_bf16 v[136:139], v[72:75], a[32:35], v[136:139]
v_mfma_f32_16x16x32_bf16 v[140:143], v[76:79], a[32:35], v[140:143]
s_add_u32 s38, s34, 7168
buffer_load_dwordx4 v[48:51], v1, s[8:11], s38 offen
s_waitcnt lgkmcnt(7)
v_mfma_f32_16x16x32_bf16 v[144:147], v[64:67], a[36:39], v[144:147]
v_mfma_f32_16x16x32_bf16 v[148:151], v[68:71], a[36:39], v[148:151]
ds_read_b128 a[4:7], v8 offset:16896
v_mfma_f32_16x16x32_bf16 v[152:155], v[72:75], a[36:39], v[152:155]
v_mfma_f32_16x16x32_bf16 v[156:159], v[76:79], a[36:39], v[156:159]
s_add_u32 s38, s34, 39936
buffer_load_dwordx4 v[52:55], v1, s[8:11], s38 offen
s_waitcnt lgkmcnt(7)
v_mfma_f32_16x16x32_bf16 v[160:163], v[64:67], a[40:43], v[160:163]
v_mfma_f32_16x16x32_bf16 v[164:167], v[68:71], a[40:43], v[164:167]
ds_read_b128 a[8:11], v8 offset:33536
v_mfma_f32_16x16x32_bf16 v[168:171], v[72:75], a[40:43], v[168:171]
v_mfma_f32_16x16x32_bf16 v[172:175], v[76:79], a[40:43], v[172:175]
s_add_u32 s38, s34, 72704
buffer_load_dwordx4 v[56:59], v1, s[8:11], s38 offen
s_waitcnt lgkmcnt(7)
v_mfma_f32_16x16x32_bf16 v[176:179], v[64:67], a[44:47], v[176:179]
v_mfma_f32_16x16x32_bf16 v[180:183], v[68:71], a[44:47], v[180:183]
ds_read_b128 a[12:15], v8 offset:50176
v_mfma_f32_16x16x32_bf16 v[184:187], v[72:75], a[44:47], v[184:187]
v_mfma_f32_16x16x32_bf16 v[188:191], v[76:79], a[44:47], v[188:191]
s_add_u32 s38, s34, 105472
buffer_load_dwordx4 v[60:63], v1, s[8:11], s38 offen
s_waitcnt lgkmcnt(7)
v_mfma_f32_16x16x32_bf16 v[192:195], v[64:67], a[48:51], v[192:195]
v_mfma_f32_16x16x32_bf16 v[196:199], v[68:71], a[48:51], v[196:199]
ds_read_b128 a[16:19], v9 offset:256
v_mfma_f32_16x16x32_bf16 v[200:203], v[72:75], a[48:51], v[200:203]
v_mfma_f32_16x16x32_bf16 v[204:207], v[76:79], a[48:51], v[204:207]
s_waitcnt lgkmcnt(7)
v_mfma_f32_16x16x32_bf16 v[208:211], v[64:67], a[52:55], v[208:211]
v_mfma_f32_16x16x32_bf16 v[212:215], v[68:71], a[52:55], v[212:215]
ds_read_b128 a[20:23], v9 offset:16896
v_mfma_f32_16x16x32_bf16 v[216:219], v[72:75], a[52:55], v[216:219]
v_mfma_f32_16x16x32_bf16 v[220:223], v[76:79], a[52:55], v[220:223]
s_waitcnt lgkmcnt(7)
v_mfma_f32_16x16x32_bf16 v[224:227], v[64:67], a[56:59], v[224:227]
v_mfma_f32_16x16x32_bf16 v[228:231], v[68:71], a[56:59], v[228:231]
ds_read_b128 a[24:27], v9 offset:33536
v_mfma_f32_16x16x32_bf16 v[232:235], v[72:75], a[56:59], v[232:235]
v_mfma_f32_16x16x32_bf16 v[236:239], v[76:79], a[56:59], v[236:239]
s_waitcnt lgkmcnt(7)
v_mfma_f32_16x16x32_bf16 v[240:243], v[64:67], a[60:63], v[240:243]
v_mfma_f32_16x16x32_bf16 v[244:247], v[68:71], a[60:63], v[244:247]
ds_read_b128 a[28:31], v9 offset:50176
v_mfma_f32_16x16x32_bf16 v[248:251], v[72:75], a[60:63], v[248:251]
v_mfma_f32_16x16x32_bf16 v[252:255], v[76:79], a[60:63], v[252:255]
s_waitcnt vmcnt(15) lgkmcnt(7)
v_mfma_f32_16x16x32_bf16 v[128:131], v[80:83], a[0:3], v[128:131]
s_waitcnt vmcnt(14)
v_mfma_f32_16x16x32_bf16 v[132:135], v[84:87], a[0:3], v[132:135]
ds_read_b128 a[32:35], v8 offset:320
s_waitcnt vmcnt(13)
v_mfma_f32_16x16x32_bf16 v[136:139], v[88:91], a[0:3], v[136:139]
s_waitcnt vmcnt(12)
v_mfma_f32_16x16x32_bf16 v[140:143], v[92:95], a[0:3], v[140:143]
s_add_u32 s38, s34, 8192
buffer_load_dwordx4 v[64:67], v1, s[8:11], s38 offen
s_waitcnt lgkmcnt(7)
v_mfma_f32_16x16x32_bf16 v[144:147], v[80:83], a[4:7], v[144:147]
v_mfma_f32_16x16x32_bf16 v[148:151], v[84:87], a[4:7], v[148:151]
ds_read_b128 a[36:39], v8 offset:16960
v_mfma_f32_16x16x32_bf16 v[152:155], v[88:91], a[4:7], v[152:155]
v_mfma_f32_16x16x32_bf16 v[156:159], v[92:95], a[4:7], v[156:159]
s_add_u32 s38, s34, 40960
buffer_load_dwordx4 v[68:71], v1, s[8:11], s38 offen
s_waitcnt lgkmcnt(7)
v_mfma_f32_16x16x32_bf16 v[160:163], v[80:83], a[8:11], v[160:163]
v_mfma_f32_16x16x32_bf16 v[164:167], v[84:87], a[8:11], v[164:167]
ds_read_b128 a[40:43], v8 offset:33600
v_mfma_f32_16x16x32_bf16 v[168:171], v[88:91], a[8:11], v[168:171]
v_mfma_f32_16x16x32_bf16 v[172:175], v[92:95], a[8:11], v[172:175]
s_add_u32 s38, s34, 73728
buffer_load_dwordx4 v[72:75], v1, s[8:11], s38 offen
s_waitcnt lgkmcnt(7)
v_mfma_f32_16x16x32_bf16 v[176:179], v[80:83], a[12:15], v[176:179]
v_mfma_f32_16x16x32_bf16 v[180:183], v[84:87], a[12:15], v[180:183]
ds_read_b128 a[44:47], v8 offset:50240
v_mfma_f32_16x16x32_bf16 v[184:187], v[88:91], a[12:15], v[184:187]
v_mfma_f32_16x16x32_bf16 v[188:191], v[92:95], a[12:15], v[188:191]
s_add_u32 s38, s34, 106496
buffer_load_dwordx4 v[76:79], v1, s[8:11], s38 offen
s_waitcnt lgkmcnt(7)
v_mfma_f32_16x16x32_bf16 v[192:195], v[80:83], a[16:19], v[192:195]
v_mfma_f32_16x16x32_bf16 v[196:199], v[84:87], a[16:19], v[196:199]
ds_read_b128 a[48:51], v9 offset:320
v_mfma_f32_16x16x32_bf16 v[200:203], v[88:91], a[16:19], v[200:203]
v_mfma_f32_16x16x32_bf16 v[204:207], v[92:95], a[16:19], v[204:207]
s_waitcnt lgkmcnt(7)
v_mfma_f32_16x16x32_bf16 v[208:211], v[80:83], a[20:23], v[208:211]
v_mfma_f32_16x16x32_bf16 v[212:215], v[84:87], a[20:23], v[212:215]
ds_read_b128 a[52:55], v9 offset:16960
v_mfma_f32_16x16x32_bf16 v[216:219], v[88:91], a[20:23], v[216:219]
v_mfma_f32_16x16x32_bf16 v[220:223], v[92:95], a[20:23], v[220:223]
s_waitcnt lgkmcnt(7)
v_mfma_f32_16x16x32_bf16 v[224:227], v[80:83], a[24:27], v[224:227]
v_mfma_f32_16x16x32_bf16 v[228:231], v[84:87], a[24:27], v[228:231]
ds_read_b128 a[56:59], v9 offset:33600
v_mfma_f32_16x16x32_bf16 v[232:235], v[88:91], a[24:27], v[232:235]
v_mfma_f32_16x16x32_bf16 v[236:239], v[92:95], a[24:27], v[236:239]
s_waitcnt lgkmcnt(7)
v_mfma_f32_16x16x32_bf16 v[240:243], v[80:83], a[28:31], v[240:243]
v_mfma_f32_16x16x32_bf16 v[244:247], v[84:87], a[28:31], v[244:247]
ds_read_b128 a[60:63], v9 offset:50240
v_mfma_f32_16x16x32_bf16 v[248:251], v[88:91], a[28:31], v[248:251]
v_mfma_f32_16x16x32_bf16 v[252:255], v[92:95], a[28:31], v[252:255]
s_waitcnt vmcnt(15) lgkmcnt(7)
v_mfma_f32_16x16x32_bf16 v[128:131], v[16:19], a[32:35], v[128:131]
s_waitcnt vmcnt(14)
v_mfma_f32_16x16x32_bf16 v[132:135], v[20:23], a[32:35], v[132:135]
ds_read_b128 a[0:3], v8 offset:384
s_waitcnt vmcnt(13)
v_mfma_f32_16x16x32_bf16 v[136:139], v[24:27], a[32:35], v[136:139]
s_waitcnt vmcnt(12)
v_mfma_f32_16x16x32_bf16 v[140:143], v[28:31], a[32:35], v[140:143]
s_add_u32 s38, s34, 9216
buffer_load_dwordx4 v[80:83], v1, s[8:11], s38 offen
s_waitcnt lgkmcnt(7)
v_mfma_f32_16x16x32_bf16 v[144:147], v[16:19], a[36:39], v[144:147]
v_mfma_f32_16x16x32_bf16 v[148:151], v[20:23], a[36:39], v[148:151]
ds_read_b128 a[4:7], v8 offset:17024
v_mfma_f32_16x16x32_bf16 v[152:155], v[24:27], a[36:39], v[152:155]
v_mfma_f32_16x16x32_bf16 v[156:159], v[28:31], a[36:39], v[156:159]
s_add_u32 s38, s34, 41984
buffer_load_dwordx4 v[84:87], v1, s[8:11], s38 offen
s_waitcnt lgkmcnt(7)
v_mfma_f32_16x16x32_bf16 v[160:163], v[16:19], a[40:43], v[160:163]
v_mfma_f32_16x16x32_bf16 v[164:167], v[20:23], a[40:43], v[164:167]
ds_read_b128 a[8:11], v8 offset:33664
v_mfma_f32_16x16x32_bf16 v[168:171], v[24:27], a[40:43], v[168:171]
v_mfma_f32_16x16x32_bf16 v[172:175], v[28:31], a[40:43], v[172:175]
s_add_u32 s38, s34, 74752
buffer_load_dwordx4 v[88:91], v1, s[8:11], s38 offen
s_waitcnt lgkmcnt(7)
v_mfma_f32_16x16x32_bf16 v[176:179], v[16:19], a[44:47], v[176:179]
v_mfma_f32_16x16x32_bf16 v[180:183], v[20:23], a[44:47], v[180:183]
ds_read_b128 a[12:15], v8 offset:50304
v_mfma_f32_16x16x32_bf16 v[184:187], v[24:27], a[44:47], v[184:187]
v_mfma_f32_16x16x32_bf16 v[188:191], v[28:31], a[44:47], v[188:191]
s_add_u32 s38, s34, 107520
buffer_load_dwordx4 v[92:95], v1, s[8:11], s38 offen
s_waitcnt lgkmcnt(7)
v_mfma_f32_16x16x32_bf16 v[192:195], v[16:19], a[48:51], v[192:195]
v_mfma_f32_16x16x32_bf16 v[196:199], v[20:23], a[48:51], v[196:199]
ds_read_b128 a[16:19], v9 offset:384
v_mfma_f32_16x16x32_bf16 v[200:203], v[24:27], a[48:51], v[200:203]
v_mfma_f32_16x16x32_bf16 v[204:207], v[28:31], a[48:51], v[204:207]
s_waitcnt lgkmcnt(7)
v_mfma_f32_16x16x32_bf16 v[208:211], v[16:19], a[52:55], v[208:211]
v_mfma_f32_16x16x32_bf16 v[212:215], v[20:23], a[52:55], v[212:215]
ds_read_b128 a[20:23], v9 offset:17024
v_mfma_f32_16x16x32_bf16 v[216:219], v[24:27], a[52:55], v[216:219]
v_mfma_f32_16x16x32_bf16 v[220:223], v[28:31], a[52:55], v[220:223]
s_waitcnt lgkmcnt(7)
v_mfma_f32_16x16x32_bf16 v[224:227], v[16:19], a[56:59], v[224:227]
v_mfma_f32_16x16x32_bf16 v[228:231], v[20:23], a[56:59], v[228:231]
ds_read_b128 a[24:27], v9 offset:33664
v_mfma_f32_16x16x32_bf16 v[232:235], v[24:27], a[56:59], v[232:235]
v_mfma_f32_16x16x32_bf16 v[236:239], v[28:31], a[56:59], v[236:239]
s_waitcnt lgkmcnt(7)
v_mfma_f32_16x16x32_bf16 v[240:243], v[16:19], a[60:63], v[240:243]
v_mfma_f32_16x16x32_bf16 v[244:247], v[20:23], a[60:63], v[244:247]
ds_read_b128 a[28:31], v9 offset:50304
v_mfma_f32_16x16x32_bf16 v[248:251], v[24:27], a[60:63], v[248:251]
v_mfma_f32_16x16x32_bf16 v[252:255], v[28:31], a[60:63], v[252:255]
s_waitcnt vmcnt(15) lgkmcnt(7)
v_mfma_f32_16x16x32_bf16 v[128:131], v[32:35], a[0:3], v[128:131]
s_waitcnt vmcnt(14)
v_mfma_f32_16x16x32_bf16 v[132:135], v[36:39], a[0:3], v[132:135]
ds_read_b128 a[32:35], v8 offset:448
s_waitcnt vmcnt(13)
v_mfma_f32_16x16x32_bf16 v[136:139], v[40:43], a[0:3], v[136:139]
s_waitcnt vmcnt(12)
v_mfma_f32_16x16x32_bf16 v[140:143], v[44:47], a[0:3], v[140:143]
s_add_u32 s38, s34, 10240
buffer_load_dwordx4 v[16:19], v1, s[8:11], s38 offen
s_waitcnt lgkmcnt(7)
v_mfma_f32_16x16x32_bf16 v[144:147], v[32:35], a[4:7], v[144:147]
v_mfma_f32_16x16x32_bf16 v[148:151], v[36:39], a[4:7], v[148:151]
ds_read_b128 a[36:39], v8 offset:17088
v_mfma_f32_16x16x32_bf16 v[152:155], v[40:43], a[4:7], v[152:155]
v_mfma_f32_16x16x32_bf16 v[156:159], v[44:47], a[4:7], v[156:159]
s_add_u32 s38, s34, 43008
buffer_load_dwordx4 v[20:23], v1, s[8:11], s38 offen
s_waitcnt lgkmcnt(7)
v_mfma_f32_16x16x32_bf16 v[160:163], v[32:35], a[8:11], v[160:163]
v_mfma_f32_16x16x32_bf16 v[164:167], v[36:39], a[8:11], v[164:167]
ds_read_b128 a[40:43], v8 offset:33728
v_mfma_f32_16x16x32_bf16 v[168:171], v[40:43], a[8:11], v[168:171]
v_mfma_f32_16x16x32_bf16 v[172:175], v[44:47], a[8:11], v[172:175]
s_add_u32 s38, s34, 75776
buffer_load_dwordx4 v[24:27], v1, s[8:11], s38 offen
s_waitcnt lgkmcnt(7)
v_mfma_f32_16x16x32_bf16 v[176:179], v[32:35], a[12:15], v[176:179]
v_mfma_f32_16x16x32_bf16 v[180:183], v[36:39], a[12:15], v[180:183]
ds_read_b128 a[44:47], v8 offset:50368
v_mfma_f32_16x16x32_bf16 v[184:187], v[40:43], a[12:15], v[184:187]
v_mfma_f32_16x16x32_bf16 v[188:191], v[44:47], a[12:15], v[188:191]
s_add_u32 s38, s34, 108544
buffer_load_dwordx4 v[28:31], v1, s[8:11], s38 offen
s_waitcnt lgkmcnt(7)
v_mfma_f32_16x16x32_bf16 v[192:195], v[32:35], a[16:19], v[192:195]
v_mfma_f32_16x16x32_bf16 v[196:199], v[36:39], a[16:19], v[196:199]
ds_read_b128 a[48:51], v9 offset:448
v_mfma_f32_16x16x32_bf16 v[200:203], v[40:43], a[16:19], v[200:203]
v_mfma_f32_16x16x32_bf16 v[204:207], v[44:47], a[16:19], v[204:207]
s_waitcnt lgkmcnt(7)
v_mfma_f32_16x16x32_bf16 v[208:211], v[32:35], a[20:23], v[208:211]
v_mfma_f32_16x16x32_bf16 v[212:215], v[36:39], a[20:23], v[212:215]
ds_read_b128 a[52:55], v9 offset:17088
v_mfma_f32_16x16x32_bf16 v[216:219], v[40:43], a[20:23], v[216:219]
v_mfma_f32_16x16x32_bf16 v[220:223], v[44:47], a[20:23], v[220:223]
s_waitcnt lgkmcnt(7)
v_mfma_f32_16x16x32_bf16 v[224:227], v[32:35], a[24:27], v[224:227]
v_mfma_f32_16x16x32_bf16 v[228:231], v[36:39], a[24:27], v[228:231]
ds_read_b128 a[56:59], v9 offset:33728
v_mfma_f32_16x16x32_bf16 v[232:235], v[40:43], a[24:27], v[232:235]
v_mfma_f32_16x16x32_bf16 v[236:239], v[44:47], a[24:27], v[236:239]
s_waitcnt lgkmcnt(7)
v_mfma_f32_16x16x32_bf16 v[240:243], v[32:35], a[28:31], v[240:243]
v_mfma_f32_16x16x32_bf16 v[244:247], v[36:39], a[28:31], v[244:247]
ds_read_b128 a[60:63], v9 offset:50368
v_mfma_f32_16x16x32_bf16 v[248:251], v[40:43], a[28:31], v[248:251]
v_mfma_f32_16x16x32_bf16 v[252:255], v[44:47], a[28:31], v[252:255]
s_waitcnt vmcnt(15) lgkmcnt(7)
v_mfma_f32_16x16x32_bf16 v[128:131], v[48:51], a[32:35], v[128:131]
s_waitcnt vmcnt(14)
v_mfma_f32_16x16x32_bf16 v[132:135], v[52:55], a[32:35], v[132:135]
ds_read_b128 a[0:3], v8 offset:512
s_waitcnt vmcnt(13)
v_mfma_f32_16x16x32_bf16 v[136:139], v[56:59], a[32:35], v[136:139]
s_waitcnt vmcnt(12)
v_mfma_f32_16x16x32_bf16 v[140:143], v[60:63], a[32:35], v[140:143]
s_add_u32 s38, s34, 11264
buffer_load_dwordx4 v[32:35], v1, s[8:11], s38 offen
s_waitcnt lgkmcnt(7)
v_mfma_f32_16x16x32_bf16 v[144:147], v[48:51], a[36:39], v[144:147]
v_mfma_f32_16x16x32_bf16 v[148:151], v[52:55], a[36:39], v[148:151]
ds_read_b128 a[4:7], v8 offset:17152
v_mfma_f32_16x16x32_bf16 v[152:155], v[56:59], a[36:39], v[152:155]
v_mfma_f32_16x16x32_bf16 v[156:159], v[60:63], a[36:39], v[156:159]
s_add_u32 s38, s34, 44032
buffer_load_dwordx4 v[36:39], v1, s[8:11], s38 offen
s_waitcnt lgkmcnt(7)
v_mfma_f32_16x16x32_bf16 v[160:163], v[48:51], a[40:43], v[160:163]
v_mfma_f32_16x16x32_bf16 v[164:167], v[52:55], a[40:43], v[164:167]
ds_read_b128 a[8:11], v8 offset:33792
v_mfma_f32_16x16x32_bf16 v[168:171], v[56:59], a[40:43], v[168:171]
v_mfma_f32_16x16x32_bf16 v[172:175], v[60:63], a[40:43], v[172:175]
s_add_u32 s38, s34, 76800
buffer_load_dwordx4 v[40:43], v1, s[8:11], s38 offen
s_waitcnt lgkmcnt(7)
v_mfma_f32_16x16x32_bf16 v[176:179], v[48:51], a[44:47], v[176:179]
v_mfma_f32_16x16x32_bf16 v[180:183], v[52:55], a[44:47], v[180:183]
ds_read_b128 a[12:15], v8 offset:50432
v_mfma_f32_16x16x32_bf16 v[184:187], v[56:59], a[44:47], v[184:187]
v_mfma_f32_16x16x32_bf16 v[188:191], v[60:63], a[44:47], v[188:191]
s_add_u32 s38, s34, 109568
buffer_load_dwordx4 v[44:47], v1, s[8:11], s38 offen
s_waitcnt lgkmcnt(7)
v_mfma_f32_16x16x32_bf16 v[192:195], v[48:51], a[48:51], v[192:195]
v_mfma_f32_16x16x32_bf16 v[196:199], v[52:55], a[48:51], v[196:199]
ds_read_b128 a[16:19], v9 offset:512
v_mfma_f32_16x16x32_bf16 v[200:203], v[56:59], a[48:51], v[200:203]
v_mfma_f32_16x16x32_bf16 v[204:207], v[60:63], a[48:51], v[204:207]
s_waitcnt lgkmcnt(7)
v_mfma_f32_16x16x32_bf16 v[208:211], v[48:51], a[52:55], v[208:211]
v_mfma_f32_16x16x32_bf16 v[212:215], v[52:55], a[52:55], v[212:215]
ds_read_b128 a[20:23], v9 offset:17152
v_mfma_f32_16x16x32_bf16 v[216:219], v[56:59], a[52:55], v[216:219]
v_mfma_f32_16x16x32_bf16 v[220:223], v[60:63], a[52:55], v[220:223]
s_waitcnt lgkmcnt(7)
v_mfma_f32_16x16x32_bf16 v[224:227], v[48:51], a[56:59], v[224:227]
v_mfma_f32_16x16x32_bf16 v[228:231], v[52:55], a[56:59], v[228:231]
ds_read_b128 a[24:27], v9 offset:33792
v_mfma_f32_16x16x32_bf16 v[232:235], v[56:59], a[56:59], v[232:235]
v_mfma_f32_16x16x32_bf16 v[236:239], v[60:63], a[56:59], v[236:239]
s_waitcnt lgkmcnt(7)
v_mfma_f32_16x16x32_bf16 v[240:243], v[48:51], a[60:63], v[240:243]
v_mfma_f32_16x16x32_bf16 v[244:247], v[52:55], a[60:63], v[244:247]
ds_read_b128 a[28:31], v9 offset:50432
v_mfma_f32_16x16x32_bf16 v[248:251], v[56:59], a[60:63], v[248:251]
v_mfma_f32_16x16x32_bf16 v[252:255], v[60:63], a[60:63], v[252:255]
s_waitcnt vmcnt(15) lgkmcnt(7)
v_mfma_f32_16x16x32_bf16 v[128:131], v[64:67], a[0:3], v[128:131]
s_waitcnt vmcnt(14)
v_mfma_f32_16x16x32_bf16 v[132:135], v[68:71], a[0:3], v[132:135]
ds_read_b128 a[32:35], v8 offset:576
s_waitcnt vmcnt(13)
v_mfma_f32_16x16x32_bf16 v[136:139], v[72:75], a[0:3], v[136:139]
s_waitcnt vmcnt(12)
v_mfma_f32_16x16x32_bf16 v[140:143], v[76:79], a[0:3], v[140:143]
s_add_u32 s38, s34, 12288
buffer_load_dwordx4 v[48:51], v1, s[8:11], s38 offen
s_waitcnt lgkmcnt(7)
v_mfma_f32_16x16x32_bf16 v[144:147], v[64:67], a[4:7], v[144:147]
v_mfma_f32_16x16x32_bf16 v[148:151], v[68:71], a[4:7], v[148:151]
ds_read_b128 a[36:39], v8 offset:17216
v_mfma_f32_16x16x32_bf16 v[152:155], v[72:75], a[4:7], v[152:155]
v_mfma_f32_16x16x32_bf16 v[156:159], v[76:79], a[4:7], v[156:159]
s_add_u32 s38, s34, 45056
buffer_load_dwordx4 v[52:55], v1, s[8:11], s38 offen
s_waitcnt lgkmcnt(7)
v_mfma_f32_16x16x32_bf16 v[160:163], v[64:67], a[8:11], v[160:163]
v_mfma_f32_16x16x32_bf16 v[164:167], v[68:71], a[8:11], v[164:167]
ds_read_b128 a[40:43], v8 offset:33856
v_mfma_f32_16x16x32_bf16 v[168:171], v[72:75], a[8:11], v[168:171]
v_mfma_f32_16x16x32_bf16 v[172:175], v[76:79], a[8:11], v[172:175]
s_add_u32 s38, s34, 77824
buffer_load_dwordx4 v[56:59], v1, s[8:11], s38 offen
s_waitcnt lgkmcnt(7)
v_mfma_f32_16x16x32_bf16 v[176:179], v[64:67], a[12:15], v[176:179]
v_mfma_f32_16x16x32_bf16 v[180:183], v[68:71], a[12:15], v[180:183]
ds_read_b128 a[44:47], v8 offset:50496
v_mfma_f32_16x16x32_bf16 v[184:187], v[72:75], a[12:15], v[184:187]
v_mfma_f32_16x16x32_bf16 v[188:191], v[76:79], a[12:15], v[188:191]
s_add_u32 s38, s34, 110592
buffer_load_dwordx4 v[60:63], v1, s[8:11], s38 offen
s_waitcnt lgkmcnt(7)
v_mfma_f32_16x16x32_bf16 v[192:195], v[64:67], a[16:19], v[192:195]
v_mfma_f32_16x16x32_bf16 v[196:199], v[68:71], a[16:19], v[196:199]
ds_read_b128 a[48:51], v9 offset:576
v_mfma_f32_16x16x32_bf16 v[200:203], v[72:75], a[16:19], v[200:203]
v_mfma_f32_16x16x32_bf16 v[204:207], v[76:79], a[16:19], v[204:207]
s_waitcnt lgkmcnt(7)
v_mfma_f32_16x16x32_bf16 v[208:211], v[64:67], a[20:23], v[208:211]
v_mfma_f32_16x16x32_bf16 v[212:215], v[68:71], a[20:23], v[212:215]
ds_read_b128 a[52:55], v9 offset:17216
v_mfma_f32_16x16x32_bf16 v[216:219], v[72:75], a[20:23], v[216:219]
v_mfma_f32_16x16x32_bf16 v[220:223], v[76:79], a[20:23], v[220:223]
s_waitcnt lgkmcnt(7)
v_mfma_f32_16x16x32_bf16 v[224:227], v[64:67], a[24:27], v[224:227]
v_mfma_f32_16x16x32_bf16 v[228:231], v[68:71], a[24:27], v[228:231]
ds_read_b128 a[56:59], v9 offset:33856
v_mfma_f32_16x16x32_bf16 v[232:235], v[72:75], a[24:27], v[232:235]
v_mfma_f32_16x16x32_bf16 v[236:239], v[76:79], a[24:27], v[236:239]
s_waitcnt lgkmcnt(7)
v_mfma_f32_16x16x32_bf16 v[240:243], v[64:67], a[28:31], v[240:243]
v_mfma_f32_16x16x32_bf16 v[244:247], v[68:71], a[28:31], v[244:247]
ds_read_b128 a[60:63], v9 offset:50496
v_mfma_f32_16x16x32_bf16 v[248:251], v[72:75], a[28:31], v[248:251]
v_mfma_f32_16x16x32_bf16 v[252:255], v[76:79], a[28:31], v[252:255]
s_waitcnt vmcnt(15) lgkmcnt(7)
v_mfma_f32_16x16x32_bf16 v[128:131], v[80:83], a[32:35], v[128:131]
s_waitcnt vmcnt(14)
v_mfma_f32_16x16x32_bf16 v[132:135], v[84:87], a[32:35], v[132:135]
ds_read_b128 a[0:3], v8 offset:640
s_waitcnt vmcnt(13)
v_mfma_f32_16x16x32_bf16 v[136:139], v[88:91], a[32:35], v[136:139]
s_waitcnt vmcnt(12)
v_mfma_f32_16x16x32_bf16 v[140:143], v[92:95], a[32:35], v[140:143]
s_add_u32 s38, s34, 13312
buffer_load_dwordx4 v[64:67], v1, s[8:11], s38 offen
s_waitcnt lgkmcnt(7)
v_mfma_f32_16x16x32_bf16 v[144:147], v[80:83], a[36:39], v[144:147]
v_mfma_f32_16x16x32_bf16 v[148:151], v[84:87], a[36:39], v[148:151]
ds_read_b128 a[4:7], v8 offset:17280
v_mfma_f32_16x16x32_bf16 v[152:155], v[88:91], a[36:39], v[152:155]
v_mfma_f32_16x16x32_bf16 v[156:159], v[92:95], a[36:39], v[156:159]
s_add_u32 s38, s34, 46080
buffer_load_dwordx4 v[68:71], v1, s[8:11], s38 offen
s_waitcnt lgkmcnt(7)
v_mfma_f32_16x16x32_bf16 v[160:163], v[80:83], a[40:43], v[160:163]
v_mfma_f32_16x16x32_bf16 v[164:167], v[84:87], a[40:43], v[164:167]
ds_read_b128 a[8:11], v8 offset:33920
v_mfma_f32_16x16x32_bf16 v[168:171], v[88:91], a[40:43], v[168:171]
v_mfma_f32_16x16x32_bf16 v[172:175], v[92:95], a[40:43], v[172:175]
s_add_u32 s38, s34, 78848
buffer_load_dwordx4 v[72:75], v1, s[8:11], s38 offen
s_waitcnt lgkmcnt(7)
v_mfma_f32_16x16x32_bf16 v[176:179], v[80:83], a[44:47], v[176:179]
v_mfma_f32_16x16x32_bf16 v[180:183], v[84:87], a[44:47], v[180:183]
ds_read_b128 a[12:15], v8 offset:50560
v_mfma_f32_16x16x32_bf16 v[184:187], v[88:91], a[44:47], v[184:187]
v_mfma_f32_16x16x32_bf16 v[188:191], v[92:95], a[44:47], v[188:191]
s_add_u32 s38, s34, 111616
buffer_load_dwordx4 v[76:79], v1, s[8:11], s38 offen
s_waitcnt lgkmcnt(7)
v_mfma_f32_16x16x32_bf16 v[192:195], v[80:83], a[48:51], v[192:195]
v_mfma_f32_16x16x32_bf16 v[196:199], v[84:87], a[48:51], v[196:199]
ds_read_b128 a[16:19], v9 offset:640
v_mfma_f32_16x16x32_bf16 v[200:203], v[88:91], a[48:51], v[200:203]
v_mfma_f32_16x16x32_bf16 v[204:207], v[92:95], a[48:51], v[204:207]
s_waitcnt lgkmcnt(7)
v_mfma_f32_16x16x32_bf16 v[208:211], v[80:83], a[52:55], v[208:211]
v_mfma_f32_16x16x32_bf16 v[212:215], v[84:87], a[52:55], v[212:215]
ds_read_b128 a[20:23], v9 offset:17280
v_mfma_f32_16x16x32_bf16 v[216:219], v[88:91], a[52:55], v[216:219]
v_mfma_f32_16x16x32_bf16 v[220:223], v[92:95], a[52:55], v[220:223]
s_waitcnt lgkmcnt(7)
v_mfma_f32_16x16x32_bf16 v[224:227], v[80:83], a[56:59], v[224:227]
v_mfma_f32_16x16x32_bf16 v[228:231], v[84:87], a[56:59], v[228:231]
ds_read_b128 a[24:27], v9 offset:33920
v_mfma_f32_16x16x32_bf16 v[232:235], v[88:91], a[56:59], v[232:235]
v_mfma_f32_16x16x32_bf16 v[236:239], v[92:95], a[56:59], v[236:239]
s_waitcnt lgkmcnt(7)
v_mfma_f32_16x16x32_bf16 v[240:243], v[80:83], a[60:63], v[240:243]
v_mfma_f32_16x16x32_bf16 v[244:247], v[84:87], a[60:63], v[244:247]
ds_read_b128 a[28:31], v9 offset:50560
v_mfma_f32_16x16x32_bf16 v[248:251], v[88:91], a[60:63], v[248:251]
v_mfma_f32_16x16x32_bf16 v[252:255], v[92:95], a[60:63], v[252:255]
s_waitcnt vmcnt(15) lgkmcnt(7)
v_mfma_f32_16x16x32_bf16 v[128:131], v[16:19], a[0:3], v[128:131]
s_waitcnt vmcnt(14)
v_mfma_f32_16x16x32_bf16 v[132:135], v[20:23], a[0:3], v[132:135]
ds_read_b128 a[32:35], v8 offset:704
s_waitcnt vmcnt(13)
v_mfma_f32_16x16x32_bf16 v[136:139], v[24:27], a[0:3], v[136:139]
s_waitcnt vmcnt(12)
v_mfma_f32_16x16x32_bf16 v[140:143], v[28:31], a[0:3], v[140:143]
s_add_u32 s38, s34, 14336
buffer_load_dwordx4 v[80:83], v1, s[8:11], s38 offen
s_waitcnt lgkmcnt(7)
v_mfma_f32_16x16x32_bf16 v[144:147], v[16:19], a[4:7], v[144:147]
v_mfma_f32_16x16x32_bf16 v[148:151], v[20:23], a[4:7], v[148:151]
ds_read_b128 a[36:39], v8 offset:17344
v_mfma_f32_16x16x32_bf16 v[152:155], v[24:27], a[4:7], v[152:155]
v_mfma_f32_16x16x32_bf16 v[156:159], v[28:31], a[4:7], v[156:159]
s_add_u32 s38, s34, 47104
buffer_load_dwordx4 v[84:87], v1, s[8:11], s38 offen
s_waitcnt lgkmcnt(7)
v_mfma_f32_16x16x32_bf16 v[160:163], v[16:19], a[8:11], v[160:163]
v_mfma_f32_16x16x32_bf16 v[164:167], v[20:23], a[8:11], v[164:167]
ds_read_b128 a[40:43], v8 offset:33984
v_mfma_f32_16x16x32_bf16 v[168:171], v[24:27], a[8:11], v[168:171]
v_mfma_f32_16x16x32_bf16 v[172:175], v[28:31], a[8:11], v[172:175]
s_add_u32 s38, s34, 79872
buffer_load_dwordx4 v[88:91], v1, s[8:11], s38 offen
s_waitcnt lgkmcnt(7)
v_mfma_f32_16x16x32_bf16 v[176:179], v[16:19], a[12:15], v[176:179]
v_mfma_f32_16x16x32_bf16 v[180:183], v[20:23], a[12:15], v[180:183]
ds_read_b128 a[44:47], v8 offset:50624
v_mfma_f32_16x16x32_bf16 v[184:187], v[24:27], a[12:15], v[184:187]
v_mfma_f32_16x16x32_bf16 v[188:191], v[28:31], a[12:15], v[188:191]
s_add_u32 s38, s34, 112640
buffer_load_dwordx4 v[92:95], v1, s[8:11], s38 offen
s_waitcnt lgkmcnt(7)
v_mfma_f32_16x16x32_bf16 v[192:195], v[16:19], a[16:19], v[192:195]
v_mfma_f32_16x16x32_bf16 v[196:199], v[20:23], a[16:19], v[196:199]
ds_read_b128 a[48:51], v9 offset:704
v_mfma_f32_16x16x32_bf16 v[200:203], v[24:27], a[16:19], v[200:203]
v_mfma_f32_16x16x32_bf16 v[204:207], v[28:31], a[16:19], v[204:207]
s_waitcnt lgkmcnt(7)
v_mfma_f32_16x16x32_bf16 v[208:211], v[16:19], a[20:23], v[208:211]
v_mfma_f32_16x16x32_bf16 v[212:215], v[20:23], a[20:23], v[212:215]
ds_read_b128 a[52:55], v9 offset:17344
v_mfma_f32_16x16x32_bf16 v[216:219], v[24:27], a[20:23], v[216:219]
v_mfma_f32_16x16x32_bf16 v[220:223], v[28:31], a[20:23], v[220:223]
s_waitcnt lgkmcnt(7)
v_mfma_f32_16x16x32_bf16 v[224:227], v[16:19], a[24:27], v[224:227]
v_mfma_f32_16x16x32_bf16 v[228:231], v[20:23], a[24:27], v[228:231]
ds_read_b128 a[56:59], v9 offset:33984
v_mfma_f32_16x16x32_bf16 v[232:235], v[24:27], a[24:27], v[232:235]
v_mfma_f32_16x16x32_bf16 v[236:239], v[28:31], a[24:27], v[236:239]
s_waitcnt lgkmcnt(7)
v_mfma_f32_16x16x32_bf16 v[240:243], v[16:19], a[28:31], v[240:243]
v_mfma_f32_16x16x32_bf16 v[244:247], v[20:23], a[28:31], v[244:247]
ds_read_b128 a[60:63], v9 offset:50624
v_mfma_f32_16x16x32_bf16 v[248:251], v[24:27], a[28:31], v[248:251]
v_mfma_f32_16x16x32_bf16 v[252:255], v[28:31], a[28:31], v[252:255]
s_waitcnt vmcnt(15) lgkmcnt(7)
v_mfma_f32_16x16x32_bf16 v[128:131], v[32:35], a[32:35], v[128:131]
s_waitcnt vmcnt(14)
v_mfma_f32_16x16x32_bf16 v[132:135], v[36:39], a[32:35], v[132:135]
ds_read_b128 a[0:3], v8 offset:768
s_waitcnt vmcnt(13)
v_mfma_f32_16x16x32_bf16 v[136:139], v[40:43], a[32:35], v[136:139]
s_waitcnt vmcnt(12)
v_mfma_f32_16x16x32_bf16 v[140:143], v[44:47], a[32:35], v[140:143]
s_add_u32 s38, s34, 15360
buffer_load_dwordx4 v[16:19], v1, s[8:11], s38 offen
s_waitcnt lgkmcnt(7)
v_mfma_f32_16x16x32_bf16 v[144:147], v[32:35], a[36:39], v[144:147]
v_mfma_f32_16x16x32_bf16 v[148:151], v[36:39], a[36:39], v[148:151]
ds_read_b128 a[4:7], v8 offset:17408
v_mfma_f32_16x16x32_bf16 v[152:155], v[40:43], a[36:39], v[152:155]
v_mfma_f32_16x16x32_bf16 v[156:159], v[44:47], a[36:39], v[156:159]
s_add_u32 s38, s34, 48128
buffer_load_dwordx4 v[20:23], v1, s[8:11], s38 offen
s_waitcnt lgkmcnt(7)
v_mfma_f32_16x16x32_bf16 v[160:163], v[32:35], a[40:43], v[160:163]
v_mfma_f32_16x16x32_bf16 v[164:167], v[36:39], a[40:43], v[164:167]
ds_read_b128 a[8:11], v8 offset:34048
v_mfma_f32_16x16x32_bf16 v[168:171], v[40:43], a[40:43], v[168:171]
v_mfma_f32_16x16x32_bf16 v[172:175], v[44:47], a[40:43], v[172:175]
s_add_u32 s38, s34, 80896
buffer_load_dwordx4 v[24:27], v1, s[8:11], s38 offen
s_waitcnt lgkmcnt(7)
v_mfma_f32_16x16x32_bf16 v[176:179], v[32:35], a[44:47], v[176:179]
v_mfma_f32_16x16x32_bf16 v[180:183], v[36:39], a[44:47], v[180:183]
ds_read_b128 a[12:15], v8 offset:50688
v_mfma_f32_16x16x32_bf16 v[184:187], v[40:43], a[44:47], v[184:187]
v_mfma_f32_16x16x32_bf16 v[188:191], v[44:47], a[44:47], v[188:191]
s_add_u32 s38, s34, 113664
buffer_load_dwordx4 v[28:31], v1, s[8:11], s38 offen
s_waitcnt lgkmcnt(7)
v_mfma_f32_16x16x32_bf16 v[192:195], v[32:35], a[48:51], v[192:195]
v_mfma_f32_16x16x32_bf16 v[196:199], v[36:39], a[48:51], v[196:199]
ds_read_b128 a[16:19], v9 offset:768
v_mfma_f32_16x16x32_bf16 v[200:203], v[40:43], a[48:51], v[200:203]
v_mfma_f32_16x16x32_bf16 v[204:207], v[44:47], a[48:51], v[204:207]
s_waitcnt lgkmcnt(7)
v_mfma_f32_16x16x32_bf16 v[208:211], v[32:35], a[52:55], v[208:211]
v_mfma_f32_16x16x32_bf16 v[212:215], v[36:39], a[52:55], v[212:215]
ds_read_b128 a[20:23], v9 offset:17408
v_mfma_f32_16x16x32_bf16 v[216:219], v[40:43], a[52:55], v[216:219]
v_mfma_f32_16x16x32_bf16 v[220:223], v[44:47], a[52:55], v[220:223]
s_waitcnt lgkmcnt(7)
v_mfma_f32_16x16x32_bf16 v[224:227], v[32:35], a[56:59], v[224:227]
v_mfma_f32_16x16x32_bf16 v[228:231], v[36:39], a[56:59], v[228:231]
ds_read_b128 a[24:27], v9 offset:34048
v_mfma_f32_16x16x32_bf16 v[232:235], v[40:43], a[56:59], v[232:235]
v_mfma_f32_16x16x32_bf16 v[236:239], v[44:47], a[56:59], v[236:239]
s_waitcnt lgkmcnt(7)
v_mfma_f32_16x16x32_bf16 v[240:243], v[32:35], a[60:63], v[240:243]
v_mfma_f32_16x16x32_bf16 v[244:247], v[36:39], a[60:63], v[244:247]
ds_read_b128 a[28:31], v9 offset:50688
v_mfma_f32_16x16x32_bf16 v[248:251], v[40:43], a[60:63], v[248:251]
v_mfma_f32_16x16x32_bf16 v[252:255], v[44:47], a[60:63], v[252:255]
s_waitcnt vmcnt(15) lgkmcnt(7)
v_mfma_f32_16x16x32_bf16 v[128:131], v[48:51], a[0:3], v[128:131]
s_waitcnt vmcnt(14)
v_mfma_f32_16x16x32_bf16 v[132:135], v[52:55], a[0:3], v[132:135]
ds_read_b128 a[32:35], v8 offset:832
s_waitcnt vmcnt(13)
v_mfma_f32_16x16x32_bf16 v[136:139], v[56:59], a[0:3], v[136:139]
s_waitcnt vmcnt(12)
v_mfma_f32_16x16x32_bf16 v[140:143], v[60:63], a[0:3], v[140:143]
s_waitcnt lgkmcnt(7)
v_mfma_f32_16x16x32_bf16 v[144:147], v[48:51], a[4:7], v[144:147]
v_mfma_f32_16x16x32_bf16 v[148:151], v[52:55], a[4:7], v[148:151]
ds_read_b128 a[36:39], v8 offset:17472
v_mfma_f32_16x16x32_bf16 v[152:155], v[56:59], a[4:7], v[152:155]
v_mfma_f32_16x16x32_bf16 v[156:159], v[60:63], a[4:7], v[156:159]
s_waitcnt lgkmcnt(7)
v_mfma_f32_16x16x32_bf16 v[160:163], v[48:51], a[8:11], v[160:163]
v_mfma_f32_16x16x32_bf16 v[164:167], v[52:55], a[8:11], v[164:167]
ds_read_b128 a[40:43], v8 offset:34112
v_mfma_f32_16x16x32_bf16 v[168:171], v[56:59], a[8:11], v[168:171]
v_mfma_f32_16x16x32_bf16 v[172:175], v[60:63], a[8:11], v[172:175]
s_waitcnt lgkmcnt(7)
v_mfma_f32_16x16x32_bf16 v[176:179], v[48:51], a[12:15], v[176:179]
v_mfma_f32_16x16x32_bf16 v[180:183], v[52:55], a[12:15], v[180:183]
ds_read_b128 a[44:47], v8 offset:50752
v_mfma_f32_16x16x32_bf16 v[184:187], v[56:59], a[12:15], v[184:187]
v_mfma_f32_16x16x32_bf16 v[188:191], v[60:63], a[12:15], v[188:191]
s_waitcnt lgkmcnt(7)
v_mfma_f32_16x16x32_bf16 v[192:195], v[48:51], a[16:19], v[192:195]
v_mfma_f32_16x16x32_bf16 v[196:199], v[52:55], a[16:19], v[196:199]
ds_read_b128 a[48:51], v9 offset:832
v_mfma_f32_16x16x32_bf16 v[200:203], v[56:59], a[16:19], v[200:203]
v_mfma_f32_16x16x32_bf16 v[204:207], v[60:63], a[16:19], v[204:207]
s_waitcnt lgkmcnt(7)
v_mfma_f32_16x16x32_bf16 v[208:211], v[48:51], a[20:23], v[208:211]
v_mfma_f32_16x16x32_bf16 v[212:215], v[52:55], a[20:23], v[212:215]
ds_read_b128 a[52:55], v9 offset:17472
v_mfma_f32_16x16x32_bf16 v[216:219], v[56:59], a[20:23], v[216:219]
v_mfma_f32_16x16x32_bf16 v[220:223], v[60:63], a[20:23], v[220:223]
s_waitcnt lgkmcnt(7)
v_mfma_f32_16x16x32_bf16 v[224:227], v[48:51], a[24:27], v[224:227]
v_mfma_f32_16x16x32_bf16 v[228:231], v[52:55], a[24:27], v[228:231]
ds_read_b128 a[56:59], v9 offset:34112
v_mfma_f32_16x16x32_bf16 v[232:235], v[56:59], a[24:27], v[232:235]
v_mfma_f32_16x16x32_bf16 v[236:239], v[60:63], a[24:27], v[236:239]
s_waitcnt lgkmcnt(7)
v_mfma_f32_16x16x32_bf16 v[240:243], v[48:51], a[28:31], v[240:243]
v_mfma_f32_16x16x32_bf16 v[244:247], v[52:55], a[28:31], v[244:247]
ds_read_b128 a[60:63], v9 offset:50752
v_mfma_f32_16x16x32_bf16 v[248:251], v[56:59], a[28:31], v[248:251]
v_mfma_f32_16x16x32_bf16 v[252:255], v[60:63], a[28:31], v[252:255]
s_waitcnt vmcnt(11) lgkmcnt(7)
v_mfma_f32_16x16x32_bf16 v[128:131], v[64:67], a[32:35], v[128:131]
s_waitcnt vmcnt(10)
v_mfma_f32_16x16x32_bf16 v[132:135], v[68:71], a[32:35], v[132:135]
ds_read_b128 a[0:3], v8 offset:896
s_waitcnt vmcnt(9)
v_mfma_f32_16x16x32_bf16 v[136:139], v[72:75], a[32:35], v[136:139]
s_waitcnt vmcnt(8)
v_mfma_f32_16x16x32_bf16 v[140:143], v[76:79], a[32:35], v[140:143]
s_waitcnt lgkmcnt(7)
v_mfma_f32_16x16x32_bf16 v[144:147], v[64:67], a[36:39], v[144:147]
v_mfma_f32_16x16x32_bf16 v[148:151], v[68:71], a[36:39], v[148:151]
ds_read_b128 a[4:7], v8 offset:17536
v_mfma_f32_16x16x32_bf16 v[152:155], v[72:75], a[36:39], v[152:155]
v_mfma_f32_16x16x32_bf16 v[156:159], v[76:79], a[36:39], v[156:159]
s_waitcnt lgkmcnt(7)
v_mfma_f32_16x16x32_bf16 v[160:163], v[64:67], a[40:43], v[160:163]
v_mfma_f32_16x16x32_bf16 v[164:167], v[68:71], a[40:43], v[164:167]
ds_read_b128 a[8:11], v8 offset:34176
v_mfma_f32_16x16x32_bf16 v[168:171], v[72:75], a[40:43], v[168:171]
v_mfma_f32_16x16x32_bf16 v[172:175], v[76:79], a[40:43], v[172:175]
s_waitcnt lgkmcnt(7)
v_mfma_f32_16x16x32_bf16 v[176:179], v[64:67], a[44:47], v[176:179]
v_mfma_f32_16x16x32_bf16 v[180:183], v[68:71], a[44:47], v[180:183]
ds_read_b128 a[12:15], v8 offset:50816
v_mfma_f32_16x16x32_bf16 v[184:187], v[72:75], a[44:47], v[184:187]
v_mfma_f32_16x16x32_bf16 v[188:191], v[76:79], a[44:47], v[188:191]
s_waitcnt lgkmcnt(7)
v_mfma_f32_16x16x32_bf16 v[192:195], v[64:67], a[48:51], v[192:195]
v_mfma_f32_16x16x32_bf16 v[196:199], v[68:71], a[48:51], v[196:199]
ds_read_b128 a[16:19], v9 offset:896
v_mfma_f32_16x16x32_bf16 v[200:203], v[72:75], a[48:51], v[200:203]
v_mfma_f32_16x16x32_bf16 v[204:207], v[76:79], a[48:51], v[204:207]
s_waitcnt lgkmcnt(7)
v_mfma_f32_16x16x32_bf16 v[208:211], v[64:67], a[52:55], v[208:211]
v_mfma_f32_16x16x32_bf16 v[212:215], v[68:71], a[52:55], v[212:215]
ds_read_b128 a[20:23], v9 offset:17536
v_mfma_f32_16x16x32_bf16 v[216:219], v[72:75], a[52:55], v[216:219]
v_mfma_f32_16x16x32_bf16 v[220:223], v[76:79], a[52:55], v[220:223]
s_waitcnt lgkmcnt(7)
v_mfma_f32_16x16x32_bf16 v[224:227], v[64:67], a[56:59], v[224:227]
v_mfma_f32_16x16x32_bf16 v[228:231], v[68:71], a[56:59], v[228:231]
ds_read_b128 a[24:27], v9 offset:34176
v_mfma_f32_16x16x32_bf16 v[232:235], v[72:75], a[56:59], v[232:235]
v_mfma_f32_16x16x32_bf16 v[236:239], v[76:79], a[56:59], v[236:239]
s_waitcnt lgkmcnt(7)
v_mfma_f32_16x16x32_bf16 v[240:243], v[64:67], a[60:63], v[240:243]
v_mfma_f32_16x16x32_bf16 v[244:247], v[68:71], a[60:63], v[244:247]
ds_read_b128 a[28:31], v9 offset:50816
v_mfma_f32_16x16x32_bf16 v[248:251], v[72:75], a[60:63], v[248:251]
v_mfma_f32_16x16x32_bf16 v[252:255], v[76:79], a[60:63], v[252:255]
s_waitcnt vmcnt(7) lgkmcnt(7)
v_mfma_f32_16x16x32_bf16 v[128:131], v[80:83], a[0:3], v[128:131]
s_waitcnt vmcnt(6)
v_mfma_f32_16x16x32_bf16 v[132:135], v[84:87], a[0:3], v[132:135]
ds_read_b128 a[32:35], v8 offset:960
s_waitcnt vmcnt(5)
v_mfma_f32_16x16x32_bf16 v[136:139], v[88:91], a[0:3], v[136:139]
s_waitcnt vmcnt(4)
v_mfma_f32_16x16x32_bf16 v[140:143], v[92:95], a[0:3], v[140:143]
s_waitcnt lgkmcnt(7)
v_mfma_f32_16x16x32_bf16 v[144:147], v[80:83], a[4:7], v[144:147]
v_mfma_f32_16x16x32_bf16 v[148:151], v[84:87], a[4:7], v[148:151]
ds_read_b128 a[36:39], v8 offset:17600
v_mfma_f32_16x16x32_bf16 v[152:155], v[88:91], a[4:7], v[152:155]
v_mfma_f32_16x16x32_bf16 v[156:159], v[92:95], a[4:7], v[156:159]
s_waitcnt lgkmcnt(7)
v_mfma_f32_16x16x32_bf16 v[160:163], v[80:83], a[8:11], v[160:163]
v_mfma_f32_16x16x32_bf16 v[164:167], v[84:87], a[8:11], v[164:167]
ds_read_b128 a[40:43], v8 offset:34240
v_mfma_f32_16x16x32_bf16 v[168:171], v[88:91], a[8:11], v[168:171]
v_mfma_f32_16x16x32_bf16 v[172:175], v[92:95], a[8:11], v[172:175]
s_waitcnt lgkmcnt(7)
v_mfma_f32_16x16x32_bf16 v[176:179], v[80:83], a[12:15], v[176:179]
v_mfma_f32_16x16x32_bf16 v[180:183], v[84:87], a[12:15], v[180:183]
ds_read_b128 a[44:47], v8 offset:50880
v_mfma_f32_16x16x32_bf16 v[184:187], v[88:91], a[12:15], v[184:187]
v_mfma_f32_16x16x32_bf16 v[188:191], v[92:95], a[12:15], v[188:191]
s_waitcnt lgkmcnt(7)
v_mfma_f32_16x16x32_bf16 v[192:195], v[80:83], a[16:19], v[192:195]
v_mfma_f32_16x16x32_bf16 v[196:199], v[84:87], a[16:19], v[196:199]
ds_read_b128 a[48:51], v9 offset:960
v_mfma_f32_16x16x32_bf16 v[200:203], v[88:91], a[16:19], v[200:203]
v_mfma_f32_16x16x32_bf16 v[204:207], v[92:95], a[16:19], v[204:207]
s_waitcnt lgkmcnt(7)
v_mfma_f32_16x16x32_bf16 v[208:211], v[80:83], a[20:23], v[208:211]
v_mfma_f32_16x16x32_bf16 v[212:215], v[84:87], a[20:23], v[212:215]
ds_read_b128 a[52:55], v9 offset:17600
v_mfma_f32_16x16x32_bf16 v[216:219], v[88:91], a[20:23], v[216:219]
v_mfma_f32_16x16x32_bf16 v[220:223], v[92:95], a[20:23], v[220:223]
s_waitcnt lgkmcnt(7)
v_mfma_f32_16x16x32_bf16 v[224:227], v[80:83], a[24:27], v[224:227]
v_mfma_f32_16x16x32_bf16 v[228:231], v[84:87], a[24:27], v[228:231]
ds_read_b128 a[56:59], v9 offset:34240
v_mfma_f32_16x16x32_bf16 v[232:235], v[88:91], a[24:27], v[232:235]
v_mfma_f32_16x16x32_bf16 v[236:239], v[92:95], a[24:27], v[236:239]
s_waitcnt lgkmcnt(7)
v_mfma_f32_16x16x32_bf16 v[240:243], v[80:83], a[28:31], v[240:243]
v_mfma_f32_16x16x32_bf16 v[244:247], v[84:87], a[28:31], v[244:247]
ds_read_b128 a[60:63], v9 offset:50880
v_mfma_f32_16x16x32_bf16 v[248:251], v[88:91], a[28:31], v[248:251]
v_mfma_f32_16x16x32_bf16 v[252:255], v[92:95], a[28:31], v[252:255]
s_waitcnt vmcnt(3) lgkmcnt(7)
v_mfma_f32_16x16x32_bf16 v[128:131], v[16:19], a[32:35], v[128:131]
s_waitcnt vmcnt(2)
v_mfma_f32_16x16x32_bf16 v[132:135], v[20:23], a[32:35], v[132:135]
s_waitcnt vmcnt(1)
v_mfma_f32_16x16x32_bf16 v[136:139], v[24:27], a[32:35], v[136:139]
s_waitcnt vmcnt(0)
v_mfma_f32_16x16x32_bf16 v[140:143], v[28:31], a[32:35], v[140:143]
s_waitcnt lgkmcnt(6)
v_mfma_f32_16x16x32_bf16 v[144:147], v[16:19], a[36:39], v[144:147]
v_mfma_f32_16x16x32_bf16 v[148:151], v[20:23], a[36:39], v[148:151]
v_mfma_f32_16x16x32_bf16 v[152:155], v[24:27], a[36:39], v[152:155]
v_mfma_f32_16x16x32_bf16 v[156:159], v[28:31], a[36:39], v[156:159]
s_waitcnt lgkmcnt(5)
v_mfma_f32_16x16x32_bf16 v[160:163], v[16:19], a[40:43], v[160:163]
v_mfma_f32_16x16x32_bf16 v[164:167], v[20:23], a[40:43], v[164:167]
v_mfma_f32_16x16x32_bf16 v[168:171], v[24:27], a[40:43], v[168:171]
v_mfma_f32_16x16x32_bf16 v[172:175], v[28:31], a[40:43], v[172:175]
s_waitcnt lgkmcnt(4)
v_mfma_f32_16x16x32_bf16 v[176:179], v[16:19], a[44:47], v[176:179]
v_mfma_f32_16x16x32_bf16 v[180:183], v[20:23], a[44:47], v[180:183]
v_mfma_f32_16x16x32_bf16 v[184:187], v[24:27], a[44:47], v[184:187]
v_mfma_f32_16x16x32_bf16 v[188:191], v[28:31], a[44:47], v[188:191]
s_waitcnt lgkmcnt(3)
v_mfma_f32_16x16x32_bf16 v[192:195], v[16:19], a[48:51], v[192:195]
v_mfma_f32_16x16x32_bf16 v[196:199], v[20:23], a[48:51], v[196:199]
v_mfma_f32_16x16x32_bf16 v[200:203], v[24:27], a[48:51], v[200:203]
v_mfma_f32_16x16x32_bf16 v[204:207], v[28:31], a[48:51], v[204:207]
s_waitcnt lgkmcnt(2)
v_mfma_f32_16x16x32_bf16 v[208:211], v[16:19], a[52:55], v[208:211]
v_mfma_f32_16x16x32_bf16 v[212:215], v[20:23], a[52:55], v[212:215]
v_mfma_f32_16x16x32_bf16 v[216:219], v[24:27], a[52:55], v[216:219]
v_mfma_f32_16x16x32_bf16 v[220:223], v[28:31], a[52:55], v[220:223]
s_waitcnt lgkmcnt(1)
v_mfma_f32_16x16x32_bf16 v[224:227], v[16:19], a[56:59], v[224:227]
v_mfma_f32_16x16x32_bf16 v[228:231], v[20:23], a[56:59], v[228:231]
v_mfma_f32_16x16x32_bf16 v[232:235], v[24:27], a[56:59], v[232:235]
v_mfma_f32_16x16x32_bf16 v[236:239], v[28:31], a[56:59], v[236:239]
s_waitcnt lgkmcnt(0)
v_mfma_f32_16x16x32_bf16 v[240:243], v[16:19], a[60:63], v[240:243]
v_mfma_f32_16x16x32_bf16 v[244:247], v[20:23], a[60:63], v[244:247]
v_mfma_f32_16x16x32_bf16 v[248:251], v[24:27], a[60:63], v[248:251]
v_mfma_f32_16x16x32_bf16 v[252:255], v[28:31], a[60:63], v[252:255]
s_waitcnt vmcnt(0) lgkmcnt(0)
s_lshl_b32 s42, s32, 7
s_barrier
s_lshl_b32 s38, s17, 5
s_add_u32 s39, s38, s42
s_mul_i32 s39, s39, 2048
s_add_u32 s39, s39, 1024
s_mul_i32 s38, s38, 1040
s_add_u32 m0, s38, 0
s_add_u32 s40, s39, 0
buffer_load_dwordx4 v1, s[12:15], s40 offen lds
s_add_u32 m0, s38, 1040
s_add_u32 s40, s39, 2048
buffer_load_dwordx4 v1, s[12:15], s40 offen lds
s_add_u32 m0, s38, 2080
s_add_u32 s40, s39, 4096
buffer_load_dwordx4 v1, s[12:15], s40 offen lds
s_add_u32 m0, s38, 3120
s_add_u32 s40, s39, 6144
buffer_load_dwordx4 v1, s[12:15], s40 offen lds
s_add_u32 m0, s38, 4160
s_add_u32 s40, s39, 8192
buffer_load_dwordx4 v1, s[12:15], s40 offen lds
s_add_u32 m0, s38, 5200
s_add_u32 s40, s39, 10240
buffer_load_dwordx4 v1, s[12:15], s40 offen lds
s_add_u32 m0, s38, 6240
s_add_u32 s40, s39, 12288
buffer_load_dwordx4 v1, s[12:15], s40 offen lds
s_add_u32 m0, s38, 7280
s_add_u32 s40, s39, 14336
buffer_load_dwordx4 v1, s[12:15], s40 offen lds
s_add_u32 m0, s38, 8320
s_add_u32 s40, s39, 16384
buffer_load_dwordx4 v1, s[12:15], s40 offen lds
s_add_u32 m0, s38, 9360
s_add_u32 s40, s39, 18432
buffer_load_dwordx4 v1, s[12:15], s40 offen lds
s_add_u32 m0, s38, 10400
s_add_u32 s40, s39, 20480
buffer_load_dwordx4 v1, s[12:15], s40 offen lds
s_add_u32 m0, s38, 11440
s_add_u32 s40, s39, 22528
buffer_load_dwordx4 v1, s[12:15], s40 offen lds
s_add_u32 m0, s38, 12480
s_add_u32 s40, s39, 24576
buffer_load_dwordx4 v1, s[12:15], s40 offen lds
s_add_u32 m0, s38, 13520
s_add_u32 s40, s39, 26624
buffer_load_dwordx4 v1, s[12:15], s40 offen lds
s_add_u32 m0, s38, 14560
s_add_u32 s40, s39, 28672
buffer_load_dwordx4 v1, s[12:15], s40 offen lds
s_add_u32 m0, s38, 15600
s_add_u32 s40, s39, 30720
buffer_load_dwordx4 v1, s[12:15], s40 offen lds
s_add_u32 m0, s38, 16640
s_add_u32 s40, s39, 32768
buffer_load_dwordx4 v1, s[12:15], s40 offen lds
s_add_u32 m0, s38, 17680
s_add_u32 s40, s39, 34816
buffer_load_dwordx4 v1, s[12:15], s40 offen lds
s_add_u32 m0, s38, 18720
s_add_u32 s40, s39, 36864
buffer_load_dwordx4 v1, s[12:15], s40 offen lds
s_add_u32 m0, s38, 19760
s_add_u32 s40, s39, 38912
buffer_load_dwordx4 v1, s[12:15], s40 offen lds
s_add_u32 m0, s38, 20800
s_add_u32 s40, s39, 40960
buffer_load_dwordx4 v1, s[12:15], s40 offen lds
s_add_u32 m0, s38, 21840
s_add_u32 s40, s39, 43008
buffer_load_dwordx4 v1, s[12:15], s40 offen lds
s_add_u32 m0, s38, 22880
s_add_u32 s40, s39, 45056
buffer_load_dwordx4 v1, s[12:15], s40 offen lds
s_add_u32 m0, s38, 23920
s_add_u32 s40, s39, 47104
buffer_load_dwordx4 v1, s[12:15], s40 offen lds
s_add_u32 m0, s38, 24960
s_add_u32 s40, s39, 49152
buffer_load_dwordx4 v1, s[12:15], s40 offen lds
s_add_u32 m0, s38, 26000
s_add_u32 s40, s39, 51200
buffer_load_dwordx4 v1, s[12:15], s40 offen lds
s_add_u32 m0, s38, 27040
s_add_u32 s40, s39, 53248
buffer_load_dwordx4 v1, s[12:15], s40 offen lds
s_add_u32 m0, s38, 28080
s_add_u32 s40, s39, 55296
buffer_load_dwordx4 v1, s[12:15], s40 offen lds
s_add_u32 m0, s38, 29120
s_add_u32 s40, s39, 57344
buffer_load_dwordx4 v1, s[12:15], s40 offen lds
s_add_u32 m0, s38, 30160
s_add_u32 s40, s39, 59392
buffer_load_dwordx4 v1, s[12:15], s40 offen lds
s_add_u32 m0, s38, 31200
s_add_u32 s40, s39, 61440
buffer_load_dwordx4 v1, s[12:15], s40 offen lds
s_add_u32 m0, s38, 32240
s_add_u32 s40, s39, 63488
buffer_load_dwordx4 v1, s[12:15], s40 offen lds
v_lshrrev_b32 v4, 4, v1
v_and_b32 v5, 15, v4
v_mul_u32_u24 v8, 1040, v5
v_lshrrev_b32 v4, 4, v4
v_lshl_add_u32 v8, v4, 4, v8
v_add_u32 v9, 66560, v8
s_add_u32 s38, s34, 16384
buffer_load_dwordx4 v[16:19], v1, s[8:11], s38 offen
s_add_u32 s38, s34, 49152
buffer_load_dwordx4 v[20:23], v1, s[8:11], s38 offen
s_add_u32 s38, s34, 81920
buffer_load_dwordx4 v[24:27], v1, s[8:11], s38 offen
s_add_u32 s38, s34, 114688
buffer_load_dwordx4 v[28:31], v1, s[8:11], s38 offen
s_add_u32 s38, s34, 17408
buffer_load_dwordx4 v[32:35], v1, s[8:11], s38 offen
s_add_u32 s38, s34, 50176
buffer_load_dwordx4 v[36:39], v1, s[8:11], s38 offen
s_add_u32 s38, s34, 82944
buffer_load_dwordx4 v[40:43], v1, s[8:11], s38 offen
s_add_u32 s38, s34, 115712
buffer_load_dwordx4 v[44:47], v1, s[8:11], s38 offen
s_add_u32 s38, s34, 18432
buffer_load_dwordx4 v[48:51], v1, s[8:11], s38 offen
s_add_u32 s38, s34, 51200
buffer_load_dwordx4 v[52:55], v1, s[8:11], s38 offen
s_add_u32 s38, s34, 83968
buffer_load_dwordx4 v[56:59], v1, s[8:11], s38 offen
s_add_u32 s38, s34, 116736
buffer_load_dwordx4 v[60:63], v1, s[8:11], s38 offen
s_add_u32 s38, s34, 19456
buffer_load_dwordx4 v[64:67], v1, s[8:11], s38 offen
s_add_u32 s38, s34, 52224
buffer_load_dwordx4 v[68:71], v1, s[8:11], s38 offen
s_add_u32 s38, s34, 84992
buffer_load_dwordx4 v[72:75], v1, s[8:11], s38 offen
s_add_u32 s38, s34, 117760
buffer_load_dwordx4 v[76:79], v1, s[8:11], s38 offen
s_waitcnt vmcnt(0)
s_barrier
ds_read_b128 a[0:3], v8 offset:0
ds_read_b128 a[4:7], v8 offset:16640
ds_read_b128 a[8:11], v8 offset:33280
ds_read_b128 a[12:15], v8 offset:49920
ds_read_b128 a[16:19], v9 offset:0
ds_read_b128 a[20:23], v9 offset:16640
ds_read_b128 a[24:27], v9 offset:33280
ds_read_b128 a[28:31], v9 offset:49920
s_waitcnt lgkmcnt(7)
v_mfma_f32_16x16x32_bf16 v[128:131], v[16:19], a[0:3], v[128:131]
v_mfma_f32_16x16x32_bf16 v[132:135], v[20:23], a[0:3], v[132:135]
ds_read_b128 a[32:35], v8 offset:64
v_mfma_f32_16x16x32_bf16 v[136:139], v[24:27], a[0:3], v[136:139]
v_mfma_f32_16x16x32_bf16 v[140:143], v[28:31], a[0:3], v[140:143]
s_add_u32 s38, s34, 20480
buffer_load_dwordx4 v[80:83], v1, s[8:11], s38 offen
s_waitcnt lgkmcnt(7)
v_mfma_f32_16x16x32_bf16 v[144:147], v[16:19], a[4:7], v[144:147]
v_mfma_f32_16x16x32_bf16 v[148:151], v[20:23], a[4:7], v[148:151]
ds_read_b128 a[36:39], v8 offset:16704
v_mfma_f32_16x16x32_bf16 v[152:155], v[24:27], a[4:7], v[152:155]
v_mfma_f32_16x16x32_bf16 v[156:159], v[28:31], a[4:7], v[156:159]
s_add_u32 s38, s34, 53248
buffer_load_dwordx4 v[84:87], v1, s[8:11], s38 offen
s_waitcnt lgkmcnt(7)
v_mfma_f32_16x16x32_bf16 v[160:163], v[16:19], a[8:11], v[160:163]
v_mfma_f32_16x16x32_bf16 v[164:167], v[20:23], a[8:11], v[164:167]
ds_read_b128 a[40:43], v8 offset:33344
v_mfma_f32_16x16x32_bf16 v[168:171], v[24:27], a[8:11], v[168:171]
v_mfma_f32_16x16x32_bf16 v[172:175], v[28:31], a[8:11], v[172:175]
s_add_u32 s38, s34, 86016
buffer_load_dwordx4 v[88:91], v1, s[8:11], s38 offen
s_waitcnt lgkmcnt(7)
v_mfma_f32_16x16x32_bf16 v[176:179], v[16:19], a[12:15], v[176:179]
v_mfma_f32_16x16x32_bf16 v[180:183], v[20:23], a[12:15], v[180:183]
ds_read_b128 a[44:47], v8 offset:49984
v_mfma_f32_16x16x32_bf16 v[184:187], v[24:27], a[12:15], v[184:187]
v_mfma_f32_16x16x32_bf16 v[188:191], v[28:31], a[12:15], v[188:191]
s_add_u32 s38, s34, 118784
buffer_load_dwordx4 v[92:95], v1, s[8:11], s38 offen
s_waitcnt lgkmcnt(7)
v_mfma_f32_16x16x32_bf16 v[192:195], v[16:19], a[16:19], v[192:195]
v_mfma_f32_16x16x32_bf16 v[196:199], v[20:23], a[16:19], v[196:199]
ds_read_b128 a[48:51], v9 offset:64
v_mfma_f32_16x16x32_bf16 v[200:203], v[24:27], a[16:19], v[200:203]
v_mfma_f32_16x16x32_bf16 v[204:207], v[28:31], a[16:19], v[204:207]
s_waitcnt lgkmcnt(7)
v_mfma_f32_16x16x32_bf16 v[208:211], v[16:19], a[20:23], v[208:211]
v_mfma_f32_16x16x32_bf16 v[212:215], v[20:23], a[20:23], v[212:215]
ds_read_b128 a[52:55], v9 offset:16704
v_mfma_f32_16x16x32_bf16 v[216:219], v[24:27], a[20:23], v[216:219]
v_mfma_f32_16x16x32_bf16 v[220:223], v[28:31], a[20:23], v[220:223]
s_waitcnt lgkmcnt(7)
v_mfma_f32_16x16x32_bf16 v[224:227], v[16:19], a[24:27], v[224:227]
v_mfma_f32_16x16x32_bf16 v[228:231], v[20:23], a[24:27], v[228:231]
ds_read_b128 a[56:59], v9 offset:33344
v_mfma_f32_16x16x32_bf16 v[232:235], v[24:27], a[24:27], v[232:235]
v_mfma_f32_16x16x32_bf16 v[236:239], v[28:31], a[24:27], v[236:239]
s_waitcnt lgkmcnt(7)
v_mfma_f32_16x16x32_bf16 v[240:243], v[16:19], a[28:31], v[240:243]
v_mfma_f32_16x16x32_bf16 v[244:247], v[20:23], a[28:31], v[244:247]
ds_read_b128 a[60:63], v9 offset:49984
v_mfma_f32_16x16x32_bf16 v[248:251], v[24:27], a[28:31], v[248:251]
v_mfma_f32_16x16x32_bf16 v[252:255], v[28:31], a[28:31], v[252:255]
s_waitcnt lgkmcnt(7)
v_mfma_f32_16x16x32_bf16 v[128:131], v[32:35], a[32:35], v[128:131]
v_mfma_f32_16x16x32_bf16 v[132:135], v[36:39], a[32:35], v[132:135]
ds_read_b128 a[0:3], v8 offset:128
v_mfma_f32_16x16x32_bf16 v[136:139], v[40:43], a[32:35], v[136:139]
v_mfma_f32_16x16x32_bf16 v[140:143], v[44:47], a[32:35], v[140:143]
s_add_u32 s38, s34, 21504
buffer_load_dwordx4 v[16:19], v1, s[8:11], s38 offen
s_waitcnt lgkmcnt(7)
v_mfma_f32_16x16x32_bf16 v[144:147], v[32:35], a[36:39], v[144:147]
v_mfma_f32_16x16x32_bf16 v[148:151], v[36:39], a[36:39], v[148:151]
ds_read_b128 a[4:7], v8 offset:16768
v_mfma_f32_16x16x32_bf16 v[152:155], v[40:43], a[36:39], v[152:155]
v_mfma_f32_16x16x32_bf16 v[156:159], v[44:47], a[36:39], v[156:159]
s_add_u32 s38, s34, 54272
buffer_load_dwordx4 v[20:23], v1, s[8:11], s38 offen
s_waitcnt lgkmcnt(7)
v_mfma_f32_16x16x32_bf16 v[160:163], v[32:35], a[40:43], v[160:163]
v_mfma_f32_16x16x32_bf16 v[164:167], v[36:39], a[40:43], v[164:167]
ds_read_b128 a[8:11], v8 offset:33408
v_mfma_f32_16x16x32_bf16 v[168:171], v[40:43], a[40:43], v[168:171]
v_mfma_f32_16x16x32_bf16 v[172:175], v[44:47], a[40:43], v[172:175]
s_add_u32 s38, s34, 87040
buffer_load_dwordx4 v[24:27], v1, s[8:11], s38 offen
s_waitcnt lgkmcnt(7)
v_mfma_f32_16x16x32_bf16 v[176:179], v[32:35], a[44:47], v[176:179]
v_mfma_f32_16x16x32_bf16 v[180:183], v[36:39], a[44:47], v[180:183]
ds_read_b128 a[12:15], v8 offset:50048
v_mfma_f32_16x16x32_bf16 v[184:187], v[40:43], a[44:47], v[184:187]
v_mfma_f32_16x16x32_bf16 v[188:191], v[44:47], a[44:47], v[188:191]
s_add_u32 s38, s34, 119808
buffer_load_dwordx4 v[28:31], v1, s[8:11], s38 offen
s_waitcnt lgkmcnt(7)
v_mfma_f32_16x16x32_bf16 v[192:195], v[32:35], a[48:51], v[192:195]
v_mfma_f32_16x16x32_bf16 v[196:199], v[36:39], a[48:51], v[196:199]
ds_read_b128 a[16:19], v9 offset:128
v_mfma_f32_16x16x32_bf16 v[200:203], v[40:43], a[48:51], v[200:203]
v_mfma_f32_16x16x32_bf16 v[204:207], v[44:47], a[48:51], v[204:207]
s_waitcnt lgkmcnt(7)
v_mfma_f32_16x16x32_bf16 v[208:211], v[32:35], a[52:55], v[208:211]
v_mfma_f32_16x16x32_bf16 v[212:215], v[36:39], a[52:55], v[212:215]
ds_read_b128 a[20:23], v9 offset:16768
v_mfma_f32_16x16x32_bf16 v[216:219], v[40:43], a[52:55], v[216:219]
v_mfma_f32_16x16x32_bf16 v[220:223], v[44:47], a[52:55], v[220:223]
s_waitcnt lgkmcnt(7)
v_mfma_f32_16x16x32_bf16 v[224:227], v[32:35], a[56:59], v[224:227]
v_mfma_f32_16x16x32_bf16 v[228:231], v[36:39], a[56:59], v[228:231]
ds_read_b128 a[24:27], v9 offset:33408
v_mfma_f32_16x16x32_bf16 v[232:235], v[40:43], a[56:59], v[232:235]
v_mfma_f32_16x16x32_bf16 v[236:239], v[44:47], a[56:59], v[236:239]
s_waitcnt lgkmcnt(7)
v_mfma_f32_16x16x32_bf16 v[240:243], v[32:35], a[60:63], v[240:243]
v_mfma_f32_16x16x32_bf16 v[244:247], v[36:39], a[60:63], v[244:247]
ds_read_b128 a[28:31], v9 offset:50048
v_mfma_f32_16x16x32_bf16 v[248:251], v[40:43], a[60:63], v[248:251]
v_mfma_f32_16x16x32_bf16 v[252:255], v[44:47], a[60:63], v[252:255]
s_waitcnt lgkmcnt(7)
v_mfma_f32_16x16x32_bf16 v[128:131], v[48:51], a[0:3], v[128:131]
v_mfma_f32_16x16x32_bf16 v[132:135], v[52:55], a[0:3], v[132:135]
ds_read_b128 a[32:35], v8 offset:192
v_mfma_f32_16x16x32_bf16 v[136:139], v[56:59], a[0:3], v[136:139]
v_mfma_f32_16x16x32_bf16 v[140:143], v[60:63], a[0:3], v[140:143]
s_add_u32 s38, s34, 22528
buffer_load_dwordx4 v[32:35], v1, s[8:11], s38 offen
s_waitcnt lgkmcnt(7)
v_mfma_f32_16x16x32_bf16 v[144:147], v[48:51], a[4:7], v[144:147]
v_mfma_f32_16x16x32_bf16 v[148:151], v[52:55], a[4:7], v[148:151]
ds_read_b128 a[36:39], v8 offset:16832
v_mfma_f32_16x16x32_bf16 v[152:155], v[56:59], a[4:7], v[152:155]
v_mfma_f32_16x16x32_bf16 v[156:159], v[60:63], a[4:7], v[156:159]
s_add_u32 s38, s34, 55296
buffer_load_dwordx4 v[36:39], v1, s[8:11], s38 offen
s_waitcnt lgkmcnt(7)
v_mfma_f32_16x16x32_bf16 v[160:163], v[48:51], a[8:11], v[160:163]
v_mfma_f32_16x16x32_bf16 v[164:167], v[52:55], a[8:11], v[164:167]
ds_read_b128 a[40:43], v8 offset:33472
v_mfma_f32_16x16x32_bf16 v[168:171], v[56:59], a[8:11], v[168:171]
v_mfma_f32_16x16x32_bf16 v[172:175], v[60:63], a[8:11], v[172:175]
s_add_u32 s38, s34, 88064
buffer_load_dwordx4 v[40:43], v1, s[8:11], s38 offen
s_waitcnt lgkmcnt(7)
v_mfma_f32_16x16x32_bf16 v[176:179], v[48:51], a[12:15], v[176:179]
v_mfma_f32_16x16x32_bf16 v[180:183], v[52:55], a[12:15], v[180:183]
ds_read_b128 a[44:47], v8 offset:50112
v_mfma_f32_16x16x32_bf16 v[184:187], v[56:59], a[12:15], v[184:187]
v_mfma_f32_16x16x32_bf16 v[188:191], v[60:63], a[12:15], v[188:191]
s_add_u32 s38, s34, 120832
buffer_load_dwordx4 v[44:47], v1, s[8:11], s38 offen
s_waitcnt lgkmcnt(7)
v_mfma_f32_16x16x32_bf16 v[192:195], v[48:51], a[16:19], v[192:195]
v_mfma_f32_16x16x32_bf16 v[196:199], v[52:55], a[16:19], v[196:199]
ds_read_b128 a[48:51], v9 offset:192
v_mfma_f32_16x16x32_bf16 v[200:203], v[56:59], a[16:19], v[200:203]
v_mfma_f32_16x16x32_bf16 v[204:207], v[60:63], a[16:19], v[204:207]
s_waitcnt lgkmcnt(7)
v_mfma_f32_16x16x32_bf16 v[208:211], v[48:51], a[20:23], v[208:211]
v_mfma_f32_16x16x32_bf16 v[212:215], v[52:55], a[20:23], v[212:215]
ds_read_b128 a[52:55], v9 offset:16832
v_mfma_f32_16x16x32_bf16 v[216:219], v[56:59], a[20:23], v[216:219]
v_mfma_f32_16x16x32_bf16 v[220:223], v[60:63], a[20:23], v[220:223]
s_waitcnt lgkmcnt(7)
v_mfma_f32_16x16x32_bf16 v[224:227], v[48:51], a[24:27], v[224:227]
v_mfma_f32_16x16x32_bf16 v[228:231], v[52:55], a[24:27], v[228:231]
ds_read_b128 a[56:59], v9 offset:33472
v_mfma_f32_16x16x32_bf16 v[232:235], v[56:59], a[24:27], v[232:235]
v_mfma_f32_16x16x32_bf16 v[236:239], v[60:63], a[24:27], v[236:239]
s_waitcnt lgkmcnt(7)
v_mfma_f32_16x16x32_bf16 v[240:243], v[48:51], a[28:31], v[240:243]
v_mfma_f32_16x16x32_bf16 v[244:247], v[52:55], a[28:31], v[244:247]
ds_read_b128 a[60:63], v9 offset:50112
v_mfma_f32_16x16x32_bf16 v[248:251], v[56:59], a[28:31], v[248:251]
v_mfma_f32_16x16x32_bf16 v[252:255], v[60:63], a[28:31], v[252:255]
s_waitcnt lgkmcnt(7)
v_mfma_f32_16x16x32_bf16 v[128:131], v[64:67], a[32:35], v[128:131]
v_mfma_f32_16x16x32_bf16 v[132:135], v[68:71], a[32:35], v[132:135]
ds_read_b128 a[0:3], v8 offset:256
v_mfma_f32_16x16x32_bf16 v[136:139], v[72:75], a[32:35], v[136:139]
v_mfma_f32_16x16x32_bf16 v[140:143], v[76:79], a[32:35], v[140:143]
s_add_u32 s38, s34, 23552
buffer_load_dwordx4 v[48:51], v1, s[8:11], s38 offen
s_waitcnt lgkmcnt(7)
v_mfma_f32_16x16x32_bf16 v[144:147], v[64:67], a[36:39], v[144:147]
v_mfma_f32_16x16x32_bf16 v[148:151], v[68:71], a[36:39], v[148:151]
ds_read_b128 a[4:7], v8 offset:16896
v_mfma_f32_16x16x32_bf16 v[152:155], v[72:75], a[36:39], v[152:155]
v_mfma_f32_16x16x32_bf16 v[156:159], v[76:79], a[36:39], v[156:159]
s_add_u32 s38, s34, 56320
buffer_load_dwordx4 v[52:55], v1, s[8:11], s38 offen
s_waitcnt lgkmcnt(7)
v_mfma_f32_16x16x32_bf16 v[160:163], v[64:67], a[40:43], v[160:163]
v_mfma_f32_16x16x32_bf16 v[164:167], v[68:71], a[40:43], v[164:167]
ds_read_b128 a[8:11], v8 offset:33536
v_mfma_f32_16x16x32_bf16 v[168:171], v[72:75], a[40:43], v[168:171]
v_mfma_f32_16x16x32_bf16 v[172:175], v[76:79], a[40:43], v[172:175]
s_add_u32 s38, s34, 89088
buffer_load_dwordx4 v[56:59], v1, s[8:11], s38 offen
s_waitcnt lgkmcnt(7)
v_mfma_f32_16x16x32_bf16 v[176:179], v[64:67], a[44:47], v[176:179]
v_mfma_f32_16x16x32_bf16 v[180:183], v[68:71], a[44:47], v[180:183]
ds_read_b128 a[12:15], v8 offset:50176
v_mfma_f32_16x16x32_bf16 v[184:187], v[72:75], a[44:47], v[184:187]
v_mfma_f32_16x16x32_bf16 v[188:191], v[76:79], a[44:47], v[188:191]
s_add_u32 s38, s34, 121856
buffer_load_dwordx4 v[60:63], v1, s[8:11], s38 offen
s_waitcnt lgkmcnt(7)
v_mfma_f32_16x16x32_bf16 v[192:195], v[64:67], a[48:51], v[192:195]
v_mfma_f32_16x16x32_bf16 v[196:199], v[68:71], a[48:51], v[196:199]
ds_read_b128 a[16:19], v9 offset:256
v_mfma_f32_16x16x32_bf16 v[200:203], v[72:75], a[48:51], v[200:203]
v_mfma_f32_16x16x32_bf16 v[204:207], v[76:79], a[48:51], v[204:207]
s_waitcnt lgkmcnt(7)
v_mfma_f32_16x16x32_bf16 v[208:211], v[64:67], a[52:55], v[208:211]
v_mfma_f32_16x16x32_bf16 v[212:215], v[68:71], a[52:55], v[212:215]
ds_read_b128 a[20:23], v9 offset:16896
v_mfma_f32_16x16x32_bf16 v[216:219], v[72:75], a[52:55], v[216:219]
v_mfma_f32_16x16x32_bf16 v[220:223], v[76:79], a[52:55], v[220:223]
s_waitcnt lgkmcnt(7)
v_mfma_f32_16x16x32_bf16 v[224:227], v[64:67], a[56:59], v[224:227]
v_mfma_f32_16x16x32_bf16 v[228:231], v[68:71], a[56:59], v[228:231]
ds_read_b128 a[24:27], v9 offset:33536
v_mfma_f32_16x16x32_bf16 v[232:235], v[72:75], a[56:59], v[232:235]
v_mfma_f32_16x16x32_bf16 v[236:239], v[76:79], a[56:59], v[236:239]
s_waitcnt lgkmcnt(7)
v_mfma_f32_16x16x32_bf16 v[240:243], v[64:67], a[60:63], v[240:243]
v_mfma_f32_16x16x32_bf16 v[244:247], v[68:71], a[60:63], v[244:247]
ds_read_b128 a[28:31], v9 offset:50176
v_mfma_f32_16x16x32_bf16 v[248:251], v[72:75], a[60:63], v[248:251]
v_mfma_f32_16x16x32_bf16 v[252:255], v[76:79], a[60:63], v[252:255]
s_waitcnt vmcnt(15) lgkmcnt(7)
v_mfma_f32_16x16x32_bf16 v[128:131], v[80:83], a[0:3], v[128:131]
s_waitcnt vmcnt(14)
v_mfma_f32_16x16x32_bf16 v[132:135], v[84:87], a[0:3], v[132:135]
ds_read_b128 a[32:35], v8 offset:320
s_waitcnt vmcnt(13)
v_mfma_f32_16x16x32_bf16 v[136:139], v[88:91], a[0:3], v[136:139]
s_waitcnt vmcnt(12)
v_mfma_f32_16x16x32_bf16 v[140:143], v[92:95], a[0:3], v[140:143]
s_add_u32 s38, s34, 24576
buffer_load_dwordx4 v[64:67], v1, s[8:11], s38 offen
s_waitcnt lgkmcnt(7)
v_mfma_f32_16x16x32_bf16 v[144:147], v[80:83], a[4:7], v[144:147]
v_mfma_f32_16x16x32_bf16 v[148:151], v[84:87], a[4:7], v[148:151]
ds_read_b128 a[36:39], v8 offset:16960
v_mfma_f32_16x16x32_bf16 v[152:155], v[88:91], a[4:7], v[152:155]
v_mfma_f32_16x16x32_bf16 v[156:159], v[92:95], a[4:7], v[156:159]
s_add_u32 s38, s34, 57344
buffer_load_dwordx4 v[68:71], v1, s[8:11], s38 offen
s_waitcnt lgkmcnt(7)
v_mfma_f32_16x16x32_bf16 v[160:163], v[80:83], a[8:11], v[160:163]
v_mfma_f32_16x16x32_bf16 v[164:167], v[84:87], a[8:11], v[164:167]
ds_read_b128 a[40:43], v8 offset:33600
v_mfma_f32_16x16x32_bf16 v[168:171], v[88:91], a[8:11], v[168:171]
v_mfma_f32_16x16x32_bf16 v[172:175], v[92:95], a[8:11], v[172:175]
s_add_u32 s38, s34, 90112
buffer_load_dwordx4 v[72:75], v1, s[8:11], s38 offen
s_waitcnt lgkmcnt(7)
v_mfma_f32_16x16x32_bf16 v[176:179], v[80:83], a[12:15], v[176:179]
v_mfma_f32_16x16x32_bf16 v[180:183], v[84:87], a[12:15], v[180:183]
ds_read_b128 a[44:47], v8 offset:50240
v_mfma_f32_16x16x32_bf16 v[184:187], v[88:91], a[12:15], v[184:187]
v_mfma_f32_16x16x32_bf16 v[188:191], v[92:95], a[12:15], v[188:191]
s_add_u32 s38, s34, 122880
buffer_load_dwordx4 v[76:79], v1, s[8:11], s38 offen
s_waitcnt lgkmcnt(7)
v_mfma_f32_16x16x32_bf16 v[192:195], v[80:83], a[16:19], v[192:195]
v_mfma_f32_16x16x32_bf16 v[196:199], v[84:87], a[16:19], v[196:199]
ds_read_b128 a[48:51], v9 offset:320
v_mfma_f32_16x16x32_bf16 v[200:203], v[88:91], a[16:19], v[200:203]
v_mfma_f32_16x16x32_bf16 v[204:207], v[92:95], a[16:19], v[204:207]
s_waitcnt lgkmcnt(7)
v_mfma_f32_16x16x32_bf16 v[208:211], v[80:83], a[20:23], v[208:211]
v_mfma_f32_16x16x32_bf16 v[212:215], v[84:87], a[20:23], v[212:215]
ds_read_b128 a[52:55], v9 offset:16960
v_mfma_f32_16x16x32_bf16 v[216:219], v[88:91], a[20:23], v[216:219]
v_mfma_f32_16x16x32_bf16 v[220:223], v[92:95], a[20:23], v[220:223]
s_waitcnt lgkmcnt(7)
v_mfma_f32_16x16x32_bf16 v[224:227], v[80:83], a[24:27], v[224:227]
v_mfma_f32_16x16x32_bf16 v[228:231], v[84:87], a[24:27], v[228:231]
ds_read_b128 a[56:59], v9 offset:33600
v_mfma_f32_16x16x32_bf16 v[232:235], v[88:91], a[24:27], v[232:235]
v_mfma_f32_16x16x32_bf16 v[236:239], v[92:95], a[24:27], v[236:239]
s_waitcnt lgkmcnt(7)
v_mfma_f32_16x16x32_bf16 v[240:243], v[80:83], a[28:31], v[240:243]
v_mfma_f32_16x16x32_bf16 v[244:247], v[84:87], a[28:31], v[244:247]
ds_read_b128 a[60:63], v9 offset:50240
v_mfma_f32_16x16x32_bf16 v[248:251], v[88:91], a[28:31], v[248:251]
v_mfma_f32_16x16x32_bf16 v[252:255], v[92:95], a[28:31], v[252:255]
s_waitcnt vmcnt(15) lgkmcnt(7)
v_mfma_f32_16x16x32_bf16 v[128:131], v[16:19], a[32:35], v[128:131]
s_waitcnt vmcnt(14)
v_mfma_f32_16x16x32_bf16 v[132:135], v[20:23], a[32:35], v[132:135]
ds_read_b128 a[0:3], v8 offset:384
s_waitcnt vmcnt(13)
v_mfma_f32_16x16x32_bf16 v[136:139], v[24:27], a[32:35], v[136:139]
s_waitcnt vmcnt(12)
v_mfma_f32_16x16x32_bf16 v[140:143], v[28:31], a[32:35], v[140:143]
s_add_u32 s38, s34, 25600
buffer_load_dwordx4 v[80:83], v1, s[8:11], s38 offen
s_waitcnt lgkmcnt(7)
v_mfma_f32_16x16x32_bf16 v[144:147], v[16:19], a[36:39], v[144:147]
v_mfma_f32_16x16x32_bf16 v[148:151], v[20:23], a[36:39], v[148:151]
ds_read_b128 a[4:7], v8 offset:17024
v_mfma_f32_16x16x32_bf16 v[152:155], v[24:27], a[36:39], v[152:155]
v_mfma_f32_16x16x32_bf16 v[156:159], v[28:31], a[36:39], v[156:159]
s_add_u32 s38, s34, 58368
buffer_load_dwordx4 v[84:87], v1, s[8:11], s38 offen
s_waitcnt lgkmcnt(7)
v_mfma_f32_16x16x32_bf16 v[160:163], v[16:19], a[40:43], v[160:163]
v_mfma_f32_16x16x32_bf16 v[164:167], v[20:23], a[40:43], v[164:167]
ds_read_b128 a[8:11], v8 offset:33664
v_mfma_f32_16x16x32_bf16 v[168:171], v[24:27], a[40:43], v[168:171]
v_mfma_f32_16x16x32_bf16 v[172:175], v[28:31], a[40:43], v[172:175]
s_add_u32 s38, s34, 91136
buffer_load_dwordx4 v[88:91], v1, s[8:11], s38 offen
s_waitcnt lgkmcnt(7)
v_mfma_f32_16x16x32_bf16 v[176:179], v[16:19], a[44:47], v[176:179]
v_mfma_f32_16x16x32_bf16 v[180:183], v[20:23], a[44:47], v[180:183]
ds_read_b128 a[12:15], v8 offset:50304
v_mfma_f32_16x16x32_bf16 v[184:187], v[24:27], a[44:47], v[184:187]
v_mfma_f32_16x16x32_bf16 v[188:191], v[28:31], a[44:47], v[188:191]
s_add_u32 s38, s34, 123904
buffer_load_dwordx4 v[92:95], v1, s[8:11], s38 offen
s_waitcnt lgkmcnt(7)
v_mfma_f32_16x16x32_bf16 v[192:195], v[16:19], a[48:51], v[192:195]
v_mfma_f32_16x16x32_bf16 v[196:199], v[20:23], a[48:51], v[196:199]
ds_read_b128 a[16:19], v9 offset:384
v_mfma_f32_16x16x32_bf16 v[200:203], v[24:27], a[48:51], v[200:203]
v_mfma_f32_16x16x32_bf16 v[204:207], v[28:31], a[48:51], v[204:207]
s_waitcnt lgkmcnt(7)
v_mfma_f32_16x16x32_bf16 v[208:211], v[16:19], a[52:55], v[208:211]
v_mfma_f32_16x16x32_bf16 v[212:215], v[20:23], a[52:55], v[212:215]
ds_read_b128 a[20:23], v9 offset:17024
v_mfma_f32_16x16x32_bf16 v[216:219], v[24:27], a[52:55], v[216:219]
v_mfma_f32_16x16x32_bf16 v[220:223], v[28:31], a[52:55], v[220:223]
s_waitcnt lgkmcnt(7)
v_mfma_f32_16x16x32_bf16 v[224:227], v[16:19], a[56:59], v[224:227]
v_mfma_f32_16x16x32_bf16 v[228:231], v[20:23], a[56:59], v[228:231]
ds_read_b128 a[24:27], v9 offset:33664
v_mfma_f32_16x16x32_bf16 v[232:235], v[24:27], a[56:59], v[232:235]
v_mfma_f32_16x16x32_bf16 v[236:239], v[28:31], a[56:59], v[236:239]
s_waitcnt lgkmcnt(7)
v_mfma_f32_16x16x32_bf16 v[240:243], v[16:19], a[60:63], v[240:243]
v_mfma_f32_16x16x32_bf16 v[244:247], v[20:23], a[60:63], v[244:247]
ds_read_b128 a[28:31], v9 offset:50304
v_mfma_f32_16x16x32_bf16 v[248:251], v[24:27], a[60:63], v[248:251]
v_mfma_f32_16x16x32_bf16 v[252:255], v[28:31], a[60:63], v[252:255]
s_waitcnt vmcnt(15) lgkmcnt(7)
v_mfma_f32_16x16x32_bf16 v[128:131], v[32:35], a[0:3], v[128:131]
s_waitcnt vmcnt(14)
v_mfma_f32_16x16x32_bf16 v[132:135], v[36:39], a[0:3], v[132:135]
ds_read_b128 a[32:35], v8 offset:448
s_waitcnt vmcnt(13)
v_mfma_f32_16x16x32_bf16 v[136:139], v[40:43], a[0:3], v[136:139]
s_waitcnt vmcnt(12)
v_mfma_f32_16x16x32_bf16 v[140:143], v[44:47], a[0:3], v[140:143]
s_add_u32 s38, s34, 26624
buffer_load_dwordx4 v[16:19], v1, s[8:11], s38 offen
s_waitcnt lgkmcnt(7)
v_mfma_f32_16x16x32_bf16 v[144:147], v[32:35], a[4:7], v[144:147]
v_mfma_f32_16x16x32_bf16 v[148:151], v[36:39], a[4:7], v[148:151]
ds_read_b128 a[36:39], v8 offset:17088
v_mfma_f32_16x16x32_bf16 v[152:155], v[40:43], a[4:7], v[152:155]
v_mfma_f32_16x16x32_bf16 v[156:159], v[44:47], a[4:7], v[156:159]
s_add_u32 s38, s34, 59392
buffer_load_dwordx4 v[20:23], v1, s[8:11], s38 offen
s_waitcnt lgkmcnt(7)
v_mfma_f32_16x16x32_bf16 v[160:163], v[32:35], a[8:11], v[160:163]
v_mfma_f32_16x16x32_bf16 v[164:167], v[36:39], a[8:11], v[164:167]
ds_read_b128 a[40:43], v8 offset:33728
v_mfma_f32_16x16x32_bf16 v[168:171], v[40:43], a[8:11], v[168:171]
v_mfma_f32_16x16x32_bf16 v[172:175], v[44:47], a[8:11], v[172:175]
s_add_u32 s38, s34, 92160
buffer_load_dwordx4 v[24:27], v1, s[8:11], s38 offen
s_waitcnt lgkmcnt(7)
v_mfma_f32_16x16x32_bf16 v[176:179], v[32:35], a[12:15], v[176:179]
v_mfma_f32_16x16x32_bf16 v[180:183], v[36:39], a[12:15], v[180:183]
ds_read_b128 a[44:47], v8 offset:50368
v_mfma_f32_16x16x32_bf16 v[184:187], v[40:43], a[12:15], v[184:187]
v_mfma_f32_16x16x32_bf16 v[188:191], v[44:47], a[12:15], v[188:191]
s_add_u32 s38, s34, 124928
buffer_load_dwordx4 v[28:31], v1, s[8:11], s38 offen
s_waitcnt lgkmcnt(7)
v_mfma_f32_16x16x32_bf16 v[192:195], v[32:35], a[16:19], v[192:195]
v_mfma_f32_16x16x32_bf16 v[196:199], v[36:39], a[16:19], v[196:199]
ds_read_b128 a[48:51], v9 offset:448
v_mfma_f32_16x16x32_bf16 v[200:203], v[40:43], a[16:19], v[200:203]
v_mfma_f32_16x16x32_bf16 v[204:207], v[44:47], a[16:19], v[204:207]
s_waitcnt lgkmcnt(7)
v_mfma_f32_16x16x32_bf16 v[208:211], v[32:35], a[20:23], v[208:211]
v_mfma_f32_16x16x32_bf16 v[212:215], v[36:39], a[20:23], v[212:215]
ds_read_b128 a[52:55], v9 offset:17088
v_mfma_f32_16x16x32_bf16 v[216:219], v[40:43], a[20:23], v[216:219]
v_mfma_f32_16x16x32_bf16 v[220:223], v[44:47], a[20:23], v[220:223]
s_waitcnt lgkmcnt(7)
v_mfma_f32_16x16x32_bf16 v[224:227], v[32:35], a[24:27], v[224:227]
v_mfma_f32_16x16x32_bf16 v[228:231], v[36:39], a[24:27], v[228:231]
ds_read_b128 a[56:59], v9 offset:33728
v_mfma_f32_16x16x32_bf16 v[232:235], v[40:43], a[24:27], v[232:235]
v_mfma_f32_16x16x32_bf16 v[236:239], v[44:47], a[24:27], v[236:239]
s_waitcnt lgkmcnt(7)
v_mfma_f32_16x16x32_bf16 v[240:243], v[32:35], a[28:31], v[240:243]
v_mfma_f32_16x16x32_bf16 v[244:247], v[36:39], a[28:31], v[244:247]
ds_read_b128 a[60:63], v9 offset:50368
v_mfma_f32_16x16x32_bf16 v[248:251], v[40:43], a[28:31], v[248:251]
v_mfma_f32_16x16x32_bf16 v[252:255], v[44:47], a[28:31], v[252:255]
s_waitcnt vmcnt(15) lgkmcnt(7)
v_mfma_f32_16x16x32_bf16 v[128:131], v[48:51], a[32:35], v[128:131]
s_waitcnt vmcnt(14)
v_mfma_f32_16x16x32_bf16 v[132:135], v[52:55], a[32:35], v[132:135]
ds_read_b128 a[0:3], v8 offset:512
s_waitcnt vmcnt(13)
v_mfma_f32_16x16x32_bf16 v[136:139], v[56:59], a[32:35], v[136:139]
s_waitcnt vmcnt(12)
v_mfma_f32_16x16x32_bf16 v[140:143], v[60:63], a[32:35], v[140:143]
s_add_u32 s38, s34, 27648
buffer_load_dwordx4 v[32:35], v1, s[8:11], s38 offen
s_waitcnt lgkmcnt(7)
v_mfma_f32_16x16x32_bf16 v[144:147], v[48:51], a[36:39], v[144:147]
v_mfma_f32_16x16x32_bf16 v[148:151], v[52:55], a[36:39], v[148:151]
ds_read_b128 a[4:7], v8 offset:17152
v_mfma_f32_16x16x32_bf16 v[152:155], v[56:59], a[36:39], v[152:155]
v_mfma_f32_16x16x32_bf16 v[156:159], v[60:63], a[36:39], v[156:159]
s_add_u32 s38, s34, 60416
buffer_load_dwordx4 v[36:39], v1, s[8:11], s38 offen
s_waitcnt lgkmcnt(7)
v_mfma_f32_16x16x32_bf16 v[160:163], v[48:51], a[40:43], v[160:163]
v_mfma_f32_16x16x32_bf16 v[164:167], v[52:55], a[40:43], v[164:167]
ds_read_b128 a[8:11], v8 offset:33792
v_mfma_f32_16x16x32_bf16 v[168:171], v[56:59], a[40:43], v[168:171]
v_mfma_f32_16x16x32_bf16 v[172:175], v[60:63], a[40:43], v[172:175]
s_add_u32 s38, s34, 93184
buffer_load_dwordx4 v[40:43], v1, s[8:11], s38 offen
s_waitcnt lgkmcnt(7)
v_mfma_f32_16x16x32_bf16 v[176:179], v[48:51], a[44:47], v[176:179]
v_mfma_f32_16x16x32_bf16 v[180:183], v[52:55], a[44:47], v[180:183]
ds_read_b128 a[12:15], v8 offset:50432
v_mfma_f32_16x16x32_bf16 v[184:187], v[56:59], a[44:47], v[184:187]
v_mfma_f32_16x16x32_bf16 v[188:191], v[60:63], a[44:47], v[188:191]
s_add_u32 s38, s34, 125952
buffer_load_dwordx4 v[44:47], v1, s[8:11], s38 offen
s_waitcnt lgkmcnt(7)
v_mfma_f32_16x16x32_bf16 v[192:195], v[48:51], a[48:51], v[192:195]
v_mfma_f32_16x16x32_bf16 v[196:199], v[52:55], a[48:51], v[196:199]
ds_read_b128 a[16:19], v9 offset:512
v_mfma_f32_16x16x32_bf16 v[200:203], v[56:59], a[48:51], v[200:203]
v_mfma_f32_16x16x32_bf16 v[204:207], v[60:63], a[48:51], v[204:207]
s_waitcnt lgkmcnt(7)
v_mfma_f32_16x16x32_bf16 v[208:211], v[48:51], a[52:55], v[208:211]
v_mfma_f32_16x16x32_bf16 v[212:215], v[52:55], a[52:55], v[212:215]
ds_read_b128 a[20:23], v9 offset:17152
v_mfma_f32_16x16x32_bf16 v[216:219], v[56:59], a[52:55], v[216:219]
v_mfma_f32_16x16x32_bf16 v[220:223], v[60:63], a[52:55], v[220:223]
s_waitcnt lgkmcnt(7)
v_mfma_f32_16x16x32_bf16 v[224:227], v[48:51], a[56:59], v[224:227]
v_mfma_f32_16x16x32_bf16 v[228:231], v[52:55], a[56:59], v[228:231]
ds_read_b128 a[24:27], v9 offset:33792
v_mfma_f32_16x16x32_bf16 v[232:235], v[56:59], a[56:59], v[232:235]
v_mfma_f32_16x16x32_bf16 v[236:239], v[60:63], a[56:59], v[236:239]
s_waitcnt lgkmcnt(7)
v_mfma_f32_16x16x32_bf16 v[240:243], v[48:51], a[60:63], v[240:243]
v_mfma_f32_16x16x32_bf16 v[244:247], v[52:55], a[60:63], v[244:247]
ds_read_b128 a[28:31], v9 offset:50432
v_mfma_f32_16x16x32_bf16 v[248:251], v[56:59], a[60:63], v[248:251]
v_mfma_f32_16x16x32_bf16 v[252:255], v[60:63], a[60:63], v[252:255]
s_waitcnt vmcnt(15) lgkmcnt(7)
v_mfma_f32_16x16x32_bf16 v[128:131], v[64:67], a[0:3], v[128:131]
s_waitcnt vmcnt(14)
v_mfma_f32_16x16x32_bf16 v[132:135], v[68:71], a[0:3], v[132:135]
ds_read_b128 a[32:35], v8 offset:576
s_waitcnt vmcnt(13)
v_mfma_f32_16x16x32_bf16 v[136:139], v[72:75], a[0:3], v[136:139]
s_waitcnt vmcnt(12)
v_mfma_f32_16x16x32_bf16 v[140:143], v[76:79], a[0:3], v[140:143]
s_add_u32 s38, s34, 28672
buffer_load_dwordx4 v[48:51], v1, s[8:11], s38 offen
s_waitcnt lgkmcnt(7)
v_mfma_f32_16x16x32_bf16 v[144:147], v[64:67], a[4:7], v[144:147]
v_mfma_f32_16x16x32_bf16 v[148:151], v[68:71], a[4:7], v[148:151]
ds_read_b128 a[36:39], v8 offset:17216
v_mfma_f32_16x16x32_bf16 v[152:155], v[72:75], a[4:7], v[152:155]
v_mfma_f32_16x16x32_bf16 v[156:159], v[76:79], a[4:7], v[156:159]
s_add_u32 s38, s34, 61440
buffer_load_dwordx4 v[52:55], v1, s[8:11], s38 offen
s_waitcnt lgkmcnt(7)
v_mfma_f32_16x16x32_bf16 v[160:163], v[64:67], a[8:11], v[160:163]
v_mfma_f32_16x16x32_bf16 v[164:167], v[68:71], a[8:11], v[164:167]
ds_read_b128 a[40:43], v8 offset:33856
v_mfma_f32_16x16x32_bf16 v[168:171], v[72:75], a[8:11], v[168:171]
v_mfma_f32_16x16x32_bf16 v[172:175], v[76:79], a[8:11], v[172:175]
s_add_u32 s38, s34, 94208
buffer_load_dwordx4 v[56:59], v1, s[8:11], s38 offen
s_waitcnt lgkmcnt(7)
v_mfma_f32_16x16x32_bf16 v[176:179], v[64:67], a[12:15], v[176:179]
v_mfma_f32_16x16x32_bf16 v[180:183], v[68:71], a[12:15], v[180:183]
ds_read_b128 a[44:47], v8 offset:50496
v_mfma_f32_16x16x32_bf16 v[184:187], v[72:75], a[12:15], v[184:187]
v_mfma_f32_16x16x32_bf16 v[188:191], v[76:79], a[12:15], v[188:191]
s_add_u32 s38, s34, 126976
buffer_load_dwordx4 v[60:63], v1, s[8:11], s38 offen
s_waitcnt lgkmcnt(7)
v_mfma_f32_16x16x32_bf16 v[192:195], v[64:67], a[16:19], v[192:195]
v_mfma_f32_16x16x32_bf16 v[196:199], v[68:71], a[16:19], v[196:199]
ds_read_b128 a[48:51], v9 offset:576
v_mfma_f32_16x16x32_bf16 v[200:203], v[72:75], a[16:19], v[200:203]
v_mfma_f32_16x16x32_bf16 v[204:207], v[76:79], a[16:19], v[204:207]
s_waitcnt lgkmcnt(7)
v_mfma_f32_16x16x32_bf16 v[208:211], v[64:67], a[20:23], v[208:211]
v_mfma_f32_16x16x32_bf16 v[212:215], v[68:71], a[20:23], v[212:215]
ds_read_b128 a[52:55], v9 offset:17216
v_mfma_f32_16x16x32_bf16 v[216:219], v[72:75], a[20:23], v[216:219]
v_mfma_f32_16x16x32_bf16 v[220:223], v[76:79], a[20:23], v[220:223]
s_waitcnt lgkmcnt(7)
v_mfma_f32_16x16x32_bf16 v[224:227], v[64:67], a[24:27], v[224:227]
v_mfma_f32_16x16x32_bf16 v[228:231], v[68:71], a[24:27], v[228:231]
ds_read_b128 a[56:59], v9 offset:33856
v_mfma_f32_16x16x32_bf16 v[232:235], v[72:75], a[24:27], v[232:235]
v_mfma_f32_16x16x32_bf16 v[236:239], v[76:79], a[24:27], v[236:239]
s_waitcnt lgkmcnt(7)
v_mfma_f32_16x16x32_bf16 v[240:243], v[64:67], a[28:31], v[240:243]
v_mfma_f32_16x16x32_bf16 v[244:247], v[68:71], a[28:31], v[244:247]
ds_read_b128 a[60:63], v9 offset:50496
v_mfma_f32_16x16x32_bf16 v[248:251], v[72:75], a[28:31], v[248:251]
v_mfma_f32_16x16x32_bf16 v[252:255], v[76:79], a[28:31], v[252:255]
s_waitcnt vmcnt(15) lgkmcnt(7)
v_mfma_f32_16x16x32_bf16 v[128:131], v[80:83], a[32:35], v[128:131]
s_waitcnt vmcnt(14)
v_mfma_f32_16x16x32_bf16 v[132:135], v[84:87], a[32:35], v[132:135]
ds_read_b128 a[0:3], v8 offset:640
s_waitcnt vmcnt(13)
v_mfma_f32_16x16x32_bf16 v[136:139], v[88:91], a[32:35], v[136:139]
s_waitcnt vmcnt(12)
v_mfma_f32_16x16x32_bf16 v[140:143], v[92:95], a[32:35], v[140:143]
s_add_u32 s38, s34, 29696
buffer_load_dwordx4 v[64:67], v1, s[8:11], s38 offen
s_waitcnt lgkmcnt(7)
v_mfma_f32_16x16x32_bf16 v[144:147], v[80:83], a[36:39], v[144:147]
v_mfma_f32_16x16x32_bf16 v[148:151], v[84:87], a[36:39], v[148:151]
ds_read_b128 a[4:7], v8 offset:17280
v_mfma_f32_16x16x32_bf16 v[152:155], v[88:91], a[36:39], v[152:155]
v_mfma_f32_16x16x32_bf16 v[156:159], v[92:95], a[36:39], v[156:159]
s_add_u32 s38, s34, 62464
buffer_load_dwordx4 v[68:71], v1, s[8:11], s38 offen
s_waitcnt lgkmcnt(7)
v_mfma_f32_16x16x32_bf16 v[160:163], v[80:83], a[40:43], v[160:163]
v_mfma_f32_16x16x32_bf16 v[164:167], v[84:87], a[40:43], v[164:167]
ds_read_b128 a[8:11], v8 offset:33920
v_mfma_f32_16x16x32_bf16 v[168:171], v[88:91], a[40:43], v[168:171]
v_mfma_f32_16x16x32_bf16 v[172:175], v[92:95], a[40:43], v[172:175]
s_add_u32 s38, s34, 95232
buffer_load_dwordx4 v[72:75], v1, s[8:11], s38 offen
s_waitcnt lgkmcnt(7)
v_mfma_f32_16x16x32_bf16 v[176:179], v[80:83], a[44:47], v[176:179]
v_mfma_f32_16x16x32_bf16 v[180:183], v[84:87], a[44:47], v[180:183]
ds_read_b128 a[12:15], v8 offset:50560
v_mfma_f32_16x16x32_bf16 v[184:187], v[88:91], a[44:47], v[184:187]
v_mfma_f32_16x16x32_bf16 v[188:191], v[92:95], a[44:47], v[188:191]
s_add_u32 s38, s34, 128000
buffer_load_dwordx4 v[76:79], v1, s[8:11], s38 offen
s_waitcnt lgkmcnt(7)
v_mfma_f32_16x16x32_bf16 v[192:195], v[80:83], a[48:51], v[192:195]
v_mfma_f32_16x16x32_bf16 v[196:199], v[84:87], a[48:51], v[196:199]
ds_read_b128 a[16:19], v9 offset:640
v_mfma_f32_16x16x32_bf16 v[200:203], v[88:91], a[48:51], v[200:203]
v_mfma_f32_16x16x32_bf16 v[204:207], v[92:95], a[48:51], v[204:207]
s_waitcnt lgkmcnt(7)
v_mfma_f32_16x16x32_bf16 v[208:211], v[80:83], a[52:55], v[208:211]
v_mfma_f32_16x16x32_bf16 v[212:215], v[84:87], a[52:55], v[212:215]
ds_read_b128 a[20:23], v9 offset:17280
v_mfma_f32_16x16x32_bf16 v[216:219], v[88:91], a[52:55], v[216:219]
v_mfma_f32_16x16x32_bf16 v[220:223], v[92:95], a[52:55], v[220:223]
s_waitcnt lgkmcnt(7)
v_mfma_f32_16x16x32_bf16 v[224:227], v[80:83], a[56:59], v[224:227]
v_mfma_f32_16x16x32_bf16 v[228:231], v[84:87], a[56:59], v[228:231]
ds_read_b128 a[24:27], v9 offset:33920
v_mfma_f32_16x16x32_bf16 v[232:235], v[88:91], a[56:59], v[232:235]
v_mfma_f32_16x16x32_bf16 v[236:239], v[92:95], a[56:59], v[236:239]
s_waitcnt lgkmcnt(7)
v_mfma_f32_16x16x32_bf16 v[240:243], v[80:83], a[60:63], v[240:243]
v_mfma_f32_16x16x32_bf16 v[244:247], v[84:87], a[60:63], v[244:247]
ds_read_b128 a[28:31], v9 offset:50560
v_mfma_f32_16x16x32_bf16 v[248:251], v[88:91], a[60:63], v[248:251]
v_mfma_f32_16x16x32_bf16 v[252:255], v[92:95], a[60:63], v[252:255]
s_waitcnt vmcnt(15) lgkmcnt(7)
v_mfma_f32_16x16x32_bf16 v[128:131], v[16:19], a[0:3], v[128:131]
s_waitcnt vmcnt(14)
v_mfma_f32_16x16x32_bf16 v[132:135], v[20:23], a[0:3], v[132:135]
ds_read_b128 a[32:35], v8 offset:704
s_waitcnt vmcnt(13)
v_mfma_f32_16x16x32_bf16 v[136:139], v[24:27], a[0:3], v[136:139]
s_waitcnt vmcnt(12)
v_mfma_f32_16x16x32_bf16 v[140:143], v[28:31], a[0:3], v[140:143]
s_add_u32 s38, s34, 30720
buffer_load_dwordx4 v[80:83], v1, s[8:11], s38 offen
s_waitcnt lgkmcnt(7)
v_mfma_f32_16x16x32_bf16 v[144:147], v[16:19], a[4:7], v[144:147]
v_mfma_f32_16x16x32_bf16 v[148:151], v[20:23], a[4:7], v[148:151]
ds_read_b128 a[36:39], v8 offset:17344
v_mfma_f32_16x16x32_bf16 v[152:155], v[24:27], a[4:7], v[152:155]
v_mfma_f32_16x16x32_bf16 v[156:159], v[28:31], a[4:7], v[156:159]
s_add_u32 s38, s34, 63488
buffer_load_dwordx4 v[84:87], v1, s[8:11], s38 offen
s_waitcnt lgkmcnt(7)
v_mfma_f32_16x16x32_bf16 v[160:163], v[16:19], a[8:11], v[160:163]
v_mfma_f32_16x16x32_bf16 v[164:167], v[20:23], a[8:11], v[164:167]
ds_read_b128 a[40:43], v8 offset:33984
v_mfma_f32_16x16x32_bf16 v[168:171], v[24:27], a[8:11], v[168:171]
v_mfma_f32_16x16x32_bf16 v[172:175], v[28:31], a[8:11], v[172:175]
s_add_u32 s38, s34, 96256
buffer_load_dwordx4 v[88:91], v1, s[8:11], s38 offen
s_waitcnt lgkmcnt(7)
v_mfma_f32_16x16x32_bf16 v[176:179], v[16:19], a[12:15], v[176:179]
v_mfma_f32_16x16x32_bf16 v[180:183], v[20:23], a[12:15], v[180:183]
ds_read_b128 a[44:47], v8 offset:50624
v_mfma_f32_16x16x32_bf16 v[184:187], v[24:27], a[12:15], v[184:187]
v_mfma_f32_16x16x32_bf16 v[188:191], v[28:31], a[12:15], v[188:191]
s_add_u32 s38, s34, 129024
buffer_load_dwordx4 v[92:95], v1, s[8:11], s38 offen
s_waitcnt lgkmcnt(7)
v_mfma_f32_16x16x32_bf16 v[192:195], v[16:19], a[16:19], v[192:195]
v_mfma_f32_16x16x32_bf16 v[196:199], v[20:23], a[16:19], v[196:199]
ds_read_b128 a[48:51], v9 offset:704
v_mfma_f32_16x16x32_bf16 v[200:203], v[24:27], a[16:19], v[200:203]
v_mfma_f32_16x16x32_bf16 v[204:207], v[28:31], a[16:19], v[204:207]
s_waitcnt lgkmcnt(7)
v_mfma_f32_16x16x32_bf16 v[208:211], v[16:19], a[20:23], v[208:211]
v_mfma_f32_16x16x32_bf16 v[212:215], v[20:23], a[20:23], v[212:215]
ds_read_b128 a[52:55], v9 offset:17344
v_mfma_f32_16x16x32_bf16 v[216:219], v[24:27], a[20:23], v[216:219]
v_mfma_f32_16x16x32_bf16 v[220:223], v[28:31], a[20:23], v[220:223]
s_waitcnt lgkmcnt(7)
v_mfma_f32_16x16x32_bf16 v[224:227], v[16:19], a[24:27], v[224:227]
v_mfma_f32_16x16x32_bf16 v[228:231], v[20:23], a[24:27], v[228:231]
ds_read_b128 a[56:59], v9 offset:33984
v_mfma_f32_16x16x32_bf16 v[232:235], v[24:27], a[24:27], v[232:235]
v_mfma_f32_16x16x32_bf16 v[236:239], v[28:31], a[24:27], v[236:239]
s_waitcnt lgkmcnt(7)
v_mfma_f32_16x16x32_bf16 v[240:243], v[16:19], a[28:31], v[240:243]
v_mfma_f32_16x16x32_bf16 v[244:247], v[20:23], a[28:31], v[244:247]
ds_read_b128 a[60:63], v9 offset:50624
v_mfma_f32_16x16x32_bf16 v[248:251], v[24:27], a[28:31], v[248:251]
v_mfma_f32_16x16x32_bf16 v[252:255], v[28:31], a[28:31], v[252:255]
s_waitcnt vmcnt(15) lgkmcnt(7)
v_mfma_f32_16x16x32_bf16 v[128:131], v[32:35], a[32:35], v[128:131]
s_waitcnt vmcnt(14)
v_mfma_f32_16x16x32_bf16 v[132:135], v[36:39], a[32:35], v[132:135]
ds_read_b128 a[0:3], v8 offset:768
s_waitcnt vmcnt(13)
v_mfma_f32_16x16x32_bf16 v[136:139], v[40:43], a[32:35], v[136:139]
s_waitcnt vmcnt(12)
v_mfma_f32_16x16x32_bf16 v[140:143], v[44:47], a[32:35], v[140:143]
s_add_u32 s38, s34, 31744
buffer_load_dwordx4 v[16:19], v1, s[8:11], s38 offen
s_waitcnt lgkmcnt(7)
v_mfma_f32_16x16x32_bf16 v[144:147], v[32:35], a[36:39], v[144:147]
v_mfma_f32_16x16x32_bf16 v[148:151], v[36:39], a[36:39], v[148:151]
ds_read_b128 a[4:7], v8 offset:17408
v_mfma_f32_16x16x32_bf16 v[152:155], v[40:43], a[36:39], v[152:155]
v_mfma_f32_16x16x32_bf16 v[156:159], v[44:47], a[36:39], v[156:159]
s_add_u32 s38, s34, 64512
buffer_load_dwordx4 v[20:23], v1, s[8:11], s38 offen
s_waitcnt lgkmcnt(7)
v_mfma_f32_16x16x32_bf16 v[160:163], v[32:35], a[40:43], v[160:163]
v_mfma_f32_16x16x32_bf16 v[164:167], v[36:39], a[40:43], v[164:167]
ds_read_b128 a[8:11], v8 offset:34048
v_mfma_f32_16x16x32_bf16 v[168:171], v[40:43], a[40:43], v[168:171]
v_mfma_f32_16x16x32_bf16 v[172:175], v[44:47], a[40:43], v[172:175]
s_add_u32 s38, s34, 97280
buffer_load_dwordx4 v[24:27], v1, s[8:11], s38 offen
s_waitcnt lgkmcnt(7)
v_mfma_f32_16x16x32_bf16 v[176:179], v[32:35], a[44:47], v[176:179]
v_mfma_f32_16x16x32_bf16 v[180:183], v[36:39], a[44:47], v[180:183]
ds_read_b128 a[12:15], v8 offset:50688
v_mfma_f32_16x16x32_bf16 v[184:187], v[40:43], a[44:47], v[184:187]
v_mfma_f32_16x16x32_bf16 v[188:191], v[44:47], a[44:47], v[188:191]
s_add_u32 s38, s34, 130048
buffer_load_dwordx4 v[28:31], v1, s[8:11], s38 offen
s_waitcnt lgkmcnt(7)
v_mfma_f32_16x16x32_bf16 v[192:195], v[32:35], a[48:51], v[192:195]
v_mfma_f32_16x16x32_bf16 v[196:199], v[36:39], a[48:51], v[196:199]
ds_read_b128 a[16:19], v9 offset:768
v_mfma_f32_16x16x32_bf16 v[200:203], v[40:43], a[48:51], v[200:203]
v_mfma_f32_16x16x32_bf16 v[204:207], v[44:47], a[48:51], v[204:207]
s_waitcnt lgkmcnt(7)
v_mfma_f32_16x16x32_bf16 v[208:211], v[32:35], a[52:55], v[208:211]
v_mfma_f32_16x16x32_bf16 v[212:215], v[36:39], a[52:55], v[212:215]
ds_read_b128 a[20:23], v9 offset:17408
v_mfma_f32_16x16x32_bf16 v[216:219], v[40:43], a[52:55], v[216:219]
v_mfma_f32_16x16x32_bf16 v[220:223], v[44:47], a[52:55], v[220:223]
s_waitcnt lgkmcnt(7)
v_mfma_f32_16x16x32_bf16 v[224:227], v[32:35], a[56:59], v[224:227]
v_mfma_f32_16x16x32_bf16 v[228:231], v[36:39], a[56:59], v[228:231]
ds_read_b128 a[24:27], v9 offset:34048
v_mfma_f32_16x16x32_bf16 v[232:235], v[40:43], a[56:59], v[232:235]
v_mfma_f32_16x16x32_bf16 v[236:239], v[44:47], a[56:59], v[236:239]
s_waitcnt lgkmcnt(7)
v_mfma_f32_16x16x32_bf16 v[240:243], v[32:35], a[60:63], v[240:243]
v_mfma_f32_16x16x32_bf16 v[244:247], v[36:39], a[60:63], v[244:247]
ds_read_b128 a[28:31], v9 offset:50688
v_mfma_f32_16x16x32_bf16 v[248:251], v[40:43], a[60:63], v[248:251]
v_mfma_f32_16x16x32_bf16 v[252:255], v[44:47], a[60:63], v[252:255]
s_waitcnt vmcnt(15) lgkmcnt(7)
v_mfma_f32_16x16x32_bf16 v[128:131], v[48:51], a[0:3], v[128:131]
s_waitcnt vmcnt(14)
v_mfma_f32_16x16x32_bf16 v[132:135], v[52:55], a[0:3], v[132:135]
ds_read_b128 a[32:35], v8 offset:832
s_waitcnt vmcnt(13)
v_mfma_f32_16x16x32_bf16 v[136:139], v[56:59], a[0:3], v[136:139]
s_waitcnt vmcnt(12)
v_mfma_f32_16x16x32_bf16 v[140:143], v[60:63], a[0:3], v[140:143]
s_waitcnt lgkmcnt(7)
v_mfma_f32_16x16x32_bf16 v[144:147], v[48:51], a[4:7], v[144:147]
v_mfma_f32_16x16x32_bf16 v[148:151], v[52:55], a[4:7], v[148:151]
ds_read_b128 a[36:39], v8 offset:17472
v_mfma_f32_16x16x32_bf16 v[152:155], v[56:59], a[4:7], v[152:155]
v_mfma_f32_16x16x32_bf16 v[156:159], v[60:63], a[4:7], v[156:159]
s_waitcnt lgkmcnt(7)
v_mfma_f32_16x16x32_bf16 v[160:163], v[48:51], a[8:11], v[160:163]
v_mfma_f32_16x16x32_bf16 v[164:167], v[52:55], a[8:11], v[164:167]
ds_read_b128 a[40:43], v8 offset:34112
v_mfma_f32_16x16x32_bf16 v[168:171], v[56:59], a[8:11], v[168:171]
v_mfma_f32_16x16x32_bf16 v[172:175], v[60:63], a[8:11], v[172:175]
s_waitcnt lgkmcnt(7)
v_mfma_f32_16x16x32_bf16 v[176:179], v[48:51], a[12:15], v[176:179]
v_mfma_f32_16x16x32_bf16 v[180:183], v[52:55], a[12:15], v[180:183]
ds_read_b128 a[44:47], v8 offset:50752
v_mfma_f32_16x16x32_bf16 v[184:187], v[56:59], a[12:15], v[184:187]
v_mfma_f32_16x16x32_bf16 v[188:191], v[60:63], a[12:15], v[188:191]
s_waitcnt lgkmcnt(7)
v_mfma_f32_16x16x32_bf16 v[192:195], v[48:51], a[16:19], v[192:195]
v_mfma_f32_16x16x32_bf16 v[196:199], v[52:55], a[16:19], v[196:199]
ds_read_b128 a[48:51], v9 offset:832
v_mfma_f32_16x16x32_bf16 v[200:203], v[56:59], a[16:19], v[200:203]
v_mfma_f32_16x16x32_bf16 v[204:207], v[60:63], a[16:19], v[204:207]
s_waitcnt lgkmcnt(7)
v_mfma_f32_16x16x32_bf16 v[208:211], v[48:51], a[20:23], v[208:211]
v_mfma_f32_16x16x32_bf16 v[212:215], v[52:55], a[20:23], v[212:215]
ds_read_b128 a[52:55], v9 offset:17472
v_mfma_f32_16x16x32_bf16 v[216:219], v[56:59], a[20:23], v[216:219]
v_mfma_f32_16x16x32_bf16 v[220:223], v[60:63], a[20:23], v[220:223]
s_waitcnt lgkmcnt(7)
v_mfma_f32_16x16x32_bf16 v[224:227], v[48:51], a[24:27], v[224:227]
v_mfma_f32_16x16x32_bf16 v[228:231], v[52:55], a[24:27], v[228:231]
ds_read_b128 a[56:59], v9 offset:34112
v_mfma_f32_16x16x32_bf16 v[232:235], v[56:59], a[24:27], v[232:235]
v_mfma_f32_16x16x32_bf16 v[236:239], v[60:63], a[24:27], v[236:239]
s_waitcnt lgkmcnt(7)
v_mfma_f32_16x16x32_bf16 v[240:243], v[48:51], a[28:31], v[240:243]
v_mfma_f32_16x16x32_bf16 v[244:247], v[52:55], a[28:31], v[244:247]
ds_read_b128 a[60:63], v9 offset:50752
v_mfma_f32_16x16x32_bf16 v[248:251], v[56:59], a[28:31], v[248:251]
v_mfma_f32_16x16x32_bf16 v[252:255], v[60:63], a[28:31], v[252:255]
s_waitcnt vmcnt(11) lgkmcnt(7)
v_mfma_f32_16x16x32_bf16 v[128:131], v[64:67], a[32:35], v[128:131]
s_waitcnt vmcnt(10)
v_mfma_f32_16x16x32_bf16 v[132:135], v[68:71], a[32:35], v[132:135]
ds_read_b128 a[0:3], v8 offset:896
s_waitcnt vmcnt(9)
v_mfma_f32_16x16x32_bf16 v[136:139], v[72:75], a[32:35], v[136:139]
s_waitcnt vmcnt(8)
v_mfma_f32_16x16x32_bf16 v[140:143], v[76:79], a[32:35], v[140:143]
s_waitcnt lgkmcnt(7)
v_mfma_f32_16x16x32_bf16 v[144:147], v[64:67], a[36:39], v[144:147]
v_mfma_f32_16x16x32_bf16 v[148:151], v[68:71], a[36:39], v[148:151]
ds_read_b128 a[4:7], v8 offset:17536
v_mfma_f32_16x16x32_bf16 v[152:155], v[72:75], a[36:39], v[152:155]
v_mfma_f32_16x16x32_bf16 v[156:159], v[76:79], a[36:39], v[156:159]
s_waitcnt lgkmcnt(7)
v_mfma_f32_16x16x32_bf16 v[160:163], v[64:67], a[40:43], v[160:163]
v_mfma_f32_16x16x32_bf16 v[164:167], v[68:71], a[40:43], v[164:167]
ds_read_b128 a[8:11], v8 offset:34176
v_mfma_f32_16x16x32_bf16 v[168:171], v[72:75], a[40:43], v[168:171]
v_mfma_f32_16x16x32_bf16 v[172:175], v[76:79], a[40:43], v[172:175]
s_waitcnt lgkmcnt(7)
v_mfma_f32_16x16x32_bf16 v[176:179], v[64:67], a[44:47], v[176:179]
v_mfma_f32_16x16x32_bf16 v[180:183], v[68:71], a[44:47], v[180:183]
ds_read_b128 a[12:15], v8 offset:50816
v_mfma_f32_16x16x32_bf16 v[184:187], v[72:75], a[44:47], v[184:187]
v_mfma_f32_16x16x32_bf16 v[188:191], v[76:79], a[44:47], v[188:191]
s_waitcnt lgkmcnt(7)
v_mfma_f32_16x16x32_bf16 v[192:195], v[64:67], a[48:51], v[192:195]
v_mfma_f32_16x16x32_bf16 v[196:199], v[68:71], a[48:51], v[196:199]
ds_read_b128 a[16:19], v9 offset:896
v_mfma_f32_16x16x32_bf16 v[200:203], v[72:75], a[48:51], v[200:203]
v_mfma_f32_16x16x32_bf16 v[204:207], v[76:79], a[48:51], v[204:207]
s_waitcnt lgkmcnt(7)
v_mfma_f32_16x16x32_bf16 v[208:211], v[64:67], a[52:55], v[208:211]
v_mfma_f32_16x16x32_bf16 v[212:215], v[68:71], a[52:55], v[212:215]
ds_read_b128 a[20:23], v9 offset:17536
v_mfma_f32_16x16x32_bf16 v[216:219], v[72:75], a[52:55], v[216:219]
v_mfma_f32_16x16x32_bf16 v[220:223], v[76:79], a[52:55], v[220:223]
s_waitcnt lgkmcnt(7)
v_mfma_f32_16x16x32_bf16 v[224:227], v[64:67], a[56:59], v[224:227]
v_mfma_f32_16x16x32_bf16 v[228:231], v[68:71], a[56:59], v[228:231]
ds_read_b128 a[24:27], v9 offset:34176
v_mfma_f32_16x16x32_bf16 v[232:235], v[72:75], a[56:59], v[232:235]
v_mfma_f32_16x16x32_bf16 v[236:239], v[76:79], a[56:59], v[236:239]
s_waitcnt lgkmcnt(7)
v_mfma_f32_16x16x32_bf16 v[240:243], v[64:67], a[60:63], v[240:243]
v_mfma_f32_16x16x32_bf16 v[244:247], v[68:71], a[60:63], v[244:247]
ds_read_b128 a[28:31], v9 offset:50816
v_mfma_f32_16x16x32_bf16 v[248:251], v[72:75], a[60:63], v[248:251]
v_mfma_f32_16x16x32_bf16 v[252:255], v[76:79], a[60:63], v[252:255]
s_waitcnt vmcnt(7) lgkmcnt(7)
v_mfma_f32_16x16x32_bf16 v[128:131], v[80:83], a[0:3], v[128:131]
s_waitcnt vmcnt(6)
v_mfma_f32_16x16x32_bf16 v[132:135], v[84:87], a[0:3], v[132:135]
ds_read_b128 a[32:35], v8 offset:960
s_waitcnt vmcnt(5)
v_mfma_f32_16x16x32_bf16 v[136:139], v[88:91], a[0:3], v[136:139]
s_waitcnt vmcnt(4)
v_mfma_f32_16x16x32_bf16 v[140:143], v[92:95], a[0:3], v[140:143]
s_waitcnt lgkmcnt(7)
v_mfma_f32_16x16x32_bf16 v[144:147], v[80:83], a[4:7], v[144:147]
v_mfma_f32_16x16x32_bf16 v[148:151], v[84:87], a[4:7], v[148:151]
ds_read_b128 a[36:39], v8 offset:17600
v_mfma_f32_16x16x32_bf16 v[152:155], v[88:91], a[4:7], v[152:155]
v_mfma_f32_16x16x32_bf16 v[156:159], v[92:95], a[4:7], v[156:159]
s_waitcnt lgkmcnt(7)
v_mfma_f32_16x16x32_bf16 v[160:163], v[80:83], a[8:11], v[160:163]
v_mfma_f32_16x16x32_bf16 v[164:167], v[84:87], a[8:11], v[164:167]
ds_read_b128 a[40:43], v8 offset:34240
v_mfma_f32_16x16x32_bf16 v[168:171], v[88:91], a[8:11], v[168:171]
v_mfma_f32_16x16x32_bf16 v[172:175], v[92:95], a[8:11], v[172:175]
s_waitcnt lgkmcnt(7)
v_mfma_f32_16x16x32_bf16 v[176:179], v[80:83], a[12:15], v[176:179]
v_mfma_f32_16x16x32_bf16 v[180:183], v[84:87], a[12:15], v[180:183]
ds_read_b128 a[44:47], v8 offset:50880
v_mfma_f32_16x16x32_bf16 v[184:187], v[88:91], a[12:15], v[184:187]
v_mfma_f32_16x16x32_bf16 v[188:191], v[92:95], a[12:15], v[188:191]
s_waitcnt lgkmcnt(7)
v_mfma_f32_16x16x32_bf16 v[192:195], v[80:83], a[16:19], v[192:195]
v_mfma_f32_16x16x32_bf16 v[196:199], v[84:87], a[16:19], v[196:199]
ds_read_b128 a[48:51], v9 offset:960
v_mfma_f32_16x16x32_bf16 v[200:203], v[88:91], a[16:19], v[200:203]
v_mfma_f32_16x16x32_bf16 v[204:207], v[92:95], a[16:19], v[204:207]
s_waitcnt lgkmcnt(7)
v_mfma_f32_16x16x32_bf16 v[208:211], v[80:83], a[20:23], v[208:211]
v_mfma_f32_16x16x32_bf16 v[212:215], v[84:87], a[20:23], v[212:215]
ds_read_b128 a[52:55], v9 offset:17600
v_mfma_f32_16x16x32_bf16 v[216:219], v[88:91], a[20:23], v[216:219]
v_mfma_f32_16x16x32_bf16 v[220:223], v[92:95], a[20:23], v[220:223]
s_waitcnt lgkmcnt(7)
v_mfma_f32_16x16x32_bf16 v[224:227], v[80:83], a[24:27], v[224:227]
v_mfma_f32_16x16x32_bf16 v[228:231], v[84:87], a[24:27], v[228:231]
ds_read_b128 a[56:59], v9 offset:34240
v_mfma_f32_16x16x32_bf16 v[232:235], v[88:91], a[24:27], v[232:235]
v_mfma_f32_16x16x32_bf16 v[236:239], v[92:95], a[24:27], v[236:239]
s_waitcnt lgkmcnt(7)
v_mfma_f32_16x16x32_bf16 v[240:243], v[80:83], a[28:31], v[240:243]
v_mfma_f32_16x16x32_bf16 v[244:247], v[84:87], a[28:31], v[244:247]
ds_read_b128 a[60:63], v9 offset:50880
v_mfma_f32_16x16x32_bf16 v[248:251], v[88:91], a[28:31], v[248:251]
v_mfma_f32_16x16x32_bf16 v[252:255], v[92:95], a[28:31], v[252:255]
s_waitcnt vmcnt(3) lgkmcnt(7)
v_mfma_f32_16x16x32_bf16 v[128:131], v[16:19], a[32:35], v[128:131]
s_waitcnt vmcnt(2)
v_mfma_f32_16x16x32_bf16 v[132:135], v[20:23], a[32:35], v[132:135]
s_waitcnt vmcnt(1)
v_mfma_f32_16x16x32_bf16 v[136:139], v[24:27], a[32:35], v[136:139]
s_waitcnt vmcnt(0)
v_mfma_f32_16x16x32_bf16 v[140:143], v[28:31], a[32:35], v[140:143]
s_waitcnt lgkmcnt(6)
v_mfma_f32_16x16x32_bf16 v[144:147], v[16:19], a[36:39], v[144:147]
v_mfma_f32_16x16x32_bf16 v[148:151], v[20:23], a[36:39], v[148:151]
v_mfma_f32_16x16x32_bf16 v[152:155], v[24:27], a[36:39], v[152:155]
v_mfma_f32_16x16x32_bf16 v[156:159], v[28:31], a[36:39], v[156:159]
s_waitcnt lgkmcnt(5)
v_mfma_f32_16x16x32_bf16 v[160:163], v[16:19], a[40:43], v[160:163]
v_mfma_f32_16x16x32_bf16 v[164:167], v[20:23], a[40:43], v[164:167]
v_mfma_f32_16x16x32_bf16 v[168:171], v[24:27], a[40:43], v[168:171]
v_mfma_f32_16x16x32_bf16 v[172:175], v[28:31], a[40:43], v[172:175]
s_waitcnt lgkmcnt(4)
v_mfma_f32_16x16x32_bf16 v[176:179], v[16:19], a[44:47], v[176:179]
v_mfma_f32_16x16x32_bf16 v[180:183], v[20:23], a[44:47], v[180:183]
v_mfma_f32_16x16x32_bf16 v[184:187], v[24:27], a[44:47], v[184:187]
v_mfma_f32_16x16x32_bf16 v[188:191], v[28:31], a[44:47], v[188:191]
s_waitcnt lgkmcnt(3)
v_mfma_f32_16x16x32_bf16 v[192:195], v[16:19], a[48:51], v[192:195]
v_mfma_f32_16x16x32_bf16 v[196:199], v[20:23], a[48:51], v[196:199]
v_mfma_f32_16x16x32_bf16 v[200:203], v[24:27], a[48:51], v[200:203]
v_mfma_f32_16x16x32_bf16 v[204:207], v[28:31], a[48:51], v[204:207]
s_waitcnt lgkmcnt(2)
v_mfma_f32_16x16x32_bf16 v[208:211], v[16:19], a[52:55], v[208:211]
v_mfma_f32_16x16x32_bf16 v[212:215], v[20:23], a[52:55], v[212:215]
v_mfma_f32_16x16x32_bf16 v[216:219], v[24:27], a[52:55], v[216:219]
v_mfma_f32_16x16x32_bf16 v[220:223], v[28:31], a[52:55], v[220:223]
s_waitcnt lgkmcnt(1)
v_mfma_f32_16x16x32_bf16 v[224:227], v[16:19], a[56:59], v[224:227]
v_mfma_f32_16x16x32_bf16 v[228:231], v[20:23], a[56:59], v[228:231]
v_mfma_f32_16x16x32_bf16 v[232:235], v[24:27], a[56:59], v[232:235]
v_mfma_f32_16x16x32_bf16 v[236:239], v[28:31], a[56:59], v[236:239]
s_waitcnt lgkmcnt(0)
v_mfma_f32_16x16x32_bf16 v[240:243], v[16:19], a[60:63], v[240:243]
v_mfma_f32_16x16x32_bf16 v[244:247], v[20:23], a[60:63], v[244:247]
v_mfma_f32_16x16x32_bf16 v[248:251], v[24:27], a[60:63], v[248:251]
v_mfma_f32_16x16x32_bf16 v[252:255], v[28:31], a[60:63], v[252:255]
s_waitcnt vmcnt(0) lgkmcnt(0)
s_load_dwordx2 s[12:13], s[0:1], 56
s_waitcnt lgkmcnt(0)
s_and_b32 s13, s13, 0xffff
s_mov_b32 s14, 2097152
s_mov_b32 s15, 0x20000
s_load_dwordx2 s[20:21], s[0:1], 120
s_waitcnt lgkmcnt(0)
s_and_b32 s21, s21, 0xffff
s_mov_b32 s22, 1024
s_mov_b32 s23, 0x20000
v_lshrrev_b32 v4, 4, v1
v_and_b32 v5, 15, v4
v_lshrrev_b32 v4, 4, v4
v_lshlrev_b32 v2, 10, v5
v_lshl_add_u32 v2, v4, 3, v2
v_lshlrev_b32 v3, 12, v5
v_lshl_add_u32 v3, v4, 4, v3
v_lshlrev_b32 v6, 3, v4
s_lshl_b32 s42, s32, 7
s_lshl_b32 s44, s42, 10
s_lshl_b32 s38, s43, 1
s_add_u32 s44, s44, s38
s_lshl_b32 s45, s42, 12
s_lshl_b32 s38, s43, 2
s_add_u32 s45, s45, s38
s_add_u32 s45, s45, 2048
s_lshl_b32 s34, s43, 1
s_add_u32 s38, s34, 0
buffer_load_dwordx2 v[120:121], v6, s[20:23], s38 offen
s_add_u32 s38, s34, 32
buffer_load_dwordx2 v[122:123], v6, s[20:23], s38 offen
s_add_u32 s38, s34, 64
buffer_load_dwordx2 v[124:125], v6, s[20:23], s38 offen
s_add_u32 s38, s34, 96
buffer_load_dwordx2 v[126:127], v6, s[20:23], s38 offen
s_waitcnt vmcnt(3)
v_lshlrev_b32 v48, 16, v120
v_and_b32 v49, 0xffff0000, v120
v_lshlrev_b32 v50, 16, v121
v_and_b32 v51, 0xffff0000, v121
s_waitcnt vmcnt(2)
v_lshlrev_b32 v52, 16, v122
v_and_b32 v53, 0xffff0000, v122
v_lshlrev_b32 v54, 16, v123
v_and_b32 v55, 0xffff0000, v123
s_waitcnt vmcnt(1)
v_lshlrev_b32 v56, 16, v124
v_and_b32 v57, 0xffff0000, v124
v_lshlrev_b32 v58, 16, v125
v_and_b32 v59, 0xffff0000, v125
s_waitcnt vmcnt(0)
v_lshlrev_b32 v60, 16, v126
v_and_b32 v61, 0xffff0000, v126
v_lshlrev_b32 v62, 16, v127
v_and_b32 v63, 0xffff0000, v127
s_add_u32 s38, s44, 0
buffer_load_dwordx2 v[64:65], v2, s[12:15], s38 offen
s_add_u32 s38, s44, 32
buffer_load_dwordx2 v[66:67], v2, s[12:15], s38 offen
s_add_u32 s38, s44, 64
buffer_load_dwordx2 v[68:69], v2, s[12:15], s38 offen
s_add_u32 s38, s44, 96
buffer_load_dwordx2 v[70:71], v2, s[12:15], s38 offen
s_add_u32 s38, s44, 16384
buffer_load_dwordx2 v[72:73], v2, s[12:15], s38 offen
s_add_u32 s38, s44, 16416
buffer_load_dwordx2 v[74:75], v2, s[12:15], s38 offen
s_add_u32 s38, s44, 16448
buffer_load_dwordx2 v[76:77], v2, s[12:15], s38 offen
s_add_u32 s38, s44, 16480
buffer_load_dwordx2 v[78:79], v2, s[12:15], s38 offen
s_add_u32 s38, s44, 32768
buffer_load_dwordx2 v[80:81], v2, s[12:15], s38 offen
s_add_u32 s38, s44, 32800
buffer_load_dwordx2 v[82:83], v2, s[12:15], s38 offen
s_add_u32 s38, s44, 32832
buffer_load_dwordx2 v[84:85], v2, s[12:15], s38 offen
s_add_u32 s38, s44, 32864
buffer_load_dwordx2 v[86:87], v2, s[12:15], s38 offen
s_add_u32 s38, s44, 49152
buffer_load_dwordx2 v[88:89], v2, s[12:15], s38 offen
s_add_u32 s38, s44, 49184
buffer_load_dwordx2 v[90:91], v2, s[12:15], s38 offen
s_add_u32 s38, s44, 49216
buffer_load_dwordx2 v[92:93], v2, s[12:15], s38 offen
s_add_u32 s38, s44, 49248
buffer_load_dwordx2 v[94:95], v2, s[12:15], s38 offen
s_waitcnt vmcnt(15)
v_lshlrev_b32 v20, 16, v64
v_and_b32 v21, 0xffff0000, v64
v_lshlrev_b32 v22, 16, v65
v_and_b32 v23, 0xffff0000, v65
v_mul_f32 v20, v20, v48
v_mul_f32 v21, v21, v49
v_mul_f32 v22, v22, v50
v_mul_f32 v23, v23, v51
v_cvt_pk_bf16_f32 v64, v20, v21
v_cvt_pk_bf16_f32 v65, v22, v23
v_lshlrev_b32 v20, 16, v64
v_and_b32 v21, 0xffff0000, v64
v_lshlrev_b32 v22, 16, v65
v_and_b32 v23, 0xffff0000, v65
v_fma_f32 v16, v128, 2.0, v20
v_fma_f32 v17, v129, 2.0, v21
v_fma_f32 v18, v130, 2.0, v22
v_fma_f32 v19, v131, 2.0, v23
s_add_u32 s38, s45, 0
buffer_store_dwordx4 v[16:19], v3, s[28:31], s38 offen
s_waitcnt vmcnt(15)
v_lshlrev_b32 v28, 16, v66
v_and_b32 v29, 0xffff0000, v66
v_lshlrev_b32 v30, 16, v67
v_and_b32 v31, 0xffff0000, v67
v_mul_f32 v28, v28, v52
v_mul_f32 v29, v29, v53
v_mul_f32 v30, v30, v54
v_mul_f32 v31, v31, v55
v_cvt_pk_bf16_f32 v66, v28, v29
v_cvt_pk_bf16_f32 v67, v30, v31
v_lshlrev_b32 v28, 16, v66
v_and_b32 v29, 0xffff0000, v66
v_lshlrev_b32 v30, 16, v67
v_and_b32 v31, 0xffff0000, v67
v_fma_f32 v24, v132, 2.0, v28
v_fma_f32 v25, v133, 2.0, v29
v_fma_f32 v26, v134, 2.0, v30
v_fma_f32 v27, v135, 2.0, v31
s_add_u32 s38, s45, 64
buffer_store_dwordx4 v[24:27], v3, s[28:31], s38 offen
s_waitcnt vmcnt(15)
v_lshlrev_b32 v36, 16, v68
v_and_b32 v37, 0xffff0000, v68
v_lshlrev_b32 v38, 16, v69
v_and_b32 v39, 0xffff0000, v69
v_mul_f32 v36, v36, v56
v_mul_f32 v37, v37, v57
v_mul_f32 v38, v38, v58
v_mul_f32 v39, v39, v59
v_cvt_pk_bf16_f32 v68, v36, v37
v_cvt_pk_bf16_f32 v69, v38, v39
v_lshlrev_b32 v36, 16, v68
v_and_b32 v37, 0xffff0000, v68
v_lshlrev_b32 v38, 16, v69
v_and_b32 v39, 0xffff0000, v69
v_fma_f32 v32, v136, 2.0, v36
v_fma_f32 v33, v137, 2.0, v37
v_fma_f32 v34, v138, 2.0, v38
v_fma_f32 v35, v139, 2.0, v39
s_add_u32 s38, s45, 128
buffer_store_dwordx4 v[32:35], v3, s[28:31], s38 offen
s_waitcnt vmcnt(15)
v_lshlrev_b32 v44, 16, v70
v_and_b32 v45, 0xffff0000, v70
v_lshlrev_b32 v46, 16, v71
v_and_b32 v47, 0xffff0000, v71
v_mul_f32 v44, v44, v60
v_mul_f32 v45, v45, v61
v_mul_f32 v46, v46, v62
v_mul_f32 v47, v47, v63
v_cvt_pk_bf16_f32 v70, v44, v45
v_cvt_pk_bf16_f32 v71, v46, v47
v_lshlrev_b32 v44, 16, v70
v_and_b32 v45, 0xffff0000, v70
v_lshlrev_b32 v46, 16, v71
v_and_b32 v47, 0xffff0000, v71
v_fma_f32 v40, v140, 2.0, v44
v_fma_f32 v41, v141, 2.0, v45
v_fma_f32 v42, v142, 2.0, v46
v_fma_f32 v43, v143, 2.0, v47
s_add_u32 s38, s45, 192
buffer_store_dwordx4 v[40:43], v3, s[28:31], s38 offen
s_waitcnt vmcnt(15)
v_lshlrev_b32 v20, 16, v72
v_and_b32 v21, 0xffff0000, v72
v_lshlrev_b32 v22, 16, v73
v_and_b32 v23, 0xffff0000, v73
v_mul_f32 v20, v20, v48
v_mul_f32 v21, v21, v49
v_mul_f32 v22, v22, v50
v_mul_f32 v23, v23, v51
v_cvt_pk_bf16_f32 v72, v20, v21
v_cvt_pk_bf16_f32 v73, v22, v23
v_lshlrev_b32 v20, 16, v72
v_and_b32 v21, 0xffff0000, v72
v_lshlrev_b32 v22, 16, v73
v_and_b32 v23, 0xffff0000, v73
v_fma_f32 v16, v144, 2.0, v20
v_fma_f32 v17, v145, 2.0, v21
v_fma_f32 v18, v146, 2.0, v22
v_fma_f32 v19, v147, 2.0, v23
s_add_u32 s38, s45, 65536
buffer_store_dwordx4 v[16:19], v3, s[28:31], s38 offen
s_waitcnt vmcnt(15)
v_lshlrev_b32 v28, 16, v74
v_and_b32 v29, 0xffff0000, v74
v_lshlrev_b32 v30, 16, v75
v_and_b32 v31, 0xffff0000, v75
v_mul_f32 v28, v28, v52
v_mul_f32 v29, v29, v53
v_mul_f32 v30, v30, v54
v_mul_f32 v31, v31, v55
v_cvt_pk_bf16_f32 v74, v28, v29
v_cvt_pk_bf16_f32 v75, v30, v31
v_lshlrev_b32 v28, 16, v74
v_and_b32 v29, 0xffff0000, v74
v_lshlrev_b32 v30, 16, v75
v_and_b32 v31, 0xffff0000, v75
v_fma_f32 v24, v148, 2.0, v28
v_fma_f32 v25, v149, 2.0, v29
v_fma_f32 v26, v150, 2.0, v30
v_fma_f32 v27, v151, 2.0, v31
s_add_u32 s38, s45, 65600
buffer_store_dwordx4 v[24:27], v3, s[28:31], s38 offen
s_waitcnt vmcnt(15)
v_lshlrev_b32 v36, 16, v76
v_and_b32 v37, 0xffff0000, v76
v_lshlrev_b32 v38, 16, v77
v_and_b32 v39, 0xffff0000, v77
v_mul_f32 v36, v36, v56
v_mul_f32 v37, v37, v57
v_mul_f32 v38, v38, v58
v_mul_f32 v39, v39, v59
v_cvt_pk_bf16_f32 v76, v36, v37
v_cvt_pk_bf16_f32 v77, v38, v39
v_lshlrev_b32 v36, 16, v76
v_and_b32 v37, 0xffff0000, v76
v_lshlrev_b32 v38, 16, v77
v_and_b32 v39, 0xffff0000, v77
v_fma_f32 v32, v152, 2.0, v36
v_fma_f32 v33, v153, 2.0, v37
v_fma_f32 v34, v154, 2.0, v38
v_fma_f32 v35, v155, 2.0, v39
s_add_u32 s38, s45, 65664
buffer_store_dwordx4 v[32:35], v3, s[28:31], s38 offen
s_waitcnt vmcnt(15)
v_lshlrev_b32 v44, 16, v78
v_and_b32 v45, 0xffff0000, v78
v_lshlrev_b32 v46, 16, v79
v_and_b32 v47, 0xffff0000, v79
v_mul_f32 v44, v44, v60
v_mul_f32 v45, v45, v61
v_mul_f32 v46, v46, v62
v_mul_f32 v47, v47, v63
v_cvt_pk_bf16_f32 v78, v44, v45
v_cvt_pk_bf16_f32 v79, v46, v47
v_lshlrev_b32 v44, 16, v78
v_and_b32 v45, 0xffff0000, v78
v_lshlrev_b32 v46, 16, v79
v_and_b32 v47, 0xffff0000, v79
v_fma_f32 v40, v156, 2.0, v44
v_fma_f32 v41, v157, 2.0, v45
v_fma_f32 v42, v158, 2.0, v46
v_fma_f32 v43, v159, 2.0, v47
s_add_u32 s38, s45, 65728
buffer_store_dwordx4 v[40:43], v3, s[28:31], s38 offen
s_waitcnt vmcnt(15)
v_lshlrev_b32 v20, 16, v80
v_and_b32 v21, 0xffff0000, v80
v_lshlrev_b32 v22, 16, v81
v_and_b32 v23, 0xffff0000, v81
v_mul_f32 v20, v20, v48
v_mul_f32 v21, v21, v49
v_mul_f32 v22, v22, v50
v_mul_f32 v23, v23, v51
v_cvt_pk_bf16_f32 v80, v20, v21
v_cvt_pk_bf16_f32 v81, v22, v23
v_lshlrev_b32 v20, 16, v80
v_and_b32 v21, 0xffff0000, v80
v_lshlrev_b32 v22, 16, v81
v_and_b32 v23, 0xffff0000, v81
v_fma_f32 v16, v160, 2.0, v20
v_fma_f32 v17, v161, 2.0, v21
v_fma_f32 v18, v162, 2.0, v22
v_fma_f32 v19, v163, 2.0, v23
s_add_u32 s38, s45, 131072
buffer_store_dwordx4 v[16:19], v3, s[28:31], s38 offen
s_waitcnt vmcnt(15)
v_lshlrev_b32 v28, 16, v82
v_and_b32 v29, 0xffff0000, v82
v_lshlrev_b32 v30, 16, v83
v_and_b32 v31, 0xffff0000, v83
v_mul_f32 v28, v28, v52
v_mul_f32 v29, v29, v53
v_mul_f32 v30, v30, v54
v_mul_f32 v31, v31, v55
v_cvt_pk_bf16_f32 v82, v28, v29
v_cvt_pk_bf16_f32 v83, v30, v31
v_lshlrev_b32 v28, 16, v82
v_and_b32 v29, 0xffff0000, v82
v_lshlrev_b32 v30, 16, v83
v_and_b32 v31, 0xffff0000, v83
v_fma_f32 v24, v164, 2.0, v28
v_fma_f32 v25, v165, 2.0, v29
v_fma_f32 v26, v166, 2.0, v30
v_fma_f32 v27, v167, 2.0, v31
s_add_u32 s38, s45, 131136
buffer_store_dwordx4 v[24:27], v3, s[28:31], s38 offen
s_waitcnt vmcnt(15)
v_lshlrev_b32 v36, 16, v84
v_and_b32 v37, 0xffff0000, v84
v_lshlrev_b32 v38, 16, v85
v_and_b32 v39, 0xffff0000, v85
v_mul_f32 v36, v36, v56
v_mul_f32 v37, v37, v57
v_mul_f32 v38, v38, v58
v_mul_f32 v39, v39, v59
v_cvt_pk_bf16_f32 v84, v36, v37
v_cvt_pk_bf16_f32 v85, v38, v39
v_lshlrev_b32 v36, 16, v84
v_and_b32 v37, 0xffff0000, v84
v_lshlrev_b32 v38, 16, v85
v_and_b32 v39, 0xffff0000, v85
v_fma_f32 v32, v168, 2.0, v36
v_fma_f32 v33, v169, 2.0, v37
v_fma_f32 v34, v170, 2.0, v38
v_fma_f32 v35, v171, 2.0, v39
s_add_u32 s38, s45, 131200
buffer_store_dwordx4 v[32:35], v3, s[28:31], s38 offen
s_waitcnt vmcnt(15)
v_lshlrev_b32 v44, 16, v86
v_and_b32 v45, 0xffff0000, v86
v_lshlrev_b32 v46, 16, v87
v_and_b32 v47, 0xffff0000, v87
v_mul_f32 v44, v44, v60
v_mul_f32 v45, v45, v61
v_mul_f32 v46, v46, v62
v_mul_f32 v47, v47, v63
v_cvt_pk_bf16_f32 v86, v44, v45
v_cvt_pk_bf16_f32 v87, v46, v47
v_lshlrev_b32 v44, 16, v86
v_and_b32 v45, 0xffff0000, v86
v_lshlrev_b32 v46, 16, v87
v_and_b32 v47, 0xffff0000, v87
v_fma_f32 v40, v172, 2.0, v44
v_fma_f32 v41, v173, 2.0, v45
v_fma_f32 v42, v174, 2.0, v46
v_fma_f32 v43, v175, 2.0, v47
s_add_u32 s38, s45, 131264
buffer_store_dwordx4 v[40:43], v3, s[28:31], s38 offen
s_waitcnt vmcnt(15)
v_lshlrev_b32 v20, 16, v88
v_and_b32 v21, 0xffff0000, v88
v_lshlrev_b32 v22, 16, v89
v_and_b32 v23, 0xffff0000, v89
v_mul_f32 v20, v20, v48
v_mul_f32 v21, v21, v49
v_mul_f32 v22, v22, v50
v_mul_f32 v23, v23, v51
v_cvt_pk_bf16_f32 v88, v20, v21
v_cvt_pk_bf16_f32 v89, v22, v23
v_lshlrev_b32 v20, 16, v88
v_and_b32 v21, 0xffff0000, v88
v_lshlrev_b32 v22, 16, v89
v_and_b32 v23, 0xffff0000, v89
v_fma_f32 v16, v176, 2.0, v20
v_fma_f32 v17, v177, 2.0, v21
v_fma_f32 v18, v178, 2.0, v22
v_fma_f32 v19, v179, 2.0, v23
s_add_u32 s38, s45, 196608
buffer_store_dwordx4 v[16:19], v3, s[28:31], s38 offen
s_waitcnt vmcnt(15)
v_lshlrev_b32 v28, 16, v90
v_and_b32 v29, 0xffff0000, v90
v_lshlrev_b32 v30, 16, v91
v_and_b32 v31, 0xffff0000, v91
v_mul_f32 v28, v28, v52
v_mul_f32 v29, v29, v53
v_mul_f32 v30, v30, v54
v_mul_f32 v31, v31, v55
v_cvt_pk_bf16_f32 v90, v28, v29
v_cvt_pk_bf16_f32 v91, v30, v31
v_lshlrev_b32 v28, 16, v90
v_and_b32 v29, 0xffff0000, v90
v_lshlrev_b32 v30, 16, v91
v_and_b32 v31, 0xffff0000, v91
v_fma_f32 v24, v180, 2.0, v28
v_fma_f32 v25, v181, 2.0, v29
v_fma_f32 v26, v182, 2.0, v30
v_fma_f32 v27, v183, 2.0, v31
s_add_u32 s38, s45, 196672
buffer_store_dwordx4 v[24:27], v3, s[28:31], s38 offen
s_waitcnt vmcnt(15)
v_lshlrev_b32 v36, 16, v92
v_and_b32 v37, 0xffff0000, v92
v_lshlrev_b32 v38, 16, v93
v_and_b32 v39, 0xffff0000, v93
v_mul_f32 v36, v36, v56
v_mul_f32 v37, v37, v57
v_mul_f32 v38, v38, v58
v_mul_f32 v39, v39, v59
v_cvt_pk_bf16_f32 v92, v36, v37
v_cvt_pk_bf16_f32 v93, v38, v39
v_lshlrev_b32 v36, 16, v92
v_and_b32 v37, 0xffff0000, v92
v_lshlrev_b32 v38, 16, v93
v_and_b32 v39, 0xffff0000, v93
v_fma_f32 v32, v184, 2.0, v36
v_fma_f32 v33, v185, 2.0, v37
v_fma_f32 v34, v186, 2.0, v38
v_fma_f32 v35, v187, 2.0, v39
s_add_u32 s38, s45, 196736
buffer_store_dwordx4 v[32:35], v3, s[28:31], s38 offen
s_waitcnt vmcnt(15)
v_lshlrev_b32 v44, 16, v94
v_and_b32 v45, 0xffff0000, v94
v_lshlrev_b32 v46, 16, v95
v_and_b32 v47, 0xffff0000, v95
v_mul_f32 v44, v44, v60
v_mul_f32 v45, v45, v61
v_mul_f32 v46, v46, v62
v_mul_f32 v47, v47, v63
v_cvt_pk_bf16_f32 v94, v44, v45
v_cvt_pk_bf16_f32 v95, v46, v47
v_lshlrev_b32 v44, 16, v94
v_and_b32 v45, 0xffff0000, v94
v_lshlrev_b32 v46, 16, v95
v_and_b32 v47, 0xffff0000, v95
v_fma_f32 v40, v188, 2.0, v44
v_fma_f32 v41, v189, 2.0, v45
v_fma_f32 v42, v190, 2.0, v46
v_fma_f32 v43, v191, 2.0, v47
s_add_u32 s38, s45, 196800
buffer_store_dwordx4 v[40:43], v3, s[28:31], s38 offen
s_add_u32 s38, s44, 65536
buffer_load_dwordx2 v[64:65], v2, s[12:15], s38 offen
s_add_u32 s38, s44, 65568
buffer_load_dwordx2 v[66:67], v2, s[12:15], s38 offen
s_add_u32 s38, s44, 65600
buffer_load_dwordx2 v[68:69], v2, s[12:15], s38 offen
s_add_u32 s38, s44, 65632
buffer_load_dwordx2 v[70:71], v2, s[12:15], s38 offen
s_add_u32 s38, s44, 81920
buffer_load_dwordx2 v[72:73], v2, s[12:15], s38 offen
s_add_u32 s38, s44, 81952
buffer_load_dwordx2 v[74:75], v2, s[12:15], s38 offen
s_add_u32 s38, s44, 81984
buffer_load_dwordx2 v[76:77], v2, s[12:15], s38 offen
s_add_u32 s38, s44, 82016
buffer_load_dwordx2 v[78:79], v2, s[12:15], s38 offen
s_add_u32 s38, s44, 98304
buffer_load_dwordx2 v[80:81], v2, s[12:15], s38 offen
s_add_u32 s38, s44, 98336
buffer_load_dwordx2 v[82:83], v2, s[12:15], s38 offen
s_add_u32 s38, s44, 98368
buffer_load_dwordx2 v[84:85], v2, s[12:15], s38 offen
s_add_u32 s38, s44, 98400
buffer_load_dwordx2 v[86:87], v2, s[12:15], s38 offen
s_add_u32 s38, s44, 114688
buffer_load_dwordx2 v[88:89], v2, s[12:15], s38 offen
s_add_u32 s38, s44, 114720
buffer_load_dwordx2 v[90:91], v2, s[12:15], s38 offen
s_add_u32 s38, s44, 114752
buffer_load_dwordx2 v[92:93], v2, s[12:15], s38 offen
s_add_u32 s38, s44, 114784
buffer_load_dwordx2 v[94:95], v2, s[12:15], s38 offen
s_waitcnt vmcnt(15)
v_lshlrev_b32 v20, 16, v64
v_and_b32 v21, 0xffff0000, v64
v_lshlrev_b32 v22, 16, v65
v_and_b32 v23, 0xffff0000, v65
v_mul_f32 v20, v20, v48
v_mul_f32 v21, v21, v49
v_mul_f32 v22, v22, v50
v_mul_f32 v23, v23, v51
v_cvt_pk_bf16_f32 v64, v20, v21
v_cvt_pk_bf16_f32 v65, v22, v23
v_lshlrev_b32 v20, 16, v64
v_and_b32 v21, 0xffff0000, v64
v_lshlrev_b32 v22, 16, v65
v_and_b32 v23, 0xffff0000, v65
v_fma_f32 v16, v192, 2.0, v20
v_fma_f32 v17, v193, 2.0, v21
v_fma_f32 v18, v194, 2.0, v22
v_fma_f32 v19, v195, 2.0, v23
s_add_u32 s38, s45, 262144
buffer_store_dwordx4 v[16:19], v3, s[28:31], s38 offen
s_waitcnt vmcnt(15)
v_lshlrev_b32 v28, 16, v66
v_and_b32 v29, 0xffff0000, v66
v_lshlrev_b32 v30, 16, v67
v_and_b32 v31, 0xffff0000, v67
v_mul_f32 v28, v28, v52
v_mul_f32 v29, v29, v53
v_mul_f32 v30, v30, v54
v_mul_f32 v31, v31, v55
v_cvt_pk_bf16_f32 v66, v28, v29
v_cvt_pk_bf16_f32 v67, v30, v31
v_lshlrev_b32 v28, 16, v66
v_and_b32 v29, 0xffff0000, v66
v_lshlrev_b32 v30, 16, v67
v_and_b32 v31, 0xffff0000, v67
v_fma_f32 v24, v196, 2.0, v28
v_fma_f32 v25, v197, 2.0, v29
v_fma_f32 v26, v198, 2.0, v30
v_fma_f32 v27, v199, 2.0, v31
s_add_u32 s38, s45, 262208
buffer_store_dwordx4 v[24:27], v3, s[28:31], s38 offen
s_waitcnt vmcnt(15)
v_lshlrev_b32 v36, 16, v68
v_and_b32 v37, 0xffff0000, v68
v_lshlrev_b32 v38, 16, v69
v_and_b32 v39, 0xffff0000, v69
v_mul_f32 v36, v36, v56
v_mul_f32 v37, v37, v57
v_mul_f32 v38, v38, v58
v_mul_f32 v39, v39, v59
v_cvt_pk_bf16_f32 v68, v36, v37
v_cvt_pk_bf16_f32 v69, v38, v39
v_lshlrev_b32 v36, 16, v68
v_and_b32 v37, 0xffff0000, v68
v_lshlrev_b32 v38, 16, v69
v_and_b32 v39, 0xffff0000, v69
v_fma_f32 v32, v200, 2.0, v36
v_fma_f32 v33, v201, 2.0, v37
v_fma_f32 v34, v202, 2.0, v38
v_fma_f32 v35, v203, 2.0, v39
s_add_u32 s38, s45, 262272
buffer_store_dwordx4 v[32:35], v3, s[28:31], s38 offen
s_waitcnt vmcnt(15)
v_lshlrev_b32 v44, 16, v70
v_and_b32 v45, 0xffff0000, v70
v_lshlrev_b32 v46, 16, v71
v_and_b32 v47, 0xffff0000, v71
v_mul_f32 v44, v44, v60
v_mul_f32 v45, v45, v61
v_mul_f32 v46, v46, v62
v_mul_f32 v47, v47, v63
v_cvt_pk_bf16_f32 v70, v44, v45
v_cvt_pk_bf16_f32 v71, v46, v47
v_lshlrev_b32 v44, 16, v70
v_and_b32 v45, 0xffff0000, v70
v_lshlrev_b32 v46, 16, v71
v_and_b32 v47, 0xffff0000, v71
v_fma_f32 v40, v204, 2.0, v44
v_fma_f32 v41, v205, 2.0, v45
v_fma_f32 v42, v206, 2.0, v46
v_fma_f32 v43, v207, 2.0, v47
s_add_u32 s38, s45, 262336
buffer_store_dwordx4 v[40:43], v3, s[28:31], s38 offen
s_waitcnt vmcnt(15)
v_lshlrev_b32 v20, 16, v72
v_and_b32 v21, 0xffff0000, v72
v_lshlrev_b32 v22, 16, v73
v_and_b32 v23, 0xffff0000, v73
v_mul_f32 v20, v20, v48
v_mul_f32 v21, v21, v49
v_mul_f32 v22, v22, v50
v_mul_f32 v23, v23, v51
v_cvt_pk_bf16_f32 v72, v20, v21
v_cvt_pk_bf16_f32 v73, v22, v23
v_lshlrev_b32 v20, 16, v72
v_and_b32 v21, 0xffff0000, v72
v_lshlrev_b32 v22, 16, v73
v_and_b32 v23, 0xffff0000, v73
v_fma_f32 v16, v208, 2.0, v20
v_fma_f32 v17, v209, 2.0, v21
v_fma_f32 v18, v210, 2.0, v22
v_fma_f32 v19, v211, 2.0, v23
s_add_u32 s38, s45, 327680
buffer_store_dwordx4 v[16:19], v3, s[28:31], s38 offen
s_waitcnt vmcnt(15)
v_lshlrev_b32 v28, 16, v74
v_and_b32 v29, 0xffff0000, v74
v_lshlrev_b32 v30, 16, v75
v_and_b32 v31, 0xffff0000, v75
v_mul_f32 v28, v28, v52
v_mul_f32 v29, v29, v53
v_mul_f32 v30, v30, v54
v_mul_f32 v31, v31, v55
v_cvt_pk_bf16_f32 v74, v28, v29
v_cvt_pk_bf16_f32 v75, v30, v31
v_lshlrev_b32 v28, 16, v74
v_and_b32 v29, 0xffff0000, v74
v_lshlrev_b32 v30, 16, v75
v_and_b32 v31, 0xffff0000, v75
v_fma_f32 v24, v212, 2.0, v28
v_fma_f32 v25, v213, 2.0, v29
v_fma_f32 v26, v214, 2.0, v30
v_fma_f32 v27, v215, 2.0, v31
s_add_u32 s38, s45, 327744
buffer_store_dwordx4 v[24:27], v3, s[28:31], s38 offen
s_waitcnt vmcnt(15)
v_lshlrev_b32 v36, 16, v76
v_and_b32 v37, 0xffff0000, v76
v_lshlrev_b32 v38, 16, v77
v_and_b32 v39, 0xffff0000, v77
v_mul_f32 v36, v36, v56
v_mul_f32 v37, v37, v57
v_mul_f32 v38, v38, v58
v_mul_f32 v39, v39, v59
v_cvt_pk_bf16_f32 v76, v36, v37
v_cvt_pk_bf16_f32 v77, v38, v39
v_lshlrev_b32 v36, 16, v76
v_and_b32 v37, 0xffff0000, v76
v_lshlrev_b32 v38, 16, v77
v_and_b32 v39, 0xffff0000, v77
v_fma_f32 v32, v216, 2.0, v36
v_fma_f32 v33, v217, 2.0, v37
v_fma_f32 v34, v218, 2.0, v38
v_fma_f32 v35, v219, 2.0, v39
s_add_u32 s38, s45, 327808
buffer_store_dwordx4 v[32:35], v3, s[28:31], s38 offen
s_waitcnt vmcnt(15)
v_lshlrev_b32 v44, 16, v78
v_and_b32 v45, 0xffff0000, v78
v_lshlrev_b32 v46, 16, v79
v_and_b32 v47, 0xffff0000, v79
v_mul_f32 v44, v44, v60
v_mul_f32 v45, v45, v61
v_mul_f32 v46, v46, v62
v_mul_f32 v47, v47, v63
v_cvt_pk_bf16_f32 v78, v44, v45
v_cvt_pk_bf16_f32 v79, v46, v47
v_lshlrev_b32 v44, 16, v78
v_and_b32 v45, 0xffff0000, v78
v_lshlrev_b32 v46, 16, v79
v_and_b32 v47, 0xffff0000, v79
v_fma_f32 v40, v220, 2.0, v44
v_fma_f32 v41, v221, 2.0, v45
v_fma_f32 v42, v222, 2.0, v46
v_fma_f32 v43, v223, 2.0, v47
s_add_u32 s38, s45, 327872
buffer_store_dwordx4 v[40:43], v3, s[28:31], s38 offen
s_waitcnt vmcnt(15)
v_lshlrev_b32 v20, 16, v80
v_and_b32 v21, 0xffff0000, v80
v_lshlrev_b32 v22, 16, v81
v_and_b32 v23, 0xffff0000, v81
v_mul_f32 v20, v20, v48
v_mul_f32 v21, v21, v49
v_mul_f32 v22, v22, v50
v_mul_f32 v23, v23, v51
v_cvt_pk_bf16_f32 v80, v20, v21
v_cvt_pk_bf16_f32 v81, v22, v23
v_lshlrev_b32 v20, 16, v80
v_and_b32 v21, 0xffff0000, v80
v_lshlrev_b32 v22, 16, v81
v_and_b32 v23, 0xffff0000, v81
v_fma_f32 v16, v224, 2.0, v20
v_fma_f32 v17, v225, 2.0, v21
v_fma_f32 v18, v226, 2.0, v22
v_fma_f32 v19, v227, 2.0, v23
s_add_u32 s38, s45, 393216
buffer_store_dwordx4 v[16:19], v3, s[28:31], s38 offen
s_waitcnt vmcnt(15)
v_lshlrev_b32 v28, 16, v82
v_and_b32 v29, 0xffff0000, v82
v_lshlrev_b32 v30, 16, v83
v_and_b32 v31, 0xffff0000, v83
v_mul_f32 v28, v28, v52
v_mul_f32 v29, v29, v53
v_mul_f32 v30, v30, v54
v_mul_f32 v31, v31, v55
v_cvt_pk_bf16_f32 v82, v28, v29
v_cvt_pk_bf16_f32 v83, v30, v31
v_lshlrev_b32 v28, 16, v82
v_and_b32 v29, 0xffff0000, v82
v_lshlrev_b32 v30, 16, v83
v_and_b32 v31, 0xffff0000, v83
v_fma_f32 v24, v228, 2.0, v28
v_fma_f32 v25, v229, 2.0, v29
v_fma_f32 v26, v230, 2.0, v30
v_fma_f32 v27, v231, 2.0, v31
s_add_u32 s38, s45, 393280
buffer_store_dwordx4 v[24:27], v3, s[28:31], s38 offen
s_waitcnt vmcnt(15)
v_lshlrev_b32 v36, 16, v84
v_and_b32 v37, 0xffff0000, v84
v_lshlrev_b32 v38, 16, v85
v_and_b32 v39, 0xffff0000, v85
v_mul_f32 v36, v36, v56
v_mul_f32 v37, v37, v57
v_mul_f32 v38, v38, v58
v_mul_f32 v39, v39, v59
v_cvt_pk_bf16_f32 v84, v36, v37
v_cvt_pk_bf16_f32 v85, v38, v39
v_lshlrev_b32 v36, 16, v84
v_and_b32 v37, 0xffff0000, v84
v_lshlrev_b32 v38, 16, v85
v_and_b32 v39, 0xffff0000, v85
v_fma_f32 v32, v232, 2.0, v36
v_fma_f32 v33, v233, 2.0, v37
v_fma_f32 v34, v234, 2.0, v38
v_fma_f32 v35, v235, 2.0, v39
s_add_u32 s38, s45, 393344
buffer_store_dwordx4 v[32:35], v3, s[28:31], s38 offen
s_waitcnt vmcnt(15)
v_lshlrev_b32 v44, 16, v86
v_and_b32 v45, 0xffff0000, v86
v_lshlrev_b32 v46, 16, v87
v_and_b32 v47, 0xffff0000, v87
v_mul_f32 v44, v44, v60
v_mul_f32 v45, v45, v61
v_mul_f32 v46, v46, v62
v_mul_f32 v47, v47, v63
v_cvt_pk_bf16_f32 v86, v44, v45
v_cvt_pk_bf16_f32 v87, v46, v47
v_lshlrev_b32 v44, 16, v86
v_and_b32 v45, 0xffff0000, v86
v_lshlrev_b32 v46, 16, v87
v_and_b32 v47, 0xffff0000, v87
v_fma_f32 v40, v236, 2.0, v44
v_fma_f32 v41, v237, 2.0, v45
v_fma_f32 v42, v238, 2.0, v46
v_fma_f32 v43, v239, 2.0, v47
s_add_u32 s38, s45, 393408
buffer_store_dwordx4 v[40:43], v3, s[28:31], s38 offen
s_waitcnt vmcnt(15)
v_lshlrev_b32 v20, 16, v88
v_and_b32 v21, 0xffff0000, v88
v_lshlrev_b32 v22, 16, v89
v_and_b32 v23, 0xffff0000, v89
v_mul_f32 v20, v20, v48
v_mul_f32 v21, v21, v49
v_mul_f32 v22, v22, v50
v_mul_f32 v23, v23, v51
v_cvt_pk_bf16_f32 v88, v20, v21
v_cvt_pk_bf16_f32 v89, v22, v23
v_lshlrev_b32 v20, 16, v88
v_and_b32 v21, 0xffff0000, v88
v_lshlrev_b32 v22, 16, v89
v_and_b32 v23, 0xffff0000, v89
v_fma_f32 v16, v240, 2.0, v20
v_fma_f32 v17, v241, 2.0, v21
v_fma_f32 v18, v242, 2.0, v22
v_fma_f32 v19, v243, 2.0, v23
s_add_u32 s38, s45, 458752
buffer_store_dwordx4 v[16:19], v3, s[28:31], s38 offen
s_waitcnt vmcnt(15)
v_lshlrev_b32 v28, 16, v90
v_and_b32 v29, 0xffff0000, v90
v_lshlrev_b32 v30, 16, v91
v_and_b32 v31, 0xffff0000, v91
v_mul_f32 v28, v28, v52
v_mul_f32 v29, v29, v53
v_mul_f32 v30, v30, v54
v_mul_f32 v31, v31, v55
v_cvt_pk_bf16_f32 v90, v28, v29
v_cvt_pk_bf16_f32 v91, v30, v31
v_lshlrev_b32 v28, 16, v90
v_and_b32 v29, 0xffff0000, v90
v_lshlrev_b32 v30, 16, v91
v_and_b32 v31, 0xffff0000, v91
v_fma_f32 v24, v244, 2.0, v28
v_fma_f32 v25, v245, 2.0, v29
v_fma_f32 v26, v246, 2.0, v30
v_fma_f32 v27, v247, 2.0, v31
s_add_u32 s38, s45, 458816
buffer_store_dwordx4 v[24:27], v3, s[28:31], s38 offen
s_waitcnt vmcnt(15)
v_lshlrev_b32 v36, 16, v92
v_and_b32 v37, 0xffff0000, v92
v_lshlrev_b32 v38, 16, v93
v_and_b32 v39, 0xffff0000, v93
v_mul_f32 v36, v36, v56
v_mul_f32 v37, v37, v57
v_mul_f32 v38, v38, v58
v_mul_f32 v39, v39, v59
v_cvt_pk_bf16_f32 v92, v36, v37
v_cvt_pk_bf16_f32 v93, v38, v39
v_lshlrev_b32 v36, 16, v92
v_and_b32 v37, 0xffff0000, v92
v_lshlrev_b32 v38, 16, v93
v_and_b32 v39, 0xffff0000, v93
v_fma_f32 v32, v248, 2.0, v36
v_fma_f32 v33, v249, 2.0, v37
v_fma_f32 v34, v250, 2.0, v38
v_fma_f32 v35, v251, 2.0, v39
s_add_u32 s38, s45, 458880
buffer_store_dwordx4 v[32:35], v3, s[28:31], s38 offen
s_waitcnt vmcnt(15)
v_lshlrev_b32 v44, 16, v94
v_and_b32 v45, 0xffff0000, v94
v_lshlrev_b32 v46, 16, v95
v_and_b32 v47, 0xffff0000, v95
v_mul_f32 v44, v44, v60
v_mul_f32 v45, v45, v61
v_mul_f32 v46, v46, v62
v_mul_f32 v47, v47, v63
v_cvt_pk_bf16_f32 v94, v44, v45
v_cvt_pk_bf16_f32 v95, v46, v47
v_lshlrev_b32 v44, 16, v94
v_and_b32 v45, 0xffff0000, v94
v_lshlrev_b32 v46, 16, v95
v_and_b32 v47, 0xffff0000, v95
v_fma_f32 v40, v252, 2.0, v44
v_fma_f32 v41, v253, 2.0, v45
v_fma_f32 v42, v254, 2.0, v46
v_fma_f32 v43, v255, 2.0, v47
s_add_u32 s38, s45, 458944
buffer_store_dwordx4 v[40:43], v3, s[28:31], s38 offen
s_waitcnt vmcnt(0) lgkmcnt(0)
s_barrier
S5_end:
s_waitcnt vmcnt(0) lgkmcnt(0)
s_barrier
s_add_u32 s64, s64, 64
s_branch R_o
L_end:
s_endpgm

.section .rodata,"a"
.p2align 6
.amdhsa_kernel concat_heads__memory_aug_recurrent_mem_tr__ssm_conv_s5__prompt_kernel
  .amdhsa_next_free_vgpr 512
  .amdhsa_next_free_sgpr 102
  .amdhsa_accum_offset 256
  .amdhsa_group_segment_fixed_size 0
  .amdhsa_kernarg_size 152
  .amdhsa_user_sgpr_count 2
  .amdhsa_user_sgpr_kernarg_segment_ptr 1
  .amdhsa_system_sgpr_workgroup_id_x 1
.end_amdhsa_kernel
```
